```python
import torch

def _softmax(x, axis=-1):
    return torch.softmax(x, dim=axis)
def _gelu(x):
    return torch.nn.functional.gelu(x, approximate="tanh")
def _silu(x):
    return torch.nn.functional.silu(x)
def _sigmoid(x):
    return torch.sigmoid(x)
def _layernorm(x, axis=-1, eps=1e-5):
    m = x.mean(dim=axis, keepdim=True)
    v = x.var(dim=axis, keepdim=True, unbiased=False)
    return (x - m) / torch.sqrt(v + eps)
def _scatter_add(tgt, idx, src, axis=0):
    return tgt.clone().index_add_(axis, idx, src)
def _segment_sum(src, seg, n):
    out = torch.zeros((n,) + src.shape[1:], dtype=src.dtype)
    return out.index_add_(0, seg, src)
def _pad(x, pw):
    flat = tuple(v for pair in reversed(pw) for v in pair)
    return torch.nn.functional.pad(x, flat)

kernel_name = 'recurrent_scan__mha_block_cached__glu_gated_swiglu__prompt'

def setup_inputs():

    _w = (lambda a: (lambda t: t.to(torch.bfloat16) if t.is_floating_point() else t)(torch.as_tensor(a)))
    def _A_setup():
        B, Sq, D = 1, 2048, 448
        H, Sk, Dh = 16, 2048, 256
        return {
            "x": _w((lambda *s: torch.randn(*s, dtype=torch.bfloat16) * 0.05)(B, Sq, D)),
            "k_cache": _w((lambda *s: torch.randn(*s, dtype=torch.bfloat16) * 1.6)(B, H, Sk, Dh)),
            "v_cache": _w((lambda *s: torch.randn(*s, dtype=torch.bfloat16) * 1.6)(B, H, Sk, Dh)),
            "wq": _w((lambda *s: torch.randn(*s, dtype=torch.bfloat16) * 1.6)(D, H * Dh) * (D ** -0.5)),
            "wo": _w((lambda *s: torch.randn(*s, dtype=torch.bfloat16) * 1.6)(H * Dh, D) * ((H * Dh) ** -0.5)),
        }
    _A_in = _A_setup()

    def _B_setup():
        B, S, D, F = 1, 2048, 448, 1792
        return {
            "x": _w((lambda *s: torch.randn(*s, dtype=torch.bfloat16) * 0.05)(B, S, D)),
            "w1": _w((lambda *s: torch.randn(*s, dtype=torch.bfloat16) * 0.2)(D, F) * (2.0 / D) ** 0.5),
            "w3": _w((lambda *s: torch.randn(*s, dtype=torch.bfloat16) * 0.2)(D, F) * (2.0 / D) ** 0.5),
            "w2": _w((lambda *s: torch.randn(*s, dtype=torch.bfloat16) * 0.2)(F, D) * (2.0 / F) ** 0.5),
        }
    _B_in = _B_setup()

    return {
        "A_x": _A_in["x"],
        "A_k_cache": _A_in["k_cache"],
        "A_v_cache": _A_in["v_cache"],
        "A_wq": _A_in["wq"],
        "A_wo": _A_in["wo"],
        "B_x": _B_in["x"],
        "B_w1": _B_in["w1"],
        "B_w3": _B_in["w3"],
        "B_w2": _B_in["w2"],
    }

def reference(A_x, A_k_cache, A_v_cache, A_wq, A_wo, B_x, B_w1, B_w3, B_w2):
    def _A_ref(x, k_cache, v_cache, wq, wo):
        B, Sq, D = x.shape
        H, Dh = 16, 256
        q = (lambda x, *d: x.permute(*d))((x @ wq).reshape(B, Sq, H, Dh), 0, 2, 1, 3)
        scores = torch.einsum("bhqd,bhkd->bhqk", q, k_cache) * (Dh ** -0.5)
        p = _softmax(scores, axis=-1)
        o = torch.einsum("bhqk,bhkd->bhqd", p, v_cache)
        return (lambda x, *d: x.permute(*d))(o, 0, 2, 1, 3).reshape(B, Sq, H * Dh) @ wo

    def _B_ref(x, w1, w3, w2):
        gate = torch.einsum("bsd,df->bsf", x, w1)
        up = torch.einsum("bsd,df->bsf", x, w3)
        h = _silu(gate) * up
        out = torch.einsum("bsf,fd->bsd", h, w2)
        return out

    x = A_x
    xn = _layernorm(x, axis=-1)
    s = _A_ref(xn, A_k_cache, A_v_cache, A_wq, A_wo)
    g = _silu(_B_ref(xn, B_w1, B_w3, B_w2))
    return x + s * g
```

```asm
; @launch grid=(256,1,1) block=(256,1,1) lds=163840
.amdgcn_target "amdgcn-amd-amdhsa--gfx950"
.text
.globl recurrent_scan__mha_block_cached__glu_gated_swiglu__prompt_kernel
.p2align 8
.type recurrent_scan__mha_block_cached__glu_gated_swiglu__prompt_kernel,@function
recurrent_scan__mha_block_cached__glu_gated_swiglu__prompt_kernel:
    s_cmp_ge_u32 s2, 256
    s_cbranch_scc1 L_end
    s_load_dwordx16 s[4:19], s[0:1], 0
    s_load_dwordx8 s[20:27], s[0:1], 64
    s_and_b32 s64, s2, 7
    s_lshr_b32 s65, s2, 3
    s_lshr_b32 s84, s65, 4
    s_lshl_b32 s64, s64, 1
    s_add_u32 s64, s64, s84
    s_and_b32 s65, s65, 15
    v_lshrrev_b32 v8, 6, v0
    s_nop 0
    v_readfirstlane_b32 s66, v8
    v_and_b32 v9, 63, v0
    v_and_b32 v10, 15, v0
    v_bfe_u32 v11, v0, 4, 2
    v_lshlrev_b32 v1, 4, v9
    s_lshl_b32 s84, s65, 2
    s_add_u32 s84, s84, s66
    s_getpc_b64 s[88:89]
L_pc:
    s_and_b32 s85, s84, 15
    s_lshl_b32 s85, s85, 13
    v_lshlrev_b32 v14, 7, v9
    v_add_u32 v14, s85, v14
    v_min_u32 v14, L_code_end-L_pc-4, v14
    global_load_dword v44, v14, s[88:89]
    s_mul_i32 s68, s65, 114688
    s_lshl_b32 s85, s66, 5
    s_lshl_b32 s67, s66, 12
    v_lshrrev_b32 v14, 3, v9
    v_add_u32 v14, s85, v14
    v_mul_u32_u24 v14, 896, v14
    v_bfe_u32 v15, v0, 1, 2
    v_xor_b32 v15, v15, v11
    v_lshl_add_u32 v14, v15, 5, v14
    v_and_b32 v15, 1, v0
    v_lshl_add_u32 v14, v15, 4, v14
    v_add_u32 v124, 0, v14
    v_add_u32 v125, 6144, v14
    v_add_u32 v126, 12288, v14
    v_add_u32 v127, 18432, v14
    s_mul_i32 s78, s64, 224
    s_lshr_b32 s82, s66, 1
    s_lshl_b32 s82, s82, 5
    s_and_b32 s83, s66, 1
    s_lshl_b32 s83, s83, 2
    s_add_u32 s82, s82, s83
    v_add_u32 v12, s82, v11
    v_mul_u32_u24 v12, 3584, v12
    v_and_b32 v13, 1, v10
    v_lshl_add_u32 v12, v13, 4, v12
    v_lshrrev_b32 v13, 1, v10
    v_add_u32 v14, 0, v11
    v_xor_b32 v14, v14, v13
    v_min_u32 v14, 6, v14
    v_lshl_add_u32 v14, v14, 5, v12
    v_add_u32 v248, 0, v14
    v_add_u32 v14, 4, v11
    v_xor_b32 v14, v14, v13
    v_min_u32 v14, 6, v14
    v_lshl_add_u32 v14, v14, 5, v12
    v_add_u32 v249, 27648, v14
    v_add_u32 v14, 0, v11
    v_xor_b32 v14, v14, v13
    v_min_u32 v14, 6, v14
    v_lshl_add_u32 v14, v14, 5, v12
    v_add_u32 v250, 55296, v14
    v_add_u32 v14, 4, v11
    v_xor_b32 v14, v14, v13
    v_min_u32 v14, 6, v14
    v_lshl_add_u32 v14, v14, 5, v12
    v_add_u32 v251, 82944, v14
    s_waitcnt lgkmcnt(0)
    s_mov_b32 s28, s4
    s_mov_b32 s29, s5
    s_mov_b32 s30, 0x1c0000
    s_mov_b32 s31, 0x20000
    s_add_u32 m0, s67, 16384
    s_nop 0
    buffer_load_dwordx4 v124, s[28:31], s68 offen offset:0 lds
    s_mov_b32 s48, s16
    s_mov_b32 s49, s17
    s_mov_b32 s50, 0x188000
    s_mov_b32 s51, 0x20000
    s_mov_b32 s52, s18
    s_mov_b32 s53, s19
    s_mov_b32 s54, 0x188000
    s_mov_b32 s55, 0x20000
    s_lshl_b32 s82, s64, 20
    s_add_u32 s32, s6, s82
    s_addc_u32 s33, s7, 0
    buffer_load_dwordx4 v125, s[28:31], s68 offen offset:1024 lds
    s_mov_b32 s34, 0x100000
    s_mov_b32 s35, 0x20000
    s_add_u32 s36, s8, s82
    s_addc_u32 s37, s9, 0
    s_mov_b32 s38, 0x100000
    s_mov_b32 s39, 0x20000
    s_mov_b32 s40, s10
    s_mov_b32 s41, s11
    s_mov_b32 s42, 0x380000
    s_mov_b32 s43, 0x20000
    s_mov_b32 s44, s12
    buffer_load_dwordx4 v126, s[28:31], s68 offen offset:2048 lds
    s_mov_b32 s45, s13
    s_mov_b32 s46, 0x380000
    s_mov_b32 s47, 0x20000
    s_mov_b32 s56, s20
    s_mov_b32 s57, s21
    s_mov_b32 s58, 0x188000
    s_mov_b32 s59, 0x20000
    s_mov_b32 s60, s26
    s_mov_b32 s61, s27
    s_mov_b32 s62, 0x10000000
    buffer_load_dwordx4 v127, s[28:31], s68 offen offset:3072 lds
    s_mov_b32 s63, 0x20000
    s_mov_b32 s20, s24
    s_mov_b32 s21, s25
    s_mov_b32 s24, s22
    s_mov_b32 s25, s23
    s_mov_b32 s22, 256
    s_mov_b32 s23, 0x20000
    s_mov_b32 s26, 1835008
    s_mov_b32 s27, 0x20000
    s_lshl_b32 s73, s65, 4
    s_add_u32 m0, s67, 32768
    s_add_u32 s68, s68, 128
    buffer_load_dwordx4 v124, s[28:31], s68 offen offset:0 lds
    s_add_u32 s87, s73, 4096
    s_lshl_b32 s3, s84, 5
    s_add_u32 s3, s3, s64
    s_lshl_b32 s3, s3, 2
    s_add_u32 s3, s3, 0x4000000
    s_and_b32 s93, s3, 0xffffff80
    v_mov_b32 v47, 0x7f000000
    v_cmp_eq_u32 vcc, 0, v9
    s_nop 0
    s_nop 0
    v_cndmask_b32 v47, v47, 0, vcc
    buffer_load_dwordx4 v125, s[28:31], s68 offen offset:1024 lds
    v_mov_b32 v45, 0x7f000000
    v_cmp_eq_u32 vcc, 0, v0
    v_mov_b32 v46, 0
    s_nop 0
    v_cndmask_b32 v45, v45, 0, vcc
    s_lshl_b32 s79, s64, 9
    s_mul_i32 s81, s64, 229376
    s_mul_i32 s74, s84, 448
    s_add_u32 s74, s74, s64
    s_lshl_b32 s74, s74, 10
    s_add_u32 s75, s74, 0x0
    buffer_load_dwordx4 v126, s[28:31], s68 offen offset:2048 lds
    s_lshl_b32 s74, s84, 4
    s_add_u32 s74, s74, s64
    s_lshl_b32 s74, s74, 13
    s_add_u32 s74, s74, 0x2000000
    s_add_u32 s91, s81, 0x3400000
    s_and_b32 s90, s64, 3
    s_lshl_b32 s90, s90, 8
    s_add_u32 s90, s90, 0x3000000
    s_mov_b32 s71, 0x53800000
    s_mov_b32 s86, 0xffff0000
    buffer_load_dwordx4 v127, s[28:31], s68 offen offset:3072 lds
    s_mov_b32 s4, 0x100001
    s_mov_b32 s5, 0x10000100
    s_mov_b32 s6, 0x200002
    s_mov_b32 s7, 0x20000200
    s_mov_b32 s8, 0x400004
    s_mov_b32 s9, 0x40000400
    s_mov_b32 s10, 0x800008
    s_mov_b32 s11, 0x80000800
    v_mov_b32 v32, 0x3f803f80
    v_mov_b32 v33, 0x3f803f80
    s_add_u32 m0, s67, 49152
    s_add_u32 s68, s68, 128
    buffer_load_dwordx4 v124, s[28:31], s68 offen offset:0 lds
    v_mov_b32 v34, 0x3f803f80
    v_mov_b32 v35, 0x3f803f80
    v_and_b32 v12, 31, v0
    v_bfe_u32 v13, v0, 5, 1
    v_lshlrev_b32 v14, 9, v10
    v_add_u32 v15, 0, v11
    v_xor_b32 v15, v15, v10
    v_lshl_add_u32 v96, v15, 4, v14
    v_add_u32 v15, 4, v11
    v_xor_b32 v15, v15, v10
    buffer_load_dwordx4 v125, s[28:31], s68 offen offset:1024 lds
    v_lshl_add_u32 v97, v15, 4, v14
    v_add_u32 v15, 8, v11
    v_xor_b32 v15, v15, v10
    v_lshl_add_u32 v98, v15, 4, v14
    v_add_u32 v15, 12, v11
    v_xor_b32 v15, v15, v10
    v_lshl_add_u32 v99, v15, 4, v14
    v_bfe_u32 v4, v0, 2, 4
    v_and_b32 v5, 3, v0
    v_and_b32 v6, 7, v4
    buffer_load_dwordx4 v126, s[28:31], s68 offen offset:2048 lds
    v_lshlrev_b32 v14, 8, v4
    v_lshl_add_u32 v14, v5, 3, v14
    v_xor_b32 v15, 0, v6
    v_lshl_add_u32 v48, v15, 5, v14
    v_add_u32 v55, 0x10000, v48
    v_xor_b32 v15, 1, v6
    v_lshl_add_u32 v49, v15, 5, v14
    v_add_u32 v56, 0x10000, v49
    v_xor_b32 v15, 2, v6
    v_lshl_add_u32 v50, v15, 5, v14
    buffer_load_dwordx4 v127, s[28:31], s68 offen offset:3072 lds
    v_add_u32 v57, 0x10000, v50
    v_xor_b32 v15, 3, v6
    v_lshl_add_u32 v51, v15, 5, v14
    v_add_u32 v58, 0x10000, v51
    v_xor_b32 v15, 4, v6
    v_lshl_add_u32 v52, v15, 5, v14
    v_add_u32 v59, 0x10000, v52
    v_xor_b32 v15, 5, v6
    v_lshl_add_u32 v53, v15, 5, v14
    v_add_u32 v60, 0x10000, v53
    s_add_u32 m0, s67, 81920
    s_add_u32 s68, s68, 128
    buffer_load_dwordx4 v124, s[28:31], s68 offen offset:0 lds
    v_xor_b32 v15, 6, v6
    v_lshl_add_u32 v54, v15, 5, v14
    v_add_u32 v61, 0x10000, v54
    v_lshlrev_b32 v14, 9, v4
    v_lshl_add_u32 v14, v5, 3, v14
    v_xor_b32 v15, 0, v6
    v_lshl_add_u32 v240, v15, 5, v14
    v_add_u32 v100, 0x10000, v240
    v_xor_b32 v15, 1, v6
    v_lshl_add_u32 v241, v15, 5, v14
    buffer_load_dwordx4 v125, s[28:31], s68 offen offset:1024 lds
    v_add_u32 v101, 0x10000, v241
    v_xor_b32 v15, 2, v6
    v_lshl_add_u32 v242, v15, 5, v14
    v_add_u32 v102, 0x10000, v242
    v_xor_b32 v15, 3, v6
    v_lshl_add_u32 v243, v15, 5, v14
    v_add_u32 v103, 0x10000, v243
    v_xor_b32 v15, 4, v6
    v_lshl_add_u32 v244, v15, 5, v14
    v_add_u32 v104, 0x10000, v244
    buffer_load_dwordx4 v126, s[28:31], s68 offen offset:2048 lds
    v_xor_b32 v15, 5, v6
    v_lshl_add_u32 v245, v15, 5, v14
    v_add_u32 v105, 0x10000, v245
    v_xor_b32 v15, 6, v6
    v_lshl_add_u32 v246, v15, 5, v14
    v_add_u32 v106, 0x10000, v246
    v_xor_b32 v15, 7, v6
    v_lshl_add_u32 v247, v15, 5, v14
    v_add_u32 v107, 0x10000, v247
    v_lshlrev_b32 v14, 7, v4
    buffer_load_dwordx4 v127, s[28:31], s68 offen offset:3072 lds
    v_lshl_add_u32 v14, v5, 3, v14
    v_bfe_u32 v7, v4, 1, 2
    v_xor_b32 v15, 0, v7
    v_lshl_add_u32 v116, v15, 5, v14
    v_add_u32 v120, 0x10000, v116
    v_xor_b32 v15, 1, v7
    v_lshl_add_u32 v117, v15, 5, v14
    v_add_u32 v121, 0x10000, v117
    v_xor_b32 v15, 2, v7
    v_lshl_add_u32 v118, v15, 5, v14
    s_add_u32 m0, s67, 98304
    s_add_u32 s68, s68, 128
    buffer_load_dwordx4 v124, s[28:31], s68 offen offset:0 lds
    v_add_u32 v122, 0x10000, v118
    v_xor_b32 v15, 3, v7
    v_lshl_add_u32 v119, v15, 5, v14
    v_add_u32 v123, 0x10000, v119
    s_and_b32 s85, s66, 1
    s_lshl_b32 s85, s85, 3
    v_lshlrev_b32 v14, 9, v13
    v_add_u32 v14, s67, v14
    v_add_u32 v15, 0, v13
    v_add_u32 v15, s85, v15
    buffer_load_dwordx4 v125, s[28:31], s68 offen offset:1024 lds
    v_xor_b32 v15, v15, v12
    v_lshl_add_u32 v108, v15, 4, v14
    v_add_u32 v15, 2, v13
    v_add_u32 v15, s85, v15
    v_xor_b32 v15, v15, v12
    v_lshl_add_u32 v109, v15, 4, v14
    v_add_u32 v15, 4, v13
    v_add_u32 v15, s85, v15
    v_xor_b32 v15, v15, v12
    v_lshl_add_u32 v110, v15, 4, v14
    buffer_load_dwordx4 v126, s[28:31], s68 offen offset:2048 lds
    v_add_u32 v15, 6, v13
    v_add_u32 v15, s85, v15
    v_xor_b32 v15, v15, v12
    v_lshl_add_u32 v111, v15, 4, v14
    s_lshl_b32 s85, s85, 1
    s_lshr_b32 s82, s66, 1
    s_lshl_b32 s82, s82, 2
    s_add_u32 s85, s85, s82
    v_add_u32 v7, s85, v13
    v_lshlrev_b32 v7, 13, v7
    buffer_load_dwordx4 v127, s[28:31], s68 offen offset:3072 lds
    v_add_u32 v15, 0, v13
    v_lshlrev_b32 v15, 1, v15
    v_xor_b32 v15, v15, v12
    v_lshl_add_u32 v112, v15, 4, v14
    v_lshl_add_u32 v15, v15, 4, v7
    v_add_u32 v252, 0, v15
    v_add_u32 v15, 2, v13
    v_lshlrev_b32 v15, 1, v15
    v_xor_b32 v15, v15, v12
    v_lshl_add_u32 v113, v15, 4, v14
    s_add_u32 m0, s67, 114688
    s_add_u32 s68, s68, 128
    buffer_load_dwordx4 v124, s[28:31], s68 offen offset:0 lds
    v_lshl_add_u32 v15, v15, 4, v7
    v_add_u32 v253, 15360, v15
    v_add_u32 v15, 4, v13
    v_lshlrev_b32 v15, 1, v15
    v_xor_b32 v15, v15, v12
    v_lshl_add_u32 v114, v15, 4, v14
    v_lshl_add_u32 v15, v15, 4, v7
    v_add_u32 v254, 63488, v15
    v_add_u32 v15, 6, v13
    v_lshlrev_b32 v15, 1, v15
    buffer_load_dwordx4 v125, s[28:31], s68 offen offset:1024 lds
    v_xor_b32 v15, v15, v12
    v_lshl_add_u32 v115, v15, 4, v14
    v_lshl_add_u32 v15, v15, 4, v7
    v_add_u32 v255, 78848, v15
    s_mov_b32 s82, 0
    s_mov_b32 s83, 0
    v_lshrrev_b32 v14, 3, v10
    v_lshlrev_b32 v14, 10, v14
    v_and_b32 v15, 7, v10
    v_lshl_add_u32 v14, v15, 7, v14
    buffer_load_dwordx4 v126, s[28:31], s68 offen offset:2048 lds
    v_add_u32 v14, s67, v14
    v_bfe_u32 v15, v10, 1, 2
    v_lshlrev_b32 v15, 1, v15
    v_xor_b32 v15, v15, v11
    v_lshl_add_u32 v2, v15, 4, v14
    v_xor_b32 v3, 64, v2
    v_add_u32 v4, 0x10000, v2
    v_add_u32 v6, 0x20000, v2
    v_add_u32 v5, 0x10000, v3
    v_add_u32 v7, 0x20000, v3
    buffer_load_dwordx4 v127, s[28:31], s68 offen offset:3072 lds
    s_mul_i32 s85, s84, 28
    v_add_u32 v14, s85, v9
    v_mov_b32 v13, 0x7f000000
    v_cmp_gt_u32 vcc, 28, v9
    v_lshlrev_b32 v42, 7, v14
    s_nop 0
    v_cndmask_b32 v42, v13, v42, vcc
    v_lshrrev_b32 v14, 1, v9
    v_add_u32 v14, s85, v14
    v_mul_u32_u24 v14, 896, v14
    v_and_b32 v15, 1, v9
    s_add_u32 m0, s67, 131072
    s_add_u32 s68, s68, 128
    buffer_load_dwordx4 v124, s[28:31], s68 offen offset:0 lds
    v_lshl_add_u32 v14, v15, 7, v14
    v_cmp_gt_u32 vcc, 56, v9
    s_nop 0
    s_nop 0
    v_cndmask_b32 v41, v13, v14, vcc
    s_and_b32 s85, s66, 1
    s_lshl_b32 s85, s85, 13
    v_lshlrev_b32 v43, 7, v9
    v_add_u32 v43, s85, v43
    s_cmp_lt_u32 s66, 2
    s_cselect_b32 s12, s32, s36
    s_cselect_b32 s13, s33, s37
    s_mov_b32 s14, 0x100000
    buffer_load_dwordx4 v125, s[28:31], s68 offen offset:1024 lds
    s_mov_b32 s15, 0x20000
    s_and_b32 s16, s65, 3
    s_lshl_b32 s16, s16, 14
    s_lshr_b32 s17, s65, 2
    s_sub_u32 s17, 4, s17
    s_lshl_b32 s17, s17, 30
    s_add_u32 s16, s16, s17
    buffer_load_dwordx4 v126, s[28:31], s68 offen offset:2048 lds
    buffer_load_dwordx4 v127, s[28:31], s68 offen offset:3072 lds
    s_add_u32 m0, s67, 0
    s_add_u32 s68, s78, 0
    s_nop 0
    buffer_load_dwordx4 v248, s[48:51], s68 offen offset:0 lds
    buffer_load_dwordx4 v249, s[48:51], s68 offen offset:1024 lds
    buffer_load_dwordx4 v250, s[48:51], s68 offen offset:2048 lds
    buffer_load_dwordx4 v251, s[48:51], s68 offen offset:3072 lds
    s_waitcnt vmcnt(28)
    ds_read_b128 v[232:235], v2 offset:16384
    ds_read_b128 v[236:239], v2 offset:18432
    ds_read_b128 v[224:227], v3 offset:16384
    ds_read_b128 v[228:231], v3 offset:18432
    s_waitcnt vmcnt(24)
    ds_read_b128 v[216:219], v2 offset:32768
    ds_read_b128 v[220:223], v2 offset:34816
    ds_read_b128 v[208:211], v3 offset:32768
    ds_read_b128 v[212:215], v3 offset:34816
    s_add_u32 m0, s67, 65536
    s_add_u32 s69, s78, 0
    s_nop 0
    buffer_load_dwordx4 v248, s[52:55], s69 offen offset:0 lds
    buffer_load_dwordx4 v249, s[52:55], s69 offen offset:1024 lds
    buffer_load_dwordx4 v250, s[52:55], s69 offen offset:2048 lds
    buffer_load_dwordx4 v251, s[52:55], s69 offen offset:3072 lds
    s_waitcnt vmcnt(24)
    ds_read_b128 v[200:203], v2 offset:49152
    ds_read_b128 v[204:207], v2 offset:51200
    s_waitcnt lgkmcnt(8)
    v_mfma_f32_16x16x32_bf16 v[16:19], v[32:35], v[232:235], 0
    v_mfma_f32_16x16x32_bf16 v[20:23], v[32:35], v[236:239], 0
    ds_read_b128 v[192:195], v3 offset:49152
    ds_read_b128 v[196:199], v3 offset:51200
    s_waitcnt lgkmcnt(8)
    v_mfma_f32_16x16x32_bf16 v[16:19], v[32:35], v[224:227], v[16:19]
    v_mfma_f32_16x16x32_bf16 v[20:23], v[32:35], v[228:231], v[20:23]
    s_waitcnt vmcnt(20)
    ds_read_b128 v[184:187], v4 offset:16384
    ds_read_b128 v[188:191], v4 offset:18432
    s_waitcnt lgkmcnt(8)
    v_mfma_f32_16x16x32_bf16 v[16:19], v[32:35], v[216:219], v[16:19]
    v_mfma_f32_16x16x32_bf16 v[20:23], v[32:35], v[220:223], v[20:23]
    ds_read_b128 v[176:179], v5 offset:16384
    ds_read_b128 v[180:183], v5 offset:18432
    s_waitcnt lgkmcnt(8)
    v_mfma_f32_16x16x32_bf16 v[16:19], v[32:35], v[208:211], v[16:19]
    v_mfma_f32_16x16x32_bf16 v[20:23], v[32:35], v[212:215], v[20:23]
    s_waitcnt vmcnt(16)
    ds_read_b128 v[168:171], v4 offset:32768
    ds_read_b128 v[172:175], v4 offset:34816
    s_waitcnt lgkmcnt(8)
    v_mfma_f32_16x16x32_bf16 v[16:19], v[32:35], v[200:203], v[16:19]
    v_mfma_f32_16x16x32_bf16 v[20:23], v[32:35], v[204:207], v[20:23]
    ds_read_b128 v[160:163], v5 offset:32768
    ds_read_b128 v[164:167], v5 offset:34816
    s_waitcnt lgkmcnt(8)
    v_mfma_f32_16x16x32_bf16 v[16:19], v[32:35], v[192:195], v[16:19]
    v_mfma_f32_16x16x32_bf16 v[20:23], v[32:35], v[196:199], v[20:23]
    s_waitcnt vmcnt(12)
    ds_read_b128 v[152:155], v4 offset:49152
    ds_read_b128 v[156:159], v4 offset:51200
    s_waitcnt lgkmcnt(8)
    v_mfma_f32_16x16x32_bf16 v[16:19], v[32:35], v[184:187], v[16:19]
    v_mfma_f32_16x16x32_bf16 v[20:23], v[32:35], v[188:191], v[20:23]
    ds_read_b128 v[144:147], v5 offset:49152
    ds_read_b128 v[148:151], v5 offset:51200
    s_waitcnt lgkmcnt(8)
    v_mfma_f32_16x16x32_bf16 v[16:19], v[32:35], v[176:179], v[16:19]
    v_mfma_f32_16x16x32_bf16 v[20:23], v[32:35], v[180:183], v[20:23]
    s_waitcnt vmcnt(8)
    ds_read_b128 v[136:139], v6 offset:0
    ds_read_b128 v[140:143], v6 offset:2048
    s_waitcnt lgkmcnt(8)
    v_mfma_f32_16x16x32_bf16 v[16:19], v[32:35], v[168:171], v[16:19]
    v_mfma_f32_16x16x32_bf16 v[20:23], v[32:35], v[172:175], v[20:23]
    ds_read_b128 v[128:131], v7 offset:0
    ds_read_b128 v[132:135], v7 offset:2048
    s_waitcnt lgkmcnt(8)
    v_mfma_f32_16x16x32_bf16 v[16:19], v[32:35], v[160:163], v[16:19]
    v_mfma_f32_16x16x32_bf16 v[20:23], v[32:35], v[164:167], v[20:23]
    s_waitcnt lgkmcnt(6)
    v_mfma_f32_16x16x32_bf16 v[16:19], v[32:35], v[152:155], v[16:19]
    v_mfma_f32_16x16x32_bf16 v[20:23], v[32:35], v[156:159], v[20:23]
    s_waitcnt lgkmcnt(4)
    v_mfma_f32_16x16x32_bf16 v[16:19], v[32:35], v[144:147], v[16:19]
    v_mfma_f32_16x16x32_bf16 v[20:23], v[32:35], v[148:151], v[20:23]
    s_waitcnt lgkmcnt(2)
    v_mfma_f32_16x16x32_bf16 v[16:19], v[32:35], v[136:139], v[16:19]
    v_mfma_f32_16x16x32_bf16 v[20:23], v[32:35], v[140:143], v[20:23]
    s_waitcnt lgkmcnt(0)
    v_mfma_f32_16x16x32_bf16 v[16:19], v[32:35], v[128:131], v[16:19]
    v_mfma_f32_16x16x32_bf16 v[20:23], v[32:35], v[132:135], v[20:23]
    s_add_u32 m0, s67, 16384
    s_add_u32 s68, s78, 229376
    s_nop 0
    buffer_load_dwordx4 v248, s[48:51], s68 offen offset:0 lds
    s_nop 2
    v_mul_f32 v8, 0x3b124925, v16
    v_cvt_pk_bf16_f32 v2, v8, v8
    v_lshlrev_b32 v2, 16, v2
    v_sub_f32 v4, v8, v2
    v_mul_f32 v9, 0x3b124925, v20
    v_cvt_pk_bf16_f32 v3, v9, v9
    buffer_load_dwordx4 v249, s[48:51], s68 offen offset:1024 lds
    v_lshlrev_b32 v3, 16, v3
    v_sub_f32 v5, v9, v3
    v_lshlrev_b32 v8, 16, v232
    v_and_b32 v9, s86, v232
    v_sub_f32 v8, v8, v2
    v_sub_f32 v9, v9, v2
    buffer_load_dwordx4 v250, s[48:51], s68 offen offset:2048 lds
    v_cvt_pk_bf16_f32 v232, v8, v9
    v_lshlrev_b32 v10, 16, v233
    v_and_b32 v11, s86, v233
    v_sub_f32 v10, v10, v2
    v_sub_f32 v11, v11, v2
    v_cvt_pk_bf16_f32 v233, v10, v11
    buffer_load_dwordx4 v251, s[48:51], s68 offen offset:3072 lds
    v_lshlrev_b32 v12, 16, v234
    v_and_b32 v13, s86, v234
    v_sub_f32 v12, v12, v2
    v_sub_f32 v13, v13, v2
    v_cvt_pk_bf16_f32 v234, v12, v13
    v_lshlrev_b32 v8, 16, v235
    s_add_u32 m0, s67, 81920
    s_add_u32 s69, s78, 229376
    s_nop 0
    buffer_load_dwordx4 v248, s[52:55], s69 offen offset:0 lds
    v_and_b32 v9, s86, v235
    v_sub_f32 v8, v8, v2
    v_sub_f32 v9, v9, v2
    v_cvt_pk_bf16_f32 v235, v8, v9
    v_lshlrev_b32 v10, 16, v236
    v_and_b32 v11, s86, v236
    buffer_load_dwordx4 v249, s[52:55], s69 offen offset:1024 lds
    v_sub_f32 v10, v10, v3
    v_sub_f32 v11, v11, v3
    v_cvt_pk_bf16_f32 v236, v10, v11
    v_lshlrev_b32 v12, 16, v237
    v_and_b32 v13, s86, v237
    v_sub_f32 v12, v12, v3
    buffer_load_dwordx4 v250, s[52:55], s69 offen offset:2048 lds
    v_sub_f32 v13, v13, v3
    v_cvt_pk_bf16_f32 v237, v12, v13
    v_lshlrev_b32 v8, 16, v238
    v_and_b32 v9, s86, v238
    v_sub_f32 v8, v8, v3
    v_sub_f32 v9, v9, v3
    buffer_load_dwordx4 v251, s[52:55], s69 offen offset:3072 lds
    v_cvt_pk_bf16_f32 v238, v8, v9
    v_lshlrev_b32 v10, 16, v239
    v_and_b32 v11, s86, v239
    v_sub_f32 v10, v10, v3
    v_sub_f32 v11, v11, v3
    v_cvt_pk_bf16_f32 v239, v10, v11
    s_waitcnt vmcnt(8)
    s_barrier
    ds_read_b64_tr_b16 v[64:65], v48 offset:0
    ds_read_b64_tr_b16 v[66:67], v48 offset:4096
    ds_read_b64_tr_b16 v[68:69], v55 offset:0
    ds_read_b64_tr_b16 v[70:71], v55 offset:4096
    ds_read_b64_tr_b16 v[72:73], v49 offset:0
    ds_read_b64_tr_b16 v[74:75], v49 offset:4096
    ds_read_b64_tr_b16 v[76:77], v56 offset:0
    ds_read_b64_tr_b16 v[78:79], v56 offset:4096
    ds_read_b64_tr_b16 v[80:81], v50 offset:0
    ds_read_b64_tr_b16 v[82:83], v50 offset:4096
    ds_read_b64_tr_b16 v[84:85], v57 offset:0
    s_waitcnt lgkmcnt(9)
    v_mfma_f32_16x16x32_bf16 a[128:131], v[64:67], v[232:235], 0
    ds_read_b64_tr_b16 v[86:87], v57 offset:4096
    v_lshlrev_b32 v8, 16, v224
    v_mfma_f32_16x16x32_bf16 a[132:135], v[64:67], v[236:239], 0
    s_waitcnt lgkmcnt(8)
    s_add_u32 m0, s67, 32768
    ds_read_b64_tr_b16 v[88:89], v51 offset:0
    v_mfma_f32_16x16x32_bf16 a[188:191], v[68:71], v[236:239], 0
    s_add_u32 s68, s78, 458752
    ds_read_b64_tr_b16 v[90:91], v51 offset:4096
    v_and_b32 v9, s86, v224
    v_mfma_f32_16x16x32_bf16 a[184:187], v[68:71], v[232:235], 0
    s_waitcnt lgkmcnt(8)
    ds_read_b64_tr_b16 v[92:93], v58 offset:0
    v_sub_f32 v8, v8, v2
    v_mfma_f32_16x16x32_bf16 a[136:139], v[72:75], v[232:235], 0
    ds_read_b64_tr_b16 v[94:95], v58 offset:4096
    v_sub_f32 v9, v9, v2
    v_mfma_f32_16x16x32_bf16 a[140:143], v[72:75], v[236:239], 0
    s_waitcnt lgkmcnt(8)
    buffer_load_dwordx4 v248, s[48:51], s68 offen offset:0 lds
    v_mfma_f32_16x16x32_bf16 a[196:199], v[76:79], v[236:239], 0
    v_cvt_pk_bf16_f32 v224, v8, v9
    v_lshlrev_b32 v10, 16, v225
    v_mfma_f32_16x16x32_bf16 a[192:195], v[76:79], v[232:235], 0
    s_waitcnt lgkmcnt(6)
    ds_read_b64_tr_b16 v[64:65], v52 offset:0
    v_and_b32 v11, s86, v225
    v_sub_f32 v10, v10, v2
    v_mfma_f32_16x16x32_bf16 a[144:147], v[80:83], v[232:235], 0
    ds_read_b64_tr_b16 v[66:67], v52 offset:4096
    buffer_load_dwordx4 v249, s[48:51], s68 offen offset:1024 lds
    v_mfma_f32_16x16x32_bf16 a[148:151], v[80:83], v[236:239], 0
    s_waitcnt lgkmcnt(6)
    ds_read_b64_tr_b16 v[68:69], v59 offset:0
    v_sub_f32 v11, v11, v2
    v_mfma_f32_16x16x32_bf16 a[204:207], v[84:87], v[236:239], 0
    ds_read_b64_tr_b16 v[70:71], v59 offset:4096
    v_cvt_pk_bf16_f32 v225, v10, v11
    v_mfma_f32_16x16x32_bf16 a[200:203], v[84:87], v[232:235], 0
    s_waitcnt lgkmcnt(6)
    ds_read_b64_tr_b16 v[72:73], v53 offset:0
    v_lshlrev_b32 v12, 16, v226
    v_and_b32 v13, s86, v226
    v_sub_f32 v12, v12, v2
    v_mfma_f32_16x16x32_bf16 a[152:155], v[88:91], v[232:235], 0
    ds_read_b64_tr_b16 v[74:75], v53 offset:4096
    buffer_load_dwordx4 v250, s[48:51], s68 offen offset:2048 lds
    v_mfma_f32_16x16x32_bf16 a[156:159], v[88:91], v[236:239], 0
    s_waitcnt lgkmcnt(6)
    ds_read_b64_tr_b16 v[76:77], v60 offset:0
    v_sub_f32 v13, v13, v2
    v_cvt_pk_bf16_f32 v226, v12, v13
    v_mfma_f32_16x16x32_bf16 a[212:215], v[92:95], v[236:239], 0
    ds_read_b64_tr_b16 v[78:79], v60 offset:4096
    v_lshlrev_b32 v8, 16, v227
    v_mfma_f32_16x16x32_bf16 a[208:211], v[92:95], v[232:235], 0
    ds_read_b64_tr_b16 v[80:81], v54 offset:0
    v_and_b32 v9, s86, v227
    v_sub_f32 v8, v8, v2
    v_sub_f32 v9, v9, v2
    v_mfma_f32_16x16x32_bf16 v[24:27], v[232:235], v[232:235], 0
    ds_read_b64_tr_b16 v[82:83], v54 offset:4096
    buffer_load_dwordx4 v251, s[48:51], s68 offen offset:3072 lds
    v_mfma_f32_16x16x32_bf16 v[28:31], v[236:239], v[236:239], 0
    s_waitcnt lgkmcnt(8)
    ds_read_b64_tr_b16 v[84:85], v61 offset:0
    v_cvt_pk_bf16_f32 v227, v8, v9
    v_mfma_f32_16x16x32_bf16 a[164:167], v[64:67], v[236:239], 0
    ds_read_b64_tr_b16 v[86:87], v61 offset:4096
    v_lshlrev_b32 v10, 16, v228
    v_and_b32 v11, s86, v228
    v_sub_f32 v10, v10, v3
    v_mfma_f32_16x16x32_bf16 a[160:163], v[64:67], v[232:235], 0
    s_waitcnt lgkmcnt(8)
    s_add_u32 m0, s67, 98304
    ds_read_b64_tr_b16 v[88:89], v48 offset:8192
    v_mfma_f32_16x16x32_bf16 a[216:219], v[68:71], v[232:235], 0
    s_add_u32 s69, s78, 458752
    ds_read_b64_tr_b16 v[90:91], v48 offset:12288
    v_sub_f32 v11, v11, v3
    v_cvt_pk_bf16_f32 v228, v10, v11
    v_lshlrev_b32 v12, 16, v229
    v_mfma_f32_16x16x32_bf16 a[220:223], v[68:71], v[236:239], 0
    s_waitcnt lgkmcnt(8)
    ds_read_b64_tr_b16 v[92:93], v55 offset:8192
    buffer_load_dwordx4 v248, s[52:55], s69 offen offset:0 lds
    v_mfma_f32_16x16x32_bf16 a[172:175], v[72:75], v[236:239], 0
    ds_read_b64_tr_b16 v[94:95], v55 offset:12288
    v_and_b32 v13, s86, v229
    v_sub_f32 v12, v12, v3
    v_mfma_f32_16x16x32_bf16 a[168:171], v[72:75], v[232:235], 0
    s_waitcnt lgkmcnt(8)
    ds_read_b64_tr_b16 v[64:65], v49 offset:8192
    v_sub_f32 v13, v13, v3
    v_cvt_pk_bf16_f32 v229, v12, v13
    v_mfma_f32_16x16x32_bf16 a[224:227], v[76:79], v[232:235], 0
    ds_read_b64_tr_b16 v[66:67], v49 offset:12288
    buffer_load_dwordx4 v249, s[52:55], s69 offen offset:1024 lds
    v_mfma_f32_16x16x32_bf16 a[228:231], v[76:79], v[236:239], 0
    s_waitcnt lgkmcnt(8)
    ds_read_b64_tr_b16 v[68:69], v56 offset:8192
    v_lshlrev_b32 v8, 16, v230
    v_and_b32 v9, s86, v230
    v_mfma_f32_16x16x32_bf16 a[180:183], v[80:83], v[236:239], 0
    ds_read_b64_tr_b16 v[70:71], v56 offset:12288
    v_sub_f32 v8, v8, v3
    v_mfma_f32_16x16x32_bf16 a[176:179], v[80:83], v[232:235], 0
    s_waitcnt lgkmcnt(8)
    ds_read_b64_tr_b16 v[72:73], v50 offset:8192
    v_sub_f32 v9, v9, v3
    v_cvt_pk_bf16_f32 v230, v8, v9
    v_lshlrev_b32 v10, 16, v231
    v_and_b32 v11, s86, v231
    v_sub_f32 v10, v10, v3
    v_sub_f32 v11, v11, v3
    v_cvt_pk_bf16_f32 v231, v10, v11
    v_mfma_f32_16x16x32_bf16 a[232:235], v[84:87], v[232:235], 0
    ds_read_b64_tr_b16 v[74:75], v50 offset:12288
    buffer_load_dwordx4 v250, s[52:55], s69 offen offset:2048 lds
    v_mfma_f32_16x16x32_bf16 a[236:239], v[84:87], v[236:239], 0
    s_waitcnt lgkmcnt(8)
    ds_read_b64_tr_b16 v[76:77], v57 offset:8192
    v_mfma_f32_16x16x32_bf16 a[132:135], v[88:91], v[228:231], a[132:135]
    ds_read_b64_tr_b16 v[78:79], v57 offset:12288
    v_lshlrev_b32 v8, 16, v216
    v_mfma_f32_16x16x32_bf16 a[128:131], v[88:91], v[224:227], a[128:131]
    s_waitcnt lgkmcnt(8)
    ds_read_b64_tr_b16 v[80:81], v51 offset:8192
    v_and_b32 v9, s86, v216
    v_mfma_f32_16x16x32_bf16 a[184:187], v[92:95], v[224:227], a[184:187]
    ds_read_b64_tr_b16 v[82:83], v51 offset:12288
    buffer_load_dwordx4 v251, s[52:55], s69 offen offset:3072 lds
    v_mfma_f32_16x16x32_bf16 a[188:191], v[92:95], v[228:231], a[188:191]
    s_waitcnt lgkmcnt(8)
    ds_read_b64_tr_b16 v[84:85], v58 offset:8192
    v_sub_f32 v8, v8, v2
    v_mfma_f32_16x16x32_bf16 a[140:143], v[64:67], v[228:231], a[140:143]
    s_waitcnt vmcnt(8)
    s_barrier
    ds_read_b64_tr_b16 v[86:87], v58 offset:12288
    v_mfma_f32_16x16x32_bf16 a[136:139], v[64:67], v[224:227], a[136:139]
    s_waitcnt lgkmcnt(8)
    v_sub_f32 v9, v9, v2
    v_cvt_pk_bf16_f32 v216, v8, v9
    v_mfma_f32_16x16x32_bf16 a[192:195], v[68:71], v[224:227], a[192:195]
    s_add_u32 m0, s67, 49152
    s_add_u32 s68, s78, 688128
    v_lshlrev_b32 v10, 16, v217
    v_mfma_f32_16x16x32_bf16 a[196:199], v[68:71], v[228:231], a[196:199]
    s_waitcnt lgkmcnt(6)
    ds_read_b64_tr_b16 v[88:89], v52 offset:8192
    buffer_load_dwordx4 v248, s[48:51], s68 offen offset:0 lds
    v_mfma_f32_16x16x32_bf16 a[148:151], v[72:75], v[228:231], a[148:151]
    ds_read_b64_tr_b16 v[90:91], v52 offset:12288
    v_and_b32 v11, s86, v217
    v_sub_f32 v10, v10, v2
    v_mfma_f32_16x16x32_bf16 a[144:147], v[72:75], v[224:227], a[144:147]
    s_waitcnt lgkmcnt(6)
    ds_read_b64_tr_b16 v[92:93], v59 offset:8192
    v_sub_f32 v11, v11, v2
    v_mfma_f32_16x16x32_bf16 a[200:203], v[76:79], v[224:227], a[200:203]
    ds_read_b64_tr_b16 v[94:95], v59 offset:12288
    v_cvt_pk_bf16_f32 v217, v10, v11
    v_mfma_f32_16x16x32_bf16 a[204:207], v[76:79], v[228:231], a[204:207]
    s_waitcnt lgkmcnt(6)
    ds_read_b64_tr_b16 v[64:65], v53 offset:8192
    v_lshlrev_b32 v12, 16, v218
    v_and_b32 v13, s86, v218
    v_mfma_f32_16x16x32_bf16 a[156:159], v[80:83], v[228:231], a[156:159]
    ds_read_b64_tr_b16 v[66:67], v53 offset:12288
    v_sub_f32 v12, v12, v2
    v_sub_f32 v13, v13, v2
    v_cvt_pk_bf16_f32 v218, v12, v13
    v_mfma_f32_16x16x32_bf16 a[152:155], v[80:83], v[224:227], a[152:155]
    s_waitcnt lgkmcnt(6)
    ds_read_b64_tr_b16 v[68:69], v60 offset:8192
    buffer_load_dwordx4 v249, s[48:51], s68 offen offset:1024 lds
    v_mfma_f32_16x16x32_bf16 a[208:211], v[84:87], v[224:227], a[208:211]
    ds_read_b64_tr_b16 v[70:71], v60 offset:12288
    v_lshlrev_b32 v8, 16, v219
    v_mfma_f32_16x16x32_bf16 a[212:215], v[84:87], v[228:231], a[212:215]
    ds_read_b64_tr_b16 v[72:73], v54 offset:8192
    v_and_b32 v9, s86, v219
    v_sub_f32 v8, v8, v2
    v_mfma_f32_16x16x32_bf16 v[24:27], v[224:227], v[224:227], v[24:27]
    ds_read_b64_tr_b16 v[74:75], v54 offset:12288
    v_sub_f32 v9, v9, v2
    v_mfma_f32_16x16x32_bf16 v[28:31], v[228:231], v[228:231], v[28:31]
    s_waitcnt lgkmcnt(8)
    ds_read_b64_tr_b16 v[76:77], v61 offset:8192
    v_cvt_pk_bf16_f32 v219, v8, v9
    v_mfma_f32_16x16x32_bf16 a[160:163], v[88:91], v[224:227], a[160:163]
    ds_read_b64_tr_b16 v[78:79], v61 offset:12288
    v_lshlrev_b32 v10, 16, v220
    v_and_b32 v11, s86, v220
    v_sub_f32 v10, v10, v3
    v_mfma_f32_16x16x32_bf16 a[164:167], v[88:91], v[228:231], a[164:167]
    s_waitcnt lgkmcnt(8)
    ds_read_b64_tr_b16 v[80:81], v48 offset:16384
    buffer_load_dwordx4 v250, s[48:51], s68 offen offset:2048 lds
    v_mfma_f32_16x16x32_bf16 a[220:223], v[92:95], v[228:231], a[220:223]
    ds_read_b64_tr_b16 v[82:83], v48 offset:20480
    v_sub_f32 v11, v11, v3
    v_cvt_pk_bf16_f32 v220, v10, v11
    v_mfma_f32_16x16x32_bf16 a[216:219], v[92:95], v[224:227], a[216:219]
    s_waitcnt lgkmcnt(8)
    ds_read_b64_tr_b16 v[84:85], v55 offset:16384
    v_lshlrev_b32 v12, 16, v221
    v_mfma_f32_16x16x32_bf16 a[168:171], v[64:67], v[224:227], a[168:171]
    ds_read_b64_tr_b16 v[86:87], v55 offset:20480
    v_and_b32 v13, s86, v221
    v_sub_f32 v12, v12, v3
    v_mfma_f32_16x16x32_bf16 a[172:175], v[64:67], v[228:231], a[172:175]
    s_waitcnt lgkmcnt(8)
    ds_read_b64_tr_b16 v[88:89], v49 offset:16384
    v_sub_f32 v13, v13, v3
    v_mfma_f32_16x16x32_bf16 a[228:231], v[68:71], v[228:231], a[228:231]
    ds_read_b64_tr_b16 v[90:91], v49 offset:20480
    v_cvt_pk_bf16_f32 v221, v12, v13
    v_lshlrev_b32 v8, 16, v222
    v_and_b32 v9, s86, v222
    v_mfma_f32_16x16x32_bf16 a[224:227], v[68:71], v[224:227], a[224:227]
    s_waitcnt lgkmcnt(8)
    ds_read_b64_tr_b16 v[92:93], v56 offset:16384
    buffer_load_dwordx4 v251, s[48:51], s68 offen offset:3072 lds
    v_mfma_f32_16x16x32_bf16 a[176:179], v[72:75], v[224:227], a[176:179]
    ds_read_b64_tr_b16 v[94:95], v56 offset:20480
    v_sub_f32 v8, v8, v3
    v_mfma_f32_16x16x32_bf16 a[180:183], v[72:75], v[228:231], a[180:183]
    s_waitcnt lgkmcnt(8)
    ds_read_b64_tr_b16 v[64:65], v50 offset:16384
    v_sub_f32 v9, v9, v3
    v_cvt_pk_bf16_f32 v222, v8, v9
    v_mfma_f32_16x16x32_bf16 a[236:239], v[76:79], v[228:231], a[236:239]
    ds_read_b64_tr_b16 v[66:67], v50 offset:20480
    v_lshlrev_b32 v10, 16, v223
    v_and_b32 v11, s86, v223
    v_sub_f32 v10, v10, v3
    v_sub_f32 v11, v11, v3
    v_cvt_pk_bf16_f32 v223, v10, v11
    v_mfma_f32_16x16x32_bf16 a[232:235], v[76:79], v[224:227], a[232:235]
    s_waitcnt lgkmcnt(8)
    ds_read_b64_tr_b16 v[68:69], v57 offset:16384
    v_mfma_f32_16x16x32_bf16 a[128:131], v[80:83], v[216:219], a[128:131]
    s_add_u32 m0, s67, 114688
    s_add_u32 s69, s78, 688128
    ds_read_b64_tr_b16 v[70:71], v57 offset:20480
    v_mfma_f32_16x16x32_bf16 a[132:135], v[80:83], v[220:223], a[132:135]
    s_waitcnt lgkmcnt(8)
    ds_read_b64_tr_b16 v[72:73], v51 offset:16384
    buffer_load_dwordx4 v248, s[52:55], s69 offen offset:0 lds
    v_mfma_f32_16x16x32_bf16 a[188:191], v[84:87], v[220:223], a[188:191]
    ds_read_b64_tr_b16 v[74:75], v51 offset:20480
    v_lshlrev_b32 v8, 16, v208
    v_mfma_f32_16x16x32_bf16 a[184:187], v[84:87], v[216:219], a[184:187]
    s_waitcnt lgkmcnt(8)
    ds_read_b64_tr_b16 v[76:77], v58 offset:16384
    v_and_b32 v9, s86, v208
    v_mfma_f32_16x16x32_bf16 a[136:139], v[88:91], v[216:219], a[136:139]
    ds_read_b64_tr_b16 v[78:79], v58 offset:20480
    v_sub_f32 v8, v8, v2
    v_mfma_f32_16x16x32_bf16 a[140:143], v[88:91], v[220:223], a[140:143]
    s_waitcnt lgkmcnt(8)
    v_sub_f32 v9, v9, v2
    v_cvt_pk_bf16_f32 v208, v8, v9
    v_mfma_f32_16x16x32_bf16 a[196:199], v[92:95], v[220:223], a[196:199]
    v_lshlrev_b32 v10, 16, v209
    v_and_b32 v11, s86, v209
    v_mfma_f32_16x16x32_bf16 a[192:195], v[92:95], v[216:219], a[192:195]
    s_waitcnt lgkmcnt(6)
    ds_read_b64_tr_b16 v[80:81], v52 offset:16384
    buffer_load_dwordx4 v249, s[52:55], s69 offen offset:1024 lds
    v_mfma_f32_16x16x32_bf16 a[144:147], v[64:67], v[216:219], a[144:147]
    ds_read_b64_tr_b16 v[82:83], v52 offset:20480
    v_sub_f32 v10, v10, v2
    v_mfma_f32_16x16x32_bf16 a[148:151], v[64:67], v[220:223], a[148:151]
    s_waitcnt lgkmcnt(6)
    ds_read_b64_tr_b16 v[84:85], v59 offset:16384
    v_sub_f32 v11, v11, v2
    v_mfma_f32_16x16x32_bf16 a[204:207], v[68:71], v[220:223], a[204:207]
    ds_read_b64_tr_b16 v[86:87], v59 offset:20480
    v_cvt_pk_bf16_f32 v209, v10, v11
    v_mfma_f32_16x16x32_bf16 a[200:203], v[68:71], v[216:219], a[200:203]
    s_waitcnt lgkmcnt(6)
    ds_read_b64_tr_b16 v[88:89], v53 offset:16384
    v_lshlrev_b32 v12, 16, v210
    v_and_b32 v13, s86, v210
    v_mfma_f32_16x16x32_bf16 a[152:155], v[72:75], v[216:219], a[152:155]
    ds_read_b64_tr_b16 v[90:91], v53 offset:20480
    v_sub_f32 v12, v12, v2
    v_sub_f32 v13, v13, v2
    v_cvt_pk_bf16_f32 v210, v12, v13
    v_mfma_f32_16x16x32_bf16 a[156:159], v[72:75], v[220:223], a[156:159]
    s_waitcnt lgkmcnt(6)
    ds_read_b64_tr_b16 v[92:93], v60 offset:16384
    buffer_load_dwordx4 v250, s[52:55], s69 offen offset:2048 lds
    v_mfma_f32_16x16x32_bf16 a[212:215], v[76:79], v[220:223], a[212:215]
    ds_read_b64_tr_b16 v[94:95], v60 offset:20480
    v_lshlrev_b32 v8, 16, v211
    v_mfma_f32_16x16x32_bf16 a[208:211], v[76:79], v[216:219], a[208:211]
    ds_read_b64_tr_b16 v[64:65], v54 offset:16384
    v_and_b32 v9, s86, v211
    v_sub_f32 v8, v8, v2
    v_mfma_f32_16x16x32_bf16 v[24:27], v[216:219], v[216:219], v[24:27]
    ds_read_b64_tr_b16 v[66:67], v54 offset:20480
    v_sub_f32 v9, v9, v2
    v_mfma_f32_16x16x32_bf16 v[28:31], v[220:223], v[220:223], v[28:31]
    s_waitcnt lgkmcnt(8)
    ds_read_b64_tr_b16 v[68:69], v61 offset:16384
    v_cvt_pk_bf16_f32 v211, v8, v9
    v_mfma_f32_16x16x32_bf16 a[164:167], v[80:83], v[220:223], a[164:167]
    ds_read_b64_tr_b16 v[70:71], v61 offset:20480
    v_lshlrev_b32 v10, 16, v212
    v_and_b32 v11, s86, v212
    v_sub_f32 v10, v10, v3
    v_mfma_f32_16x16x32_bf16 a[160:163], v[80:83], v[216:219], a[160:163]
    s_waitcnt lgkmcnt(8)
    ds_read_b64_tr_b16 v[72:73], v48 offset:24576
    buffer_load_dwordx4 v251, s[52:55], s69 offen offset:3072 lds
    v_mfma_f32_16x16x32_bf16 a[216:219], v[84:87], v[216:219], a[216:219]
    ds_read_b64_tr_b16 v[74:75], v48 offset:28672
    v_sub_f32 v11, v11, v3
    v_cvt_pk_bf16_f32 v212, v10, v11
    v_mfma_f32_16x16x32_bf16 a[220:223], v[84:87], v[220:223], a[220:223]
    s_waitcnt lgkmcnt(8)
    ds_read_b64_tr_b16 v[76:77], v55 offset:24576
    v_lshlrev_b32 v12, 16, v213
    v_mfma_f32_16x16x32_bf16 a[172:175], v[88:91], v[220:223], a[172:175]
    ds_read_b64_tr_b16 v[78:79], v55 offset:28672
    v_and_b32 v13, s86, v213
    v_sub_f32 v12, v12, v3
    v_mfma_f32_16x16x32_bf16 a[168:171], v[88:91], v[216:219], a[168:171]
    s_waitcnt lgkmcnt(8)
    ds_read_b64_tr_b16 v[80:81], v49 offset:24576
    v_sub_f32 v13, v13, v3
    v_mfma_f32_16x16x32_bf16 a[224:227], v[92:95], v[216:219], a[224:227]
    ds_read_b64_tr_b16 v[82:83], v49 offset:28672
    v_cvt_pk_bf16_f32 v213, v12, v13
    v_mfma_f32_16x16x32_bf16 a[228:231], v[92:95], v[220:223], a[228:231]
    s_waitcnt lgkmcnt(8)
    ds_read_b64_tr_b16 v[84:85], v56 offset:24576
    v_lshlrev_b32 v8, 16, v214
    v_and_b32 v9, s86, v214
    v_mfma_f32_16x16x32_bf16 a[180:183], v[64:67], v[220:223], a[180:183]
    ds_read_b64_tr_b16 v[86:87], v56 offset:28672
    v_sub_f32 v8, v8, v3
    v_mfma_f32_16x16x32_bf16 a[176:179], v[64:67], v[216:219], a[176:179]
    s_waitcnt lgkmcnt(8)
    ds_read_b64_tr_b16 v[88:89], v50 offset:24576
    v_sub_f32 v9, v9, v3
    v_cvt_pk_bf16_f32 v214, v8, v9
    v_mfma_f32_16x16x32_bf16 a[232:235], v[68:71], v[216:219], a[232:235]
    ds_read_b64_tr_b16 v[90:91], v50 offset:28672
    v_lshlrev_b32 v10, 16, v215
    v_and_b32 v11, s86, v215
    v_sub_f32 v10, v10, v3
    v_sub_f32 v11, v11, v3
    v_cvt_pk_bf16_f32 v215, v10, v11
    v_mfma_f32_16x16x32_bf16 a[236:239], v[68:71], v[220:223], a[236:239]
    s_waitcnt lgkmcnt(8)
    ds_read_b64_tr_b16 v[92:93], v57 offset:24576
    v_mfma_f32_16x16x32_bf16 a[132:135], v[72:75], v[212:215], a[132:135]
    ds_read_b64_tr_b16 v[94:95], v57 offset:28672
    v_lshlrev_b32 v8, 16, v200
    v_mfma_f32_16x16x32_bf16 a[128:131], v[72:75], v[208:211], a[128:131]
    s_waitcnt lgkmcnt(8)
    ds_read_b64_tr_b16 v[64:65], v51 offset:24576
    v_and_b32 v9, s86, v200
    v_mfma_f32_16x16x32_bf16 a[184:187], v[76:79], v[208:211], a[184:187]
    ds_read_b64_tr_b16 v[66:67], v51 offset:28672
    v_sub_f32 v8, v8, v2
    v_mfma_f32_16x16x32_bf16 a[188:191], v[76:79], v[212:215], a[188:191]
    s_waitcnt lgkmcnt(8)
    ds_read_b64_tr_b16 v[68:69], v58 offset:24576
    v_sub_f32 v9, v9, v2
    v_mfma_f32_16x16x32_bf16 a[140:143], v[80:83], v[212:215], a[140:143]
    s_waitcnt vmcnt(8)
    s_barrier
    ds_read_b64_tr_b16 v[70:71], v58 offset:28672
    v_mfma_f32_16x16x32_bf16 a[136:139], v[80:83], v[208:211], a[136:139]
    s_waitcnt lgkmcnt(8)
    v_cvt_pk_bf16_f32 v200, v8, v9
    v_lshlrev_b32 v10, 16, v201
    v_mfma_f32_16x16x32_bf16 a[192:195], v[84:87], v[208:211], a[192:195]
    s_add_u32 m0, s67, 0
    s_add_u32 s68, s78, 917504
    v_and_b32 v11, s86, v201
    v_mfma_f32_16x16x32_bf16 a[196:199], v[84:87], v[212:215], a[196:199]
    s_waitcnt lgkmcnt(6)
    ds_read_b64_tr_b16 v[72:73], v52 offset:24576
    buffer_load_dwordx4 v248, s[48:51], s68 offen offset:0 lds
    v_mfma_f32_16x16x32_bf16 a[148:151], v[88:91], v[212:215], a[148:151]
    ds_read_b64_tr_b16 v[74:75], v52 offset:28672
    v_sub_f32 v10, v10, v2
    v_mfma_f32_16x16x32_bf16 a[144:147], v[88:91], v[208:211], a[144:147]
    s_waitcnt lgkmcnt(6)
    ds_read_b64_tr_b16 v[76:77], v59 offset:24576
    v_sub_f32 v11, v11, v2
    v_mfma_f32_16x16x32_bf16 a[200:203], v[92:95], v[208:211], a[200:203]
    ds_read_b64_tr_b16 v[78:79], v59 offset:28672
    v_cvt_pk_bf16_f32 v201, v10, v11
    v_mfma_f32_16x16x32_bf16 a[204:207], v[92:95], v[212:215], a[204:207]
    s_waitcnt lgkmcnt(6)
    ds_read_b64_tr_b16 v[80:81], v53 offset:24576
    v_lshlrev_b32 v12, 16, v202
    v_and_b32 v13, s86, v202
    v_mfma_f32_16x16x32_bf16 a[156:159], v[64:67], v[212:215], a[156:159]
    ds_read_b64_tr_b16 v[82:83], v53 offset:28672
    v_sub_f32 v12, v12, v2
    v_sub_f32 v13, v13, v2
    v_cvt_pk_bf16_f32 v202, v12, v13
    v_mfma_f32_16x16x32_bf16 a[152:155], v[64:67], v[208:211], a[152:155]
    s_waitcnt lgkmcnt(6)
    ds_read_b64_tr_b16 v[84:85], v60 offset:24576
    buffer_load_dwordx4 v249, s[48:51], s68 offen offset:1024 lds
    v_mfma_f32_16x16x32_bf16 a[208:211], v[68:71], v[208:211], a[208:211]
    ds_read_b64_tr_b16 v[86:87], v60 offset:28672
    v_lshlrev_b32 v8, 16, v203
    v_mfma_f32_16x16x32_bf16 a[212:215], v[68:71], v[212:215], a[212:215]
    ds_read_b64_tr_b16 v[88:89], v54 offset:24576
    v_and_b32 v9, s86, v203
    v_sub_f32 v8, v8, v2
    v_mfma_f32_16x16x32_bf16 v[24:27], v[208:211], v[208:211], v[24:27]
    ds_read_b64_tr_b16 v[90:91], v54 offset:28672
    v_sub_f32 v9, v9, v2
    v_mfma_f32_16x16x32_bf16 v[28:31], v[212:215], v[212:215], v[28:31]
    s_waitcnt lgkmcnt(8)
    ds_read_b64_tr_b16 v[92:93], v61 offset:24576
    v_cvt_pk_bf16_f32 v203, v8, v9
    v_mfma_f32_16x16x32_bf16 a[160:163], v[72:75], v[208:211], a[160:163]
    ds_read_b64_tr_b16 v[94:95], v61 offset:28672
    v_lshlrev_b32 v10, 16, v204
    v_and_b32 v11, s86, v204
    v_sub_f32 v10, v10, v3
    v_mfma_f32_16x16x32_bf16 a[164:167], v[72:75], v[212:215], a[164:167]
    s_waitcnt lgkmcnt(8)
    ds_read_b64_tr_b16 v[64:65], v48 offset:32768
    buffer_load_dwordx4 v250, s[48:51], s68 offen offset:2048 lds
    v_mfma_f32_16x16x32_bf16 a[220:223], v[76:79], v[212:215], a[220:223]
    ds_read_b64_tr_b16 v[66:67], v48 offset:36864
    v_sub_f32 v11, v11, v3
    v_cvt_pk_bf16_f32 v204, v10, v11
    v_mfma_f32_16x16x32_bf16 a[216:219], v[76:79], v[208:211], a[216:219]
    s_waitcnt lgkmcnt(8)
    ds_read_b64_tr_b16 v[68:69], v55 offset:32768
    v_lshlrev_b32 v12, 16, v205
    v_mfma_f32_16x16x32_bf16 a[168:171], v[80:83], v[208:211], a[168:171]
    ds_read_b64_tr_b16 v[70:71], v55 offset:36864
    v_and_b32 v13, s86, v205
    v_sub_f32 v12, v12, v3
    v_mfma_f32_16x16x32_bf16 a[172:175], v[80:83], v[212:215], a[172:175]
    s_waitcnt lgkmcnt(8)
    ds_read_b64_tr_b16 v[72:73], v49 offset:32768
    v_sub_f32 v13, v13, v3
    v_mfma_f32_16x16x32_bf16 a[228:231], v[84:87], v[212:215], a[228:231]
    ds_read_b64_tr_b16 v[74:75], v49 offset:36864
    v_cvt_pk_bf16_f32 v205, v12, v13
    v_lshlrev_b32 v8, 16, v206
    v_and_b32 v9, s86, v206
    v_mfma_f32_16x16x32_bf16 a[224:227], v[84:87], v[208:211], a[224:227]
    s_waitcnt lgkmcnt(8)
    ds_read_b64_tr_b16 v[76:77], v56 offset:32768
    buffer_load_dwordx4 v251, s[48:51], s68 offen offset:3072 lds
    v_mfma_f32_16x16x32_bf16 a[176:179], v[88:91], v[208:211], a[176:179]
    ds_read_b64_tr_b16 v[78:79], v56 offset:36864
    v_sub_f32 v8, v8, v3
    v_mfma_f32_16x16x32_bf16 a[180:183], v[88:91], v[212:215], a[180:183]
    s_waitcnt lgkmcnt(8)
    ds_read_b64_tr_b16 v[80:81], v50 offset:32768
    v_sub_f32 v9, v9, v3
    v_cvt_pk_bf16_f32 v206, v8, v9
    v_mfma_f32_16x16x32_bf16 a[236:239], v[92:95], v[212:215], a[236:239]
    ds_read_b64_tr_b16 v[82:83], v50 offset:36864
    v_lshlrev_b32 v10, 16, v207
    v_and_b32 v11, s86, v207
    v_sub_f32 v10, v10, v3
    v_sub_f32 v11, v11, v3
    v_cvt_pk_bf16_f32 v207, v10, v11
    v_mfma_f32_16x16x32_bf16 a[232:235], v[92:95], v[208:211], a[232:235]
    s_waitcnt lgkmcnt(8)
    ds_read_b64_tr_b16 v[84:85], v57 offset:32768
    v_mfma_f32_16x16x32_bf16 a[128:131], v[64:67], v[200:203], a[128:131]
    s_add_u32 m0, s67, 65536
    s_add_u32 s69, s78, 917504
    ds_read_b64_tr_b16 v[86:87], v57 offset:36864
    v_mfma_f32_16x16x32_bf16 a[132:135], v[64:67], v[204:207], a[132:135]
    s_waitcnt lgkmcnt(8)
    ds_read_b64_tr_b16 v[88:89], v51 offset:32768
    buffer_load_dwordx4 v248, s[52:55], s69 offen offset:0 lds
    v_mfma_f32_16x16x32_bf16 a[188:191], v[68:71], v[204:207], a[188:191]
    ds_read_b64_tr_b16 v[90:91], v51 offset:36864
    v_lshlrev_b32 v8, 16, v192
    v_mfma_f32_16x16x32_bf16 a[184:187], v[68:71], v[200:203], a[184:187]
    s_waitcnt lgkmcnt(8)
    ds_read_b64_tr_b16 v[92:93], v58 offset:32768
    v_and_b32 v9, s86, v192
    v_mfma_f32_16x16x32_bf16 a[136:139], v[72:75], v[200:203], a[136:139]
    ds_read_b64_tr_b16 v[94:95], v58 offset:36864
    v_sub_f32 v8, v8, v2
    v_mfma_f32_16x16x32_bf16 a[140:143], v[72:75], v[204:207], a[140:143]
    s_waitcnt lgkmcnt(8)
    v_sub_f32 v9, v9, v2
    v_cvt_pk_bf16_f32 v192, v8, v9
    v_mfma_f32_16x16x32_bf16 a[196:199], v[76:79], v[204:207], a[196:199]
    v_lshlrev_b32 v10, 16, v193
    v_and_b32 v11, s86, v193
    v_mfma_f32_16x16x32_bf16 a[192:195], v[76:79], v[200:203], a[192:195]
    s_waitcnt lgkmcnt(6)
    ds_read_b64_tr_b16 v[64:65], v52 offset:32768
    buffer_load_dwordx4 v249, s[52:55], s69 offen offset:1024 lds
    v_mfma_f32_16x16x32_bf16 a[144:147], v[80:83], v[200:203], a[144:147]
    ds_read_b64_tr_b16 v[66:67], v52 offset:36864
    v_sub_f32 v10, v10, v2
    v_mfma_f32_16x16x32_bf16 a[148:151], v[80:83], v[204:207], a[148:151]
    s_waitcnt lgkmcnt(6)
    ds_read_b64_tr_b16 v[68:69], v59 offset:32768
    v_sub_f32 v11, v11, v2
    v_mfma_f32_16x16x32_bf16 a[204:207], v[84:87], v[204:207], a[204:207]
    ds_read_b64_tr_b16 v[70:71], v59 offset:36864
    v_cvt_pk_bf16_f32 v193, v10, v11
    v_mfma_f32_16x16x32_bf16 a[200:203], v[84:87], v[200:203], a[200:203]
    s_waitcnt lgkmcnt(6)
    ds_read_b64_tr_b16 v[72:73], v53 offset:32768
    v_lshlrev_b32 v12, 16, v194
    v_and_b32 v13, s86, v194
    v_mfma_f32_16x16x32_bf16 a[152:155], v[88:91], v[200:203], a[152:155]
    ds_read_b64_tr_b16 v[74:75], v53 offset:36864
    v_sub_f32 v12, v12, v2
    v_sub_f32 v13, v13, v2
    v_cvt_pk_bf16_f32 v194, v12, v13
    v_mfma_f32_16x16x32_bf16 a[156:159], v[88:91], v[204:207], a[156:159]
    s_waitcnt lgkmcnt(6)
    ds_read_b64_tr_b16 v[76:77], v60 offset:32768
    buffer_load_dwordx4 v250, s[52:55], s69 offen offset:2048 lds
    v_mfma_f32_16x16x32_bf16 a[212:215], v[92:95], v[204:207], a[212:215]
    ds_read_b64_tr_b16 v[78:79], v60 offset:36864
    v_lshlrev_b32 v8, 16, v195
    v_mfma_f32_16x16x32_bf16 a[208:211], v[92:95], v[200:203], a[208:211]
    ds_read_b64_tr_b16 v[80:81], v54 offset:32768
    v_and_b32 v9, s86, v195
    v_sub_f32 v8, v8, v2
    v_mfma_f32_16x16x32_bf16 v[24:27], v[200:203], v[200:203], v[24:27]
    ds_read_b64_tr_b16 v[82:83], v54 offset:36864
    v_sub_f32 v9, v9, v2
    v_mfma_f32_16x16x32_bf16 v[28:31], v[204:207], v[204:207], v[28:31]
    s_waitcnt lgkmcnt(8)
    ds_read_b64_tr_b16 v[84:85], v61 offset:32768
    v_cvt_pk_bf16_f32 v195, v8, v9
    v_mfma_f32_16x16x32_bf16 a[164:167], v[64:67], v[204:207], a[164:167]
    ds_read_b64_tr_b16 v[86:87], v61 offset:36864
    v_lshlrev_b32 v10, 16, v196
    v_and_b32 v11, s86, v196
    v_sub_f32 v10, v10, v3
    v_mfma_f32_16x16x32_bf16 a[160:163], v[64:67], v[200:203], a[160:163]
    s_waitcnt lgkmcnt(8)
    ds_read_b64_tr_b16 v[88:89], v48 offset:40960
    buffer_load_dwordx4 v251, s[52:55], s69 offen offset:3072 lds
    v_mfma_f32_16x16x32_bf16 a[216:219], v[68:71], v[200:203], a[216:219]
    ds_read_b64_tr_b16 v[90:91], v48 offset:45056
    v_sub_f32 v11, v11, v3
    v_cvt_pk_bf16_f32 v196, v10, v11
    v_mfma_f32_16x16x32_bf16 a[220:223], v[68:71], v[204:207], a[220:223]
    s_waitcnt lgkmcnt(8)
    ds_read_b64_tr_b16 v[92:93], v55 offset:40960
    v_lshlrev_b32 v12, 16, v197
    v_mfma_f32_16x16x32_bf16 a[172:175], v[72:75], v[204:207], a[172:175]
    ds_read_b64_tr_b16 v[94:95], v55 offset:45056
    v_and_b32 v13, s86, v197
    v_sub_f32 v12, v12, v3
    v_mfma_f32_16x16x32_bf16 a[168:171], v[72:75], v[200:203], a[168:171]
    s_waitcnt lgkmcnt(8)
    ds_read_b64_tr_b16 v[64:65], v49 offset:40960
    v_sub_f32 v13, v13, v3
    v_mfma_f32_16x16x32_bf16 a[224:227], v[76:79], v[200:203], a[224:227]
    ds_read_b64_tr_b16 v[66:67], v49 offset:45056
    v_cvt_pk_bf16_f32 v197, v12, v13
    v_mfma_f32_16x16x32_bf16 a[228:231], v[76:79], v[204:207], a[228:231]
    s_waitcnt lgkmcnt(8)
    ds_read_b64_tr_b16 v[68:69], v56 offset:40960
    v_lshlrev_b32 v8, 16, v198
    v_and_b32 v9, s86, v198
    v_mfma_f32_16x16x32_bf16 a[180:183], v[80:83], v[204:207], a[180:183]
    ds_read_b64_tr_b16 v[70:71], v56 offset:45056
    v_sub_f32 v8, v8, v3
    v_mfma_f32_16x16x32_bf16 a[176:179], v[80:83], v[200:203], a[176:179]
    s_waitcnt lgkmcnt(8)
    ds_read_b64_tr_b16 v[72:73], v50 offset:40960
    v_sub_f32 v9, v9, v3
    v_cvt_pk_bf16_f32 v198, v8, v9
    v_mfma_f32_16x16x32_bf16 a[232:235], v[84:87], v[200:203], a[232:235]
    ds_read_b64_tr_b16 v[74:75], v50 offset:45056
    v_lshlrev_b32 v10, 16, v199
    v_and_b32 v11, s86, v199
    v_sub_f32 v10, v10, v3
    v_sub_f32 v11, v11, v3
    v_cvt_pk_bf16_f32 v199, v10, v11
    v_mfma_f32_16x16x32_bf16 a[236:239], v[84:87], v[204:207], a[236:239]
    s_waitcnt lgkmcnt(8)
    ds_read_b64_tr_b16 v[76:77], v57 offset:40960
    v_mfma_f32_16x16x32_bf16 a[132:135], v[88:91], v[196:199], a[132:135]
    ds_read_b64_tr_b16 v[78:79], v57 offset:45056
    v_lshlrev_b32 v8, 16, v184
    v_mfma_f32_16x16x32_bf16 a[128:131], v[88:91], v[192:195], a[128:131]
    s_waitcnt lgkmcnt(8)
    ds_read_b64_tr_b16 v[80:81], v51 offset:40960
    v_and_b32 v9, s86, v184
    v_mfma_f32_16x16x32_bf16 a[184:187], v[92:95], v[192:195], a[184:187]
    ds_read_b64_tr_b16 v[82:83], v51 offset:45056
    v_sub_f32 v8, v8, v2
    v_mfma_f32_16x16x32_bf16 a[188:191], v[92:95], v[196:199], a[188:191]
    s_waitcnt lgkmcnt(8)
    ds_read_b64_tr_b16 v[84:85], v58 offset:40960
    v_sub_f32 v9, v9, v2
    v_mfma_f32_16x16x32_bf16 a[140:143], v[64:67], v[196:199], a[140:143]
    s_waitcnt vmcnt(8)
    s_barrier
    ds_read_b64_tr_b16 v[86:87], v58 offset:45056
    v_mfma_f32_16x16x32_bf16 a[136:139], v[64:67], v[192:195], a[136:139]
    s_waitcnt lgkmcnt(8)
    v_cvt_pk_bf16_f32 v184, v8, v9
    v_lshlrev_b32 v10, 16, v185
    v_mfma_f32_16x16x32_bf16 a[192:195], v[68:71], v[192:195], a[192:195]
    s_add_u32 m0, s67, 16384
    s_add_u32 s68, s78, 1146880
    v_and_b32 v11, s86, v185
    v_mfma_f32_16x16x32_bf16 a[196:199], v[68:71], v[196:199], a[196:199]
    s_waitcnt lgkmcnt(6)
    ds_read_b64_tr_b16 v[88:89], v52 offset:40960
    buffer_load_dwordx4 v248, s[48:51], s68 offen offset:0 lds
    v_mfma_f32_16x16x32_bf16 a[148:151], v[72:75], v[196:199], a[148:151]
    ds_read_b64_tr_b16 v[90:91], v52 offset:45056
    v_sub_f32 v10, v10, v2
    v_mfma_f32_16x16x32_bf16 a[144:147], v[72:75], v[192:195], a[144:147]
    s_waitcnt lgkmcnt(6)
    ds_read_b64_tr_b16 v[92:93], v59 offset:40960
    v_sub_f32 v11, v11, v2
    v_mfma_f32_16x16x32_bf16 a[200:203], v[76:79], v[192:195], a[200:203]
    ds_read_b64_tr_b16 v[94:95], v59 offset:45056
    v_cvt_pk_bf16_f32 v185, v10, v11
    v_mfma_f32_16x16x32_bf16 a[204:207], v[76:79], v[196:199], a[204:207]
    s_waitcnt lgkmcnt(6)
    ds_read_b64_tr_b16 v[64:65], v53 offset:40960
    v_lshlrev_b32 v12, 16, v186
    v_and_b32 v13, s86, v186
    v_mfma_f32_16x16x32_bf16 a[156:159], v[80:83], v[196:199], a[156:159]
    ds_read_b64_tr_b16 v[66:67], v53 offset:45056
    v_sub_f32 v12, v12, v2
    v_sub_f32 v13, v13, v2
    v_cvt_pk_bf16_f32 v186, v12, v13
    v_mfma_f32_16x16x32_bf16 a[152:155], v[80:83], v[192:195], a[152:155]
    s_waitcnt lgkmcnt(6)
    ds_read_b64_tr_b16 v[68:69], v60 offset:40960
    buffer_load_dwordx4 v249, s[48:51], s68 offen offset:1024 lds
    v_mfma_f32_16x16x32_bf16 a[208:211], v[84:87], v[192:195], a[208:211]
    ds_read_b64_tr_b16 v[70:71], v60 offset:45056
    v_lshlrev_b32 v8, 16, v187
    v_mfma_f32_16x16x32_bf16 a[212:215], v[84:87], v[196:199], a[212:215]
    ds_read_b64_tr_b16 v[72:73], v54 offset:40960
    v_and_b32 v9, s86, v187
    v_sub_f32 v8, v8, v2
    v_mfma_f32_16x16x32_bf16 v[24:27], v[192:195], v[192:195], v[24:27]
    ds_read_b64_tr_b16 v[74:75], v54 offset:45056
    v_sub_f32 v9, v9, v2
    v_mfma_f32_16x16x32_bf16 v[28:31], v[196:199], v[196:199], v[28:31]
    s_waitcnt lgkmcnt(8)
    ds_read_b64_tr_b16 v[76:77], v61 offset:40960
    v_cvt_pk_bf16_f32 v187, v8, v9
    v_mfma_f32_16x16x32_bf16 a[160:163], v[88:91], v[192:195], a[160:163]
    ds_read_b64_tr_b16 v[78:79], v61 offset:45056
    v_lshlrev_b32 v10, 16, v188
    v_and_b32 v11, s86, v188
    v_sub_f32 v10, v10, v3
    v_mfma_f32_16x16x32_bf16 a[164:167], v[88:91], v[196:199], a[164:167]
    s_waitcnt lgkmcnt(8)
    ds_read_b64_tr_b16 v[80:81], v48 offset:49152
    buffer_load_dwordx4 v250, s[48:51], s68 offen offset:2048 lds
    v_mfma_f32_16x16x32_bf16 a[220:223], v[92:95], v[196:199], a[220:223]
    ds_read_b64_tr_b16 v[82:83], v48 offset:53248
    v_sub_f32 v11, v11, v3
    v_cvt_pk_bf16_f32 v188, v10, v11
    v_mfma_f32_16x16x32_bf16 a[216:219], v[92:95], v[192:195], a[216:219]
    s_waitcnt lgkmcnt(8)
    ds_read_b64_tr_b16 v[84:85], v55 offset:49152
    v_lshlrev_b32 v12, 16, v189
    v_mfma_f32_16x16x32_bf16 a[168:171], v[64:67], v[192:195], a[168:171]
    ds_read_b64_tr_b16 v[86:87], v55 offset:53248
    v_and_b32 v13, s86, v189
    v_sub_f32 v12, v12, v3
    v_mfma_f32_16x16x32_bf16 a[172:175], v[64:67], v[196:199], a[172:175]
    s_waitcnt lgkmcnt(8)
    ds_read_b64_tr_b16 v[88:89], v49 offset:49152
    v_sub_f32 v13, v13, v3
    v_mfma_f32_16x16x32_bf16 a[228:231], v[68:71], v[196:199], a[228:231]
    ds_read_b64_tr_b16 v[90:91], v49 offset:53248
    v_cvt_pk_bf16_f32 v189, v12, v13
    v_lshlrev_b32 v8, 16, v190
    v_and_b32 v9, s86, v190
    v_mfma_f32_16x16x32_bf16 a[224:227], v[68:71], v[192:195], a[224:227]
    s_waitcnt lgkmcnt(8)
    ds_read_b64_tr_b16 v[92:93], v56 offset:49152
    buffer_load_dwordx4 v251, s[48:51], s68 offen offset:3072 lds
    v_mfma_f32_16x16x32_bf16 a[176:179], v[72:75], v[192:195], a[176:179]
    ds_read_b64_tr_b16 v[94:95], v56 offset:53248
    v_sub_f32 v8, v8, v3
    v_mfma_f32_16x16x32_bf16 a[180:183], v[72:75], v[196:199], a[180:183]
    s_waitcnt lgkmcnt(8)
    ds_read_b64_tr_b16 v[64:65], v50 offset:49152
    v_sub_f32 v9, v9, v3
    v_cvt_pk_bf16_f32 v190, v8, v9
    v_mfma_f32_16x16x32_bf16 a[236:239], v[76:79], v[196:199], a[236:239]
    ds_read_b64_tr_b16 v[66:67], v50 offset:53248
    v_lshlrev_b32 v10, 16, v191
    v_and_b32 v11, s86, v191
    v_sub_f32 v10, v10, v3
    v_sub_f32 v11, v11, v3
    v_cvt_pk_bf16_f32 v191, v10, v11
    v_mfma_f32_16x16x32_bf16 a[232:235], v[76:79], v[192:195], a[232:235]
    s_waitcnt lgkmcnt(8)
    ds_read_b64_tr_b16 v[68:69], v57 offset:49152
    v_mfma_f32_16x16x32_bf16 a[128:131], v[80:83], v[184:187], a[128:131]
    s_add_u32 m0, s67, 81920
    s_add_u32 s69, s78, 1146880
    ds_read_b64_tr_b16 v[70:71], v57 offset:53248
    v_mfma_f32_16x16x32_bf16 a[132:135], v[80:83], v[188:191], a[132:135]
    s_waitcnt lgkmcnt(8)
    ds_read_b64_tr_b16 v[72:73], v51 offset:49152
    buffer_load_dwordx4 v248, s[52:55], s69 offen offset:0 lds
    v_mfma_f32_16x16x32_bf16 a[188:191], v[84:87], v[188:191], a[188:191]
    ds_read_b64_tr_b16 v[74:75], v51 offset:53248
    v_lshlrev_b32 v8, 16, v176
    v_mfma_f32_16x16x32_bf16 a[184:187], v[84:87], v[184:187], a[184:187]
    s_waitcnt lgkmcnt(8)
    ds_read_b64_tr_b16 v[76:77], v58 offset:49152
    v_and_b32 v9, s86, v176
    v_mfma_f32_16x16x32_bf16 a[136:139], v[88:91], v[184:187], a[136:139]
    ds_read_b64_tr_b16 v[78:79], v58 offset:53248
    v_sub_f32 v8, v8, v2
    v_mfma_f32_16x16x32_bf16 a[140:143], v[88:91], v[188:191], a[140:143]
    s_waitcnt lgkmcnt(8)
    v_sub_f32 v9, v9, v2
    v_cvt_pk_bf16_f32 v176, v8, v9
    v_mfma_f32_16x16x32_bf16 a[196:199], v[92:95], v[188:191], a[196:199]
    v_lshlrev_b32 v10, 16, v177
    v_and_b32 v11, s86, v177
    v_mfma_f32_16x16x32_bf16 a[192:195], v[92:95], v[184:187], a[192:195]
    s_waitcnt lgkmcnt(6)
    ds_read_b64_tr_b16 v[80:81], v52 offset:49152
    buffer_load_dwordx4 v249, s[52:55], s69 offen offset:1024 lds
    v_mfma_f32_16x16x32_bf16 a[144:147], v[64:67], v[184:187], a[144:147]
    ds_read_b64_tr_b16 v[82:83], v52 offset:53248
    v_sub_f32 v10, v10, v2
    v_mfma_f32_16x16x32_bf16 a[148:151], v[64:67], v[188:191], a[148:151]
    s_waitcnt lgkmcnt(6)
    ds_read_b64_tr_b16 v[84:85], v59 offset:49152
    v_sub_f32 v11, v11, v2
    v_mfma_f32_16x16x32_bf16 a[204:207], v[68:71], v[188:191], a[204:207]
    ds_read_b64_tr_b16 v[86:87], v59 offset:53248
    v_cvt_pk_bf16_f32 v177, v10, v11
    v_mfma_f32_16x16x32_bf16 a[200:203], v[68:71], v[184:187], a[200:203]
    s_waitcnt lgkmcnt(6)
    ds_read_b64_tr_b16 v[88:89], v53 offset:49152
    v_lshlrev_b32 v12, 16, v178
    v_and_b32 v13, s86, v178
    v_mfma_f32_16x16x32_bf16 a[152:155], v[72:75], v[184:187], a[152:155]
    ds_read_b64_tr_b16 v[90:91], v53 offset:53248
    v_sub_f32 v12, v12, v2
    v_sub_f32 v13, v13, v2
    v_cvt_pk_bf16_f32 v178, v12, v13
    v_mfma_f32_16x16x32_bf16 a[156:159], v[72:75], v[188:191], a[156:159]
    s_waitcnt lgkmcnt(6)
    ds_read_b64_tr_b16 v[92:93], v60 offset:49152
    buffer_load_dwordx4 v250, s[52:55], s69 offen offset:2048 lds
    v_mfma_f32_16x16x32_bf16 a[212:215], v[76:79], v[188:191], a[212:215]
    ds_read_b64_tr_b16 v[94:95], v60 offset:53248
    v_lshlrev_b32 v8, 16, v179
    v_mfma_f32_16x16x32_bf16 a[208:211], v[76:79], v[184:187], a[208:211]
    ds_read_b64_tr_b16 v[64:65], v54 offset:49152
    v_and_b32 v9, s86, v179
    v_sub_f32 v8, v8, v2
    v_mfma_f32_16x16x32_bf16 v[24:27], v[184:187], v[184:187], v[24:27]
    ds_read_b64_tr_b16 v[66:67], v54 offset:53248
    v_sub_f32 v9, v9, v2
    v_mfma_f32_16x16x32_bf16 v[28:31], v[188:191], v[188:191], v[28:31]
    s_waitcnt lgkmcnt(8)
    ds_read_b64_tr_b16 v[68:69], v61 offset:49152
    v_cvt_pk_bf16_f32 v179, v8, v9
    v_mfma_f32_16x16x32_bf16 a[164:167], v[80:83], v[188:191], a[164:167]
    ds_read_b64_tr_b16 v[70:71], v61 offset:53248
    v_lshlrev_b32 v10, 16, v180
    v_and_b32 v11, s86, v180
    v_sub_f32 v10, v10, v3
    v_mfma_f32_16x16x32_bf16 a[160:163], v[80:83], v[184:187], a[160:163]
    s_waitcnt lgkmcnt(8)
    ds_read_b64_tr_b16 v[72:73], v48 offset:57344
    buffer_load_dwordx4 v251, s[52:55], s69 offen offset:3072 lds
    v_mfma_f32_16x16x32_bf16 a[216:219], v[84:87], v[184:187], a[216:219]
    ds_read_b64_tr_b16 v[74:75], v48 offset:61440
    v_sub_f32 v11, v11, v3
    v_cvt_pk_bf16_f32 v180, v10, v11
    v_mfma_f32_16x16x32_bf16 a[220:223], v[84:87], v[188:191], a[220:223]
    s_waitcnt lgkmcnt(8)
    ds_read_b64_tr_b16 v[76:77], v55 offset:57344
    v_lshlrev_b32 v12, 16, v181
    v_mfma_f32_16x16x32_bf16 a[172:175], v[88:91], v[188:191], a[172:175]
    ds_read_b64_tr_b16 v[78:79], v55 offset:61440
    v_and_b32 v13, s86, v181
    v_sub_f32 v12, v12, v3
    v_mfma_f32_16x16x32_bf16 a[168:171], v[88:91], v[184:187], a[168:171]
    s_waitcnt lgkmcnt(8)
    ds_read_b64_tr_b16 v[80:81], v49 offset:57344
    v_sub_f32 v13, v13, v3
    v_mfma_f32_16x16x32_bf16 a[224:227], v[92:95], v[184:187], a[224:227]
    ds_read_b64_tr_b16 v[82:83], v49 offset:61440
    v_cvt_pk_bf16_f32 v181, v12, v13
    v_mfma_f32_16x16x32_bf16 a[228:231], v[92:95], v[188:191], a[228:231]
    s_waitcnt lgkmcnt(8)
    ds_read_b64_tr_b16 v[84:85], v56 offset:57344
    v_lshlrev_b32 v8, 16, v182
    v_and_b32 v9, s86, v182
    v_mfma_f32_16x16x32_bf16 a[180:183], v[64:67], v[188:191], a[180:183]
    ds_read_b64_tr_b16 v[86:87], v56 offset:61440
    v_sub_f32 v8, v8, v3
    v_mfma_f32_16x16x32_bf16 a[176:179], v[64:67], v[184:187], a[176:179]
    s_waitcnt lgkmcnt(8)
    ds_read_b64_tr_b16 v[88:89], v50 offset:57344
    v_sub_f32 v9, v9, v3
    v_cvt_pk_bf16_f32 v182, v8, v9
    v_mfma_f32_16x16x32_bf16 a[232:235], v[68:71], v[184:187], a[232:235]
    ds_read_b64_tr_b16 v[90:91], v50 offset:61440
    v_lshlrev_b32 v10, 16, v183
    v_and_b32 v11, s86, v183
    v_sub_f32 v10, v10, v3
    v_sub_f32 v11, v11, v3
    v_cvt_pk_bf16_f32 v183, v10, v11
    v_mfma_f32_16x16x32_bf16 a[236:239], v[68:71], v[188:191], a[236:239]
    s_waitcnt lgkmcnt(8)
    ds_read_b64_tr_b16 v[92:93], v57 offset:57344
    v_mfma_f32_16x16x32_bf16 a[132:135], v[72:75], v[180:183], a[132:135]
    ds_read_b64_tr_b16 v[94:95], v57 offset:61440
    v_lshlrev_b32 v8, 16, v168
    v_mfma_f32_16x16x32_bf16 a[128:131], v[72:75], v[176:179], a[128:131]
    s_waitcnt lgkmcnt(8)
    ds_read_b64_tr_b16 v[64:65], v51 offset:57344
    v_and_b32 v9, s86, v168
    v_mfma_f32_16x16x32_bf16 a[184:187], v[76:79], v[176:179], a[184:187]
    ds_read_b64_tr_b16 v[66:67], v51 offset:61440
    v_sub_f32 v8, v8, v2
    v_mfma_f32_16x16x32_bf16 a[188:191], v[76:79], v[180:183], a[188:191]
    s_waitcnt lgkmcnt(8)
    ds_read_b64_tr_b16 v[68:69], v58 offset:57344
    v_sub_f32 v9, v9, v2
    v_mfma_f32_16x16x32_bf16 a[140:143], v[80:83], v[180:183], a[140:143]
    s_waitcnt vmcnt(8)
    s_barrier
    ds_read_b64_tr_b16 v[70:71], v58 offset:61440
    v_mfma_f32_16x16x32_bf16 a[136:139], v[80:83], v[176:179], a[136:139]
    s_waitcnt lgkmcnt(8)
    v_cvt_pk_bf16_f32 v168, v8, v9
    v_lshlrev_b32 v10, 16, v169
    v_mfma_f32_16x16x32_bf16 a[192:195], v[84:87], v[176:179], a[192:195]
    s_add_u32 m0, s67, 32768
    s_add_u32 s68, s78, 1376256
    v_and_b32 v11, s86, v169
    v_mfma_f32_16x16x32_bf16 a[196:199], v[84:87], v[180:183], a[196:199]
    s_waitcnt lgkmcnt(6)
    ds_read_b64_tr_b16 v[72:73], v52 offset:57344
    buffer_load_dwordx4 v248, s[48:51], s68 offen offset:0 lds
    v_mfma_f32_16x16x32_bf16 a[148:151], v[88:91], v[180:183], a[148:151]
    ds_read_b64_tr_b16 v[74:75], v52 offset:61440
    v_sub_f32 v10, v10, v2
    v_mfma_f32_16x16x32_bf16 a[144:147], v[88:91], v[176:179], a[144:147]
    s_waitcnt lgkmcnt(6)
    ds_read_b64_tr_b16 v[76:77], v59 offset:57344
    v_sub_f32 v11, v11, v2
    v_mfma_f32_16x16x32_bf16 a[200:203], v[92:95], v[176:179], a[200:203]
    ds_read_b64_tr_b16 v[78:79], v59 offset:61440
    v_cvt_pk_bf16_f32 v169, v10, v11
    v_mfma_f32_16x16x32_bf16 a[204:207], v[92:95], v[180:183], a[204:207]
    s_waitcnt lgkmcnt(6)
    ds_read_b64_tr_b16 v[80:81], v53 offset:57344
    v_lshlrev_b32 v12, 16, v170
    v_and_b32 v13, s86, v170
    v_mfma_f32_16x16x32_bf16 a[156:159], v[64:67], v[180:183], a[156:159]
    ds_read_b64_tr_b16 v[82:83], v53 offset:61440
    v_sub_f32 v12, v12, v2
    v_sub_f32 v13, v13, v2
    v_cvt_pk_bf16_f32 v170, v12, v13
    v_mfma_f32_16x16x32_bf16 a[152:155], v[64:67], v[176:179], a[152:155]
    s_waitcnt lgkmcnt(6)
    ds_read_b64_tr_b16 v[84:85], v60 offset:57344
    buffer_load_dwordx4 v249, s[48:51], s68 offen offset:1024 lds
    v_mfma_f32_16x16x32_bf16 a[208:211], v[68:71], v[176:179], a[208:211]
    ds_read_b64_tr_b16 v[86:87], v60 offset:61440
    v_lshlrev_b32 v8, 16, v171
    v_mfma_f32_16x16x32_bf16 a[212:215], v[68:71], v[180:183], a[212:215]
    ds_read_b64_tr_b16 v[88:89], v54 offset:57344
    v_and_b32 v9, s86, v171
    v_sub_f32 v8, v8, v2
    v_mfma_f32_16x16x32_bf16 v[24:27], v[176:179], v[176:179], v[24:27]
    ds_read_b64_tr_b16 v[90:91], v54 offset:61440
    v_sub_f32 v9, v9, v2
    v_mfma_f32_16x16x32_bf16 v[28:31], v[180:183], v[180:183], v[28:31]
    s_waitcnt lgkmcnt(8)
    ds_read_b64_tr_b16 v[92:93], v61 offset:57344
    v_cvt_pk_bf16_f32 v171, v8, v9
    v_mfma_f32_16x16x32_bf16 a[160:163], v[72:75], v[176:179], a[160:163]
    ds_read_b64_tr_b16 v[94:95], v61 offset:61440
    v_lshlrev_b32 v10, 16, v172
    v_and_b32 v11, s86, v172
    v_sub_f32 v10, v10, v3
    v_mfma_f32_16x16x32_bf16 a[164:167], v[72:75], v[180:183], a[164:167]
    s_waitcnt lgkmcnt(8)
    ds_read_b64_tr_b16 v[64:65], v48 offset:0
    buffer_load_dwordx4 v250, s[48:51], s68 offen offset:2048 lds
    v_mfma_f32_16x16x32_bf16 a[220:223], v[76:79], v[180:183], a[220:223]
    ds_read_b64_tr_b16 v[66:67], v48 offset:4096
    v_sub_f32 v11, v11, v3
    v_cvt_pk_bf16_f32 v172, v10, v11
    v_mfma_f32_16x16x32_bf16 a[216:219], v[76:79], v[176:179], a[216:219]
    s_waitcnt lgkmcnt(8)
    ds_read_b64_tr_b16 v[68:69], v55 offset:0
    v_lshlrev_b32 v12, 16, v173
    v_mfma_f32_16x16x32_bf16 a[168:171], v[80:83], v[176:179], a[168:171]
    ds_read_b64_tr_b16 v[70:71], v55 offset:4096
    v_and_b32 v13, s86, v173
    v_sub_f32 v12, v12, v3
    v_mfma_f32_16x16x32_bf16 a[172:175], v[80:83], v[180:183], a[172:175]
    s_waitcnt lgkmcnt(8)
    ds_read_b64_tr_b16 v[72:73], v49 offset:0
    v_sub_f32 v13, v13, v3
    v_mfma_f32_16x16x32_bf16 a[228:231], v[84:87], v[180:183], a[228:231]
    ds_read_b64_tr_b16 v[74:75], v49 offset:4096
    v_cvt_pk_bf16_f32 v173, v12, v13
    v_lshlrev_b32 v8, 16, v174
    v_and_b32 v9, s86, v174
    v_mfma_f32_16x16x32_bf16 a[224:227], v[84:87], v[176:179], a[224:227]
    s_waitcnt lgkmcnt(8)
    ds_read_b64_tr_b16 v[76:77], v56 offset:0
    buffer_load_dwordx4 v251, s[48:51], s68 offen offset:3072 lds
    v_mfma_f32_16x16x32_bf16 a[176:179], v[88:91], v[176:179], a[176:179]
    ds_read_b64_tr_b16 v[78:79], v56 offset:4096
    v_sub_f32 v8, v8, v3
    v_mfma_f32_16x16x32_bf16 a[180:183], v[88:91], v[180:183], a[180:183]
    s_waitcnt lgkmcnt(8)
    ds_read_b64_tr_b16 v[80:81], v50 offset:0
    v_sub_f32 v9, v9, v3
    v_cvt_pk_bf16_f32 v174, v8, v9
    v_mfma_f32_16x16x32_bf16 a[236:239], v[92:95], v[180:183], a[236:239]
    ds_read_b64_tr_b16 v[82:83], v50 offset:4096
    v_lshlrev_b32 v10, 16, v175
    v_and_b32 v11, s86, v175
    v_sub_f32 v10, v10, v3
    v_sub_f32 v11, v11, v3
    v_cvt_pk_bf16_f32 v175, v10, v11
    v_mfma_f32_16x16x32_bf16 a[232:235], v[92:95], v[176:179], a[232:235]
    s_waitcnt lgkmcnt(8)
    ds_read_b64_tr_b16 v[84:85], v57 offset:0
    v_mfma_f32_16x16x32_bf16 a[128:131], v[64:67], v[168:171], a[128:131]
    s_add_u32 m0, s67, 98304
    s_add_u32 s69, s78, 1376256
    ds_read_b64_tr_b16 v[86:87], v57 offset:4096
    v_mfma_f32_16x16x32_bf16 a[132:135], v[64:67], v[172:175], a[132:135]
    s_waitcnt lgkmcnt(8)
    ds_read_b64_tr_b16 v[88:89], v51 offset:0
    buffer_load_dwordx4 v248, s[52:55], s69 offen offset:0 lds
    v_mfma_f32_16x16x32_bf16 a[188:191], v[68:71], v[172:175], a[188:191]
    ds_read_b64_tr_b16 v[90:91], v51 offset:4096
    v_lshlrev_b32 v8, 16, v160
    v_mfma_f32_16x16x32_bf16 a[184:187], v[68:71], v[168:171], a[184:187]
    s_waitcnt lgkmcnt(8)
    ds_read_b64_tr_b16 v[92:93], v58 offset:0
    v_and_b32 v9, s86, v160
    v_mfma_f32_16x16x32_bf16 a[136:139], v[72:75], v[168:171], a[136:139]
    ds_read_b64_tr_b16 v[94:95], v58 offset:4096
    v_sub_f32 v8, v8, v2
    v_mfma_f32_16x16x32_bf16 a[140:143], v[72:75], v[172:175], a[140:143]
    s_waitcnt lgkmcnt(8)
    v_sub_f32 v9, v9, v2
    v_cvt_pk_bf16_f32 v160, v8, v9
    v_mfma_f32_16x16x32_bf16 a[196:199], v[76:79], v[172:175], a[196:199]
    v_lshlrev_b32 v10, 16, v161
    v_and_b32 v11, s86, v161
    v_mfma_f32_16x16x32_bf16 a[192:195], v[76:79], v[168:171], a[192:195]
    s_waitcnt lgkmcnt(6)
    ds_read_b64_tr_b16 v[64:65], v52 offset:0
    buffer_load_dwordx4 v249, s[52:55], s69 offen offset:1024 lds
    v_mfma_f32_16x16x32_bf16 a[144:147], v[80:83], v[168:171], a[144:147]
    ds_read_b64_tr_b16 v[66:67], v52 offset:4096
    v_sub_f32 v10, v10, v2
    v_mfma_f32_16x16x32_bf16 a[148:151], v[80:83], v[172:175], a[148:151]
    s_waitcnt lgkmcnt(6)
    ds_read_b64_tr_b16 v[68:69], v59 offset:0
    v_sub_f32 v11, v11, v2
    v_mfma_f32_16x16x32_bf16 a[204:207], v[84:87], v[172:175], a[204:207]
    ds_read_b64_tr_b16 v[70:71], v59 offset:4096
    v_cvt_pk_bf16_f32 v161, v10, v11
    v_mfma_f32_16x16x32_bf16 a[200:203], v[84:87], v[168:171], a[200:203]
    s_waitcnt lgkmcnt(6)
    ds_read_b64_tr_b16 v[72:73], v53 offset:0
    v_lshlrev_b32 v12, 16, v162
    v_and_b32 v13, s86, v162
    v_mfma_f32_16x16x32_bf16 a[152:155], v[88:91], v[168:171], a[152:155]
    ds_read_b64_tr_b16 v[74:75], v53 offset:4096
    v_sub_f32 v12, v12, v2
    v_sub_f32 v13, v13, v2
    v_cvt_pk_bf16_f32 v162, v12, v13
    v_mfma_f32_16x16x32_bf16 a[156:159], v[88:91], v[172:175], a[156:159]
    s_waitcnt lgkmcnt(6)
    ds_read_b64_tr_b16 v[76:77], v60 offset:0
    buffer_load_dwordx4 v250, s[52:55], s69 offen offset:2048 lds
    v_mfma_f32_16x16x32_bf16 a[212:215], v[92:95], v[172:175], a[212:215]
    ds_read_b64_tr_b16 v[78:79], v60 offset:4096
    v_lshlrev_b32 v8, 16, v163
    v_mfma_f32_16x16x32_bf16 a[208:211], v[92:95], v[168:171], a[208:211]
    ds_read_b64_tr_b16 v[80:81], v54 offset:0
    v_and_b32 v9, s86, v163
    v_sub_f32 v8, v8, v2
    v_mfma_f32_16x16x32_bf16 v[24:27], v[168:171], v[168:171], v[24:27]
    ds_read_b64_tr_b16 v[82:83], v54 offset:4096
    v_sub_f32 v9, v9, v2
    v_mfma_f32_16x16x32_bf16 v[28:31], v[172:175], v[172:175], v[28:31]
    s_waitcnt lgkmcnt(8)
    ds_read_b64_tr_b16 v[84:85], v61 offset:0
    v_cvt_pk_bf16_f32 v163, v8, v9
    v_mfma_f32_16x16x32_bf16 a[164:167], v[64:67], v[172:175], a[164:167]
    ds_read_b64_tr_b16 v[86:87], v61 offset:4096
    v_lshlrev_b32 v10, 16, v164
    v_and_b32 v11, s86, v164
    v_sub_f32 v10, v10, v3
    v_mfma_f32_16x16x32_bf16 a[160:163], v[64:67], v[168:171], a[160:163]
    s_waitcnt lgkmcnt(8)
    ds_read_b64_tr_b16 v[88:89], v48 offset:8192
    buffer_load_dwordx4 v251, s[52:55], s69 offen offset:3072 lds
    v_mfma_f32_16x16x32_bf16 a[216:219], v[68:71], v[168:171], a[216:219]
    ds_read_b64_tr_b16 v[90:91], v48 offset:12288
    v_sub_f32 v11, v11, v3
    v_cvt_pk_bf16_f32 v164, v10, v11
    v_mfma_f32_16x16x32_bf16 a[220:223], v[68:71], v[172:175], a[220:223]
    s_waitcnt lgkmcnt(8)
    ds_read_b64_tr_b16 v[92:93], v55 offset:8192
    v_lshlrev_b32 v12, 16, v165
    v_mfma_f32_16x16x32_bf16 a[172:175], v[72:75], v[172:175], a[172:175]
    ds_read_b64_tr_b16 v[94:95], v55 offset:12288
    v_and_b32 v13, s86, v165
    v_sub_f32 v12, v12, v3
    v_mfma_f32_16x16x32_bf16 a[168:171], v[72:75], v[168:171], a[168:171]
    s_waitcnt lgkmcnt(8)
    ds_read_b64_tr_b16 v[64:65], v49 offset:8192
    v_sub_f32 v13, v13, v3
    v_mfma_f32_16x16x32_bf16 a[224:227], v[76:79], v[168:171], a[224:227]
    ds_read_b64_tr_b16 v[66:67], v49 offset:12288
    v_cvt_pk_bf16_f32 v165, v12, v13
    v_lshlrev_b32 v8, 16, v166
    v_and_b32 v9, s86, v166
    v_mfma_f32_16x16x32_bf16 a[228:231], v[76:79], v[172:175], a[228:231]
    s_waitcnt lgkmcnt(8)
    ds_read_b64_tr_b16 v[68:69], v56 offset:8192
    buffer_load_dword v44, v43, s[12:15], s16 offen
    v_mfma_f32_16x16x32_bf16 a[180:183], v[80:83], v[172:175], a[180:183]
    s_add_u32 s16, s16, 0x40010000
    ds_read_b64_tr_b16 v[70:71], v56 offset:12288
    v_sub_f32 v8, v8, v3
    v_mfma_f32_16x16x32_bf16 a[176:179], v[80:83], v[168:171], a[176:179]
    s_waitcnt lgkmcnt(8)
    ds_read_b64_tr_b16 v[72:73], v50 offset:8192
    v_sub_f32 v9, v9, v3
    v_cvt_pk_bf16_f32 v166, v8, v9
    v_mfma_f32_16x16x32_bf16 a[232:235], v[84:87], v[168:171], a[232:235]
    ds_read_b64_tr_b16 v[74:75], v50 offset:12288
    v_lshlrev_b32 v10, 16, v167
    v_and_b32 v11, s86, v167
    v_sub_f32 v10, v10, v3
    v_sub_f32 v11, v11, v3
    v_cvt_pk_bf16_f32 v167, v10, v11
    v_mfma_f32_16x16x32_bf16 a[236:239], v[84:87], v[172:175], a[236:239]
    s_waitcnt lgkmcnt(8)
    ds_read_b64_tr_b16 v[76:77], v57 offset:8192
    v_mfma_f32_16x16x32_bf16 a[132:135], v[88:91], v[164:167], a[132:135]
    ds_read_b64_tr_b16 v[78:79], v57 offset:12288
    v_lshlrev_b32 v8, 16, v152
    v_mfma_f32_16x16x32_bf16 a[128:131], v[88:91], v[160:163], a[128:131]
    s_waitcnt lgkmcnt(8)
    ds_read_b64_tr_b16 v[80:81], v51 offset:8192
    v_and_b32 v9, s86, v152
    v_mfma_f32_16x16x32_bf16 a[184:187], v[92:95], v[160:163], a[184:187]
    ds_read_b64_tr_b16 v[82:83], v51 offset:12288
    v_sub_f32 v8, v8, v2
    v_mfma_f32_16x16x32_bf16 a[188:191], v[92:95], v[164:167], a[188:191]
    s_waitcnt lgkmcnt(8)
    ds_read_b64_tr_b16 v[84:85], v58 offset:8192
    v_sub_f32 v9, v9, v2
    v_mfma_f32_16x16x32_bf16 a[140:143], v[64:67], v[164:167], a[140:143]
    s_waitcnt vmcnt(9)
    s_barrier
    ds_read_b64_tr_b16 v[86:87], v58 offset:12288
    v_mfma_f32_16x16x32_bf16 a[136:139], v[64:67], v[160:163], a[136:139]
    s_waitcnt lgkmcnt(8)
    v_cvt_pk_bf16_f32 v152, v8, v9
    v_lshlrev_b32 v10, 16, v153
    v_mfma_f32_16x16x32_bf16 a[192:195], v[68:71], v[160:163], a[192:195]
    s_add_u32 m0, s67, 49152
    s_add_u32 s68, s79, 0
    v_and_b32 v11, s86, v153
    v_mfma_f32_16x16x32_bf16 a[196:199], v[68:71], v[164:167], a[196:199]
    s_waitcnt lgkmcnt(6)
    ds_read_b64_tr_b16 v[88:89], v52 offset:8192
    buffer_load_dwordx4 v252, s[40:43], s68 offen offset:0 lds
    v_mfma_f32_16x16x32_bf16 a[148:151], v[72:75], v[164:167], a[148:151]
    ds_read_b64_tr_b16 v[90:91], v52 offset:12288
    v_sub_f32 v10, v10, v2
    v_mfma_f32_16x16x32_bf16 a[144:147], v[72:75], v[160:163], a[144:147]
    s_waitcnt lgkmcnt(6)
    ds_read_b64_tr_b16 v[92:93], v59 offset:8192
    v_sub_f32 v11, v11, v2
    v_mfma_f32_16x16x32_bf16 a[200:203], v[76:79], v[160:163], a[200:203]
    ds_read_b64_tr_b16 v[94:95], v59 offset:12288
    v_cvt_pk_bf16_f32 v153, v10, v11
    v_mfma_f32_16x16x32_bf16 a[204:207], v[76:79], v[164:167], a[204:207]
    s_waitcnt lgkmcnt(6)
    ds_read_b64_tr_b16 v[64:65], v53 offset:8192
    v_lshlrev_b32 v12, 16, v154
    v_and_b32 v13, s86, v154
    v_mfma_f32_16x16x32_bf16 a[156:159], v[80:83], v[164:167], a[156:159]
    ds_read_b64_tr_b16 v[66:67], v53 offset:12288
    v_sub_f32 v12, v12, v2
    v_sub_f32 v13, v13, v2
    v_cvt_pk_bf16_f32 v154, v12, v13
    v_mfma_f32_16x16x32_bf16 a[152:155], v[80:83], v[160:163], a[152:155]
    s_waitcnt lgkmcnt(6)
    ds_read_b64_tr_b16 v[68:69], v60 offset:8192
    buffer_load_dwordx4 v253, s[40:43], s68 offen offset:1024 lds
    v_mfma_f32_16x16x32_bf16 a[208:211], v[84:87], v[160:163], a[208:211]
    ds_read_b64_tr_b16 v[70:71], v60 offset:12288
    v_lshlrev_b32 v8, 16, v155
    v_mfma_f32_16x16x32_bf16 a[212:215], v[84:87], v[164:167], a[212:215]
    ds_read_b64_tr_b16 v[72:73], v54 offset:8192
    v_and_b32 v9, s86, v155
    v_sub_f32 v8, v8, v2
    v_mfma_f32_16x16x32_bf16 v[24:27], v[160:163], v[160:163], v[24:27]
    ds_read_b64_tr_b16 v[74:75], v54 offset:12288
    v_sub_f32 v9, v9, v2
    v_mfma_f32_16x16x32_bf16 v[28:31], v[164:167], v[164:167], v[28:31]
    s_waitcnt lgkmcnt(8)
    ds_read_b64_tr_b16 v[76:77], v61 offset:8192
    v_cvt_pk_bf16_f32 v155, v8, v9
    v_mfma_f32_16x16x32_bf16 a[160:163], v[88:91], v[160:163], a[160:163]
    ds_read_b64_tr_b16 v[78:79], v61 offset:12288
    v_lshlrev_b32 v10, 16, v156
    v_and_b32 v11, s86, v156
    v_sub_f32 v10, v10, v3
    v_mfma_f32_16x16x32_bf16 a[164:167], v[88:91], v[164:167], a[164:167]
    s_waitcnt lgkmcnt(8)
    ds_read_b64_tr_b16 v[80:81], v48 offset:16384
    buffer_load_dwordx4 v254, s[40:43], s68 offen offset:2048 lds
    v_mfma_f32_16x16x32_bf16 a[220:223], v[92:95], v[164:167], a[220:223]
    ds_read_b64_tr_b16 v[82:83], v48 offset:20480
    v_sub_f32 v11, v11, v3
    v_cvt_pk_bf16_f32 v156, v10, v11
    v_mfma_f32_16x16x32_bf16 a[216:219], v[92:95], v[160:163], a[216:219]
    s_waitcnt lgkmcnt(8)
    ds_read_b64_tr_b16 v[84:85], v55 offset:16384
    v_lshlrev_b32 v12, 16, v157
    v_mfma_f32_16x16x32_bf16 a[168:171], v[64:67], v[160:163], a[168:171]
    ds_read_b64_tr_b16 v[86:87], v55 offset:20480
    v_and_b32 v13, s86, v157
    v_sub_f32 v12, v12, v3
    v_mfma_f32_16x16x32_bf16 a[172:175], v[64:67], v[164:167], a[172:175]
    s_waitcnt lgkmcnt(8)
    ds_read_b64_tr_b16 v[88:89], v49 offset:16384
    v_sub_f32 v13, v13, v3
    v_mfma_f32_16x16x32_bf16 a[228:231], v[68:71], v[164:167], a[228:231]
    ds_read_b64_tr_b16 v[90:91], v49 offset:20480
    v_cvt_pk_bf16_f32 v157, v12, v13
    v_lshlrev_b32 v8, 16, v158
    v_and_b32 v9, s86, v158
    v_mfma_f32_16x16x32_bf16 a[224:227], v[68:71], v[160:163], a[224:227]
    s_waitcnt lgkmcnt(8)
    ds_read_b64_tr_b16 v[92:93], v56 offset:16384
    buffer_load_dwordx4 v255, s[40:43], s68 offen offset:3072 lds
    v_mfma_f32_16x16x32_bf16 a[176:179], v[72:75], v[160:163], a[176:179]
    ds_read_b64_tr_b16 v[94:95], v56 offset:20480
    v_sub_f32 v8, v8, v3
    v_mfma_f32_16x16x32_bf16 a[180:183], v[72:75], v[164:167], a[180:183]
    s_waitcnt lgkmcnt(8)
    ds_read_b64_tr_b16 v[64:65], v50 offset:16384
    v_sub_f32 v9, v9, v3
    v_cvt_pk_bf16_f32 v158, v8, v9
    v_mfma_f32_16x16x32_bf16 a[236:239], v[76:79], v[164:167], a[236:239]
    ds_read_b64_tr_b16 v[66:67], v50 offset:20480
    v_lshlrev_b32 v10, 16, v159
    v_and_b32 v11, s86, v159
    v_sub_f32 v10, v10, v3
    v_sub_f32 v11, v11, v3
    v_cvt_pk_bf16_f32 v159, v10, v11
    v_mfma_f32_16x16x32_bf16 a[232:235], v[76:79], v[160:163], a[232:235]
    s_waitcnt lgkmcnt(8)
    ds_read_b64_tr_b16 v[68:69], v57 offset:16384
    v_mfma_f32_16x16x32_bf16 a[128:131], v[80:83], v[152:155], a[128:131]
    s_add_u32 m0, s67, 114688
    s_add_u32 s69, s79, 262144
    ds_read_b64_tr_b16 v[70:71], v57 offset:20480
    v_mfma_f32_16x16x32_bf16 a[132:135], v[80:83], v[156:159], a[132:135]
    s_waitcnt lgkmcnt(8)
    ds_read_b64_tr_b16 v[72:73], v51 offset:16384
    buffer_load_dwordx4 v252, s[40:43], s69 offen offset:0 lds
    v_mfma_f32_16x16x32_bf16 a[188:191], v[84:87], v[156:159], a[188:191]
    ds_read_b64_tr_b16 v[74:75], v51 offset:20480
    v_lshlrev_b32 v8, 16, v144
    v_mfma_f32_16x16x32_bf16 a[184:187], v[84:87], v[152:155], a[184:187]
    s_waitcnt lgkmcnt(8)
    ds_read_b64_tr_b16 v[76:77], v58 offset:16384
    v_and_b32 v9, s86, v144
    v_mfma_f32_16x16x32_bf16 a[136:139], v[88:91], v[152:155], a[136:139]
    ds_read_b64_tr_b16 v[78:79], v58 offset:20480
    v_sub_f32 v8, v8, v2
    v_mfma_f32_16x16x32_bf16 a[140:143], v[88:91], v[156:159], a[140:143]
    s_waitcnt lgkmcnt(8)
    v_sub_f32 v9, v9, v2
    v_cvt_pk_bf16_f32 v144, v8, v9
    v_mfma_f32_16x16x32_bf16 a[196:199], v[92:95], v[156:159], a[196:199]
    v_lshlrev_b32 v10, 16, v145
    v_and_b32 v11, s86, v145
    v_mfma_f32_16x16x32_bf16 a[192:195], v[92:95], v[152:155], a[192:195]
    s_waitcnt lgkmcnt(6)
    ds_read_b64_tr_b16 v[80:81], v52 offset:16384
    buffer_load_dwordx4 v253, s[40:43], s69 offen offset:1024 lds
    v_mfma_f32_16x16x32_bf16 a[144:147], v[64:67], v[152:155], a[144:147]
    ds_read_b64_tr_b16 v[82:83], v52 offset:20480
    v_sub_f32 v10, v10, v2
    v_mfma_f32_16x16x32_bf16 a[148:151], v[64:67], v[156:159], a[148:151]
    s_waitcnt lgkmcnt(6)
    ds_read_b64_tr_b16 v[84:85], v59 offset:16384
    v_sub_f32 v11, v11, v2
    v_mfma_f32_16x16x32_bf16 a[204:207], v[68:71], v[156:159], a[204:207]
    ds_read_b64_tr_b16 v[86:87], v59 offset:20480
    v_cvt_pk_bf16_f32 v145, v10, v11
    v_mfma_f32_16x16x32_bf16 a[200:203], v[68:71], v[152:155], a[200:203]
    s_waitcnt lgkmcnt(6)
    ds_read_b64_tr_b16 v[88:89], v53 offset:16384
    v_lshlrev_b32 v12, 16, v146
    v_and_b32 v13, s86, v146
    v_mfma_f32_16x16x32_bf16 a[152:155], v[72:75], v[152:155], a[152:155]
    ds_read_b64_tr_b16 v[90:91], v53 offset:20480
    v_sub_f32 v12, v12, v2
    v_sub_f32 v13, v13, v2
    v_cvt_pk_bf16_f32 v146, v12, v13
    v_mfma_f32_16x16x32_bf16 a[156:159], v[72:75], v[156:159], a[156:159]
    s_waitcnt lgkmcnt(6)
    ds_read_b64_tr_b16 v[92:93], v60 offset:16384
    buffer_load_dwordx4 v254, s[40:43], s69 offen offset:2048 lds
    v_mfma_f32_16x16x32_bf16 a[212:215], v[76:79], v[156:159], a[212:215]
    ds_read_b64_tr_b16 v[94:95], v60 offset:20480
    v_lshlrev_b32 v8, 16, v147
    v_mfma_f32_16x16x32_bf16 a[208:211], v[76:79], v[152:155], a[208:211]
    ds_read_b64_tr_b16 v[64:65], v54 offset:16384
    v_and_b32 v9, s86, v147
    v_sub_f32 v8, v8, v2
    v_mfma_f32_16x16x32_bf16 v[24:27], v[152:155], v[152:155], v[24:27]
    ds_read_b64_tr_b16 v[66:67], v54 offset:20480
    v_sub_f32 v9, v9, v2
    v_mfma_f32_16x16x32_bf16 v[28:31], v[156:159], v[156:159], v[28:31]
    s_waitcnt lgkmcnt(8)
    ds_read_b64_tr_b16 v[68:69], v61 offset:16384
    v_cvt_pk_bf16_f32 v147, v8, v9
    v_mfma_f32_16x16x32_bf16 a[164:167], v[80:83], v[156:159], a[164:167]
    ds_read_b64_tr_b16 v[70:71], v61 offset:20480
    v_lshlrev_b32 v10, 16, v148
    v_and_b32 v11, s86, v148
    v_sub_f32 v10, v10, v3
    v_mfma_f32_16x16x32_bf16 a[160:163], v[80:83], v[152:155], a[160:163]
    s_waitcnt lgkmcnt(8)
    ds_read_b64_tr_b16 v[72:73], v48 offset:24576
    buffer_load_dwordx4 v255, s[40:43], s69 offen offset:3072 lds
    v_mfma_f32_16x16x32_bf16 a[216:219], v[84:87], v[152:155], a[216:219]
    ds_read_b64_tr_b16 v[74:75], v48 offset:28672
    v_sub_f32 v11, v11, v3
    v_cvt_pk_bf16_f32 v148, v10, v11
    v_mfma_f32_16x16x32_bf16 a[220:223], v[84:87], v[156:159], a[220:223]
    s_waitcnt lgkmcnt(8)
    ds_read_b64_tr_b16 v[76:77], v55 offset:24576
    v_lshlrev_b32 v12, 16, v149
    v_mfma_f32_16x16x32_bf16 a[172:175], v[88:91], v[156:159], a[172:175]
    ds_read_b64_tr_b16 v[78:79], v55 offset:28672
    v_and_b32 v13, s86, v149
    v_sub_f32 v12, v12, v3
    v_mfma_f32_16x16x32_bf16 a[168:171], v[88:91], v[152:155], a[168:171]
    s_waitcnt lgkmcnt(8)
    ds_read_b64_tr_b16 v[80:81], v49 offset:24576
    v_sub_f32 v13, v13, v3
    v_mfma_f32_16x16x32_bf16 a[224:227], v[92:95], v[152:155], a[224:227]
    ds_read_b64_tr_b16 v[82:83], v49 offset:28672
    v_cvt_pk_bf16_f32 v149, v12, v13
    v_mfma_f32_16x16x32_bf16 a[228:231], v[92:95], v[156:159], a[228:231]
    s_waitcnt lgkmcnt(8)
    ds_read_b64_tr_b16 v[84:85], v56 offset:24576
    v_lshlrev_b32 v8, 16, v150
    v_and_b32 v9, s86, v150
    v_mfma_f32_16x16x32_bf16 a[180:183], v[64:67], v[156:159], a[180:183]
    ds_read_b64_tr_b16 v[86:87], v56 offset:28672
    v_sub_f32 v8, v8, v3
    v_mfma_f32_16x16x32_bf16 a[176:179], v[64:67], v[152:155], a[176:179]
    s_waitcnt lgkmcnt(8)
    ds_read_b64_tr_b16 v[88:89], v50 offset:24576
    v_sub_f32 v9, v9, v3
    v_cvt_pk_bf16_f32 v150, v8, v9
    v_mfma_f32_16x16x32_bf16 a[232:235], v[68:71], v[152:155], a[232:235]
    ds_read_b64_tr_b16 v[90:91], v50 offset:28672
    v_lshlrev_b32 v10, 16, v151
    v_and_b32 v11, s86, v151
    v_sub_f32 v10, v10, v3
    v_sub_f32 v11, v11, v3
    v_cvt_pk_bf16_f32 v151, v10, v11
    v_mfma_f32_16x16x32_bf16 a[236:239], v[68:71], v[156:159], a[236:239]
    s_waitcnt lgkmcnt(8)
    ds_read_b64_tr_b16 v[92:93], v57 offset:24576
    v_mfma_f32_16x16x32_bf16 a[132:135], v[72:75], v[148:151], a[132:135]
    ds_read_b64_tr_b16 v[94:95], v57 offset:28672
    v_lshlrev_b32 v8, 16, v136
    v_mfma_f32_16x16x32_bf16 a[128:131], v[72:75], v[144:147], a[128:131]
    s_waitcnt lgkmcnt(8)
    ds_read_b64_tr_b16 v[64:65], v51 offset:24576
    v_and_b32 v9, s86, v136
    v_mfma_f32_16x16x32_bf16 a[184:187], v[76:79], v[144:147], a[184:187]
    ds_read_b64_tr_b16 v[66:67], v51 offset:28672
    v_sub_f32 v8, v8, v2
    v_mfma_f32_16x16x32_bf16 a[188:191], v[76:79], v[148:151], a[188:191]
    s_waitcnt lgkmcnt(8)
    ds_read_b64_tr_b16 v[68:69], v58 offset:24576
    v_sub_f32 v9, v9, v2
    v_mfma_f32_16x16x32_bf16 a[140:143], v[80:83], v[148:151], a[140:143]
    s_waitcnt vmcnt(9)
    s_barrier
    ds_read_b64_tr_b16 v[70:71], v58 offset:28672
    v_mfma_f32_16x16x32_bf16 a[136:139], v[80:83], v[144:147], a[136:139]
    s_waitcnt lgkmcnt(8)
    v_cvt_pk_bf16_f32 v136, v8, v9
    v_lshlrev_b32 v10, 16, v137
    v_mfma_f32_16x16x32_bf16 a[192:195], v[84:87], v[144:147], a[192:195]
    s_add_u32 m0, s67, 0
    s_add_u32 s68, s79, 524288
    v_and_b32 v11, s86, v137
    v_mfma_f32_16x16x32_bf16 a[196:199], v[84:87], v[148:151], a[196:199]
    s_waitcnt lgkmcnt(6)
    ds_read_b64_tr_b16 v[72:73], v52 offset:24576
    buffer_load_dwordx4 v252, s[40:43], s68 offen offset:0 lds
    v_mfma_f32_16x16x32_bf16 a[148:151], v[88:91], v[148:151], a[148:151]
    ds_read_b64_tr_b16 v[74:75], v52 offset:28672
    v_sub_f32 v10, v10, v2
    v_mfma_f32_16x16x32_bf16 a[144:147], v[88:91], v[144:147], a[144:147]
    s_waitcnt lgkmcnt(6)
    ds_read_b64_tr_b16 v[76:77], v59 offset:24576
    v_sub_f32 v11, v11, v2
    v_mfma_f32_16x16x32_bf16 a[200:203], v[92:95], v[144:147], a[200:203]
    ds_read_b64_tr_b16 v[78:79], v59 offset:28672
    v_cvt_pk_bf16_f32 v137, v10, v11
    v_mfma_f32_16x16x32_bf16 a[204:207], v[92:95], v[148:151], a[204:207]
    s_waitcnt lgkmcnt(6)
    ds_read_b64_tr_b16 v[80:81], v53 offset:24576
    v_lshlrev_b32 v12, 16, v138
    v_and_b32 v13, s86, v138
    v_mfma_f32_16x16x32_bf16 a[156:159], v[64:67], v[148:151], a[156:159]
    ds_read_b64_tr_b16 v[82:83], v53 offset:28672
    v_sub_f32 v12, v12, v2
    v_sub_f32 v13, v13, v2
    v_cvt_pk_bf16_f32 v138, v12, v13
    v_mfma_f32_16x16x32_bf16 a[152:155], v[64:67], v[144:147], a[152:155]
    s_waitcnt lgkmcnt(6)
    ds_read_b64_tr_b16 v[84:85], v60 offset:24576
    buffer_load_dwordx4 v253, s[40:43], s68 offen offset:1024 lds
    v_mfma_f32_16x16x32_bf16 a[208:211], v[68:71], v[144:147], a[208:211]
    ds_read_b64_tr_b16 v[86:87], v60 offset:28672
    v_lshlrev_b32 v8, 16, v139
    v_mfma_f32_16x16x32_bf16 a[212:215], v[68:71], v[148:151], a[212:215]
    ds_read_b64_tr_b16 v[88:89], v54 offset:24576
    v_and_b32 v9, s86, v139
    v_sub_f32 v8, v8, v2
    v_mfma_f32_16x16x32_bf16 v[24:27], v[144:147], v[144:147], v[24:27]
    ds_read_b64_tr_b16 v[90:91], v54 offset:28672
    v_sub_f32 v9, v9, v2
    v_mfma_f32_16x16x32_bf16 v[28:31], v[148:151], v[148:151], v[28:31]
    s_waitcnt lgkmcnt(8)
    ds_read_b64_tr_b16 v[92:93], v61 offset:24576
    v_cvt_pk_bf16_f32 v139, v8, v9
    v_mfma_f32_16x16x32_bf16 a[160:163], v[72:75], v[144:147], a[160:163]
    ds_read_b64_tr_b16 v[94:95], v61 offset:28672
    v_lshlrev_b32 v10, 16, v140
    v_and_b32 v11, s86, v140
    v_sub_f32 v10, v10, v3
    v_mfma_f32_16x16x32_bf16 a[164:167], v[72:75], v[148:151], a[164:167]
    s_waitcnt lgkmcnt(8)
    ds_read_b64_tr_b16 v[64:65], v48 offset:32768
    buffer_load_dwordx4 v254, s[40:43], s68 offen offset:2048 lds
    v_mfma_f32_16x16x32_bf16 a[220:223], v[76:79], v[148:151], a[220:223]
    ds_read_b64_tr_b16 v[66:67], v48 offset:36864
    v_sub_f32 v11, v11, v3
    v_cvt_pk_bf16_f32 v140, v10, v11
    v_mfma_f32_16x16x32_bf16 a[216:219], v[76:79], v[144:147], a[216:219]
    s_waitcnt lgkmcnt(8)
    ds_read_b64_tr_b16 v[68:69], v55 offset:32768
    v_lshlrev_b32 v12, 16, v141
    v_mfma_f32_16x16x32_bf16 a[168:171], v[80:83], v[144:147], a[168:171]
    ds_read_b64_tr_b16 v[70:71], v55 offset:36864
    v_and_b32 v13, s86, v141
    v_sub_f32 v12, v12, v3
    v_mfma_f32_16x16x32_bf16 a[172:175], v[80:83], v[148:151], a[172:175]
    s_waitcnt lgkmcnt(8)
    ds_read_b64_tr_b16 v[72:73], v49 offset:32768
    v_sub_f32 v13, v13, v3
    v_mfma_f32_16x16x32_bf16 a[228:231], v[84:87], v[148:151], a[228:231]
    ds_read_b64_tr_b16 v[74:75], v49 offset:36864
    v_cvt_pk_bf16_f32 v141, v12, v13
    v_lshlrev_b32 v8, 16, v142
    v_and_b32 v9, s86, v142
    v_mfma_f32_16x16x32_bf16 a[224:227], v[84:87], v[144:147], a[224:227]
    s_waitcnt lgkmcnt(8)
    ds_read_b64_tr_b16 v[76:77], v56 offset:32768
    buffer_load_dwordx4 v255, s[40:43], s68 offen offset:3072 lds
    v_mfma_f32_16x16x32_bf16 a[176:179], v[88:91], v[144:147], a[176:179]
    ds_read_b64_tr_b16 v[78:79], v56 offset:36864
    v_sub_f32 v8, v8, v3
    v_mfma_f32_16x16x32_bf16 a[180:183], v[88:91], v[148:151], a[180:183]
    s_waitcnt lgkmcnt(8)
    ds_read_b64_tr_b16 v[80:81], v50 offset:32768
    v_sub_f32 v9, v9, v3
    v_cvt_pk_bf16_f32 v142, v8, v9
    v_mfma_f32_16x16x32_bf16 a[236:239], v[92:95], v[148:151], a[236:239]
    ds_read_b64_tr_b16 v[82:83], v50 offset:36864
    v_lshlrev_b32 v10, 16, v143
    v_and_b32 v11, s86, v143
    v_sub_f32 v10, v10, v3
    v_sub_f32 v11, v11, v3
    v_cvt_pk_bf16_f32 v143, v10, v11
    v_mfma_f32_16x16x32_bf16 a[232:235], v[92:95], v[144:147], a[232:235]
    s_waitcnt lgkmcnt(8)
    ds_read_b64_tr_b16 v[84:85], v57 offset:32768
    v_mfma_f32_16x16x32_bf16 a[128:131], v[64:67], v[136:139], a[128:131]
    s_add_u32 m0, s67, 65536
    s_add_u32 s69, s79, 786432
    ds_read_b64_tr_b16 v[86:87], v57 offset:36864
    v_mfma_f32_16x16x32_bf16 a[132:135], v[64:67], v[140:143], a[132:135]
    s_waitcnt lgkmcnt(8)
    ds_read_b64_tr_b16 v[88:89], v51 offset:32768
    buffer_load_dwordx4 v252, s[40:43], s69 offen offset:0 lds
    v_mfma_f32_16x16x32_bf16 a[188:191], v[68:71], v[140:143], a[188:191]
    ds_read_b64_tr_b16 v[90:91], v51 offset:36864
    v_lshlrev_b32 v8, 16, v128
    v_mfma_f32_16x16x32_bf16 a[184:187], v[68:71], v[136:139], a[184:187]
    s_waitcnt lgkmcnt(8)
    ds_read_b64_tr_b16 v[92:93], v58 offset:32768
    v_and_b32 v9, s86, v128
    v_mfma_f32_16x16x32_bf16 a[136:139], v[72:75], v[136:139], a[136:139]
    ds_read_b64_tr_b16 v[94:95], v58 offset:36864
    v_sub_f32 v8, v8, v2
    v_mfma_f32_16x16x32_bf16 a[140:143], v[72:75], v[140:143], a[140:143]
    s_waitcnt lgkmcnt(8)
    v_sub_f32 v9, v9, v2
    v_cvt_pk_bf16_f32 v128, v8, v9
    v_mfma_f32_16x16x32_bf16 a[196:199], v[76:79], v[140:143], a[196:199]
    v_lshlrev_b32 v10, 16, v129
    v_and_b32 v11, s86, v129
    v_mfma_f32_16x16x32_bf16 a[192:195], v[76:79], v[136:139], a[192:195]
    s_waitcnt lgkmcnt(6)
    ds_read_b64_tr_b16 v[64:65], v52 offset:32768
    buffer_load_dwordx4 v253, s[40:43], s69 offen offset:1024 lds
    v_mfma_f32_16x16x32_bf16 a[144:147], v[80:83], v[136:139], a[144:147]
    ds_read_b64_tr_b16 v[66:67], v52 offset:36864
    v_sub_f32 v10, v10, v2
    v_mfma_f32_16x16x32_bf16 a[148:151], v[80:83], v[140:143], a[148:151]
    s_waitcnt lgkmcnt(6)
    ds_read_b64_tr_b16 v[68:69], v59 offset:32768
    v_sub_f32 v11, v11, v2
    v_mfma_f32_16x16x32_bf16 a[204:207], v[84:87], v[140:143], a[204:207]
    ds_read_b64_tr_b16 v[70:71], v59 offset:36864
    v_cvt_pk_bf16_f32 v129, v10, v11
    v_mfma_f32_16x16x32_bf16 a[200:203], v[84:87], v[136:139], a[200:203]
    s_waitcnt lgkmcnt(6)
    ds_read_b64_tr_b16 v[72:73], v53 offset:32768
    v_lshlrev_b32 v12, 16, v130
    v_and_b32 v13, s86, v130
    v_mfma_f32_16x16x32_bf16 a[152:155], v[88:91], v[136:139], a[152:155]
    ds_read_b64_tr_b16 v[74:75], v53 offset:36864
    v_sub_f32 v12, v12, v2
    v_sub_f32 v13, v13, v2
    v_cvt_pk_bf16_f32 v130, v12, v13
    v_mfma_f32_16x16x32_bf16 a[156:159], v[88:91], v[140:143], a[156:159]
    s_waitcnt lgkmcnt(6)
    ds_read_b64_tr_b16 v[76:77], v60 offset:32768
    buffer_load_dwordx4 v254, s[40:43], s69 offen offset:2048 lds
    v_mfma_f32_16x16x32_bf16 a[212:215], v[92:95], v[140:143], a[212:215]
    ds_read_b64_tr_b16 v[78:79], v60 offset:36864
    v_lshlrev_b32 v8, 16, v131
    v_mfma_f32_16x16x32_bf16 a[208:211], v[92:95], v[136:139], a[208:211]
    ds_read_b64_tr_b16 v[80:81], v54 offset:32768
    v_and_b32 v9, s86, v131
    v_sub_f32 v8, v8, v2
    v_mfma_f32_16x16x32_bf16 v[24:27], v[136:139], v[136:139], v[24:27]
    ds_read_b64_tr_b16 v[82:83], v54 offset:36864
    v_sub_f32 v9, v9, v2
    v_mfma_f32_16x16x32_bf16 v[28:31], v[140:143], v[140:143], v[28:31]
    s_waitcnt lgkmcnt(8)
    ds_read_b64_tr_b16 v[84:85], v61 offset:32768
    v_cvt_pk_bf16_f32 v131, v8, v9
    v_mfma_f32_16x16x32_bf16 a[164:167], v[64:67], v[140:143], a[164:167]
    ds_read_b64_tr_b16 v[86:87], v61 offset:36864
    v_lshlrev_b32 v10, 16, v132
    v_and_b32 v11, s86, v132
    v_sub_f32 v10, v10, v3
    v_mfma_f32_16x16x32_bf16 a[160:163], v[64:67], v[136:139], a[160:163]
    s_waitcnt lgkmcnt(8)
    ds_read_b64_tr_b16 v[88:89], v48 offset:40960
    buffer_load_dwordx4 v255, s[40:43], s69 offen offset:3072 lds
    v_mfma_f32_16x16x32_bf16 a[216:219], v[68:71], v[136:139], a[216:219]
    ds_read_b64_tr_b16 v[90:91], v48 offset:45056
    v_sub_f32 v11, v11, v3
    v_cvt_pk_bf16_f32 v132, v10, v11
    v_mfma_f32_16x16x32_bf16 a[220:223], v[68:71], v[140:143], a[220:223]
    s_waitcnt lgkmcnt(8)
    ds_read_b64_tr_b16 v[92:93], v55 offset:40960
    v_lshlrev_b32 v12, 16, v133
    v_mfma_f32_16x16x32_bf16 a[172:175], v[72:75], v[140:143], a[172:175]
    ds_read_b64_tr_b16 v[94:95], v55 offset:45056
    v_and_b32 v13, s86, v133
    v_sub_f32 v12, v12, v3
    v_mfma_f32_16x16x32_bf16 a[168:171], v[72:75], v[136:139], a[168:171]
    s_waitcnt lgkmcnt(8)
    ds_read_b64_tr_b16 v[64:65], v49 offset:40960
    v_sub_f32 v13, v13, v3
    v_mfma_f32_16x16x32_bf16 a[224:227], v[76:79], v[136:139], a[224:227]
    ds_read_b64_tr_b16 v[66:67], v49 offset:45056
    v_cvt_pk_bf16_f32 v133, v12, v13
    v_mfma_f32_16x16x32_bf16 a[228:231], v[76:79], v[140:143], a[228:231]
    s_waitcnt lgkmcnt(8)
    ds_read_b64_tr_b16 v[68:69], v56 offset:40960
    v_lshlrev_b32 v8, 16, v134
    v_and_b32 v9, s86, v134
    v_mfma_f32_16x16x32_bf16 a[180:183], v[80:83], v[140:143], a[180:183]
    ds_read_b64_tr_b16 v[70:71], v56 offset:45056
    v_sub_f32 v8, v8, v3
    v_mfma_f32_16x16x32_bf16 a[176:179], v[80:83], v[136:139], a[176:179]
    s_waitcnt lgkmcnt(8)
    ds_read_b64_tr_b16 v[72:73], v50 offset:40960
    v_sub_f32 v9, v9, v3
    v_cvt_pk_bf16_f32 v134, v8, v9
    v_mfma_f32_16x16x32_bf16 a[232:235], v[84:87], v[136:139], a[232:235]
    ds_read_b64_tr_b16 v[74:75], v50 offset:45056
    v_lshlrev_b32 v10, 16, v135
    v_and_b32 v11, s86, v135
    v_sub_f32 v10, v10, v3
    v_sub_f32 v11, v11, v3
    v_cvt_pk_bf16_f32 v135, v10, v11
    v_mfma_f32_16x16x32_bf16 a[236:239], v[84:87], v[140:143], a[236:239]
    s_waitcnt lgkmcnt(8)
    ds_read_b64_tr_b16 v[76:77], v57 offset:40960
    v_mfma_f32_16x16x32_bf16 a[132:135], v[88:91], v[132:135], a[132:135]
    ds_read_b64_tr_b16 v[78:79], v57 offset:45056
    v_mfma_f32_16x16x32_bf16 a[128:131], v[88:91], v[128:131], a[128:131]
    s_waitcnt lgkmcnt(8)
    ds_read_b64_tr_b16 v[80:81], v51 offset:40960
    v_mfma_f32_16x16x32_bf16 a[184:187], v[92:95], v[128:131], a[184:187]
    ds_read_b64_tr_b16 v[82:83], v51 offset:45056
    v_mfma_f32_16x16x32_bf16 a[188:191], v[92:95], v[132:135], a[188:191]
    s_waitcnt lgkmcnt(8)
    ds_read_b64_tr_b16 v[84:85], v58 offset:40960
    v_mfma_f32_16x16x32_bf16 a[140:143], v[64:67], v[132:135], a[140:143]
    s_waitcnt vmcnt(8)
    s_barrier
    ds_read_b64_tr_b16 v[86:87], v58 offset:45056
    v_mfma_f32_16x16x32_bf16 a[136:139], v[64:67], v[128:131], a[136:139]
    s_waitcnt lgkmcnt(8)
    v_mfma_f32_16x16x32_bf16 a[192:195], v[68:71], v[128:131], a[192:195]
    s_add_u32 m0, s67, 16384
    s_add_u32 s68, s79, 1048576
    ds_read_b64_tr_b16 v[88:89], v52 offset:40960
    v_mfma_f32_16x16x32_bf16 a[196:199], v[68:71], v[132:135], a[196:199]
    s_waitcnt lgkmcnt(7)
    ds_read_b64_tr_b16 v[90:91], v52 offset:45056
    buffer_load_dwordx4 v252, s[40:43], s68 offen offset:0 lds
    v_mfma_f32_16x16x32_bf16 a[148:151], v[72:75], v[132:135], a[148:151]
    ds_read_b64_tr_b16 v[92:93], v59 offset:40960
    v_mfma_f32_16x16x32_bf16 a[144:147], v[72:75], v[128:131], a[144:147]
    s_waitcnt lgkmcnt(7)
    ds_read_b64_tr_b16 v[94:95], v59 offset:45056
    v_mfma_f32_16x16x32_bf16 a[200:203], v[76:79], v[128:131], a[200:203]
    ds_read_b64_tr_b16 v[64:65], v53 offset:40960
    v_mfma_f32_16x16x32_bf16 a[204:207], v[76:79], v[132:135], a[204:207]
    s_waitcnt lgkmcnt(7)
    ds_read_b64_tr_b16 v[66:67], v53 offset:45056
    v_mfma_f32_16x16x32_bf16 a[156:159], v[80:83], v[132:135], a[156:159]
    ds_read_b64_tr_b16 v[68:69], v60 offset:40960
    v_mfma_f32_16x16x32_bf16 a[152:155], v[80:83], v[128:131], a[152:155]
    s_waitcnt lgkmcnt(7)
    ds_read_b64_tr_b16 v[70:71], v60 offset:45056
    buffer_load_dwordx4 v253, s[40:43], s68 offen offset:1024 lds
    v_mfma_f32_16x16x32_bf16 a[208:211], v[84:87], v[128:131], a[208:211]
    ds_read_b64_tr_b16 v[72:73], v54 offset:40960
    v_mfma_f32_16x16x32_bf16 a[212:215], v[84:87], v[132:135], a[212:215]
    ds_read_b64_tr_b16 v[74:75], v54 offset:45056
    v_mfma_f32_16x16x32_bf16 v[24:27], v[128:131], v[128:131], v[24:27]
    ds_read_b64_tr_b16 v[76:77], v61 offset:40960
    v_mfma_f32_16x16x32_bf16 v[28:31], v[132:135], v[132:135], v[28:31]
    s_waitcnt lgkmcnt(9)
    ds_read_b64_tr_b16 v[78:79], v61 offset:45056
    v_mfma_f32_16x16x32_bf16 a[160:163], v[88:91], v[128:131], a[160:163]
    ds_read_b64_tr_b16 v[80:81], v240 offset:49152
    v_mfma_f32_16x16x32_bf16 a[164:167], v[88:91], v[132:135], a[164:167]
    s_waitcnt lgkmcnt(9)
    ds_read_b64_tr_b16 v[82:83], v240 offset:57344
    buffer_load_dwordx4 v254, s[40:43], s68 offen offset:2048 lds
    v_mfma_f32_16x16x32_bf16 a[220:223], v[92:95], v[132:135], a[220:223]
    ds_read_b64_tr_b16 v[84:85], v241 offset:49152
    v_mfma_f32_16x16x32_bf16 a[216:219], v[92:95], v[128:131], a[216:219]
    s_waitcnt lgkmcnt(9)
    ds_read_b64_tr_b16 v[86:87], v241 offset:57344
    v_mfma_f32_16x16x32_bf16 a[168:171], v[64:67], v[128:131], a[168:171]
    ds_read_b64_tr_b16 v[88:89], v242 offset:49152
    v_mfma_f32_16x16x32_bf16 a[172:175], v[64:67], v[132:135], a[172:175]
    s_waitcnt lgkmcnt(9)
    ds_read_b64_tr_b16 v[90:91], v242 offset:57344
    v_cndmask_b32 v6, 0, v24, s[4:5]
    v_mfma_f32_16x16x32_bf16 a[228:231], v[68:71], v[132:135], a[228:231]
    ds_read_b64_tr_b16 v[92:93], v243 offset:49152
    v_cndmask_b32 v6, v6, v25, s[6:7]
    v_mfma_f32_16x16x32_bf16 a[224:227], v[68:71], v[128:131], a[224:227]
    s_waitcnt lgkmcnt(9)
    ds_read_b64_tr_b16 v[94:95], v243 offset:57344
    buffer_load_dwordx4 v255, s[40:43], s68 offen offset:3072 lds
    v_mfma_f32_16x16x32_bf16 a[176:179], v[72:75], v[128:131], a[176:179]
    ds_read_b64_tr_b16 v[64:65], v244 offset:49152
    v_cndmask_b32 v6, v6, v26, s[8:9]
    v_mfma_f32_16x16x32_bf16 a[180:183], v[72:75], v[132:135], a[180:183]
    s_waitcnt lgkmcnt(9)
    ds_read_b64_tr_b16 v[66:67], v244 offset:57344
    v_cndmask_b32 v6, v6, v27, s[10:11]
    v_mfma_f32_16x16x32_bf16 a[236:239], v[76:79], v[132:135], a[236:239]
    ds_read_b64_tr_b16 v[68:69], v245 offset:49152
    v_mov_b32 v8, v6
    v_mfma_f32_16x16x32_bf16 a[232:235], v[76:79], v[128:131], a[232:235]
    s_waitcnt lgkmcnt(9)
    ds_read_b64_tr_b16 v[70:71], v245 offset:57344
    v_permlane32_swap_b32 v6, v8
    v_add_f32 v6, v6, v8
    v_mfma_f32_16x16x32_bf16 a[0:3], v[80:83], v[232:235], 0
    s_add_u32 m0, s67, 81920
    s_add_u32 s69, s79, 1310720
    ds_read_b64_tr_b16 v[72:73], v246 offset:49152
    v_mfma_f32_16x16x32_bf16 a[4:7], v[80:83], v[236:239], 0
    s_waitcnt lgkmcnt(9)
    ds_read_b64_tr_b16 v[74:75], v246 offset:57344
    buffer_load_dwordx4 v252, s[40:43], s69 offen offset:0 lds
    v_mfma_f32_16x16x32_bf16 a[12:15], v[84:87], v[236:239], 0
    ds_read_b64_tr_b16 v[76:77], v247 offset:49152
    v_mov_b32 v8, v6
    s_nop 1
    v_permlane16_swap_b32 v6, v8
    v_mfma_f32_16x16x32_bf16 a[8:11], v[84:87], v[232:235], 0
    s_waitcnt lgkmcnt(9)
    ds_read_b64_tr_b16 v[78:79], v247 offset:57344
    v_add_f32 v6, v6, v8
    v_mfma_f32_16x16x32_bf16 a[16:19], v[88:91], v[232:235], 0
    ds_read_b64_tr_b16 v[80:81], v240 offset:49408
    v_mul_f32 v8, v4, v4
    v_mfma_f32_16x16x32_bf16 a[20:23], v[88:91], v[236:239], 0
    s_waitcnt lgkmcnt(9)
    ds_read_b64_tr_b16 v[82:83], v240 offset:57600
    v_mul_f32 v6, 0x3b124925, v6
    v_sub_f32 v6, v6, v8
    v_mfma_f32_16x16x32_bf16 a[28:31], v[92:95], v[236:239], 0
    ds_read_b64_tr_b16 v[84:85], v241 offset:49408
    v_max_f32 v6, 0, v6
    v_cvt_pk_bf16_f32 v6, v6, v6
    v_lshlrev_b32 v6, 16, v6
    v_mfma_f32_16x16x32_bf16 a[24:27], v[92:95], v[232:235], 0
    s_waitcnt lgkmcnt(9)
    ds_read_b64_tr_b16 v[86:87], v241 offset:57600
    buffer_load_dwordx4 v253, s[40:43], s69 offen offset:1024 lds
    v_mfma_f32_16x16x32_bf16 a[32:35], v[64:67], v[232:235], 0
    ds_read_b64_tr_b16 v[88:89], v242 offset:49408
    v_add_f32 v6, 0x3727c5ac, v6
    v_mfma_f32_16x16x32_bf16 a[36:39], v[64:67], v[236:239], 0
    s_waitcnt lgkmcnt(9)
    ds_read_b64_tr_b16 v[90:91], v242 offset:57600
    v_cvt_pk_bf16_f32 v6, v6, v6
    v_lshlrev_b32 v6, 16, v6
    v_mfma_f32_16x16x32_bf16 a[44:47], v[68:71], v[236:239], 0
    ds_read_b64_tr_b16 v[92:93], v243 offset:49408
    v_sqrt_f32 v6, v6
    v_mfma_f32_16x16x32_bf16 a[40:43], v[68:71], v[232:235], 0
    s_waitcnt lgkmcnt(9)
    ds_read_b64_tr_b16 v[94:95], v243 offset:57600
    v_cvt_pk_bf16_f32 v6, v6, v6
    v_mfma_f32_16x16x32_bf16 a[48:51], v[72:75], v[232:235], 0
    ds_read_b64_tr_b16 v[64:65], v244 offset:49408
    v_lshlrev_b32 v6, 16, v6
    v_rcp_f32 v8, v6
    v_mfma_f32_16x16x32_bf16 a[52:55], v[72:75], v[236:239], 0
    s_waitcnt lgkmcnt(9)
    ds_read_b64_tr_b16 v[66:67], v244 offset:57600
    buffer_load_dwordx4 v254, s[40:43], s69 offen offset:2048 lds
    v_mfma_f32_16x16x32_bf16 a[60:63], v[76:79], v[236:239], 0
    ds_read_b64_tr_b16 v[68:69], v245 offset:49408
    v_mul_f32 v6, v6, v6
    v_mul_f32 v2, 0x3db8aa3b, v8
    v_mfma_f32_16x16x32_bf16 a[56:59], v[76:79], v[232:235], 0
    s_waitcnt lgkmcnt(9)
    ds_read_b64_tr_b16 v[70:71], v245 offset:57600
    v_mul_f32 v4, 0xbfb8aa3b, v8
    v_mfma_f32_16x16x32_bf16 a[64:67], v[80:83], v[232:235], 0
    ds_read_b64_tr_b16 v[72:73], v246 offset:49408
    v_cndmask_b32 v7, 0, v28, s[4:5]
    v_cndmask_b32 v7, v7, v29, s[6:7]
    v_mfma_f32_16x16x32_bf16 a[68:71], v[80:83], v[236:239], 0
    s_waitcnt lgkmcnt(9)
    ds_read_b64_tr_b16 v[74:75], v246 offset:57600
    v_cndmask_b32 v7, v7, v30, s[8:9]
    v_cndmask_b32 v7, v7, v31, s[10:11]
    v_mfma_f32_16x16x32_bf16 a[76:79], v[84:87], v[236:239], 0
    ds_read_b64_tr_b16 v[76:77], v247 offset:49408
    v_mov_b32 v9, v7
    s_nop 1
    v_permlane32_swap_b32 v7, v9
    v_mfma_f32_16x16x32_bf16 a[72:75], v[84:87], v[232:235], 0
    s_waitcnt lgkmcnt(9)
    ds_read_b64_tr_b16 v[78:79], v247 offset:57600
    buffer_load_dwordx4 v255, s[40:43], s69 offen offset:3072 lds
    v_mfma_f32_16x16x32_bf16 a[80:83], v[88:91], v[232:235], 0
    ds_read_b64_tr_b16 v[80:81], v100 offset:49152
    v_add_f32 v7, v7, v9
    v_mfma_f32_16x16x32_bf16 a[84:87], v[88:91], v[236:239], 0
    s_waitcnt lgkmcnt(9)
    ds_read_b64_tr_b16 v[82:83], v100 offset:57344
    v_mov_b32 v9, v7
    s_nop 1
    v_permlane16_swap_b32 v7, v9
    v_mfma_f32_16x16x32_bf16 a[92:95], v[92:95], v[236:239], 0
    ds_read_b64_tr_b16 v[84:85], v101 offset:49152
    v_add_f32 v7, v7, v9
    v_mfma_f32_16x16x32_bf16 a[88:91], v[92:95], v[232:235], 0
    s_waitcnt lgkmcnt(9)
    ds_read_b64_tr_b16 v[86:87], v101 offset:57344
    v_mul_f32 v9, v5, v5
    v_mfma_f32_16x16x32_bf16 a[96:99], v[64:67], v[232:235], 0
    ds_read_b64_tr_b16 v[88:89], v102 offset:49152
    v_mul_f32 v7, 0x3b124925, v7
    v_sub_f32 v7, v7, v9
    v_mfma_f32_16x16x32_bf16 a[100:103], v[64:67], v[236:239], 0
    s_waitcnt lgkmcnt(9)
    ds_read_b64_tr_b16 v[90:91], v102 offset:57344
    v_max_f32 v7, 0, v7
    v_mfma_f32_16x16x32_bf16 a[108:111], v[68:71], v[236:239], 0
    ds_read_b64_tr_b16 v[92:93], v103 offset:49152
    v_cvt_pk_bf16_f32 v7, v7, v7
    v_lshlrev_b32 v7, 16, v7
    v_mfma_f32_16x16x32_bf16 a[104:107], v[68:71], v[232:235], 0
    s_waitcnt lgkmcnt(9)
    ds_read_b64_tr_b16 v[94:95], v103 offset:57344
    v_add_f32 v7, 0x3727c5ac, v7
    v_mfma_f32_16x16x32_bf16 a[112:115], v[72:75], v[232:235], 0
    ds_read_b64_tr_b16 v[64:65], v104 offset:49152
    v_cvt_pk_bf16_f32 v7, v7, v7
    v_lshlrev_b32 v7, 16, v7
    v_mfma_f32_16x16x32_bf16 a[116:119], v[72:75], v[236:239], 0
    s_waitcnt lgkmcnt(9)
    ds_read_b64_tr_b16 v[66:67], v104 offset:57344
    v_sqrt_f32 v7, v7
    v_mfma_f32_16x16x32_bf16 a[124:127], v[76:79], v[236:239], 0
    ds_read_b64_tr_b16 v[68:69], v105 offset:49152
    v_cvt_pk_bf16_f32 v7, v7, v7
    v_mfma_f32_16x16x32_bf16 a[120:123], v[76:79], v[232:235], 0
    s_waitcnt lgkmcnt(9)
    ds_read_b64_tr_b16 v[70:71], v105 offset:57344
    v_lshlrev_b32 v7, 16, v7
    v_rcp_f32 v9, v7
    v_mul_f32 v7, v7, v7
    v_mul_f32 v3, 0x3db8aa3b, v9
    v_mul_f32 v5, 0xbfb8aa3b, v9
    v_mfma_f32_16x16x32_bf16 a[0:3], v[80:83], v[224:227], a[0:3]
    ds_read_b64_tr_b16 v[72:73], v106 offset:49152
    v_mfma_f32_16x16x32_bf16 a[4:7], v[80:83], v[228:231], a[4:7]
    s_waitcnt lgkmcnt(9)
    ds_read_b64_tr_b16 v[74:75], v106 offset:57344
    v_accvgpr_read_b32 v48, a128
    v_mfma_f32_16x16x32_bf16 a[12:15], v[84:87], v[228:231], a[12:15]
    ds_read_b64_tr_b16 v[76:77], v107 offset:49152
    v_accvgpr_read_b32 v49, a184
    v_mfma_f32_16x16x32_bf16 a[8:11], v[84:87], v[224:227], a[8:11]
    s_waitcnt lgkmcnt(9)
    ds_read_b64_tr_b16 v[78:79], v107 offset:57344
    v_mul_f32 v50, v48, v4
    v_exp_f32 v50, v50
    v_mfma_f32_16x16x32_bf16 a[16:19], v[88:91], v[224:227], a[16:19]
    ds_read_b64_tr_b16 v[80:81], v100 offset:49408
    v_accvgpr_read_b32 v51, a129
    v_mfma_f32_16x16x32_bf16 a[20:23], v[88:91], v[228:231], a[20:23]
    s_waitcnt lgkmcnt(9)
    ds_read_b64_tr_b16 v[82:83], v100 offset:57600
    v_accvgpr_read_b32 v52, a185
    v_mul_f32 v53, v51, v4
    v_exp_f32 v53, v53
    v_mfma_f32_16x16x32_bf16 a[28:31], v[92:95], v[228:231], a[28:31]
    s_waitcnt vmcnt(8)
    s_barrier
    ds_read_b64_tr_b16 v[84:85], v101 offset:49408
    v_mfma_f32_16x16x32_bf16 a[24:27], v[92:95], v[224:227], a[24:27]
    s_waitcnt lgkmcnt(9)
    ds_read_b64_tr_b16 v[86:87], v101 offset:57600
    v_mul_f32 v48, v48, v49
    v_fma_f32 v50, v50, v6, v6
    v_mfma_f32_16x16x32_bf16 a[32:35], v[64:67], v[224:227], a[32:35]
    s_add_u32 m0, s67, 32768
    s_add_u32 s68, s79, 1572864
    ds_read_b64_tr_b16 v[88:89], v102 offset:49408
    v_rcp_f32 v50, v50
    v_mfma_f32_16x16x32_bf16 a[36:39], v[64:67], v[228:231], a[36:39]
    s_waitcnt lgkmcnt(9)
    ds_read_b64_tr_b16 v[90:91], v102 offset:57600
    buffer_load_dwordx4 v252, s[40:43], s68 offen offset:0 lds
    v_mfma_f32_16x16x32_bf16 a[44:47], v[68:71], v[228:231], a[44:47]
    ds_read_b64_tr_b16 v[92:93], v103 offset:49408
    v_accvgpr_read_b32 v54, a130
    v_mfma_f32_16x16x32_bf16 a[40:43], v[68:71], v[224:227], a[40:43]
    s_waitcnt lgkmcnt(9)
    ds_read_b64_tr_b16 v[94:95], v103 offset:57600
    v_accvgpr_read_b32 v55, a186
    v_mul_f32 v56, v54, v4
    v_mfma_f32_16x16x32_bf16 a[48:51], v[72:75], v[224:227], a[48:51]
    ds_read_b64_tr_b16 v[64:65], v104 offset:49408
    v_exp_f32 v56, v56
    v_mfma_f32_16x16x32_bf16 a[52:55], v[72:75], v[228:231], a[52:55]
    s_waitcnt lgkmcnt(9)
    ds_read_b64_tr_b16 v[66:67], v104 offset:57600
    v_mul_f32 v51, v51, v52
    v_mfma_f32_16x16x32_bf16 a[60:63], v[76:79], v[228:231], a[60:63]
    ds_read_b64_tr_b16 v[68:69], v105 offset:49408
    v_fma_f32 v53, v53, v6, v6
    v_rcp_f32 v53, v53
    v_mul_f32 v60, v48, v50
    v_mfma_f32_16x16x32_bf16 a[56:59], v[76:79], v[224:227], a[56:59]
    s_waitcnt lgkmcnt(9)
    ds_read_b64_tr_b16 v[70:71], v105 offset:57600
    buffer_load_dwordx4 v253, s[40:43], s68 offen offset:1024 lds
    v_mfma_f32_16x16x32_bf16 a[64:67], v[80:83], v[224:227], a[64:67]
    ds_read_b64_tr_b16 v[72:73], v106 offset:49408
    v_accvgpr_read_b32 v57, a131
    v_mfma_f32_16x16x32_bf16 a[68:71], v[80:83], v[228:231], a[68:71]
    s_waitcnt lgkmcnt(9)
    ds_read_b64_tr_b16 v[74:75], v106 offset:57600
    v_accvgpr_read_b32 v58, a187
    v_mul_f32 v59, v57, v4
    v_mfma_f32_16x16x32_bf16 a[76:79], v[84:87], v[228:231], a[76:79]
    ds_read_b64_tr_b16 v[76:77], v107 offset:49408
    v_exp_f32 v59, v59
    v_mfma_f32_16x16x32_bf16 a[72:75], v[84:87], v[224:227], a[72:75]
    s_waitcnt lgkmcnt(9)
    ds_read_b64_tr_b16 v[78:79], v107 offset:57600
    v_mul_f32 v54, v54, v55
    v_mfma_f32_16x16x32_bf16 a[80:83], v[88:91], v[224:227], a[80:83]
    ds_read_b64_tr_b16 v[80:81], v240 offset:0
    v_fma_f32 v56, v56, v6, v6
    v_rcp_f32 v56, v56
    v_mfma_f32_16x16x32_bf16 a[84:87], v[88:91], v[228:231], a[84:87]
    s_waitcnt lgkmcnt(9)
    ds_read_b64_tr_b16 v[82:83], v240 offset:8192
    buffer_load_dwordx4 v254, s[40:43], s68 offen offset:2048 lds
    v_mfma_f32_16x16x32_bf16 a[92:95], v[92:95], v[228:231], a[92:95]
    ds_read_b64_tr_b16 v[84:85], v241 offset:0
    v_mul_f32 v61, v51, v53
    v_cvt_pk_bf16_f32 v232, v60, v61
    v_mfma_f32_16x16x32_bf16 a[88:91], v[92:95], v[224:227], a[88:91]
    s_waitcnt lgkmcnt(9)
    ds_read_b64_tr_b16 v[86:87], v241 offset:8192
    v_accvgpr_read_b32 v48, a132
    v_accvgpr_read_b32 v49, a188
    v_mfma_f32_16x16x32_bf16 a[96:99], v[64:67], v[224:227], a[96:99]
    ds_read_b64_tr_b16 v[88:89], v242 offset:0
    v_mul_f32 v50, v48, v5
    v_mfma_f32_16x16x32_bf16 a[100:103], v[64:67], v[228:231], a[100:103]
    s_waitcnt lgkmcnt(9)
    ds_read_b64_tr_b16 v[90:91], v242 offset:8192
    v_exp_f32 v50, v50
    v_mfma_f32_16x16x32_bf16 a[108:111], v[68:71], v[228:231], a[108:111]
    ds_read_b64_tr_b16 v[92:93], v243 offset:0
    v_mul_f32 v57, v57, v58
    v_fma_f32 v59, v59, v6, v6
    v_rcp_f32 v59, v59
    v_mfma_f32_16x16x32_bf16 a[104:107], v[68:71], v[224:227], a[104:107]
    s_waitcnt lgkmcnt(9)
    ds_read_b64_tr_b16 v[94:95], v243 offset:8192
    buffer_load_dwordx4 v255, s[40:43], s68 offen offset:3072 lds
    v_mfma_f32_16x16x32_bf16 a[112:115], v[72:75], v[224:227], a[112:115]
    ds_read_b64_tr_b16 v[64:65], v244 offset:0
    v_mul_f32 v60, v54, v56
    v_mfma_f32_16x16x32_bf16 a[116:119], v[72:75], v[228:231], a[116:119]
    s_waitcnt lgkmcnt(9)
    ds_read_b64_tr_b16 v[66:67], v244 offset:8192
    v_accvgpr_read_b32 v51, a133
    v_accvgpr_read_b32 v52, a189
    v_mfma_f32_16x16x32_bf16 a[124:127], v[76:79], v[228:231], a[124:127]
    ds_read_b64_tr_b16 v[68:69], v245 offset:0
    v_mul_f32 v53, v51, v5
    v_mfma_f32_16x16x32_bf16 a[120:123], v[76:79], v[224:227], a[120:123]
    s_waitcnt lgkmcnt(9)
    ds_read_b64_tr_b16 v[70:71], v245 offset:8192
    v_exp_f32 v53, v53
    v_mul_f32 v48, v48, v49
    v_mfma_f32_16x16x32_bf16 a[0:3], v[80:83], v[216:219], a[0:3]
    s_add_u32 m0, s67, 98304
    s_add_u32 s69, s79, 1835008
    ds_read_b64_tr_b16 v[72:73], v246 offset:0
    v_fma_f32 v50, v50, v7, v7
    v_rcp_f32 v50, v50
    v_mfma_f32_16x16x32_bf16 a[4:7], v[80:83], v[220:223], a[4:7]
    s_waitcnt lgkmcnt(9)
    ds_read_b64_tr_b16 v[74:75], v246 offset:8192
    buffer_load_dwordx4 v252, s[40:43], s69 offen offset:0 lds
    v_mfma_f32_16x16x32_bf16 a[12:15], v[84:87], v[220:223], a[12:15]
    ds_read_b64_tr_b16 v[76:77], v247 offset:0
    v_mul_f32 v61, v57, v59
    v_mfma_f32_16x16x32_bf16 a[8:11], v[84:87], v[216:219], a[8:11]
    s_waitcnt lgkmcnt(9)
    ds_read_b64_tr_b16 v[78:79], v247 offset:8192
    v_cvt_pk_bf16_f32 v233, v60, v61
    v_mfma_f32_16x16x32_bf16 a[16:19], v[88:91], v[216:219], a[16:19]
    ds_read_b64_tr_b16 v[80:81], v240 offset:256
    v_accvgpr_read_b32 v54, a134
    v_accvgpr_read_b32 v55, a190
    v_mfma_f32_16x16x32_bf16 a[20:23], v[88:91], v[220:223], a[20:23]
    s_waitcnt lgkmcnt(9)
    ds_read_b64_tr_b16 v[82:83], v240 offset:8448
    v_mul_f32 v56, v54, v5
    v_exp_f32 v56, v56
    v_mfma_f32_16x16x32_bf16 a[28:31], v[92:95], v[220:223], a[28:31]
    ds_read_b64_tr_b16 v[84:85], v241 offset:256
    v_mul_f32 v51, v51, v52
    v_fma_f32 v53, v53, v7, v7
    v_mfma_f32_16x16x32_bf16 a[24:27], v[92:95], v[216:219], a[24:27]
    s_waitcnt lgkmcnt(9)
    ds_read_b64_tr_b16 v[86:87], v241 offset:8448
    buffer_load_dwordx4 v253, s[40:43], s69 offen offset:1024 lds
    v_mfma_f32_16x16x32_bf16 a[32:35], v[64:67], v[216:219], a[32:35]
    ds_read_b64_tr_b16 v[88:89], v242 offset:256
    v_rcp_f32 v53, v53
    v_mfma_f32_16x16x32_bf16 a[36:39], v[64:67], v[220:223], a[36:39]
    s_waitcnt lgkmcnt(9)
    ds_read_b64_tr_b16 v[90:91], v242 offset:8448
    v_mul_f32 v60, v48, v50
    v_mfma_f32_16x16x32_bf16 a[44:47], v[68:71], v[220:223], a[44:47]
    ds_read_b64_tr_b16 v[92:93], v243 offset:256
    v_accvgpr_read_b32 v57, a135
    v_accvgpr_read_b32 v58, a191
    v_mfma_f32_16x16x32_bf16 a[40:43], v[68:71], v[216:219], a[40:43]
    s_waitcnt lgkmcnt(9)
    ds_read_b64_tr_b16 v[94:95], v243 offset:8448
    v_mul_f32 v59, v57, v5
    v_exp_f32 v59, v59
    v_mfma_f32_16x16x32_bf16 a[48:51], v[72:75], v[216:219], a[48:51]
    ds_read_b64_tr_b16 v[64:65], v244 offset:256
    v_mul_f32 v54, v54, v55
    v_fma_f32 v56, v56, v7, v7
    v_mfma_f32_16x16x32_bf16 a[52:55], v[72:75], v[220:223], a[52:55]
    s_waitcnt lgkmcnt(9)
    ds_read_b64_tr_b16 v[66:67], v244 offset:8448
    buffer_load_dwordx4 v254, s[40:43], s69 offen offset:2048 lds
    v_mfma_f32_16x16x32_bf16 a[60:63], v[76:79], v[220:223], a[60:63]
    ds_read_b64_tr_b16 v[68:69], v245 offset:256
    v_rcp_f32 v56, v56
    v_mfma_f32_16x16x32_bf16 a[56:59], v[76:79], v[216:219], a[56:59]
    s_waitcnt lgkmcnt(9)
    ds_read_b64_tr_b16 v[70:71], v245 offset:8448
    v_mul_f32 v61, v51, v53
    v_mfma_f32_16x16x32_bf16 a[64:67], v[80:83], v[216:219], a[64:67]
    ds_read_b64_tr_b16 v[72:73], v246 offset:256
    v_cvt_pk_bf16_f32 v236, v60, v61
    v_accvgpr_read_b32 v48, a136
    v_mfma_f32_16x16x32_bf16 a[68:71], v[80:83], v[220:223], a[68:71]
    s_waitcnt lgkmcnt(9)
    ds_read_b64_tr_b16 v[74:75], v246 offset:8448
    v_accvgpr_read_b32 v49, a192
    v_mfma_f32_16x16x32_bf16 a[76:79], v[84:87], v[220:223], a[76:79]
    ds_read_b64_tr_b16 v[76:77], v247 offset:256
    v_mul_f32 v50, v48, v4
    v_exp_f32 v50, v50
    v_mul_f32 v57, v57, v58
    v_mfma_f32_16x16x32_bf16 a[72:75], v[84:87], v[216:219], a[72:75]
    s_waitcnt lgkmcnt(9)
    ds_read_b64_tr_b16 v[78:79], v247 offset:8448
    buffer_load_dwordx4 v255, s[40:43], s69 offen offset:3072 lds
    v_mfma_f32_16x16x32_bf16 a[80:83], v[88:91], v[216:219], a[80:83]
    ds_read_b64_tr_b16 v[80:81], v100 offset:0
    v_fma_f32 v59, v59, v7, v7
    v_mfma_f32_16x16x32_bf16 a[84:87], v[88:91], v[220:223], a[84:87]
    s_waitcnt lgkmcnt(9)
    ds_read_b64_tr_b16 v[82:83], v100 offset:8192
    v_rcp_f32 v59, v59
    v_mfma_f32_16x16x32_bf16 a[92:95], v[92:95], v[220:223], a[92:95]
    ds_read_b64_tr_b16 v[84:85], v101 offset:0
    v_mul_f32 v60, v54, v56
    v_accvgpr_read_b32 v51, a137
    v_mfma_f32_16x16x32_bf16 a[88:91], v[92:95], v[216:219], a[88:91]
    s_waitcnt lgkmcnt(9)
    ds_read_b64_tr_b16 v[86:87], v101 offset:8192
    v_accvgpr_read_b32 v52, a193
    v_mfma_f32_16x16x32_bf16 a[96:99], v[64:67], v[216:219], a[96:99]
    ds_read_b64_tr_b16 v[88:89], v102 offset:0
    v_mul_f32 v53, v51, v4
    v_exp_f32 v53, v53
    v_mul_f32 v48, v48, v49
    v_mfma_f32_16x16x32_bf16 a[100:103], v[64:67], v[220:223], a[100:103]
    s_waitcnt lgkmcnt(9)
    ds_read_b64_tr_b16 v[90:91], v102 offset:8192
    buffer_load_dword v44, v43, s[12:15], s16 offen
    v_mfma_f32_16x16x32_bf16 a[108:111], v[68:71], v[220:223], a[108:111]
    s_add_u32 s16, s16, 0x40010000
    ds_read_b64_tr_b16 v[92:93], v103 offset:0
    v_fma_f32 v50, v50, v6, v6
    v_mfma_f32_16x16x32_bf16 a[104:107], v[68:71], v[216:219], a[104:107]
    s_waitcnt lgkmcnt(9)
    ds_read_b64_tr_b16 v[94:95], v103 offset:8192
    v_rcp_f32 v50, v50
    v_mfma_f32_16x16x32_bf16 a[112:115], v[72:75], v[216:219], a[112:115]
    ds_read_b64_tr_b16 v[64:65], v104 offset:0
    v_mul_f32 v61, v57, v59
    v_cvt_pk_bf16_f32 v237, v60, v61
    v_mfma_f32_16x16x32_bf16 a[116:119], v[72:75], v[220:223], a[116:119]
    s_waitcnt lgkmcnt(9)
    ds_read_b64_tr_b16 v[66:67], v104 offset:8192
    v_accvgpr_read_b32 v54, a138
    v_mfma_f32_16x16x32_bf16 a[124:127], v[76:79], v[220:223], a[124:127]
    ds_read_b64_tr_b16 v[68:69], v105 offset:0
    v_accvgpr_read_b32 v55, a194
    v_mul_f32 v56, v54, v4
    v_mfma_f32_16x16x32_bf16 a[120:123], v[76:79], v[216:219], a[120:123]
    s_waitcnt lgkmcnt(9)
    ds_read_b64_tr_b16 v[70:71], v105 offset:8192
    v_exp_f32 v56, v56
    v_mfma_f32_16x16x32_bf16 a[0:3], v[80:83], v[208:211], a[0:3]
    ds_read_b64_tr_b16 v[72:73], v106 offset:0
    v_mul_f32 v51, v51, v52
    v_mfma_f32_16x16x32_bf16 a[4:7], v[80:83], v[212:215], a[4:7]
    s_waitcnt lgkmcnt(9)
    ds_read_b64_tr_b16 v[74:75], v106 offset:8192
    v_fma_f32 v53, v53, v6, v6
    v_rcp_f32 v53, v53
    v_mfma_f32_16x16x32_bf16 a[12:15], v[84:87], v[212:215], a[12:15]
    ds_read_b64_tr_b16 v[76:77], v107 offset:0
    v_mul_f32 v60, v48, v50
    v_mfma_f32_16x16x32_bf16 a[8:11], v[84:87], v[208:211], a[8:11]
    s_waitcnt lgkmcnt(9)
    ds_read_b64_tr_b16 v[78:79], v107 offset:8192
    v_accvgpr_read_b32 v57, a139
    v_mfma_f32_16x16x32_bf16 a[16:19], v[88:91], v[208:211], a[16:19]
    ds_read_b64_tr_b16 v[80:81], v100 offset:256
    v_accvgpr_read_b32 v58, a195
    v_mul_f32 v59, v57, v4
    v_mfma_f32_16x16x32_bf16 a[20:23], v[88:91], v[212:215], a[20:23]
    s_waitcnt lgkmcnt(9)
    ds_read_b64_tr_b16 v[82:83], v100 offset:8448
    v_exp_f32 v59, v59
    v_mul_f32 v54, v54, v55
    v_mfma_f32_16x16x32_bf16 a[28:31], v[92:95], v[212:215], a[28:31]
    s_waitcnt vmcnt(9)
    s_barrier
    ds_read_b64_tr_b16 v[84:85], v101 offset:256
    v_mfma_f32_16x16x32_bf16 a[24:27], v[92:95], v[208:211], a[24:27]
    s_waitcnt lgkmcnt(9)
    ds_read_b64_tr_b16 v[86:87], v101 offset:8448
    v_fma_f32 v56, v56, v6, v6
    v_rcp_f32 v56, v56
    v_mfma_f32_16x16x32_bf16 a[32:35], v[64:67], v[208:211], a[32:35]
    s_add_u32 m0, s67, 49152
    s_add_u32 s68, s79, 2097152
    ds_read_b64_tr_b16 v[88:89], v102 offset:256
    v_mul_f32 v61, v51, v53
    v_cvt_pk_bf16_f32 v234, v60, v61
    v_mfma_f32_16x16x32_bf16 a[36:39], v[64:67], v[212:215], a[36:39]
    s_waitcnt lgkmcnt(9)
    ds_read_b64_tr_b16 v[90:91], v102 offset:8448
    buffer_load_dwordx4 v252, s[40:43], s68 offen offset:0 lds
    v_mfma_f32_16x16x32_bf16 a[44:47], v[68:71], v[212:215], a[44:47]
    ds_read_b64_tr_b16 v[92:93], v103 offset:256
    v_accvgpr_read_b32 v48, a140
    v_accvgpr_read_b32 v49, a196
    v_mfma_f32_16x16x32_bf16 a[40:43], v[68:71], v[208:211], a[40:43]
    s_waitcnt lgkmcnt(9)
    ds_read_b64_tr_b16 v[94:95], v103 offset:8448
    v_mul_f32 v50, v48, v5
    v_mfma_f32_16x16x32_bf16 a[48:51], v[72:75], v[208:211], a[48:51]
    ds_read_b64_tr_b16 v[64:65], v104 offset:256
    v_exp_f32 v50, v50
    v_mfma_f32_16x16x32_bf16 a[52:55], v[72:75], v[212:215], a[52:55]
    s_waitcnt lgkmcnt(9)
    ds_read_b64_tr_b16 v[66:67], v104 offset:8448
    v_mul_f32 v57, v57, v58
    v_mfma_f32_16x16x32_bf16 a[60:63], v[76:79], v[212:215], a[60:63]
    ds_read_b64_tr_b16 v[68:69], v105 offset:256
    v_fma_f32 v59, v59, v6, v6
    v_rcp_f32 v59, v59
    v_mul_f32 v60, v54, v56
    v_mfma_f32_16x16x32_bf16 a[56:59], v[76:79], v[208:211], a[56:59]
    s_waitcnt lgkmcnt(9)
    ds_read_b64_tr_b16 v[70:71], v105 offset:8448
    buffer_load_dwordx4 v253, s[40:43], s68 offen offset:1024 lds
    v_mfma_f32_16x16x32_bf16 a[64:67], v[80:83], v[208:211], a[64:67]
    ds_read_b64_tr_b16 v[72:73], v106 offset:256
    v_accvgpr_read_b32 v51, a141
    v_mfma_f32_16x16x32_bf16 a[68:71], v[80:83], v[212:215], a[68:71]
    s_waitcnt lgkmcnt(9)
    ds_read_b64_tr_b16 v[74:75], v106 offset:8448
    v_accvgpr_read_b32 v52, a197
    v_mul_f32 v53, v51, v5
    v_mfma_f32_16x16x32_bf16 a[76:79], v[84:87], v[212:215], a[76:79]
    ds_read_b64_tr_b16 v[76:77], v107 offset:256
    v_exp_f32 v53, v53
    v_mfma_f32_16x16x32_bf16 a[72:75], v[84:87], v[208:211], a[72:75]
    s_waitcnt lgkmcnt(9)
    ds_read_b64_tr_b16 v[78:79], v107 offset:8448
    v_mul_f32 v48, v48, v49
    v_mfma_f32_16x16x32_bf16 a[80:83], v[88:91], v[208:211], a[80:83]
    ds_read_b64_tr_b16 v[80:81], v240 offset:16384
    v_fma_f32 v50, v50, v7, v7
    v_rcp_f32 v50, v50
    v_mul_f32 v61, v57, v59
    v_mfma_f32_16x16x32_bf16 a[84:87], v[88:91], v[212:215], a[84:87]
    s_waitcnt lgkmcnt(9)
    ds_read_b64_tr_b16 v[82:83], v240 offset:24576
    buffer_load_dwordx4 v254, s[40:43], s68 offen offset:2048 lds
    v_mfma_f32_16x16x32_bf16 a[92:95], v[92:95], v[212:215], a[92:95]
    ds_read_b64_tr_b16 v[84:85], v100 offset:16384
    v_cvt_pk_bf16_f32 v235, v60, v61
    v_mfma_f32_16x16x32_bf16 a[88:91], v[92:95], v[208:211], a[88:91]
    s_waitcnt lgkmcnt(9)
    ds_read_b64_tr_b16 v[86:87], v100 offset:24576
    v_accvgpr_read_b32 v54, a142
    v_accvgpr_read_b32 v55, a198
    v_mfma_f32_16x16x32_bf16 a[96:99], v[64:67], v[208:211], a[96:99]
    ds_read_b64_tr_b16 v[88:89], v241 offset:16384
    v_mul_f32 v56, v54, v5
    v_exp_f32 v56, v56
    v_mfma_f32_16x16x32_bf16 a[100:103], v[64:67], v[212:215], a[100:103]
    s_waitcnt lgkmcnt(9)
    ds_read_b64_tr_b16 v[90:91], v241 offset:24576
    v_mul_f32 v51, v51, v52
    v_mfma_f32_16x16x32_bf16 a[108:111], v[68:71], v[212:215], a[108:111]
    ds_read_b64_tr_b16 v[92:93], v101 offset:16384
    v_fma_f32 v53, v53, v7, v7
    v_rcp_f32 v53, v53
    v_mfma_f32_16x16x32_bf16 a[104:107], v[68:71], v[208:211], a[104:107]
    s_waitcnt lgkmcnt(9)
    ds_read_b64_tr_b16 v[94:95], v101 offset:24576
    buffer_load_dwordx4 v255, s[40:43], s68 offen offset:3072 lds
    v_mfma_f32_16x16x32_bf16 a[112:115], v[72:75], v[208:211], a[112:115]
    ds_read_b64_tr_b16 v[64:65], v242 offset:16384
    v_mul_f32 v60, v48, v50
    v_mfma_f32_16x16x32_bf16 a[116:119], v[72:75], v[212:215], a[116:119]
    s_waitcnt lgkmcnt(9)
    ds_read_b64_tr_b16 v[66:67], v242 offset:24576
    v_accvgpr_read_b32 v57, a143
    v_accvgpr_read_b32 v58, a199
    v_mfma_f32_16x16x32_bf16 a[124:127], v[76:79], v[212:215], a[124:127]
    ds_read_b64_tr_b16 v[68:69], v102 offset:16384
    v_mul_f32 v59, v57, v5
    v_mfma_f32_16x16x32_bf16 a[120:123], v[76:79], v[208:211], a[120:123]
    s_waitcnt lgkmcnt(9)
    ds_read_b64_tr_b16 v[70:71], v102 offset:24576
    v_exp_f32 v59, v59
    v_mul_f32 v54, v54, v55
    v_fma_f32 v56, v56, v7, v7
    v_mfma_f32_16x16x32_bf16 a[0:3], v[80:83], v[200:203], a[0:3]
    s_waitcnt lgkmcnt(8)
    s_add_u32 m0, s67, 114688
    ds_read_b64_tr_b16 v[72:73], v243 offset:16384
    v_rcp_f32 v56, v56
    v_mfma_f32_16x16x32_bf16 a[0:3], v[84:87], v[192:195], a[0:3]
    s_add_u32 s69, s79, 2359296
    ds_read_b64_tr_b16 v[74:75], v243 offset:24576
    v_mul_f32 v61, v51, v53
    v_mfma_f32_16x16x32_bf16 a[4:7], v[84:87], v[196:199], a[4:7]
    ds_read_b64_tr_b16 v[76:77], v103 offset:16384
    buffer_load_dwordx4 v252, s[40:43], s69 offen offset:0 lds
    v_mfma_f32_16x16x32_bf16 a[4:7], v[80:83], v[204:207], a[4:7]
    s_waitcnt lgkmcnt(9)
    ds_read_b64_tr_b16 v[78:79], v103 offset:24576
    v_cvt_pk_bf16_f32 v238, v60, v61
    v_accvgpr_read_b32 v48, a144
    v_mfma_f32_16x16x32_bf16 a[8:11], v[88:91], v[200:203], a[8:11]
    s_waitcnt lgkmcnt(8)
    ds_read_b64_tr_b16 v[80:81], v244 offset:16384
    v_accvgpr_read_b32 v49, a200
    v_mfma_f32_16x16x32_bf16 a[8:11], v[92:95], v[192:195], a[8:11]
    ds_read_b64_tr_b16 v[82:83], v244 offset:24576
    v_mul_f32 v50, v48, v4
    v_exp_f32 v50, v50
    v_mfma_f32_16x16x32_bf16 a[12:15], v[92:95], v[196:199], a[12:15]
    ds_read_b64_tr_b16 v[84:85], v104 offset:16384
    v_mul_f32 v57, v57, v58
    v_fma_f32 v59, v59, v7, v7
    v_mfma_f32_16x16x32_bf16 a[12:15], v[88:91], v[204:207], a[12:15]
    s_waitcnt lgkmcnt(9)
    ds_read_b64_tr_b16 v[86:87], v104 offset:24576
    buffer_load_dwordx4 v253, s[40:43], s69 offen offset:1024 lds
    v_mfma_f32_16x16x32_bf16 a[16:19], v[64:67], v[200:203], a[16:19]
    s_waitcnt lgkmcnt(8)
    ds_read_b64_tr_b16 v[88:89], v245 offset:16384
    v_rcp_f32 v59, v59
    v_mfma_f32_16x16x32_bf16 a[16:19], v[68:71], v[192:195], a[16:19]
    ds_read_b64_tr_b16 v[90:91], v245 offset:24576
    v_mul_f32 v60, v54, v56
    v_accvgpr_read_b32 v51, a145
    v_mfma_f32_16x16x32_bf16 a[20:23], v[68:71], v[196:199], a[20:23]
    ds_read_b64_tr_b16 v[92:93], v105 offset:16384
    v_accvgpr_read_b32 v52, a201
    v_mfma_f32_16x16x32_bf16 a[20:23], v[64:67], v[204:207], a[20:23]
    s_waitcnt lgkmcnt(9)
    ds_read_b64_tr_b16 v[94:95], v105 offset:24576
    v_mul_f32 v53, v51, v4
    v_exp_f32 v53, v53
    v_mfma_f32_16x16x32_bf16 a[24:27], v[72:75], v[200:203], a[24:27]
    s_waitcnt lgkmcnt(8)
    ds_read_b64_tr_b16 v[64:65], v246 offset:16384
    v_mul_f32 v48, v48, v49
    v_fma_f32 v50, v50, v6, v6
    v_mfma_f32_16x16x32_bf16 a[24:27], v[76:79], v[192:195], a[24:27]
    ds_read_b64_tr_b16 v[66:67], v246 offset:24576
    buffer_load_dwordx4 v254, s[40:43], s69 offen offset:2048 lds
    v_mfma_f32_16x16x32_bf16 a[28:31], v[76:79], v[196:199], a[28:31]
    ds_read_b64_tr_b16 v[68:69], v106 offset:16384
    v_rcp_f32 v50, v50
    v_mfma_f32_16x16x32_bf16 a[28:31], v[72:75], v[204:207], a[28:31]
    s_waitcnt lgkmcnt(9)
    ds_read_b64_tr_b16 v[70:71], v106 offset:24576
    v_mul_f32 v61, v57, v59
    v_mfma_f32_16x16x32_bf16 a[32:35], v[80:83], v[200:203], a[32:35]
    s_waitcnt lgkmcnt(8)
    ds_read_b64_tr_b16 v[72:73], v247 offset:16384
    v_cvt_pk_bf16_f32 v239, v60, v61
    v_accvgpr_read_b32 v54, a146
    v_mfma_f32_16x16x32_bf16 a[32:35], v[84:87], v[192:195], a[32:35]
    ds_read_b64_tr_b16 v[74:75], v247 offset:24576
    v_accvgpr_read_b32 v55, a202
    v_mul_f32 v56, v54, v4
    v_mfma_f32_16x16x32_bf16 a[36:39], v[84:87], v[196:199], a[36:39]
    ds_read_b64_tr_b16 v[76:77], v107 offset:16384
    v_exp_f32 v56, v56
    v_mul_f32 v51, v51, v52
    v_mfma_f32_16x16x32_bf16 a[36:39], v[80:83], v[204:207], a[36:39]
    s_waitcnt lgkmcnt(9)
    ds_read_b64_tr_b16 v[78:79], v107 offset:24576
    buffer_load_dwordx4 v255, s[40:43], s69 offen offset:3072 lds
    v_mfma_f32_16x16x32_bf16 a[40:43], v[88:91], v[200:203], a[40:43]
    s_waitcnt lgkmcnt(8)
    ds_read_b64_tr_b16 v[80:81], v240 offset:16640
    v_fma_f32 v53, v53, v6, v6
    v_rcp_f32 v53, v53
    v_mfma_f32_16x16x32_bf16 a[40:43], v[92:95], v[192:195], a[40:43]
    ds_read_b64_tr_b16 v[82:83], v240 offset:24832
    v_mul_f32 v60, v48, v50
    v_mfma_f32_16x16x32_bf16 a[44:47], v[92:95], v[196:199], a[44:47]
    ds_read_b64_tr_b16 v[84:85], v100 offset:16640
    v_accvgpr_read_b32 v57, a147
    v_mfma_f32_16x16x32_bf16 a[44:47], v[88:91], v[204:207], a[44:47]
    s_waitcnt lgkmcnt(9)
    ds_read_b64_tr_b16 v[86:87], v100 offset:24832
    v_accvgpr_read_b32 v58, a203
    v_mul_f32 v59, v57, v4
    v_mfma_f32_16x16x32_bf16 a[48:51], v[64:67], v[200:203], a[48:51]
    s_waitcnt lgkmcnt(8)
    ds_read_b64_tr_b16 v[88:89], v241 offset:16640
    v_exp_f32 v59, v59
    v_mfma_f32_16x16x32_bf16 a[48:51], v[68:71], v[192:195], a[48:51]
    ds_read_b64_tr_b16 v[90:91], v241 offset:24832
    v_mul_f32 v54, v54, v55
    v_mfma_f32_16x16x32_bf16 a[52:55], v[68:71], v[196:199], a[52:55]
    ds_read_b64_tr_b16 v[92:93], v101 offset:16640
    v_fma_f32 v56, v56, v6, v6
    v_mfma_f32_16x16x32_bf16 a[52:55], v[64:67], v[204:207], a[52:55]
    s_waitcnt lgkmcnt(9)
    ds_read_b64_tr_b16 v[94:95], v101 offset:24832
    v_rcp_f32 v56, v56
    v_mfma_f32_16x16x32_bf16 a[56:59], v[72:75], v[200:203], a[56:59]
    s_waitcnt lgkmcnt(8)
    ds_read_b64_tr_b16 v[64:65], v242 offset:16640
    v_mul_f32 v61, v51, v53
    v_cvt_pk_bf16_f32 v224, v60, v61
    v_mfma_f32_16x16x32_bf16 a[56:59], v[76:79], v[192:195], a[56:59]
    ds_read_b64_tr_b16 v[66:67], v242 offset:24832
    v_accvgpr_read_b32 v48, a148
    v_mfma_f32_16x16x32_bf16 a[60:63], v[76:79], v[196:199], a[60:63]
    ds_read_b64_tr_b16 v[68:69], v102 offset:16640
    v_accvgpr_read_b32 v49, a204
    v_mul_f32 v50, v48, v5
    v_mfma_f32_16x16x32_bf16 a[60:63], v[72:75], v[204:207], a[60:63]
    s_waitcnt lgkmcnt(9)
    ds_read_b64_tr_b16 v[70:71], v102 offset:24832
    v_exp_f32 v50, v50
    v_mfma_f32_16x16x32_bf16 a[64:67], v[80:83], v[200:203], a[64:67]
    s_waitcnt lgkmcnt(8)
    ds_read_b64_tr_b16 v[72:73], v243 offset:16640
    v_mul_f32 v57, v57, v58
    v_mfma_f32_16x16x32_bf16 a[64:67], v[84:87], v[192:195], a[64:67]
    ds_read_b64_tr_b16 v[74:75], v243 offset:24832
    v_fma_f32 v59, v59, v6, v6
    v_rcp_f32 v59, v59
    v_mfma_f32_16x16x32_bf16 a[68:71], v[84:87], v[196:199], a[68:71]
    ds_read_b64_tr_b16 v[76:77], v103 offset:16640
    v_mul_f32 v60, v54, v56
    v_mfma_f32_16x16x32_bf16 a[68:71], v[80:83], v[204:207], a[68:71]
    s_waitcnt lgkmcnt(9)
    ds_read_b64_tr_b16 v[78:79], v103 offset:24832
    v_accvgpr_read_b32 v51, a149
    v_mfma_f32_16x16x32_bf16 a[72:75], v[88:91], v[200:203], a[72:75]
    s_waitcnt lgkmcnt(8)
    ds_read_b64_tr_b16 v[80:81], v244 offset:16640
    v_accvgpr_read_b32 v52, a205
    v_mul_f32 v53, v51, v5
    v_mfma_f32_16x16x32_bf16 a[72:75], v[92:95], v[192:195], a[72:75]
    ds_read_b64_tr_b16 v[82:83], v244 offset:24832
    v_exp_f32 v53, v53
    v_mul_f32 v48, v48, v49
    v_mfma_f32_16x16x32_bf16 a[76:79], v[92:95], v[196:199], a[76:79]
    s_waitcnt vmcnt(9)
    s_barrier
    ds_read_b64_tr_b16 v[84:85], v104 offset:16640
    v_mfma_f32_16x16x32_bf16 a[76:79], v[88:91], v[204:207], a[76:79]
    s_waitcnt lgkmcnt(9)
    ds_read_b64_tr_b16 v[86:87], v104 offset:24832
    v_fma_f32 v50, v50, v7, v7
    v_rcp_f32 v50, v50
    v_mfma_f32_16x16x32_bf16 a[80:83], v[64:67], v[200:203], a[80:83]
    s_waitcnt lgkmcnt(8)
    s_add_u32 m0, s67, 0
    ds_read_b64_tr_b16 v[88:89], v245 offset:16640
    v_mul_f32 v61, v57, v59
    v_cvt_pk_bf16_f32 v225, v60, v61
    v_mfma_f32_16x16x32_bf16 a[80:83], v[68:71], v[192:195], a[80:83]
    s_add_u32 s68, s79, 2621440
    ds_read_b64_tr_b16 v[90:91], v245 offset:24832
    v_accvgpr_read_b32 v54, a150
    v_accvgpr_read_b32 v55, a206
    v_mfma_f32_16x16x32_bf16 a[84:87], v[68:71], v[196:199], a[84:87]
    ds_read_b64_tr_b16 v[92:93], v105 offset:16640
    buffer_load_dwordx4 v252, s[40:43], s68 offen offset:0 lds
    v_mfma_f32_16x16x32_bf16 a[84:87], v[64:67], v[204:207], a[84:87]
    s_waitcnt lgkmcnt(9)
    ds_read_b64_tr_b16 v[94:95], v105 offset:24832
    v_mul_f32 v56, v54, v5
    v_mfma_f32_16x16x32_bf16 a[88:91], v[72:75], v[200:203], a[88:91]
    s_waitcnt lgkmcnt(8)
    ds_read_b64_tr_b16 v[64:65], v246 offset:16640
    v_exp_f32 v56, v56
    v_mfma_f32_16x16x32_bf16 a[88:91], v[76:79], v[192:195], a[88:91]
    ds_read_b64_tr_b16 v[66:67], v246 offset:24832
    v_mul_f32 v51, v51, v52
    v_fma_f32 v53, v53, v7, v7
    v_mfma_f32_16x16x32_bf16 a[92:95], v[76:79], v[196:199], a[92:95]
    ds_read_b64_tr_b16 v[68:69], v106 offset:16640
    v_rcp_f32 v53, v53
    v_mul_f32 v60, v48, v50
    v_mfma_f32_16x16x32_bf16 a[92:95], v[72:75], v[204:207], a[92:95]
    s_waitcnt lgkmcnt(9)
    ds_read_b64_tr_b16 v[70:71], v106 offset:24832
    buffer_load_dwordx4 v253, s[40:43], s68 offen offset:1024 lds
    v_mfma_f32_16x16x32_bf16 a[96:99], v[80:83], v[200:203], a[96:99]
    s_waitcnt lgkmcnt(8)
    ds_read_b64_tr_b16 v[72:73], v247 offset:16640
    v_accvgpr_read_b32 v57, a151
    v_accvgpr_read_b32 v58, a207
    v_mfma_f32_16x16x32_bf16 a[96:99], v[84:87], v[192:195], a[96:99]
    ds_read_b64_tr_b16 v[74:75], v247 offset:24832
    v_mul_f32 v59, v57, v5
    v_mfma_f32_16x16x32_bf16 a[100:103], v[84:87], v[196:199], a[100:103]
    ds_read_b64_tr_b16 v[76:77], v107 offset:16640
    v_exp_f32 v59, v59
    v_mfma_f32_16x16x32_bf16 a[100:103], v[80:83], v[204:207], a[100:103]
    s_waitcnt lgkmcnt(9)
    ds_read_b64_tr_b16 v[78:79], v107 offset:24832
    v_mul_f32 v54, v54, v55
    v_fma_f32 v56, v56, v7, v7
    v_mfma_f32_16x16x32_bf16 a[104:107], v[88:91], v[200:203], a[104:107]
    s_waitcnt lgkmcnt(8)
    ds_read_b64_tr_b16 v[80:81], v240 offset:32768
    v_rcp_f32 v56, v56
    v_mul_f32 v61, v51, v53
    v_mfma_f32_16x16x32_bf16 a[104:107], v[92:95], v[192:195], a[104:107]
    ds_read_b64_tr_b16 v[82:83], v240 offset:40960
    buffer_load_dwordx4 v254, s[40:43], s68 offen offset:2048 lds
    v_mfma_f32_16x16x32_bf16 a[108:111], v[92:95], v[196:199], a[108:111]
    ds_read_b64_tr_b16 v[84:85], v100 offset:32768
    v_cvt_pk_bf16_f32 v228, v60, v61
    v_accvgpr_read_b32 v48, a152
    v_mfma_f32_16x16x32_bf16 a[108:111], v[88:91], v[204:207], a[108:111]
    s_waitcnt lgkmcnt(9)
    ds_read_b64_tr_b16 v[86:87], v100 offset:40960
    v_accvgpr_read_b32 v49, a208
    v_mfma_f32_16x16x32_bf16 a[112:115], v[64:67], v[200:203], a[112:115]
    s_waitcnt lgkmcnt(8)
    ds_read_b64_tr_b16 v[88:89], v241 offset:32768
    v_mul_f32 v50, v48, v4
    v_exp_f32 v50, v50
    v_mfma_f32_16x16x32_bf16 a[112:115], v[68:71], v[192:195], a[112:115]
    ds_read_b64_tr_b16 v[90:91], v241 offset:40960
    v_mul_f32 v57, v57, v58
    v_mfma_f32_16x16x32_bf16 a[116:119], v[68:71], v[196:199], a[116:119]
    ds_read_b64_tr_b16 v[92:93], v101 offset:32768
    v_fma_f32 v59, v59, v7, v7
    v_rcp_f32 v59, v59
    v_mfma_f32_16x16x32_bf16 a[116:119], v[64:67], v[204:207], a[116:119]
    s_waitcnt lgkmcnt(9)
    ds_read_b64_tr_b16 v[94:95], v101 offset:40960
    buffer_load_dwordx4 v255, s[40:43], s68 offen offset:3072 lds
    v_mfma_f32_16x16x32_bf16 a[120:123], v[72:75], v[200:203], a[120:123]
    s_waitcnt lgkmcnt(8)
    ds_read_b64_tr_b16 v[64:65], v242 offset:32768
    v_mul_f32 v60, v54, v56
    v_mfma_f32_16x16x32_bf16 a[120:123], v[76:79], v[192:195], a[120:123]
    ds_read_b64_tr_b16 v[66:67], v242 offset:40960
    v_accvgpr_read_b32 v51, a153
    v_accvgpr_read_b32 v52, a209
    v_mfma_f32_16x16x32_bf16 a[124:127], v[76:79], v[196:199], a[124:127]
    ds_read_b64_tr_b16 v[68:69], v102 offset:32768
    v_mul_f32 v53, v51, v4
    v_exp_f32 v53, v53
    v_mfma_f32_16x16x32_bf16 a[124:127], v[72:75], v[204:207], a[124:127]
    s_waitcnt lgkmcnt(9)
    ds_read_b64_tr_b16 v[70:71], v102 offset:40960
    v_mul_f32 v48, v48, v49
    v_fma_f32 v50, v50, v6, v6
    v_mfma_f32_16x16x32_bf16 a[0:3], v[80:83], v[184:187], a[0:3]
    s_waitcnt lgkmcnt(8)
    s_add_u32 m0, s67, 65536
    ds_read_b64_tr_b16 v[72:73], v243 offset:32768
    v_rcp_f32 v50, v50
    v_mfma_f32_16x16x32_bf16 a[0:3], v[84:87], v[176:179], a[0:3]
    s_add_u32 s69, s79, 2883584
    ds_read_b64_tr_b16 v[74:75], v243 offset:40960
    v_mul_f32 v61, v57, v59
    v_mfma_f32_16x16x32_bf16 a[4:7], v[84:87], v[180:183], a[4:7]
    ds_read_b64_tr_b16 v[76:77], v103 offset:32768
    buffer_load_dwordx4 v252, s[40:43], s69 offen offset:0 lds
    v_mfma_f32_16x16x32_bf16 a[4:7], v[80:83], v[188:191], a[4:7]
    s_waitcnt lgkmcnt(9)
    ds_read_b64_tr_b16 v[78:79], v103 offset:40960
    v_cvt_pk_bf16_f32 v229, v60, v61
    v_accvgpr_read_b32 v54, a154
    v_mfma_f32_16x16x32_bf16 a[8:11], v[88:91], v[184:187], a[8:11]
    s_waitcnt lgkmcnt(8)
    ds_read_b64_tr_b16 v[80:81], v244 offset:32768
    v_accvgpr_read_b32 v55, a210
    v_mul_f32 v56, v54, v4
    v_mfma_f32_16x16x32_bf16 a[8:11], v[92:95], v[176:179], a[8:11]
    ds_read_b64_tr_b16 v[82:83], v244 offset:40960
    v_exp_f32 v56, v56
    v_mfma_f32_16x16x32_bf16 a[12:15], v[92:95], v[180:183], a[12:15]
    ds_read_b64_tr_b16 v[84:85], v104 offset:32768
    v_mul_f32 v51, v51, v52
    v_fma_f32 v53, v53, v6, v6
    v_mfma_f32_16x16x32_bf16 a[12:15], v[88:91], v[188:191], a[12:15]
    s_waitcnt lgkmcnt(9)
    ds_read_b64_tr_b16 v[86:87], v104 offset:40960
    buffer_load_dwordx4 v253, s[40:43], s69 offen offset:1024 lds
    v_mfma_f32_16x16x32_bf16 a[16:19], v[64:67], v[184:187], a[16:19]
    s_waitcnt lgkmcnt(8)
    ds_read_b64_tr_b16 v[88:89], v245 offset:32768
    v_rcp_f32 v53, v53
    v_mfma_f32_16x16x32_bf16 a[16:19], v[68:71], v[176:179], a[16:19]
    ds_read_b64_tr_b16 v[90:91], v245 offset:40960
    v_mul_f32 v60, v48, v50
    v_accvgpr_read_b32 v57, a155
    v_mfma_f32_16x16x32_bf16 a[20:23], v[68:71], v[180:183], a[20:23]
    ds_read_b64_tr_b16 v[92:93], v105 offset:32768
    v_accvgpr_read_b32 v58, a211
    v_mfma_f32_16x16x32_bf16 a[20:23], v[64:67], v[188:191], a[20:23]
    s_waitcnt lgkmcnt(9)
    ds_read_b64_tr_b16 v[94:95], v105 offset:40960
    v_mul_f32 v59, v57, v4
    v_exp_f32 v59, v59
    v_mfma_f32_16x16x32_bf16 a[24:27], v[72:75], v[184:187], a[24:27]
    s_waitcnt lgkmcnt(8)
    ds_read_b64_tr_b16 v[64:65], v246 offset:32768
    v_mul_f32 v54, v54, v55
    v_fma_f32 v56, v56, v6, v6
    v_mfma_f32_16x16x32_bf16 a[24:27], v[76:79], v[176:179], a[24:27]
    ds_read_b64_tr_b16 v[66:67], v246 offset:40960
    buffer_load_dwordx4 v254, s[40:43], s69 offen offset:2048 lds
    v_mfma_f32_16x16x32_bf16 a[28:31], v[76:79], v[180:183], a[28:31]
    ds_read_b64_tr_b16 v[68:69], v106 offset:32768
    v_rcp_f32 v56, v56
    v_mfma_f32_16x16x32_bf16 a[28:31], v[72:75], v[188:191], a[28:31]
    s_waitcnt lgkmcnt(9)
    ds_read_b64_tr_b16 v[70:71], v106 offset:40960
    v_mul_f32 v61, v51, v53
    v_cvt_pk_bf16_f32 v226, v60, v61
    v_mfma_f32_16x16x32_bf16 a[32:35], v[80:83], v[184:187], a[32:35]
    s_waitcnt lgkmcnt(8)
    ds_read_b64_tr_b16 v[72:73], v247 offset:32768
    v_accvgpr_read_b32 v48, a156
    v_mfma_f32_16x16x32_bf16 a[32:35], v[84:87], v[176:179], a[32:35]
    ds_read_b64_tr_b16 v[74:75], v247 offset:40960
    v_accvgpr_read_b32 v49, a212
    v_mul_f32 v50, v48, v5
    v_mfma_f32_16x16x32_bf16 a[36:39], v[84:87], v[180:183], a[36:39]
    ds_read_b64_tr_b16 v[76:77], v107 offset:32768
    v_exp_f32 v50, v50
    v_mul_f32 v57, v57, v58
    v_mfma_f32_16x16x32_bf16 a[36:39], v[80:83], v[188:191], a[36:39]
    s_waitcnt lgkmcnt(9)
    ds_read_b64_tr_b16 v[78:79], v107 offset:40960
    buffer_load_dwordx4 v255, s[40:43], s69 offen offset:3072 lds
    v_mfma_f32_16x16x32_bf16 a[40:43], v[88:91], v[184:187], a[40:43]
    s_waitcnt lgkmcnt(8)
    ds_read_b64_tr_b16 v[80:81], v240 offset:33024
    v_fma_f32 v59, v59, v6, v6
    v_rcp_f32 v59, v59
    v_mfma_f32_16x16x32_bf16 a[40:43], v[92:95], v[176:179], a[40:43]
    ds_read_b64_tr_b16 v[82:83], v240 offset:41216
    v_mul_f32 v60, v54, v56
    v_mfma_f32_16x16x32_bf16 a[44:47], v[92:95], v[180:183], a[44:47]
    ds_read_b64_tr_b16 v[84:85], v100 offset:33024
    v_accvgpr_read_b32 v51, a157
    v_mfma_f32_16x16x32_bf16 a[44:47], v[88:91], v[188:191], a[44:47]
    s_waitcnt lgkmcnt(9)
    ds_read_b64_tr_b16 v[86:87], v100 offset:41216
    v_accvgpr_read_b32 v52, a213
    v_mul_f32 v53, v51, v5
    v_mfma_f32_16x16x32_bf16 a[48:51], v[64:67], v[184:187], a[48:51]
    s_waitcnt lgkmcnt(8)
    ds_read_b64_tr_b16 v[88:89], v241 offset:33024
    v_exp_f32 v53, v53
    v_mul_f32 v48, v48, v49
    v_mfma_f32_16x16x32_bf16 a[48:51], v[68:71], v[176:179], a[48:51]
    ds_read_b64_tr_b16 v[90:91], v241 offset:41216
    buffer_store_dword v46, v47, s[60:63], s3 offen sc1
    v_mfma_f32_16x16x32_bf16 a[52:55], v[68:71], v[180:183], a[52:55]
    ds_read_b64_tr_b16 v[92:93], v101 offset:33024
    v_fma_f32 v50, v50, v7, v7
    v_rcp_f32 v50, v50
    v_mfma_f32_16x16x32_bf16 a[52:55], v[64:67], v[188:191], a[52:55]
    s_waitcnt lgkmcnt(9)
    ds_read_b64_tr_b16 v[94:95], v101 offset:41216
    v_mul_f32 v61, v57, v59
    v_mfma_f32_16x16x32_bf16 a[56:59], v[72:75], v[184:187], a[56:59]
    s_waitcnt lgkmcnt(8)
    ds_read_b64_tr_b16 v[64:65], v242 offset:33024
    v_cvt_pk_bf16_f32 v227, v60, v61
    v_mfma_f32_16x16x32_bf16 a[56:59], v[76:79], v[176:179], a[56:59]
    ds_read_b64_tr_b16 v[66:67], v242 offset:41216
    v_accvgpr_read_b32 v54, a158
    v_accvgpr_read_b32 v55, a214
    v_mfma_f32_16x16x32_bf16 a[60:63], v[76:79], v[180:183], a[60:63]
    ds_read_b64_tr_b16 v[68:69], v102 offset:33024
    v_mul_f32 v56, v54, v5
    v_mfma_f32_16x16x32_bf16 a[60:63], v[72:75], v[188:191], a[60:63]
    s_waitcnt lgkmcnt(9)
    ds_read_b64_tr_b16 v[70:71], v102 offset:41216
    v_exp_f32 v56, v56
    v_mfma_f32_16x16x32_bf16 a[64:67], v[80:83], v[184:187], a[64:67]
    s_waitcnt lgkmcnt(8)
    ds_read_b64_tr_b16 v[72:73], v243 offset:33024
    v_mul_f32 v51, v51, v52
    v_fma_f32 v53, v53, v7, v7
    v_mfma_f32_16x16x32_bf16 a[64:67], v[84:87], v[176:179], a[64:67]
    ds_read_b64_tr_b16 v[74:75], v243 offset:41216
    v_rcp_f32 v53, v53
    v_mfma_f32_16x16x32_bf16 a[68:71], v[84:87], v[180:183], a[68:71]
    ds_read_b64_tr_b16 v[76:77], v103 offset:33024
    v_mul_f32 v60, v48, v50
    v_mfma_f32_16x16x32_bf16 a[68:71], v[80:83], v[188:191], a[68:71]
    s_waitcnt lgkmcnt(9)
    ds_read_b64_tr_b16 v[78:79], v103 offset:41216
    v_accvgpr_read_b32 v57, a159
    v_accvgpr_read_b32 v58, a215
    v_mfma_f32_16x16x32_bf16 a[72:75], v[88:91], v[184:187], a[72:75]
    s_waitcnt lgkmcnt(8)
    ds_read_b64_tr_b16 v[80:81], v244 offset:33024
    v_mul_f32 v59, v57, v5
    v_mfma_f32_16x16x32_bf16 a[72:75], v[92:95], v[176:179], a[72:75]
    ds_read_b64_tr_b16 v[82:83], v244 offset:41216
    v_exp_f32 v59, v59
    v_mul_f32 v54, v54, v55
    v_mfma_f32_16x16x32_bf16 a[76:79], v[92:95], v[180:183], a[76:79]
    s_waitcnt vmcnt(9)
    s_barrier
    ds_read_b64_tr_b16 v[84:85], v104 offset:33024
    v_mfma_f32_16x16x32_bf16 a[76:79], v[88:91], v[188:191], a[76:79]
    s_waitcnt lgkmcnt(9)
    ds_read_b64_tr_b16 v[86:87], v104 offset:41216
    v_fma_f32 v56, v56, v7, v7
    v_rcp_f32 v56, v56
    v_mul_f32 v61, v51, v53
    v_mfma_f32_16x16x32_bf16 a[80:83], v[64:67], v[184:187], a[80:83]
    s_waitcnt lgkmcnt(8)
    s_add_u32 m0, s67, 16384
    ds_read_b64_tr_b16 v[88:89], v245 offset:33024
    v_cvt_pk_bf16_f32 v230, v60, v61
    v_mfma_f32_16x16x32_bf16 a[80:83], v[68:71], v[176:179], a[80:83]
    s_add_u32 s68, s79, 3145728
    ds_read_b64_tr_b16 v[90:91], v245 offset:41216
    v_accvgpr_read_b32 v48, a160
    v_accvgpr_read_b32 v49, a216
    v_mfma_f32_16x16x32_bf16 a[84:87], v[68:71], v[180:183], a[84:87]
    ds_read_b64_tr_b16 v[92:93], v105 offset:33024
    buffer_load_dwordx4 v252, s[40:43], s68 offen offset:0 lds
    v_mfma_f32_16x16x32_bf16 a[84:87], v[64:67], v[188:191], a[84:87]
    s_waitcnt lgkmcnt(9)
    ds_read_b64_tr_b16 v[94:95], v105 offset:41216
    v_mul_f32 v50, v48, v4
    v_exp_f32 v50, v50
    v_mfma_f32_16x16x32_bf16 a[88:91], v[72:75], v[184:187], a[88:91]
    s_waitcnt lgkmcnt(8)
    ds_read_b64_tr_b16 v[64:65], v246 offset:33024
    v_mul_f32 v57, v57, v58
    v_mfma_f32_16x16x32_bf16 a[88:91], v[76:79], v[176:179], a[88:91]
    ds_read_b64_tr_b16 v[66:67], v246 offset:41216
    v_fma_f32 v59, v59, v7, v7
    v_mfma_f32_16x16x32_bf16 a[92:95], v[76:79], v[180:183], a[92:95]
    ds_read_b64_tr_b16 v[68:69], v106 offset:33024
    v_rcp_f32 v59, v59
    v_mul_f32 v60, v54, v56
    v_mfma_f32_16x16x32_bf16 a[92:95], v[72:75], v[188:191], a[92:95]
    s_waitcnt lgkmcnt(9)
    ds_read_b64_tr_b16 v[70:71], v106 offset:41216
    buffer_load_dwordx4 v253, s[40:43], s68 offen offset:1024 lds
    v_mfma_f32_16x16x32_bf16 a[96:99], v[80:83], v[184:187], a[96:99]
    s_waitcnt lgkmcnt(8)
    ds_read_b64_tr_b16 v[72:73], v247 offset:33024
    v_accvgpr_read_b32 v51, a161
    v_accvgpr_read_b32 v52, a217
    v_mfma_f32_16x16x32_bf16 a[96:99], v[84:87], v[176:179], a[96:99]
    ds_read_b64_tr_b16 v[74:75], v247 offset:41216
    v_mul_f32 v53, v51, v4
    v_exp_f32 v53, v53
    v_mfma_f32_16x16x32_bf16 a[100:103], v[84:87], v[180:183], a[100:103]
    ds_read_b64_tr_b16 v[76:77], v107 offset:33024
    v_mul_f32 v48, v48, v49
    v_mfma_f32_16x16x32_bf16 a[100:103], v[80:83], v[188:191], a[100:103]
    s_waitcnt lgkmcnt(9)
    ds_read_b64_tr_b16 v[78:79], v107 offset:41216
    v_fma_f32 v50, v50, v6, v6
    v_mfma_f32_16x16x32_bf16 a[104:107], v[88:91], v[184:187], a[104:107]
    s_waitcnt lgkmcnt(8)
    ds_read_b64_tr_b16 v[80:81], v240 offset:49152
    v_rcp_f32 v50, v50
    v_mul_f32 v61, v57, v59
    v_mfma_f32_16x16x32_bf16 a[104:107], v[92:95], v[176:179], a[104:107]
    ds_read_b64_tr_b16 v[82:83], v240 offset:57344
    buffer_load_dwordx4 v254, s[40:43], s68 offen offset:2048 lds
    v_mfma_f32_16x16x32_bf16 a[108:111], v[92:95], v[180:183], a[108:111]
    ds_read_b64_tr_b16 v[84:85], v100 offset:49152
    v_cvt_pk_bf16_f32 v231, v60, v61
    v_accvgpr_read_b32 v54, a162
    v_mfma_f32_16x16x32_bf16 a[108:111], v[88:91], v[188:191], a[108:111]
    s_waitcnt lgkmcnt(9)
    ds_read_b64_tr_b16 v[86:87], v100 offset:57344
    v_accvgpr_read_b32 v55, a218
    v_mfma_f32_16x16x32_bf16 a[112:115], v[64:67], v[184:187], a[112:115]
    s_waitcnt lgkmcnt(8)
    ds_read_b64_tr_b16 v[88:89], v241 offset:49152
    v_mul_f32 v56, v54, v4
    v_exp_f32 v56, v56
    v_mfma_f32_16x16x32_bf16 a[112:115], v[68:71], v[176:179], a[112:115]
    ds_read_b64_tr_b16 v[90:91], v241 offset:57344
    v_mul_f32 v51, v51, v52
    v_mfma_f32_16x16x32_bf16 a[116:119], v[68:71], v[180:183], a[116:119]
    ds_read_b64_tr_b16 v[92:93], v101 offset:49152
    v_fma_f32 v53, v53, v6, v6
    v_rcp_f32 v53, v53
    v_mfma_f32_16x16x32_bf16 a[116:119], v[64:67], v[188:191], a[116:119]
    s_waitcnt lgkmcnt(9)
    ds_read_b64_tr_b16 v[94:95], v101 offset:57344
    buffer_load_dwordx4 v255, s[40:43], s68 offen offset:3072 lds
    v_mfma_f32_16x16x32_bf16 a[120:123], v[72:75], v[184:187], a[120:123]
    s_waitcnt lgkmcnt(8)
    ds_read_b64_tr_b16 v[64:65], v242 offset:49152
    v_mul_f32 v60, v48, v50
    v_accvgpr_read_b32 v57, a163
    v_mfma_f32_16x16x32_bf16 a[120:123], v[76:79], v[176:179], a[120:123]
    ds_read_b64_tr_b16 v[66:67], v242 offset:57344
    v_accvgpr_read_b32 v58, a219
    v_mfma_f32_16x16x32_bf16 a[124:127], v[76:79], v[180:183], a[124:127]
    ds_read_b64_tr_b16 v[68:69], v102 offset:49152
    v_mul_f32 v59, v57, v4
    v_exp_f32 v59, v59
    v_mfma_f32_16x16x32_bf16 a[124:127], v[72:75], v[188:191], a[124:127]
    s_waitcnt lgkmcnt(9)
    ds_read_b64_tr_b16 v[70:71], v102 offset:57344
    v_mul_f32 v54, v54, v55
    v_fma_f32 v56, v56, v6, v6
    v_mfma_f32_16x16x32_bf16 a[0:3], v[80:83], v[168:171], a[0:3]
    s_waitcnt lgkmcnt(8)
    s_add_u32 m0, s67, 81920
    ds_read_b64_tr_b16 v[72:73], v243 offset:49152
    v_rcp_f32 v56, v56
    v_mfma_f32_16x16x32_bf16 a[0:3], v[84:87], v[160:163], a[0:3]
    s_add_u32 s69, s79, 3407872
    ds_read_b64_tr_b16 v[74:75], v243 offset:57344
    v_mul_f32 v61, v51, v53
    v_mfma_f32_16x16x32_bf16 a[4:7], v[84:87], v[164:167], a[4:7]
    ds_read_b64_tr_b16 v[76:77], v103 offset:49152
    buffer_load_dwordx4 v252, s[40:43], s69 offen offset:0 lds
    v_mfma_f32_16x16x32_bf16 a[4:7], v[80:83], v[172:175], a[4:7]
    s_waitcnt lgkmcnt(9)
    ds_read_b64_tr_b16 v[78:79], v103 offset:57344
    v_cvt_pk_bf16_f32 v216, v60, v61
    v_accvgpr_read_b32 v48, a164
    v_mfma_f32_16x16x32_bf16 a[8:11], v[88:91], v[168:171], a[8:11]
    s_waitcnt lgkmcnt(8)
    ds_read_b64_tr_b16 v[80:81], v244 offset:49152
    v_accvgpr_read_b32 v49, a220
    v_mul_f32 v50, v48, v5
    v_mfma_f32_16x16x32_bf16 a[8:11], v[92:95], v[160:163], a[8:11]
    ds_read_b64_tr_b16 v[82:83], v244 offset:57344
    v_exp_f32 v50, v50
    v_mfma_f32_16x16x32_bf16 a[12:15], v[92:95], v[164:167], a[12:15]
    ds_read_b64_tr_b16 v[84:85], v104 offset:49152
    v_mul_f32 v57, v57, v58
    v_fma_f32 v59, v59, v6, v6
    v_rcp_f32 v59, v59
    v_mfma_f32_16x16x32_bf16 a[12:15], v[88:91], v[172:175], a[12:15]
    s_waitcnt lgkmcnt(9)
    ds_read_b64_tr_b16 v[86:87], v104 offset:57344
    buffer_load_dwordx4 v253, s[40:43], s69 offen offset:1024 lds
    v_mfma_f32_16x16x32_bf16 a[16:19], v[64:67], v[168:171], a[16:19]
    s_waitcnt lgkmcnt(8)
    ds_read_b64_tr_b16 v[88:89], v245 offset:49152
    v_mul_f32 v60, v54, v56
    v_mfma_f32_16x16x32_bf16 a[16:19], v[68:71], v[160:163], a[16:19]
    ds_read_b64_tr_b16 v[90:91], v245 offset:57344
    v_accvgpr_read_b32 v51, a165
    v_mfma_f32_16x16x32_bf16 a[20:23], v[68:71], v[164:167], a[20:23]
    ds_read_b64_tr_b16 v[92:93], v105 offset:49152
    v_accvgpr_read_b32 v52, a221
    v_mul_f32 v53, v51, v5
    v_mfma_f32_16x16x32_bf16 a[20:23], v[64:67], v[172:175], a[20:23]
    s_waitcnt lgkmcnt(9)
    ds_read_b64_tr_b16 v[94:95], v105 offset:57344
    v_exp_f32 v53, v53
    v_mfma_f32_16x16x32_bf16 a[24:27], v[72:75], v[168:171], a[24:27]
    s_waitcnt lgkmcnt(8)
    ds_read_b64_tr_b16 v[64:65], v246 offset:49152
    v_mul_f32 v48, v48, v49
    v_fma_f32 v50, v50, v7, v7
    v_rcp_f32 v50, v50
    v_mfma_f32_16x16x32_bf16 a[24:27], v[76:79], v[160:163], a[24:27]
    ds_read_b64_tr_b16 v[66:67], v246 offset:57344
    buffer_load_dwordx4 v254, s[40:43], s69 offen offset:2048 lds
    v_mfma_f32_16x16x32_bf16 a[28:31], v[76:79], v[164:167], a[28:31]
    ds_read_b64_tr_b16 v[68:69], v106 offset:49152
    v_mul_f32 v61, v57, v59
    v_mfma_f32_16x16x32_bf16 a[28:31], v[72:75], v[172:175], a[28:31]
    s_waitcnt lgkmcnt(9)
    ds_read_b64_tr_b16 v[70:71], v106 offset:57344
    v_cvt_pk_bf16_f32 v217, v60, v61
    v_mfma_f32_16x16x32_bf16 a[32:35], v[80:83], v[168:171], a[32:35]
    s_waitcnt lgkmcnt(8)
    ds_read_b64_tr_b16 v[72:73], v247 offset:49152
    v_accvgpr_read_b32 v54, a166
    v_accvgpr_read_b32 v55, a222
    v_mfma_f32_16x16x32_bf16 a[32:35], v[84:87], v[160:163], a[32:35]
    ds_read_b64_tr_b16 v[74:75], v247 offset:57344
    v_mul_f32 v56, v54, v5
    v_mfma_f32_16x16x32_bf16 a[36:39], v[84:87], v[164:167], a[36:39]
    ds_read_b64_tr_b16 v[76:77], v107 offset:49152
    v_exp_f32 v56, v56
    v_mul_f32 v51, v51, v52
    v_mfma_f32_16x16x32_bf16 a[36:39], v[80:83], v[172:175], a[36:39]
    s_waitcnt lgkmcnt(9)
    ds_read_b64_tr_b16 v[78:79], v107 offset:57344
    buffer_load_dwordx4 v255, s[40:43], s69 offen offset:3072 lds
    v_mfma_f32_16x16x32_bf16 a[40:43], v[88:91], v[168:171], a[40:43]
    s_waitcnt lgkmcnt(8)
    ds_read_b64_tr_b16 v[80:81], v240 offset:49408
    v_fma_f32 v53, v53, v7, v7
    v_rcp_f32 v53, v53
    v_mfma_f32_16x16x32_bf16 a[40:43], v[92:95], v[160:163], a[40:43]
    ds_read_b64_tr_b16 v[82:83], v240 offset:57600
    v_mul_f32 v60, v48, v50
    v_mfma_f32_16x16x32_bf16 a[44:47], v[92:95], v[164:167], a[44:47]
    ds_read_b64_tr_b16 v[84:85], v100 offset:49408
    v_accvgpr_read_b32 v57, a167
    v_mfma_f32_16x16x32_bf16 a[44:47], v[88:91], v[172:175], a[44:47]
    s_waitcnt lgkmcnt(9)
    ds_read_b64_tr_b16 v[86:87], v100 offset:57600
    v_accvgpr_read_b32 v58, a223
    v_mul_f32 v59, v57, v5
    v_mfma_f32_16x16x32_bf16 a[48:51], v[64:67], v[168:171], a[48:51]
    s_waitcnt lgkmcnt(8)
    ds_read_b64_tr_b16 v[88:89], v241 offset:49408
    v_exp_f32 v59, v59
    v_mfma_f32_16x16x32_bf16 a[48:51], v[68:71], v[160:163], a[48:51]
    ds_read_b64_tr_b16 v[90:91], v241 offset:57600
    v_mul_f32 v54, v54, v55
    v_mfma_f32_16x16x32_bf16 a[52:55], v[68:71], v[164:167], a[52:55]
    ds_read_b64_tr_b16 v[92:93], v101 offset:49408
    v_fma_f32 v56, v56, v7, v7
    v_rcp_f32 v56, v56
    v_mfma_f32_16x16x32_bf16 a[52:55], v[64:67], v[172:175], a[52:55]
    s_waitcnt lgkmcnt(9)
    ds_read_b64_tr_b16 v[94:95], v101 offset:57600
    v_mul_f32 v61, v51, v53
    v_mfma_f32_16x16x32_bf16 a[56:59], v[72:75], v[168:171], a[56:59]
    s_waitcnt lgkmcnt(8)
    ds_read_b64_tr_b16 v[64:65], v242 offset:49408
    v_cvt_pk_bf16_f32 v220, v60, v61
    v_mfma_f32_16x16x32_bf16 a[56:59], v[76:79], v[160:163], a[56:59]
    ds_read_b64_tr_b16 v[66:67], v242 offset:57600
    v_accvgpr_read_b32 v48, a168
    v_accvgpr_read_b32 v49, a224
    v_mfma_f32_16x16x32_bf16 a[60:63], v[76:79], v[164:167], a[60:63]
    ds_read_b64_tr_b16 v[68:69], v102 offset:49408
    v_mul_f32 v50, v48, v4
    v_exp_f32 v50, v50
    v_mfma_f32_16x16x32_bf16 a[60:63], v[72:75], v[172:175], a[60:63]
    s_waitcnt lgkmcnt(9)
    ds_read_b64_tr_b16 v[70:71], v102 offset:57600
    v_mul_f32 v57, v57, v58
    v_mfma_f32_16x16x32_bf16 a[64:67], v[80:83], v[168:171], a[64:67]
    s_waitcnt lgkmcnt(8)
    ds_read_b64_tr_b16 v[72:73], v243 offset:49408
    v_fma_f32 v59, v59, v7, v7
    v_mfma_f32_16x16x32_bf16 a[64:67], v[84:87], v[160:163], a[64:67]
    ds_read_b64_tr_b16 v[74:75], v243 offset:57600
    v_rcp_f32 v59, v59
    v_mfma_f32_16x16x32_bf16 a[68:71], v[84:87], v[164:167], a[68:71]
    ds_read_b64_tr_b16 v[76:77], v103 offset:49408
    v_mul_f32 v60, v54, v56
    v_mfma_f32_16x16x32_bf16 a[68:71], v[80:83], v[172:175], a[68:71]
    s_waitcnt lgkmcnt(9)
    ds_read_b64_tr_b16 v[78:79], v103 offset:57600
    v_accvgpr_read_b32 v51, a169
    v_accvgpr_read_b32 v52, a225
    v_mfma_f32_16x16x32_bf16 a[72:75], v[88:91], v[168:171], a[72:75]
    s_waitcnt lgkmcnt(8)
    ds_read_b64_tr_b16 v[80:81], v244 offset:49408
    v_mul_f32 v53, v51, v4
    v_mfma_f32_16x16x32_bf16 a[72:75], v[92:95], v[160:163], a[72:75]
    ds_read_b64_tr_b16 v[82:83], v244 offset:57600
    v_exp_f32 v53, v53
    v_mul_f32 v48, v48, v49
    v_fma_f32 v50, v50, v6, v6
    v_mfma_f32_16x16x32_bf16 a[76:79], v[92:95], v[164:167], a[76:79]
    s_waitcnt vmcnt(9)
    s_barrier
    ds_read_b64_tr_b16 v[84:85], v104 offset:49408
    v_mfma_f32_16x16x32_bf16 a[76:79], v[88:91], v[172:175], a[76:79]
    s_waitcnt lgkmcnt(9)
    ds_read_b64_tr_b16 v[86:87], v104 offset:57600
    v_rcp_f32 v50, v50
    v_mul_f32 v61, v57, v59
    v_mfma_f32_16x16x32_bf16 a[80:83], v[64:67], v[168:171], a[80:83]
    s_waitcnt lgkmcnt(8)
    s_add_u32 m0, s67, 32768
    ds_read_b64_tr_b16 v[88:89], v245 offset:49408
    v_cvt_pk_bf16_f32 v221, v60, v61
    v_accvgpr_read_b32 v54, a170
    v_mfma_f32_16x16x32_bf16 a[80:83], v[68:71], v[160:163], a[80:83]
    ds_read_b64_tr_b16 v[90:91], v245 offset:57600
    buffer_load_dwordx4 v108, s[32:35], s82 offen offset:0 lds
    v_mfma_f32_16x16x32_bf16 a[84:87], v[68:71], v[164:167], a[84:87]
    ds_read_b64_tr_b16 v[92:93], v105 offset:49408
    v_accvgpr_read_b32 v55, a226
    v_mfma_f32_16x16x32_bf16 a[84:87], v[64:67], v[172:175], a[84:87]
    s_waitcnt lgkmcnt(9)
    ds_read_b64_tr_b16 v[94:95], v105 offset:57600
    v_mul_f32 v56, v54, v4
    v_exp_f32 v56, v56
    v_mfma_f32_16x16x32_bf16 a[88:91], v[72:75], v[168:171], a[88:91]
    s_waitcnt lgkmcnt(8)
    ds_read_b64_tr_b16 v[64:65], v246 offset:49408
    v_mul_f32 v51, v51, v52
    v_mfma_f32_16x16x32_bf16 a[88:91], v[76:79], v[160:163], a[88:91]
    ds_read_b64_tr_b16 v[66:67], v246 offset:57600
    v_fma_f32 v53, v53, v6, v6
    v_mfma_f32_16x16x32_bf16 a[92:95], v[76:79], v[164:167], a[92:95]
    ds_read_b64_tr_b16 v[68:69], v106 offset:49408
    v_rcp_f32 v53, v53
    v_mul_f32 v60, v48, v50
    v_mfma_f32_16x16x32_bf16 a[92:95], v[72:75], v[172:175], a[92:95]
    s_waitcnt lgkmcnt(9)
    ds_read_b64_tr_b16 v[70:71], v106 offset:57600
    buffer_load_dwordx4 v109, s[32:35], s82 offen offset:1024 lds
    v_mfma_f32_16x16x32_bf16 a[96:99], v[80:83], v[168:171], a[96:99]
    s_waitcnt lgkmcnt(8)
    ds_read_b64_tr_b16 v[72:73], v247 offset:49408
    v_accvgpr_read_b32 v57, a171
    v_accvgpr_read_b32 v58, a227
    v_mfma_f32_16x16x32_bf16 a[96:99], v[84:87], v[160:163], a[96:99]
    ds_read_b64_tr_b16 v[74:75], v247 offset:57600
    v_mul_f32 v59, v57, v4
    v_exp_f32 v59, v59
    v_mfma_f32_16x16x32_bf16 a[100:103], v[84:87], v[164:167], a[100:103]
    ds_read_b64_tr_b16 v[76:77], v107 offset:49408
    v_mul_f32 v54, v54, v55
    v_mfma_f32_16x16x32_bf16 a[100:103], v[80:83], v[172:175], a[100:103]
    s_waitcnt lgkmcnt(9)
    ds_read_b64_tr_b16 v[78:79], v107 offset:57600
    v_fma_f32 v56, v56, v6, v6
    v_mfma_f32_16x16x32_bf16 a[104:107], v[88:91], v[168:171], a[104:107]
    s_waitcnt lgkmcnt(8)
    ds_read_b64_tr_b16 v[80:81], v240 offset:0
    v_rcp_f32 v56, v56
    v_mul_f32 v61, v51, v53
    v_mfma_f32_16x16x32_bf16 a[104:107], v[92:95], v[160:163], a[104:107]
    ds_read_b64_tr_b16 v[82:83], v240 offset:8192
    buffer_load_dwordx4 v110, s[32:35], s82 offen offset:2048 lds
    v_mfma_f32_16x16x32_bf16 a[108:111], v[92:95], v[164:167], a[108:111]
    ds_read_b64_tr_b16 v[84:85], v100 offset:0
    v_cvt_pk_bf16_f32 v218, v60, v61
    v_accvgpr_read_b32 v48, a172
    v_mfma_f32_16x16x32_bf16 a[108:111], v[88:91], v[172:175], a[108:111]
    s_waitcnt lgkmcnt(9)
    ds_read_b64_tr_b16 v[86:87], v100 offset:8192
    v_accvgpr_read_b32 v49, a228
    v_mul_f32 v50, v48, v5
    v_mfma_f32_16x16x32_bf16 a[112:115], v[64:67], v[168:171], a[112:115]
    s_waitcnt lgkmcnt(8)
    ds_read_b64_tr_b16 v[88:89], v241 offset:0
    v_exp_f32 v50, v50
    v_mfma_f32_16x16x32_bf16 a[112:115], v[68:71], v[160:163], a[112:115]
    ds_read_b64_tr_b16 v[90:91], v241 offset:8192
    v_mul_f32 v57, v57, v58
    v_mfma_f32_16x16x32_bf16 a[116:119], v[68:71], v[164:167], a[116:119]
    ds_read_b64_tr_b16 v[92:93], v101 offset:0
    v_fma_f32 v59, v59, v6, v6
    v_rcp_f32 v59, v59
    v_mfma_f32_16x16x32_bf16 a[116:119], v[64:67], v[172:175], a[116:119]
    s_waitcnt lgkmcnt(9)
    ds_read_b64_tr_b16 v[94:95], v101 offset:8192
    buffer_load_dwordx4 v111, s[32:35], s82 offen offset:3072 lds
    v_mul_f32 v60, v54, v56
    v_accvgpr_read_b32 v51, a173
    v_mfma_f32_16x16x32_bf16 a[120:123], v[72:75], v[168:171], a[120:123]
    s_waitcnt lgkmcnt(8)
    s_add_u32 s82, s82, 16384
    ds_read_b64_tr_b16 v[64:65], v242 offset:0
    v_mfma_f32_16x16x32_bf16 a[120:123], v[76:79], v[160:163], a[120:123]
    ds_read_b64_tr_b16 v[66:67], v242 offset:8192
    v_accvgpr_read_b32 v52, a229
    v_mul_f32 v53, v51, v5
    v_mfma_f32_16x16x32_bf16 a[124:127], v[76:79], v[164:167], a[124:127]
    ds_read_b64_tr_b16 v[68:69], v102 offset:0
    v_exp_f32 v53, v53
    v_mfma_f32_16x16x32_bf16 a[124:127], v[72:75], v[172:175], a[124:127]
    s_waitcnt lgkmcnt(9)
    ds_read_b64_tr_b16 v[70:71], v102 offset:8192
    v_mul_f32 v48, v48, v49
    v_mfma_f32_16x16x32_bf16 a[0:3], v[80:83], v[152:155], a[0:3]
    s_waitcnt lgkmcnt(8)
    ds_read_b64_tr_b16 v[72:73], v243 offset:0
    v_fma_f32 v50, v50, v7, v7
    v_rcp_f32 v50, v50
    v_mfma_f32_16x16x32_bf16 a[0:3], v[84:87], v[144:147], a[0:3]
    ds_read_b64_tr_b16 v[74:75], v243 offset:8192
    buffer_load_dword v44, v43, s[12:15], s16 offen
    v_mfma_f32_16x16x32_bf16 a[4:7], v[84:87], v[148:151], a[4:7]
    s_add_u32 s16, s16, 0x40010000
    ds_read_b64_tr_b16 v[76:77], v103 offset:0
    v_mul_f32 v61, v57, v59
    v_cvt_pk_bf16_f32 v219, v60, v61
    v_mfma_f32_16x16x32_bf16 a[4:7], v[80:83], v[156:159], a[4:7]
    s_waitcnt lgkmcnt(9)
    ds_read_b64_tr_b16 v[78:79], v103 offset:8192
    v_accvgpr_read_b32 v54, a174
    v_mfma_f32_16x16x32_bf16 a[8:11], v[88:91], v[152:155], a[8:11]
    s_waitcnt lgkmcnt(8)
    ds_read_b64_tr_b16 v[80:81], v244 offset:0
    v_accvgpr_read_b32 v55, a230
    v_mul_f32 v56, v54, v5
    v_mfma_f32_16x16x32_bf16 a[8:11], v[92:95], v[144:147], a[8:11]
    ds_read_b64_tr_b16 v[82:83], v244 offset:8192
    v_exp_f32 v56, v56
    v_mfma_f32_16x16x32_bf16 a[12:15], v[92:95], v[148:151], a[12:15]
    ds_read_b64_tr_b16 v[84:85], v104 offset:0
    v_mul_f32 v51, v51, v52
    v_mfma_f32_16x16x32_bf16 a[12:15], v[88:91], v[156:159], a[12:15]
    s_waitcnt lgkmcnt(9)
    ds_read_b64_tr_b16 v[86:87], v104 offset:8192
    v_fma_f32 v53, v53, v7, v7
    v_rcp_f32 v53, v53
    v_mfma_f32_16x16x32_bf16 a[16:19], v[64:67], v[152:155], a[16:19]
    s_waitcnt lgkmcnt(8)
    ds_read_b64_tr_b16 v[88:89], v245 offset:0
    v_mul_f32 v60, v48, v50
    v_mfma_f32_16x16x32_bf16 a[16:19], v[68:71], v[144:147], a[16:19]
    ds_read_b64_tr_b16 v[90:91], v245 offset:8192
    v_accvgpr_read_b32 v57, a175
    v_mfma_f32_16x16x32_bf16 a[20:23], v[68:71], v[148:151], a[20:23]
    ds_read_b64_tr_b16 v[92:93], v105 offset:0
    v_accvgpr_read_b32 v58, a231
    v_mul_f32 v59, v57, v5
    v_mfma_f32_16x16x32_bf16 a[20:23], v[64:67], v[156:159], a[20:23]
    s_waitcnt lgkmcnt(9)
    ds_read_b64_tr_b16 v[94:95], v105 offset:8192
    v_exp_f32 v59, v59
    v_mfma_f32_16x16x32_bf16 a[24:27], v[72:75], v[152:155], a[24:27]
    s_waitcnt lgkmcnt(8)
    ds_read_b64_tr_b16 v[64:65], v246 offset:0
    v_mul_f32 v54, v54, v55
    v_mfma_f32_16x16x32_bf16 a[24:27], v[76:79], v[144:147], a[24:27]
    ds_read_b64_tr_b16 v[66:67], v246 offset:8192
    v_fma_f32 v56, v56, v7, v7
    v_rcp_f32 v56, v56
    v_mfma_f32_16x16x32_bf16 a[28:31], v[76:79], v[148:151], a[28:31]
    ds_read_b64_tr_b16 v[68:69], v106 offset:0
    v_mul_f32 v61, v51, v53
    v_mfma_f32_16x16x32_bf16 a[28:31], v[72:75], v[156:159], a[28:31]
    s_waitcnt lgkmcnt(9)
    ds_read_b64_tr_b16 v[70:71], v106 offset:8192
    v_cvt_pk_bf16_f32 v222, v60, v61
    v_mfma_f32_16x16x32_bf16 a[32:35], v[80:83], v[152:155], a[32:35]
    s_waitcnt lgkmcnt(8)
    ds_read_b64_tr_b16 v[72:73], v247 offset:0
    v_accvgpr_read_b32 v48, a176
    v_accvgpr_read_b32 v49, a232
    v_mfma_f32_16x16x32_bf16 a[32:35], v[84:87], v[144:147], a[32:35]
    ds_read_b64_tr_b16 v[74:75], v247 offset:8192
    v_mul_f32 v50, v48, v4
    v_mfma_f32_16x16x32_bf16 a[36:39], v[84:87], v[148:151], a[36:39]
    ds_read_b64_tr_b16 v[76:77], v107 offset:0
    v_exp_f32 v50, v50
    v_mfma_f32_16x16x32_bf16 a[36:39], v[80:83], v[156:159], a[36:39]
    s_waitcnt lgkmcnt(9)
    ds_read_b64_tr_b16 v[78:79], v107 offset:8192
    v_mul_f32 v57, v57, v58
    v_fma_f32 v59, v59, v7, v7
    v_mfma_f32_16x16x32_bf16 a[40:43], v[88:91], v[152:155], a[40:43]
    s_waitcnt lgkmcnt(8)
    ds_read_b64_tr_b16 v[80:81], v240 offset:256
    v_rcp_f32 v59, v59
    v_mfma_f32_16x16x32_bf16 a[40:43], v[92:95], v[144:147], a[40:43]
    ds_read_b64_tr_b16 v[82:83], v240 offset:8448
    v_mul_f32 v60, v54, v56
    v_mfma_f32_16x16x32_bf16 a[44:47], v[92:95], v[148:151], a[44:47]
    ds_read_b64_tr_b16 v[84:85], v100 offset:256
    v_accvgpr_read_b32 v51, a177
    v_accvgpr_read_b32 v52, a233
    v_mfma_f32_16x16x32_bf16 a[44:47], v[88:91], v[156:159], a[44:47]
    s_waitcnt lgkmcnt(9)
    ds_read_b64_tr_b16 v[86:87], v100 offset:8448
    v_mul_f32 v53, v51, v4
    v_mfma_f32_16x16x32_bf16 a[48:51], v[64:67], v[152:155], a[48:51]
    s_waitcnt lgkmcnt(8)
    ds_read_b64_tr_b16 v[88:89], v241 offset:256
    v_exp_f32 v53, v53
    v_mfma_f32_16x16x32_bf16 a[48:51], v[68:71], v[144:147], a[48:51]
    ds_read_b64_tr_b16 v[90:91], v241 offset:8448
    v_mul_f32 v48, v48, v49
    v_fma_f32 v50, v50, v6, v6
    v_mfma_f32_16x16x32_bf16 a[52:55], v[68:71], v[148:151], a[52:55]
    ds_read_b64_tr_b16 v[92:93], v101 offset:256
    v_rcp_f32 v50, v50
    v_mfma_f32_16x16x32_bf16 a[52:55], v[64:67], v[156:159], a[52:55]
    s_waitcnt lgkmcnt(9)
    ds_read_b64_tr_b16 v[94:95], v101 offset:8448
    v_mul_f32 v61, v57, v59
    v_mfma_f32_16x16x32_bf16 a[56:59], v[72:75], v[152:155], a[56:59]
    s_waitcnt lgkmcnt(8)
    ds_read_b64_tr_b16 v[64:65], v242 offset:256
    v_cvt_pk_bf16_f32 v223, v60, v61
    v_mfma_f32_16x16x32_bf16 a[56:59], v[76:79], v[144:147], a[56:59]
    ds_read_b64_tr_b16 v[66:67], v242 offset:8448
    v_accvgpr_read_b32 v54, a178
    v_accvgpr_read_b32 v55, a234
    v_mfma_f32_16x16x32_bf16 a[60:63], v[76:79], v[148:151], a[60:63]
    ds_read_b64_tr_b16 v[68:69], v102 offset:256
    v_mul_f32 v56, v54, v4
    v_exp_f32 v56, v56
    v_mfma_f32_16x16x32_bf16 a[60:63], v[72:75], v[156:159], a[60:63]
    s_waitcnt lgkmcnt(9)
    ds_read_b64_tr_b16 v[70:71], v102 offset:8448
    v_mul_f32 v51, v51, v52
    v_mfma_f32_16x16x32_bf16 a[64:67], v[80:83], v[152:155], a[64:67]
    s_waitcnt lgkmcnt(8)
    ds_read_b64_tr_b16 v[72:73], v243 offset:256
    v_fma_f32 v53, v53, v6, v6
    v_mfma_f32_16x16x32_bf16 a[64:67], v[84:87], v[144:147], a[64:67]
    ds_read_b64_tr_b16 v[74:75], v243 offset:8448
    v_rcp_f32 v53, v53
    v_mfma_f32_16x16x32_bf16 a[68:71], v[84:87], v[148:151], a[68:71]
    ds_read_b64_tr_b16 v[76:77], v103 offset:256
    v_mul_f32 v60, v48, v50
    v_mfma_f32_16x16x32_bf16 a[68:71], v[80:83], v[156:159], a[68:71]
    s_waitcnt lgkmcnt(9)
    ds_read_b64_tr_b16 v[78:79], v103 offset:8448
    v_accvgpr_read_b32 v57, a179
    v_accvgpr_read_b32 v58, a235
    v_mfma_f32_16x16x32_bf16 a[72:75], v[88:91], v[152:155], a[72:75]
    s_waitcnt lgkmcnt(8)
    ds_read_b64_tr_b16 v[80:81], v244 offset:256
    v_mul_f32 v59, v57, v4
    v_exp_f32 v59, v59
    v_mfma_f32_16x16x32_bf16 a[72:75], v[92:95], v[144:147], a[72:75]
    ds_read_b64_tr_b16 v[82:83], v244 offset:8448
    v_mul_f32 v54, v54, v55
    v_fma_f32 v56, v56, v6, v6
    v_mfma_f32_16x16x32_bf16 a[76:79], v[92:95], v[148:151], a[76:79]
    s_waitcnt vmcnt(5)
    s_barrier
    ds_read_b64_tr_b16 v[84:85], v104 offset:256
    v_mfma_f32_16x16x32_bf16 a[76:79], v[88:91], v[156:159], a[76:79]
    s_waitcnt lgkmcnt(9)
    ds_read_b64_tr_b16 v[86:87], v104 offset:8448
    v_rcp_f32 v56, v56
    v_mul_f32 v61, v51, v53
    v_mfma_f32_16x16x32_bf16 a[80:83], v[64:67], v[152:155], a[80:83]
    s_waitcnt lgkmcnt(8)
    s_add_u32 m0, s67, 49152
    ds_read_b64_tr_b16 v[88:89], v245 offset:256
    v_cvt_pk_bf16_f32 v208, v60, v61
    v_accvgpr_read_b32 v48, a180
    v_mfma_f32_16x16x32_bf16 a[80:83], v[68:71], v[144:147], a[80:83]
    ds_read_b64_tr_b16 v[90:91], v245 offset:8448
    buffer_load_dwordx4 v108, s[32:35], s82 offen offset:0 lds
    v_mfma_f32_16x16x32_bf16 a[84:87], v[68:71], v[148:151], a[84:87]
    ds_read_b64_tr_b16 v[92:93], v105 offset:256
    v_accvgpr_read_b32 v49, a236
    v_mul_f32 v50, v48, v5
    v_mfma_f32_16x16x32_bf16 a[84:87], v[64:67], v[156:159], a[84:87]
    s_waitcnt lgkmcnt(9)
    ds_read_b64_tr_b16 v[94:95], v105 offset:8448
    v_exp_f32 v50, v50
    v_mfma_f32_16x16x32_bf16 a[88:91], v[72:75], v[152:155], a[88:91]
    s_waitcnt lgkmcnt(8)
    ds_read_b64_tr_b16 v[64:65], v246 offset:256
    v_mul_f32 v57, v57, v58
    v_mfma_f32_16x16x32_bf16 a[88:91], v[76:79], v[144:147], a[88:91]
    ds_read_b64_tr_b16 v[66:67], v246 offset:8448
    v_fma_f32 v59, v59, v6, v6
    v_mfma_f32_16x16x32_bf16 a[92:95], v[76:79], v[148:151], a[92:95]
    ds_read_b64_tr_b16 v[68:69], v106 offset:256
    v_rcp_f32 v59, v59
    v_mul_f32 v60, v54, v56
    v_accvgpr_read_b32 v51, a181
    v_mfma_f32_16x16x32_bf16 a[92:95], v[72:75], v[156:159], a[92:95]
    s_waitcnt lgkmcnt(9)
    ds_read_b64_tr_b16 v[70:71], v106 offset:8448
    buffer_load_dwordx4 v109, s[32:35], s82 offen offset:1024 lds
    v_mfma_f32_16x16x32_bf16 a[96:99], v[80:83], v[152:155], a[96:99]
    s_waitcnt lgkmcnt(8)
    ds_read_b64_tr_b16 v[72:73], v247 offset:256
    v_accvgpr_read_b32 v52, a237
    v_mfma_f32_16x16x32_bf16 a[96:99], v[84:87], v[144:147], a[96:99]
    ds_read_b64_tr_b16 v[74:75], v247 offset:8448
    v_mul_f32 v53, v51, v5
    v_exp_f32 v53, v53
    v_mfma_f32_16x16x32_bf16 a[100:103], v[84:87], v[148:151], a[100:103]
    ds_read_b64_tr_b16 v[76:77], v107 offset:256
    v_mul_f32 v48, v48, v49
    v_mfma_f32_16x16x32_bf16 a[100:103], v[80:83], v[156:159], a[100:103]
    s_waitcnt lgkmcnt(9)
    ds_read_b64_tr_b16 v[78:79], v107 offset:8448
    v_fma_f32 v50, v50, v7, v7
    v_mfma_f32_16x16x32_bf16 a[104:107], v[88:91], v[152:155], a[104:107]
    s_waitcnt lgkmcnt(8)
    ds_read_b64_tr_b16 v[80:81], v240 offset:16384
    v_rcp_f32 v50, v50
    v_mul_f32 v61, v57, v59
    v_cvt_pk_bf16_f32 v209, v60, v61
    v_mfma_f32_16x16x32_bf16 a[104:107], v[92:95], v[144:147], a[104:107]
    ds_read_b64_tr_b16 v[82:83], v240 offset:24576
    buffer_load_dwordx4 v110, s[32:35], s82 offen offset:2048 lds
    v_mfma_f32_16x16x32_bf16 a[108:111], v[92:95], v[148:151], a[108:111]
    ds_read_b64_tr_b16 v[84:85], v100 offset:16384
    v_accvgpr_read_b32 v54, a182
    v_mfma_f32_16x16x32_bf16 a[108:111], v[88:91], v[156:159], a[108:111]
    s_waitcnt lgkmcnt(9)
    ds_read_b64_tr_b16 v[86:87], v100 offset:24576
    v_accvgpr_read_b32 v55, a238
    v_mul_f32 v56, v54, v5
    v_mfma_f32_16x16x32_bf16 a[112:115], v[64:67], v[152:155], a[112:115]
    s_waitcnt lgkmcnt(8)
    ds_read_b64_tr_b16 v[88:89], v241 offset:16384
    v_exp_f32 v56, v56
    v_mfma_f32_16x16x32_bf16 a[112:115], v[68:71], v[144:147], a[112:115]
    ds_read_b64_tr_b16 v[90:91], v241 offset:24576
    v_mul_f32 v51, v51, v52
    v_mfma_f32_16x16x32_bf16 a[116:119], v[68:71], v[148:151], a[116:119]
    ds_read_b64_tr_b16 v[92:93], v101 offset:16384
    v_fma_f32 v53, v53, v7, v7
    v_rcp_f32 v53, v53
    v_mfma_f32_16x16x32_bf16 a[116:119], v[64:67], v[156:159], a[116:119]
    s_waitcnt lgkmcnt(9)
    ds_read_b64_tr_b16 v[94:95], v101 offset:24576
    buffer_load_dwordx4 v111, s[32:35], s82 offen offset:3072 lds
    v_mul_f32 v60, v48, v50
    v_accvgpr_read_b32 v57, a183
    v_mfma_f32_16x16x32_bf16 a[120:123], v[72:75], v[152:155], a[120:123]
    s_waitcnt lgkmcnt(8)
    s_add_u32 s82, s82, 16384
    ds_read_b64_tr_b16 v[64:65], v242 offset:16384
    v_mfma_f32_16x16x32_bf16 a[120:123], v[76:79], v[144:147], a[120:123]
    ds_read_b64_tr_b16 v[66:67], v242 offset:24576
    v_accvgpr_read_b32 v58, a239
    v_mul_f32 v59, v57, v5
    v_mfma_f32_16x16x32_bf16 a[124:127], v[76:79], v[148:151], a[124:127]
    ds_read_b64_tr_b16 v[68:69], v102 offset:16384
    v_exp_f32 v59, v59
    v_mfma_f32_16x16x32_bf16 a[124:127], v[72:75], v[156:159], a[124:127]
    s_waitcnt lgkmcnt(9)
    ds_read_b64_tr_b16 v[70:71], v102 offset:24576
    v_mul_f32 v54, v54, v55
    v_fma_f32 v56, v56, v7, v7
    v_rcp_f32 v56, v56
    v_mfma_f32_16x16x32_bf16 a[0:3], v[80:83], v[136:139], a[0:3]
    s_waitcnt lgkmcnt(8)
    s_add_u32 m0, s67, 114688
    ds_read_b64_tr_b16 v[72:73], v243 offset:16384
    v_mfma_f32_16x16x32_bf16 a[0:3], v[84:87], v[128:131], a[0:3]
    ds_read_b64_tr_b16 v[74:75], v243 offset:24576
    buffer_load_dwordx4 v112, s[36:39], s83 offen offset:0 lds
    v_mfma_f32_16x16x32_bf16 a[4:7], v[84:87], v[132:135], a[4:7]
    ds_read_b64_tr_b16 v[76:77], v103 offset:16384
    v_mul_f32 v61, v51, v53
    v_cvt_pk_bf16_f32 v212, v60, v61
    v_mfma_f32_16x16x32_bf16 a[4:7], v[80:83], v[140:143], a[4:7]
    s_waitcnt lgkmcnt(9)
    ds_read_b64_tr_b16 v[78:79], v103 offset:24576
    v_mul_f32 v57, v57, v58
    v_fma_f32 v59, v59, v7, v7
    v_mfma_f32_16x16x32_bf16 a[8:11], v[88:91], v[136:139], a[8:11]
    s_waitcnt lgkmcnt(8)
    ds_read_b64_tr_b16 v[80:81], v244 offset:16384
    v_rcp_f32 v59, v59
    v_mfma_f32_16x16x32_bf16 a[8:11], v[92:95], v[128:131], a[8:11]
    ds_read_b64_tr_b16 v[82:83], v244 offset:24576
    v_mul_f32 v60, v54, v56
    v_mfma_f32_16x16x32_bf16 a[12:15], v[92:95], v[132:135], a[12:15]
    ds_read_b64_tr_b16 v[84:85], v104 offset:16384
    v_mul_f32 v61, v57, v59
    v_cvt_pk_bf16_f32 v213, v60, v61
    v_mov_b32 v210, 0
    v_mfma_f32_16x16x32_bf16 a[12:15], v[88:91], v[140:143], a[12:15]
    s_waitcnt lgkmcnt(9)
    ds_read_b64_tr_b16 v[86:87], v104 offset:24576
    buffer_load_dwordx4 v113, s[36:39], s83 offen offset:1024 lds
    v_mfma_f32_16x16x32_bf16 a[16:19], v[64:67], v[136:139], a[16:19]
    s_waitcnt lgkmcnt(8)
    ds_read_b64_tr_b16 v[88:89], v245 offset:16384
    v_mov_b32 v211, 0
    v_mov_b32 v214, 0
    v_mfma_f32_16x16x32_bf16 a[16:19], v[68:71], v[128:131], a[16:19]
    ds_read_b64_tr_b16 v[90:91], v245 offset:24576
    v_mov_b32 v215, 0
    v_mfma_f32_16x16x32_bf16 a[20:23], v[68:71], v[132:135], a[20:23]
    ds_read_b64_tr_b16 v[92:93], v105 offset:16384
    v_mfma_f32_16x16x32_bf16 a[20:23], v[64:67], v[140:143], a[20:23]
    s_waitcnt lgkmcnt(9)
    ds_read_b64_tr_b16 v[94:95], v105 offset:24576
    v_accvgpr_read_b32 v48, a0
    v_mfma_f32_16x16x32_bf16 a[24:27], v[72:75], v[136:139], a[24:27]
    s_waitcnt lgkmcnt(8)
    ds_read_b64_tr_b16 v[64:65], v246 offset:16384
    v_accvgpr_read_b32 v49, a1
    v_accvgpr_read_b32 v50, a2
    v_accvgpr_read_b32 v51, a3
    v_mul_f32 v48, v48, v2
    v_mul_f32 v49, v49, v2
    v_mul_f32 v50, v50, v2
    v_mul_f32 v51, v51, v2
    v_cvt_pk_bf16_f32 v16, v48, v49
    v_mfma_f32_16x16x32_bf16 a[24:27], v[76:79], v[128:131], a[24:27]
    ds_read_b64_tr_b16 v[66:67], v246 offset:24576
    buffer_load_dwordx4 v114, s[36:39], s83 offen offset:2048 lds
    v_mfma_f32_16x16x32_bf16 a[28:31], v[76:79], v[132:135], a[28:31]
    ds_read_b64_tr_b16 v[68:69], v106 offset:16384
    v_cvt_pk_bf16_f32 v17, v50, v51
    v_accvgpr_read_b32 v52, a8
    v_accvgpr_read_b32 v53, a9
    v_accvgpr_read_b32 v54, a10
    v_mfma_f32_16x16x32_bf16 a[28:31], v[72:75], v[140:143], a[28:31]
    s_waitcnt lgkmcnt(9)
    ds_read_b64_tr_b16 v[70:71], v106 offset:24576
    v_accvgpr_read_b32 v55, a11
    v_mul_f32 v52, v52, v2
    v_mul_f32 v53, v53, v2
    v_mul_f32 v54, v54, v2
    v_mul_f32 v55, v55, v2
    v_mfma_f32_16x16x32_bf16 a[32:35], v[80:83], v[136:139], a[32:35]
    s_waitcnt lgkmcnt(8)
    ds_read_b64_tr_b16 v[72:73], v247 offset:16384
    v_cvt_pk_bf16_f32 v18, v52, v53
    v_cvt_pk_bf16_f32 v19, v54, v55
    s_nop 0
    v_permlane32_swap_b32 v16, v18
    v_mfma_f32_16x16x32_bf16 a[32:35], v[84:87], v[128:131], a[32:35]
    ds_read_b64_tr_b16 v[74:75], v247 offset:24576
    v_permlane32_swap_b32 v17, v19
    v_permlane16_swap_b32 v16, v18
    v_mfma_f32_16x16x32_bf16 a[36:39], v[84:87], v[132:135], a[36:39]
    ds_read_b64_tr_b16 v[76:77], v107 offset:16384
    v_permlane16_swap_b32 v17, v19
    v_accvgpr_read_b32 v56, a4
    v_accvgpr_read_b32 v57, a5
    v_accvgpr_read_b32 v58, a6
    v_accvgpr_read_b32 v59, a7
    v_mul_f32 v56, v56, v3
    v_mul_f32 v57, v57, v3
    v_mul_f32 v58, v58, v3
    v_mfma_f32_16x16x32_bf16 a[36:39], v[80:83], v[140:143], a[36:39]
    s_waitcnt lgkmcnt(9)
    ds_read_b64_tr_b16 v[78:79], v107 offset:24576
    buffer_load_dwordx4 v115, s[36:39], s83 offen offset:3072 lds
    v_mul_f32 v59, v59, v3
    v_cvt_pk_bf16_f32 v160, v56, v57
    v_cvt_pk_bf16_f32 v161, v58, v59
    v_accvgpr_read_b32 v48, a12
    v_mfma_f32_16x16x32_bf16 a[40:43], v[88:91], v[136:139], a[40:43]
    s_waitcnt lgkmcnt(8)
    s_add_u32 s83, s83, 16384
    ds_read_b64_tr_b16 v[80:81], v240 offset:16640
    v_mfma_f32_16x16x32_bf16 a[40:43], v[92:95], v[128:131], a[40:43]
    ds_read_b64_tr_b16 v[82:83], v240 offset:24832
    v_accvgpr_read_b32 v49, a13
    v_accvgpr_read_b32 v50, a14
    v_accvgpr_read_b32 v51, a15
    v_mul_f32 v48, v48, v3
    v_mul_f32 v49, v49, v3
    v_mfma_f32_16x16x32_bf16 a[44:47], v[92:95], v[132:135], a[44:47]
    ds_read_b64_tr_b16 v[84:85], v100 offset:16640
    v_mul_f32 v50, v50, v3
    v_mul_f32 v51, v51, v3
    v_cvt_pk_bf16_f32 v162, v48, v49
    v_cvt_pk_bf16_f32 v163, v50, v51
    v_mfma_f32_16x16x32_bf16 a[44:47], v[88:91], v[140:143], a[44:47]
    s_waitcnt lgkmcnt(9)
    ds_read_b64_tr_b16 v[86:87], v100 offset:24832
    v_permlane32_swap_b32 v160, v162
    v_permlane32_swap_b32 v161, v163
    v_mfma_f32_16x16x32_bf16 a[48:51], v[64:67], v[136:139], a[48:51]
    s_waitcnt lgkmcnt(8)
    ds_read_b64_tr_b16 v[88:89], v241 offset:16640
    v_permlane16_swap_b32 v160, v162
    v_permlane16_swap_b32 v161, v163
    v_mfma_f32_16x16x32_bf16 a[48:51], v[68:71], v[128:131], a[48:51]
    ds_read_b64_tr_b16 v[90:91], v241 offset:24832
    v_accvgpr_read_b32 v52, a16
    v_accvgpr_read_b32 v53, a17
    v_accvgpr_read_b32 v54, a18
    v_accvgpr_read_b32 v55, a19
    v_mul_f32 v52, v52, v2
    v_mfma_f32_16x16x32_bf16 a[52:55], v[68:71], v[132:135], a[52:55]
    ds_read_b64_tr_b16 v[92:93], v101 offset:16640
    v_mul_f32 v53, v53, v2
    v_mul_f32 v54, v54, v2
    v_mul_f32 v55, v55, v2
    v_cvt_pk_bf16_f32 v20, v52, v53
    v_mfma_f32_16x16x32_bf16 a[52:55], v[64:67], v[140:143], a[52:55]
    s_waitcnt lgkmcnt(9)
    ds_read_b64_tr_b16 v[94:95], v101 offset:24832
    v_cvt_pk_bf16_f32 v21, v54, v55
    v_accvgpr_read_b32 v56, a24
    v_accvgpr_read_b32 v57, a25
    v_accvgpr_read_b32 v58, a26
    v_mfma_f32_16x16x32_bf16 a[56:59], v[72:75], v[136:139], a[56:59]
    s_waitcnt lgkmcnt(8)
    ds_read_b64_tr_b16 v[64:65], v242 offset:16640
    v_accvgpr_read_b32 v59, a27
    v_mul_f32 v56, v56, v2
    v_mul_f32 v57, v57, v2
    v_mul_f32 v58, v58, v2
    v_mul_f32 v59, v59, v2
    v_mfma_f32_16x16x32_bf16 a[56:59], v[76:79], v[128:131], a[56:59]
    ds_read_b64_tr_b16 v[66:67], v242 offset:24832
    v_cvt_pk_bf16_f32 v22, v56, v57
    v_cvt_pk_bf16_f32 v23, v58, v59
    s_nop 0
    v_permlane32_swap_b32 v20, v22
    v_mfma_f32_16x16x32_bf16 a[60:63], v[76:79], v[132:135], a[60:63]
    ds_read_b64_tr_b16 v[68:69], v102 offset:16640
    v_permlane32_swap_b32 v21, v23
    v_permlane16_swap_b32 v20, v22
    v_mfma_f32_16x16x32_bf16 a[60:63], v[72:75], v[140:143], a[60:63]
    s_waitcnt lgkmcnt(9)
    ds_read_b64_tr_b16 v[70:71], v102 offset:24832
    v_permlane16_swap_b32 v21, v23
    v_accvgpr_read_b32 v48, a20
    v_accvgpr_read_b32 v49, a21
    v_accvgpr_read_b32 v50, a22
    v_mfma_f32_16x16x32_bf16 a[64:67], v[80:83], v[136:139], a[64:67]
    s_waitcnt lgkmcnt(8)
    ds_read_b64_tr_b16 v[72:73], v243 offset:16640
    v_accvgpr_read_b32 v51, a23
    v_mul_f32 v48, v48, v3
    v_mul_f32 v49, v49, v3
    v_mul_f32 v50, v50, v3
    v_mfma_f32_16x16x32_bf16 a[64:67], v[84:87], v[128:131], a[64:67]
    ds_read_b64_tr_b16 v[74:75], v243 offset:24832
    v_mul_f32 v51, v51, v3
    v_cvt_pk_bf16_f32 v164, v48, v49
    v_cvt_pk_bf16_f32 v165, v50, v51
    v_accvgpr_read_b32 v52, a28
    v_mfma_f32_16x16x32_bf16 a[68:71], v[84:87], v[132:135], a[68:71]
    ds_read_b64_tr_b16 v[76:77], v103 offset:16640
    v_accvgpr_read_b32 v53, a29
    v_accvgpr_read_b32 v54, a30
    v_accvgpr_read_b32 v55, a31
    v_mul_f32 v52, v52, v3
    v_mul_f32 v53, v53, v3
    v_mfma_f32_16x16x32_bf16 a[68:71], v[80:83], v[140:143], a[68:71]
    s_waitcnt lgkmcnt(9)
    ds_read_b64_tr_b16 v[78:79], v103 offset:24832
    v_mul_f32 v54, v54, v3
    v_mul_f32 v55, v55, v3
    v_cvt_pk_bf16_f32 v166, v52, v53
    v_cvt_pk_bf16_f32 v167, v54, v55
    v_mfma_f32_16x16x32_bf16 a[72:75], v[88:91], v[136:139], a[72:75]
    s_waitcnt lgkmcnt(8)
    ds_read_b64_tr_b16 v[80:81], v244 offset:16640
    v_permlane32_swap_b32 v164, v166
    v_permlane32_swap_b32 v165, v167
    v_mfma_f32_16x16x32_bf16 a[72:75], v[92:95], v[128:131], a[72:75]
    ds_read_b64_tr_b16 v[82:83], v244 offset:24832
    v_permlane16_swap_b32 v164, v166
    v_permlane16_swap_b32 v165, v167
    v_accvgpr_read_b32 v56, a32
    v_accvgpr_read_b32 v57, a33
    v_accvgpr_read_b32 v58, a34
    v_accvgpr_read_b32 v59, a35
    v_mul_f32 v56, v56, v2
    v_mfma_f32_16x16x32_bf16 a[76:79], v[92:95], v[132:135], a[76:79]
    s_waitcnt vmcnt(9)
    s_barrier
    ds_read_b64_tr_b16 v[84:85], v104 offset:16640
    v_mfma_f32_16x16x32_bf16 a[76:79], v[88:91], v[140:143], a[76:79]
    s_waitcnt lgkmcnt(9)
    ds_read_b64_tr_b16 v[86:87], v104 offset:24832
    v_mul_f32 v57, v57, v2
    v_mul_f32 v58, v58, v2
    v_mul_f32 v59, v59, v2
    v_cvt_pk_bf16_f32 v24, v56, v57
    v_cvt_pk_bf16_f32 v25, v58, v59
    v_accvgpr_read_b32 v48, a40
    v_accvgpr_read_b32 v49, a41
    v_accvgpr_read_b32 v50, a42
    v_mfma_f32_16x16x32_bf16 a[80:83], v[64:67], v[136:139], a[80:83]
    s_waitcnt lgkmcnt(8)
    s_add_u32 m0, s67, 0
    ds_read_b64_tr_b16 v[88:89], v245 offset:16640
    v_accvgpr_read_b32 v51, a43
    v_mul_f32 v48, v48, v2
    v_mul_f32 v49, v49, v2
    v_mul_f32 v50, v50, v2
    v_mul_f32 v51, v51, v2
    v_mfma_f32_16x16x32_bf16 a[80:83], v[68:71], v[128:131], a[80:83]
    ds_read_b64_tr_b16 v[90:91], v245 offset:24832
    buffer_load_dwordx4 v108, s[32:35], s82 offen offset:0 lds
    v_mfma_f32_16x16x32_bf16 a[84:87], v[68:71], v[132:135], a[84:87]
    ds_read_b64_tr_b16 v[92:93], v105 offset:16640
    v_cvt_pk_bf16_f32 v26, v48, v49
    v_cvt_pk_bf16_f32 v27, v50, v51
    s_nop 0
    v_permlane32_swap_b32 v24, v26
    v_mfma_f32_16x16x32_bf16 a[84:87], v[64:67], v[140:143], a[84:87]
    s_waitcnt lgkmcnt(9)
    ds_read_b64_tr_b16 v[94:95], v105 offset:24832
    v_permlane32_swap_b32 v25, v27
    v_permlane16_swap_b32 v24, v26
    s_nop 0
    v_permlane16_swap_b32 v25, v27
    v_accvgpr_read_b32 v52, a36
    v_accvgpr_read_b32 v53, a37
    v_accvgpr_read_b32 v54, a38
    v_mfma_f32_16x16x32_bf16 a[88:91], v[72:75], v[136:139], a[88:91]
    s_waitcnt lgkmcnt(8)
    ds_read_b64_tr_b16 v[64:65], v246 offset:16640
    buffer_load_dwordx4 v109, s[32:35], s82 offen offset:1024 lds
    v_mfma_f32_16x16x32_bf16 a[88:91], v[76:79], v[128:131], a[88:91]
    ds_read_b64_tr_b16 v[66:67], v246 offset:24832
    v_accvgpr_read_b32 v55, a39
    v_mul_f32 v52, v52, v3
    v_mul_f32 v53, v53, v3
    v_mul_f32 v54, v54, v3
    v_mfma_f32_16x16x32_bf16 a[92:95], v[76:79], v[132:135], a[92:95]
    ds_read_b64_tr_b16 v[68:69], v106 offset:16640
    v_mul_f32 v55, v55, v3
    v_cvt_pk_bf16_f32 v168, v52, v53
    v_cvt_pk_bf16_f32 v169, v54, v55
    v_accvgpr_read_b32 v56, a44
    v_accvgpr_read_b32 v57, a45
    v_accvgpr_read_b32 v58, a46
    v_accvgpr_read_b32 v59, a47
    v_mul_f32 v56, v56, v3
    v_mul_f32 v57, v57, v3
    v_mfma_f32_16x16x32_bf16 a[92:95], v[72:75], v[140:143], a[92:95]
    s_waitcnt lgkmcnt(9)
    ds_read_b64_tr_b16 v[70:71], v106 offset:24832
    buffer_load_dwordx4 v110, s[32:35], s82 offen offset:2048 lds
    v_mfma_f32_16x16x32_bf16 a[96:99], v[80:83], v[136:139], a[96:99]
    s_waitcnt lgkmcnt(8)
    ds_read_b64_tr_b16 v[72:73], v247 offset:16640
    v_mul_f32 v58, v58, v3
    v_mul_f32 v59, v59, v3
    v_cvt_pk_bf16_f32 v170, v56, v57
    v_cvt_pk_bf16_f32 v171, v58, v59
    v_mfma_f32_16x16x32_bf16 a[96:99], v[84:87], v[128:131], a[96:99]
    ds_read_b64_tr_b16 v[74:75], v247 offset:24832
    v_permlane32_swap_b32 v168, v170
    v_permlane32_swap_b32 v169, v171
    v_mfma_f32_16x16x32_bf16 a[100:103], v[84:87], v[132:135], a[100:103]
    ds_read_b64_tr_b16 v[76:77], v107 offset:16640
    v_permlane16_swap_b32 v168, v170
    v_permlane16_swap_b32 v169, v171
    v_mfma_f32_16x16x32_bf16 a[100:103], v[80:83], v[140:143], a[100:103]
    s_waitcnt lgkmcnt(9)
    ds_read_b64_tr_b16 v[78:79], v107 offset:24832
    v_accvgpr_read_b32 v48, a48
    v_accvgpr_read_b32 v49, a49
    v_accvgpr_read_b32 v50, a50
    v_accvgpr_read_b32 v51, a51
    v_mul_f32 v48, v48, v2
    v_mul_f32 v49, v49, v2
    v_mul_f32 v50, v50, v2
    v_mul_f32 v51, v51, v2
    v_cvt_pk_bf16_f32 v28, v48, v49
    v_cvt_pk_bf16_f32 v29, v50, v51
    v_mfma_f32_16x16x32_bf16 a[104:107], v[88:91], v[136:139], a[104:107]
    s_waitcnt lgkmcnt(8)
    buffer_load_dwordx4 v111, s[32:35], s82 offen offset:3072 lds
    v_accvgpr_read_b32 v52, a56
    v_accvgpr_read_b32 v53, a57
    v_accvgpr_read_b32 v54, a58
    v_accvgpr_read_b32 v55, a59
    v_mfma_f32_16x16x32_bf16 a[104:107], v[92:95], v[128:131], a[104:107]
    s_add_u32 s82, s82, 16384
    ds_read_b128 a[128:131], v96 offset:32768
    v_mfma_f32_16x16x32_bf16 a[108:111], v[92:95], v[132:135], a[108:111]
    s_add_u32 m0, s67, 65536
    v_mul_f32 v52, v52, v2
    v_mul_f32 v53, v53, v2
    v_mul_f32 v54, v54, v2
    v_mul_f32 v55, v55, v2
    v_cvt_pk_bf16_f32 v30, v52, v53
    v_mfma_f32_16x16x32_bf16 a[108:111], v[88:91], v[140:143], a[108:111]
    s_waitcnt lgkmcnt(7)
    ds_read_b128 a[132:135], v96 offset:40960
    v_cvt_pk_bf16_f32 v31, v54, v55
    v_permlane32_swap_b32 v28, v30
    s_nop 0
    v_permlane32_swap_b32 v29, v31
    v_permlane16_swap_b32 v28, v30
    s_nop 0
    v_permlane16_swap_b32 v29, v31
    v_mfma_f32_16x16x32_bf16 a[112:115], v[64:67], v[136:139], a[112:115]
    s_waitcnt lgkmcnt(6)
    buffer_load_dwordx4 v112, s[36:39], s83 offen offset:0 lds
    v_mfma_f32_16x16x32_bf16 a[112:115], v[68:71], v[128:131], a[112:115]
    ds_read_b128 a[136:139], v97 offset:32768
    v_accvgpr_read_b32 v56, a52
    v_accvgpr_read_b32 v57, a53
    v_accvgpr_read_b32 v58, a54
    v_accvgpr_read_b32 v59, a55
    v_mul_f32 v56, v56, v3
    v_mfma_f32_16x16x32_bf16 a[116:119], v[68:71], v[132:135], a[116:119]
    v_mul_f32 v57, v57, v3
    v_mul_f32 v58, v58, v3
    v_mul_f32 v59, v59, v3
    v_cvt_pk_bf16_f32 v172, v56, v57
    v_cvt_pk_bf16_f32 v173, v58, v59
    v_mfma_f32_16x16x32_bf16 a[116:119], v[64:67], v[140:143], a[116:119]
    s_waitcnt lgkmcnt(5)
    ds_read_b128 a[140:143], v97 offset:40960
    v_accvgpr_read_b32 v48, a60
    v_accvgpr_read_b32 v49, a61
    v_accvgpr_read_b32 v50, a62
    v_accvgpr_read_b32 v51, a63
    v_mul_f32 v48, v48, v3
    v_mul_f32 v49, v49, v3
    v_mul_f32 v50, v50, v3
    v_mul_f32 v51, v51, v3
    v_cvt_pk_bf16_f32 v174, v48, v49
    v_mfma_f32_16x16x32_bf16 a[120:123], v[72:75], v[136:139], a[120:123]
    s_waitcnt lgkmcnt(4)
    buffer_load_dwordx4 v113, s[36:39], s83 offen offset:1024 lds
    v_mfma_f32_16x16x32_bf16 a[120:123], v[76:79], v[128:131], a[120:123]
    ds_read_b128 a[144:147], v98 offset:32768
    v_cvt_pk_bf16_f32 v175, v50, v51
    v_permlane32_swap_b32 v172, v174
    s_nop 0
    v_permlane32_swap_b32 v173, v175
    v_mfma_f32_16x16x32_bf16 a[124:127], v[76:79], v[132:135], a[124:127]
    v_permlane16_swap_b32 v172, v174
    v_permlane16_swap_b32 v173, v175
    v_mfma_f32_16x16x32_bf16 a[124:127], v[72:75], v[140:143], a[124:127]
    s_waitcnt lgkmcnt(4)
    ds_read_b128 a[148:151], v98 offset:40960
    v_accvgpr_read_b32 v52, a64
    v_accvgpr_read_b32 v53, a65
    v_accvgpr_read_b32 v54, a66
    v_accvgpr_read_b32 v55, a67
    v_mul_f32 v52, v52, v2
    v_mul_f32 v53, v53, v2
    v_mul_f32 v54, v54, v2
    v_mov_b32 v128, v16
    v_mov_b32 v129, v17
    v_mov_b32 v130, v18
    v_mov_b32 v131, v19
    v_mov_b32 v132, v20
    v_mov_b32 v133, v21
    v_mov_b32 v134, v22
    v_mov_b32 v135, v23
    v_mov_b32 v136, v24
    v_mov_b32 v137, v25
    v_mov_b32 v138, v26
    v_mov_b32 v139, v27
    v_mov_b32 v140, v28
    v_mov_b32 v141, v29
    v_mov_b32 v142, v30
    v_mov_b32 v143, v31
    v_mfma_f32_16x16x32_bf16 v[16:19], a[128:131], v[128:131], 0
    buffer_load_dwordx4 v114, s[36:39], s83 offen offset:2048 lds
    v_mfma_f32_16x16x32_bf16 v[20:23], a[128:131], v[160:163], 0
    s_waitcnt lgkmcnt(4)
    ds_read_b128 a[152:155], v99 offset:32768
    v_mul_f32 v55, v55, v2
    v_cvt_pk_bf16_f32 v144, v52, v53
    v_cvt_pk_bf16_f32 v145, v54, v55
    v_accvgpr_read_b32 v56, a72
    v_mfma_f32_16x16x32_bf16 v[28:31], a[132:135], v[160:163], 0
    v_accvgpr_read_b32 v57, a73
    v_accvgpr_read_b32 v58, a74
    v_accvgpr_read_b32 v59, a75
    v_mfma_f32_16x16x32_bf16 v[24:27], a[132:135], v[128:131], 0
    s_waitcnt lgkmcnt(4)
    ds_read_b128 a[156:159], v99 offset:40960
    v_mul_f32 v56, v56, v2
    v_mul_f32 v57, v57, v2
    v_mul_f32 v58, v58, v2
    v_mul_f32 v59, v59, v2
    v_cvt_pk_bf16_f32 v146, v56, v57
    v_cvt_pk_bf16_f32 v147, v58, v59
    s_nop 0
    v_permlane32_swap_b32 v144, v146
    v_mfma_f32_16x16x32_bf16 v[16:19], a[136:139], v[132:135], v[16:19]
    buffer_load_dwordx4 v115, s[36:39], s83 offen offset:3072 lds
    v_permlane32_swap_b32 v145, v147
    v_permlane16_swap_b32 v144, v146
    v_mov_b32 v12, v41
    v_mfma_f32_16x16x32_bf16 v[20:23], a[136:139], v[164:167], v[20:23]
    s_waitcnt lgkmcnt(4)
    s_add_u32 s83, s83, 16384
    ds_read_b128 a[160:163], v96 offset:33024
    v_mov_b32 v9, v43
    v_mfma_f32_16x16x32_bf16 v[28:31], a[140:143], v[164:167], v[28:31]
    s_waitcnt vmcnt(8)
    s_barrier
    v_permlane16_swap_b32 v145, v147
    v_mov_b32 v11, v42
    v_mfma_f32_16x16x32_bf16 v[24:27], a[140:143], v[132:135], v[24:27]
    s_waitcnt lgkmcnt(4)
    ds_read_b128 a[164:167], v96 offset:41216
    v_accvgpr_read_b32 v48, a68
    v_accvgpr_read_b32 v49, a69
    v_accvgpr_read_b32 v50, a70
    v_accvgpr_read_b32 v51, a71
    v_mov_b32 v4, v45
    v_mfma_f32_16x16x32_bf16 v[16:19], a[144:147], v[136:139], v[16:19]
    s_add_u32 m0, s67, 16384
    v_mul_f32 v48, v48, v3
    v_mul_f32 v49, v49, v3
    v_mul_f32 v50, v50, v3
    v_mov_b32 v13, v47
    v_mfma_f32_16x16x32_bf16 v[20:23], a[144:147], v[168:171], v[20:23]
    s_waitcnt lgkmcnt(4)
    ds_read_b128 a[168:171], v97 offset:33024
    v_mul_f32 v51, v51, v3
    v_cvt_pk_bf16_f32 v176, v48, v49
    v_cvt_pk_bf16_f32 v177, v50, v51
    v_accvgpr_read_b32 v52, a76
    v_accvgpr_read_b32 v53, a77
    v_accvgpr_read_b32 v54, a78
    v_accvgpr_read_b32 v55, a79
    v_mfma_f32_16x16x32_bf16 v[28:31], a[148:151], v[168:171], v[28:31]
    buffer_load_dwordx4 v108, s[32:35], s82 offen offset:0 lds
    v_mfma_f32_16x16x32_bf16 v[24:27], a[148:151], v[136:139], v[24:27]
    s_waitcnt lgkmcnt(4)
    ds_read_b128 a[172:175], v97 offset:41216
    v_mul_f32 v52, v52, v3
    v_mul_f32 v53, v53, v3
    v_mul_f32 v54, v54, v3
    v_mul_f32 v55, v55, v3
    v_mfma_f32_16x16x32_bf16 v[16:19], a[152:155], v[140:143], v[16:19]
    v_cvt_pk_bf16_f32 v178, v52, v53
    v_cvt_pk_bf16_f32 v179, v54, v55
    s_nop 0
    v_permlane32_swap_b32 v176, v178
    v_mfma_f32_16x16x32_bf16 v[20:23], a[152:155], v[172:175], v[20:23]
    s_waitcnt lgkmcnt(4)
    ds_read_b128 a[176:179], v98 offset:33024
    v_permlane32_swap_b32 v177, v179
    v_permlane16_swap_b32 v176, v178
    v_mfma_f32_16x16x32_bf16 v[28:31], a[156:159], v[172:175], v[28:31]
    v_permlane16_swap_b32 v177, v179
    v_mfma_f32_16x16x32_bf16 v[24:27], a[156:159], v[140:143], v[24:27]
    s_waitcnt lgkmcnt(4)
    ds_read_b128 a[180:183], v98 offset:41216
    v_accvgpr_read_b32 v56, a80
    v_accvgpr_read_b32 v57, a81
    v_accvgpr_read_b32 v58, a82
    v_accvgpr_read_b32 v59, a83
    v_mul_f32 v56, v56, v2
    v_mul_f32 v57, v57, v2
    v_mul_f32 v58, v58, v2
    v_mul_f32 v59, v59, v2
    v_cvt_pk_bf16_f32 v148, v56, v57
    v_cvt_pk_bf16_f32 v149, v58, v59
    v_accvgpr_read_b32 v48, a88
    v_accvgpr_read_b32 v49, a89
    v_accvgpr_read_b32 v50, a90
    v_accvgpr_read_b32 v51, a91
    v_mul_f32 v48, v48, v2
    v_mul_f32 v49, v49, v2
    v_mul_f32 v50, v50, v2
    v_mul_f32 v51, v51, v2
    v_cvt_pk_bf16_f32 v150, v48, v49
    v_cvt_pk_bf16_f32 v151, v50, v51
    s_nop 0
    v_permlane32_swap_b32 v148, v150
    v_permlane32_swap_b32 v149, v151
    s_nop 0
    v_permlane16_swap_b32 v148, v150
    v_permlane16_swap_b32 v149, v151
    v_mfma_f32_16x16x32_bf16 v[16:19], a[160:163], v[144:147], v[16:19]
    buffer_load_dwordx4 v109, s[32:35], s82 offen offset:1024 lds
    v_mfma_f32_16x16x32_bf16 v[20:23], a[160:163], v[176:179], v[20:23]
    s_waitcnt lgkmcnt(4)
    ds_read_b128 a[184:187], v99 offset:33024
    v_accvgpr_read_b32 v52, a84
    v_accvgpr_read_b32 v53, a85
    v_accvgpr_read_b32 v54, a86
    v_accvgpr_read_b32 v55, a87
    v_mul_f32 v52, v52, v3
    v_mul_f32 v53, v53, v3
    v_mul_f32 v54, v54, v3
    v_mul_f32 v55, v55, v3
    v_cvt_pk_bf16_f32 v180, v52, v53
    v_cvt_pk_bf16_f32 v181, v54, v55
    v_accvgpr_read_b32 v56, a92
    v_accvgpr_read_b32 v57, a93
    v_accvgpr_read_b32 v58, a94
    v_accvgpr_read_b32 v59, a95
    v_mfma_f32_16x16x32_bf16 v[28:31], a[164:167], v[176:179], v[28:31]
    v_mul_f32 v56, v56, v3
    v_mul_f32 v57, v57, v3
    v_mul_f32 v58, v58, v3
    v_mul_f32 v59, v59, v3
    v_cvt_pk_bf16_f32 v182, v56, v57
    v_cvt_pk_bf16_f32 v183, v58, v59
    s_nop 0
    v_permlane32_swap_b32 v180, v182
    v_permlane32_swap_b32 v181, v183
    s_nop 0
    v_permlane16_swap_b32 v180, v182
    v_permlane16_swap_b32 v181, v183
    v_mfma_f32_16x16x32_bf16 v[24:27], a[164:167], v[144:147], v[24:27]
    s_waitcnt lgkmcnt(4)
    ds_read_b128 a[188:191], v99 offset:41216
    v_accvgpr_read_b32 v48, a96
    v_accvgpr_read_b32 v49, a97
    v_accvgpr_read_b32 v50, a98
    v_accvgpr_read_b32 v51, a99
    v_mul_f32 v48, v48, v2
    v_mul_f32 v49, v49, v2
    v_mul_f32 v50, v50, v2
    v_mul_f32 v51, v51, v2
    v_cvt_pk_bf16_f32 v152, v48, v49
    v_cvt_pk_bf16_f32 v153, v50, v51
    v_accvgpr_read_b32 v52, a104
    v_accvgpr_read_b32 v53, a105
    v_accvgpr_read_b32 v54, a106
    v_accvgpr_read_b32 v55, a107
    v_mfma_f32_16x16x32_bf16 v[16:19], a[168:171], v[148:151], v[16:19]
    v_mul_f32 v52, v52, v2
    v_mul_f32 v53, v53, v2
    v_mul_f32 v54, v54, v2
    v_mul_f32 v55, v55, v2
    v_cvt_pk_bf16_f32 v154, v52, v53
    v_cvt_pk_bf16_f32 v155, v54, v55
    s_nop 0
    v_permlane32_swap_b32 v152, v154
    v_permlane32_swap_b32 v153, v155
    s_nop 0
    v_permlane16_swap_b32 v152, v154
    v_permlane16_swap_b32 v153, v155
    v_accvgpr_read_b32 v56, a100
    v_accvgpr_read_b32 v57, a101
    v_accvgpr_read_b32 v58, a102
    v_accvgpr_read_b32 v59, a103
    v_mul_f32 v56, v56, v3
    v_mul_f32 v57, v57, v3
    v_mul_f32 v58, v58, v3
    v_mul_f32 v59, v59, v3
    v_cvt_pk_bf16_f32 v184, v56, v57
    v_cvt_pk_bf16_f32 v185, v58, v59
    v_accvgpr_read_b32 v48, a108
    v_accvgpr_read_b32 v49, a109
    v_accvgpr_read_b32 v50, a110
    v_accvgpr_read_b32 v51, a111
    v_mfma_f32_16x16x32_bf16 v[20:23], a[168:171], v[180:183], v[20:23]
    s_waitcnt lgkmcnt(4)
    ds_read_b128 a[128:131], v96 offset:49152
    buffer_load_dwordx4 v110, s[32:35], s82 offen offset:2048 lds
    v_mfma_f32_16x16x32_bf16 v[28:31], a[172:175], v[180:183], v[28:31]
    ds_read_b128 a[132:135], v97 offset:49152
    v_mul_f32 v48, v48, v3
    v_mul_f32 v49, v49, v3
    v_mul_f32 v50, v50, v3
    v_mul_f32 v51, v51, v3
    v_cvt_pk_bf16_f32 v186, v48, v49
    v_cvt_pk_bf16_f32 v187, v50, v51
    s_nop 0
    v_permlane32_swap_b32 v184, v186
    v_permlane32_swap_b32 v185, v187
    s_nop 0
    v_permlane16_swap_b32 v184, v186
    v_permlane16_swap_b32 v185, v187
    v_mfma_f32_16x16x32_bf16 v[24:27], a[172:175], v[148:151], v[24:27]
    s_waitcnt lgkmcnt(5)
    ds_read_b128 a[136:139], v98 offset:49152
    v_accvgpr_read_b32 v52, a112
    v_accvgpr_read_b32 v53, a113
    v_accvgpr_read_b32 v54, a114
    v_accvgpr_read_b32 v55, a115
    v_mul_f32 v52, v52, v2
    v_mul_f32 v53, v53, v2
    v_mul_f32 v54, v54, v2
    v_mul_f32 v55, v55, v2
    v_cvt_pk_bf16_f32 v156, v52, v53
    v_cvt_pk_bf16_f32 v157, v54, v55
    v_accvgpr_read_b32 v56, a120
    v_accvgpr_read_b32 v57, a121
    v_accvgpr_read_b32 v58, a122
    v_accvgpr_read_b32 v59, a123
    v_mfma_f32_16x16x32_bf16 v[16:19], a[176:179], v[152:155], v[16:19]
    ds_read_b128 a[140:143], v99 offset:49152
    v_mul_f32 v56, v56, v2
    v_mul_f32 v57, v57, v2
    v_mul_f32 v58, v58, v2
    v_mul_f32 v59, v59, v2
    v_cvt_pk_bf16_f32 v158, v56, v57
    v_cvt_pk_bf16_f32 v159, v58, v59
    s_nop 0
    v_permlane32_swap_b32 v156, v158
    v_permlane32_swap_b32 v157, v159
    s_nop 0
    v_permlane16_swap_b32 v156, v158
    v_permlane16_swap_b32 v157, v159
    v_mfma_f32_16x16x32_bf16 v[20:23], a[176:179], v[184:187], v[20:23]
    s_waitcnt lgkmcnt(6)
    ds_read_b128 a[144:147], v96 offset:49408
    v_accvgpr_read_b32 v48, a116
    v_accvgpr_read_b32 v49, a117
    v_accvgpr_read_b32 v50, a118
    v_accvgpr_read_b32 v51, a119
    v_mul_f32 v48, v48, v3
    v_mul_f32 v49, v49, v3
    v_mul_f32 v50, v50, v3
    v_mul_f32 v51, v51, v3
    v_cvt_pk_bf16_f32 v188, v48, v49
    v_cvt_pk_bf16_f32 v189, v50, v51
    v_accvgpr_read_b32 v52, a124
    v_accvgpr_read_b32 v53, a125
    v_accvgpr_read_b32 v54, a126
    v_accvgpr_read_b32 v55, a127
    v_mfma_f32_16x16x32_bf16 v[28:31], a[180:183], v[184:187], v[28:31]
    ds_read_b128 a[148:151], v97 offset:49408
    v_mul_f32 v52, v52, v3
    v_mul_f32 v53, v53, v3
    v_mul_f32 v54, v54, v3
    v_mul_f32 v55, v55, v3
    v_cvt_pk_bf16_f32 v190, v52, v53
    v_cvt_pk_bf16_f32 v191, v54, v55
    s_nop 0
    v_permlane32_swap_b32 v188, v190
    v_permlane32_swap_b32 v189, v191
    s_nop 0
    v_permlane16_swap_b32 v188, v190
    v_permlane16_swap_b32 v189, v191
    v_mfma_f32_16x16x32_bf16 v[24:27], a[180:183], v[152:155], v[24:27]
    s_waitcnt lgkmcnt(7)
    ds_read_b128 a[152:155], v98 offset:49408
    v_mfma_f32_16x16x32_bf16 v[16:19], a[184:187], v[156:159], v[16:19]
    ds_read_b128 a[156:159], v99 offset:49408
    v_mfma_f32_16x16x32_bf16 v[20:23], a[184:187], v[188:191], v[20:23]
    s_waitcnt lgkmcnt(8)
    buffer_load_dwordx4 v111, s[32:35], s82 offen offset:3072 lds
    v_mfma_f32_16x16x32_bf16 v[28:31], a[188:191], v[188:191], v[28:31]
    s_add_u32 s82, s82, 16384
    v_mfma_f32_16x16x32_bf16 v[24:27], a[188:191], v[156:159], v[24:27]
    s_waitcnt lgkmcnt(7)
    v_mfma_f32_16x16x32_bf16 v[32:35], a[128:131], v[128:131], 0
    s_waitcnt lgkmcnt(6)
    s_add_u32 m0, s67, 81920
    v_mov_b32 v3, 1
    v_mfma_f32_16x16x32_bf16 v[32:35], a[132:135], v[132:135], v[32:35]
    s_waitcnt lgkmcnt(5)
    buffer_load_dwordx4 v112, s[36:39], s83 offen offset:0 lds
    v_lshrrev_b32 v2, 24, v4
    v_mfma_f32_16x16x32_bf16 v[32:35], a[136:139], v[136:139], v[32:35]
    s_waitcnt lgkmcnt(4)
    v_and_b32 v2, 0x40, v2
    v_mfma_f32_16x16x32_bf16 v[32:35], a[140:143], v[140:143], v[32:35]
    s_waitcnt lgkmcnt(3)
    v_max3_f32 v60, v16, v17, v18
    v_max3_f32 v60, v60, v19, v24
    v_mfma_f32_16x16x32_bf16 v[32:35], a[144:147], v[144:147], v[32:35]
    s_waitcnt lgkmcnt(2)
    v_max3_f32 v60, v60, v25, v26
    v_max_f32 v60, v60, v27
    v_mfma_f32_16x16x32_bf16 v[32:35], a[148:151], v[148:151], v[32:35]
    s_waitcnt lgkmcnt(1)
    ds_read_b128 a[160:163], v96 offset:57344
    v_mov_b32 v63, v60
    v_mfma_f32_16x16x32_bf16 v[32:35], a[152:155], v[152:155], v[32:35]
    s_waitcnt lgkmcnt(1)
    ds_read_b128 a[164:167], v97 offset:57344
    v_permlane32_swap_b32 v60, v63
    v_mfma_f32_16x16x32_bf16 v[32:35], a[156:159], v[156:159], v[32:35]
    ds_read_b128 a[168:171], v98 offset:57344
    buffer_load_dwordx4 v113, s[36:39], s83 offen offset:1024 lds
    v_max_f32 v60, v60, v63
    v_mfma_f32_16x16x32_bf16 v[36:39], a[156:159], v[188:191], 0
    ds_read_b128 a[172:175], v99 offset:57344
    v_mov_b32 v63, v60
    v_mfma_f32_16x16x32_bf16 v[36:39], a[152:155], v[184:187], v[36:39]
    ds_read_b128 a[176:179], v96 offset:57600
    v_permlane16_swap_b32 v60, v63
    v_max_f32 v60, v60, v63
    v_mfma_f32_16x16x32_bf16 v[36:39], a[148:151], v[180:183], v[36:39]
    ds_read_b128 a[180:183], v97 offset:57600
    v_sub_f32 v16, v16, v60
    v_sub_f32 v17, v17, v60
    v_sub_f32 v18, v18, v60
    v_sub_f32 v19, v19, v60
    v_mfma_f32_16x16x32_bf16 v[36:39], a[144:147], v[176:179], v[36:39]
    ds_read_b128 a[184:187], v98 offset:57600
    v_sub_f32 v24, v24, v60
    v_sub_f32 v25, v25, v60
    v_sub_f32 v26, v26, v60
    v_sub_f32 v27, v27, v60
    v_mfma_f32_16x16x32_bf16 v[36:39], a[140:143], v[172:175], v[36:39]
    ds_read_b128 a[188:191], v99 offset:57600
    v_mov_b32 v56, 0
    v_max3_f32 v61, v20, v21, v22
    v_max3_f32 v61, v61, v23, v28
    v_mfma_f32_16x16x32_bf16 v[36:39], a[136:139], v[168:171], v[36:39]
    ds_read_b64_tr_b16 a[192:193], v100 offset:49152
    buffer_load_dwordx4 v114, s[36:39], s83 offen offset:2048 lds
    v_max3_f32 v61, v61, v29, v30
    v_max_f32 v61, v61, v31
    v_mov_b32 v63, v61
    s_nop 1
    v_permlane32_swap_b32 v61, v63
    v_mfma_f32_16x16x32_bf16 v[36:39], a[132:135], v[164:167], v[36:39]
    ds_read_b64_tr_b16 a[194:195], v100 offset:57344
    v_max_f32 v61, v61, v63
    v_mov_b32 v63, v61
    s_nop 1
    v_permlane16_swap_b32 v61, v63
    v_max_f32 v61, v61, v63
    v_sub_f32 v20, v20, v61
    v_sub_f32 v21, v21, v61
    v_sub_f32 v22, v22, v61
    v_sub_f32 v23, v23, v61
    v_sub_f32 v28, v28, v61
    v_sub_f32 v29, v29, v61
    v_sub_f32 v30, v30, v61
    v_sub_f32 v31, v31, v61
    v_mov_b32 v57, 0
    v_mfma_f32_16x16x32_bf16 v[36:39], a[128:131], v[160:163], v[36:39]
    s_waitcnt lgkmcnt(9)
    ds_read_b64_tr_b16 a[196:197], v101 offset:49152
    v_exp_f32 v64, v16
    v_exp_f32 v65, v17
    v_mfma_f32_16x16x32_bf16 v[40:43], a[160:163], v[128:131], 0
    s_waitcnt lgkmcnt(9)
    ds_read_b64_tr_b16 a[198:199], v101 offset:57344
    v_exp_f32 v66, v18
    v_add_f32 v58, v56, v64
    v_add_f32 v58, v58, v65
    v_cvt_pk_bf16_f32 v80, v64, v65
    v_mfma_f32_16x16x32_bf16 v[40:43], a[164:167], v[132:135], v[40:43]
    s_waitcnt lgkmcnt(9)
    ds_read_b64_tr_b16 a[200:201], v102 offset:49152
    v_exp_f32 v67, v19
    v_add_f32 v58, v58, v66
    v_mfma_f32_16x16x32_bf16 v[40:43], a[168:171], v[136:139], v[40:43]
    s_waitcnt lgkmcnt(9)
    ds_read_b64_tr_b16 a[202:203], v102 offset:57344
    v_exp_f32 v68, v20
    v_exp_f32 v69, v21
    v_add_f32 v58, v58, v67
    v_cvt_pk_bf16_f32 v81, v66, v67
    v_mfma_f32_16x16x32_bf16 v[40:43], a[172:175], v[140:143], v[40:43]
    s_waitcnt lgkmcnt(9)
    ds_read_b64_tr_b16 a[204:205], v103 offset:49152
    buffer_load_dwordx4 v115, s[36:39], s83 offen offset:3072 lds
    v_exp_f32 v70, v22
    v_add_f32 v59, v57, v68
    v_add_f32 v59, v59, v69
    v_cvt_pk_bf16_f32 v84, v68, v69
    v_mfma_f32_16x16x32_bf16 v[40:43], a[176:179], v[144:147], v[40:43]
    s_waitcnt lgkmcnt(9)
    s_add_u32 s83, s83, 16384
    ds_read_b64_tr_b16 a[206:207], v103 offset:57344
    v_exp_f32 v71, v23
    v_add_f32 v59, v59, v70
    v_mfma_f32_16x16x32_bf16 v[40:43], a[180:183], v[148:151], v[40:43]
    s_waitcnt lgkmcnt(9)
    ds_read_b64_tr_b16 a[208:209], v104 offset:49152
    v_exp_f32 v72, v24
    v_exp_f32 v73, v25
    v_add_f32 v59, v59, v71
    v_cvt_pk_bf16_f32 v85, v70, v71
    v_mfma_f32_16x16x32_bf16 v[40:43], a[184:187], v[152:155], v[40:43]
    s_waitcnt lgkmcnt(9)
    ds_read_b64_tr_b16 a[210:211], v104 offset:57344
    v_exp_f32 v74, v26
    v_add_f32 v58, v58, v72
    v_add_f32 v58, v58, v73
    v_cvt_pk_bf16_f32 v82, v72, v73
    v_mfma_f32_16x16x32_bf16 v[40:43], a[188:191], v[156:159], v[40:43]
    ds_read_b64_tr_b16 a[212:213], v105 offset:49152
    v_exp_f32 v75, v27
    v_add_f32 v58, v58, v74
    v_mfma_f32_16x16x32_bf16 v[44:47], a[188:191], v[188:191], 0
    ds_read_b64_tr_b16 a[214:215], v105 offset:57344
    v_exp_f32 v76, v28
    v_exp_f32 v77, v29
    v_add_f32 v58, v58, v75
    v_cvt_pk_bf16_f32 v83, v74, v75
    v_mfma_f32_16x16x32_bf16 v[44:47], a[184:187], v[184:187], v[44:47]
    ds_read_b64_tr_b16 a[216:217], v106 offset:49152
    v_exp_f32 v78, v30
    v_add_f32 v59, v59, v76
    v_add_f32 v59, v59, v77
    v_cvt_pk_bf16_f32 v86, v76, v77
    v_mfma_f32_16x16x32_bf16 v[44:47], a[180:183], v[180:183], v[44:47]
    ds_read_b64_tr_b16 a[218:219], v106 offset:57344
    v_exp_f32 v79, v31
    v_mfma_f32_16x16x32_bf16 v[44:47], a[176:179], v[176:179], v[44:47]
    s_waitcnt lgkmcnt(12)
    ds_read_b64_tr_b16 a[220:221], v107 offset:49152
    v_add_f32 v59, v59, v78
    v_mfma_f32_16x16x32_bf16 v[44:47], a[172:175], v[172:175], v[44:47]
    ds_read_b64_tr_b16 a[222:223], v107 offset:57344
    v_add_f32 v59, v59, v79
    v_mfma_f32_16x16x32_bf16 v[44:47], a[168:171], v[168:171], v[44:47]
    s_waitcnt lgkmcnt(12)
    ds_read_b64_tr_b16 a[224:225], v100 offset:49408
    v_cvt_pk_bf16_f32 v87, v78, v79
    v_add_f32 v62, v58, v59
    v_cmp_nge_f32 vcc, s71, v62
    v_mfma_f32_16x16x32_bf16 v[44:47], a[164:167], v[164:167], v[44:47]
    ds_read_b64_tr_b16 a[226:227], v100 offset:57600
    v_sub_f32 v32, v32, v60
    v_mfma_f32_16x16x32_bf16 v[44:47], a[160:163], v[160:163], v[44:47]
    s_waitcnt lgkmcnt(12)
    ds_read_b64_tr_b16 a[228:229], v101 offset:49408
    v_sub_f32 v33, v33, v60
    v_mfma_f32_16x16x32_bf16 a[0:3], a[192:195], v[80:83], 0
    ds_read_b64_tr_b16 a[230:231], v101 offset:57600
    buffer_store_dwordx4 v[232:235], v1, s[60:63], s74 offen offset:0 sc1
    v_sub_f32 v34, v34, v60
    v_mfma_f32_16x16x32_bf16 a[4:7], a[192:195], v[84:87], 0
    s_waitcnt lgkmcnt(12)
    ds_read_b64_tr_b16 a[232:233], v102 offset:49408
    v_sub_f32 v35, v35, v60
    v_mfma_f32_16x16x32_bf16 a[12:15], a[196:199], v[84:87], 0
    ds_read_b64_tr_b16 a[234:235], v102 offset:57600
    v_sub_f32 v36, v36, v61
    v_mfma_f32_16x16x32_bf16 a[8:11], a[196:199], v[80:83], 0
    s_waitcnt lgkmcnt(12)
    ds_read_b64_tr_b16 a[236:237], v103 offset:49408
    buffer_store_dwordx4 v[236:239], v1, s[60:63], s74 offen offset:1024 sc1
    v_sub_f32 v37, v37, v61
    v_mfma_f32_16x16x32_bf16 a[16:19], a[200:203], v[80:83], 0
    ds_read_b64_tr_b16 a[238:239], v103 offset:57600
    v_sub_f32 v38, v38, v61
    v_mfma_f32_16x16x32_bf16 a[20:23], a[200:203], v[84:87], 0
    s_waitcnt lgkmcnt(12)
    ds_read_b64_tr_b16 a[240:241], v104 offset:49408
    v_sub_f32 v39, v39, v61
    v_mfma_f32_16x16x32_bf16 a[28:31], a[204:207], v[84:87], 0
    s_waitcnt vmcnt(10)
    s_barrier
    ds_read_b64_tr_b16 a[242:243], v104 offset:57600
    v_mfma_f32_16x16x32_bf16 a[24:27], a[204:207], v[80:83], 0
    s_waitcnt lgkmcnt(12)
    buffer_store_dwordx4 v[224:227], v1, s[60:63], s74 offen offset:2048 sc1
    v_exp_f32 v64, v32
    v_mfma_f32_16x16x32_bf16 a[32:35], a[208:211], v[80:83], 0
    s_add_u32 m0, s67, 32768
    ds_read_b64_tr_b16 a[244:245], v105 offset:49408
    v_add_f32 v56, v58, v64
    v_mfma_f32_16x16x32_bf16 a[36:39], a[208:211], v[84:87], 0
    s_waitcnt lgkmcnt(12)
    ds_read_b64_tr_b16 a[246:247], v105 offset:57600
    buffer_load_dwordx4 v108, s[32:35], s82 offen offset:0 lds
    v_sub_f32 v40, v40, v60
    v_sub_f32 v41, v41, v60
    v_sub_f32 v42, v42, v60
    v_mfma_f32_16x16x32_bf16 a[44:47], a[212:215], v[84:87], 0
    buffer_store_dwordx4 v[228:231], v1, s[60:63], s74 offen offset:3072 sc1
    v_exp_f32 v65, v33
    v_mfma_f32_16x16x32_bf16 a[40:43], a[212:215], v[80:83], 0
    s_waitcnt lgkmcnt(12)
    ds_read_b64_tr_b16 a[248:249], v106 offset:49408
    v_add_f32 v56, v56, v65
    v_mfma_f32_16x16x32_bf16 a[48:51], a[216:219], v[80:83], 0
    ds_read_b64_tr_b16 a[250:251], v106 offset:57600
    v_cvt_pk_bf16_f32 v88, v64, v65
    v_mfma_f32_16x16x32_bf16 a[52:55], a[216:219], v[84:87], 0
    s_waitcnt lgkmcnt(12)
    v_exp_f32 v66, v34
    v_mfma_f32_16x16x32_bf16 a[60:63], a[220:223], v[84:87], 0
    s_add_u32 s74, s74, 4096
    ds_read_b64_tr_b16 a[252:253], v107 offset:49408
    buffer_store_dwordx4 v[216:219], v1, s[60:63], s74 offen offset:0 sc1
    v_add_f32 v56, v56, v66
    v_mfma_f32_16x16x32_bf16 a[56:59], a[220:223], v[80:83], 0
    s_waitcnt lgkmcnt(12)
    ds_read_b64_tr_b16 a[254:255], v107 offset:57600
    buffer_load_dwordx4 v109, s[32:35], s82 offen offset:1024 lds
    v_sub_f32 v43, v43, v60
    v_sub_f32 v44, v44, v61
    v_sub_f32 v45, v45, v61
    v_sub_f32 v46, v46, v61
    v_mfma_f32_16x16x32_bf16 a[64:67], a[224:227], v[80:83], 0
    v_exp_f32 v67, v35
    v_sub_f32 v47, v47, v61
    v_mfma_f32_16x16x32_bf16 a[68:71], a[224:227], v[84:87], 0
    s_waitcnt lgkmcnt(12)
    ds_read_b128 a[128:131], v96 offset:0
    v_add_f32 v56, v56, v67
    v_mfma_f32_16x16x32_bf16 a[76:79], a[228:231], v[84:87], 0
    ds_read_b128 a[132:135], v97 offset:0
    buffer_store_dwordx4 v[220:223], v1, s[60:63], s74 offen offset:1024 sc1
    v_cvt_pk_bf16_f32 v89, v66, v67
    v_mfma_f32_16x16x32_bf16 a[72:75], a[228:231], v[80:83], 0
    s_waitcnt lgkmcnt(12)
    v_exp_f32 v68, v36
    v_mfma_f32_16x16x32_bf16 a[80:83], a[232:235], v[80:83], 0
    ds_read_b128 a[136:139], v98 offset:0
    v_add_f32 v57, v59, v68
    v_mfma_f32_16x16x32_bf16 a[84:87], a[232:235], v[84:87], 0
    s_waitcnt lgkmcnt(11)
    ds_read_b128 a[140:143], v99 offset:0
    buffer_load_dwordx4 v110, s[32:35], s82 offen offset:2048 lds
    buffer_store_dwordx4 v[208:211], v1, s[60:63], s74 offen offset:2048 sc1
    v_sub_f32 v48, 0, v60
    v_sub_f32 v49, 0, v60
    v_sub_f32 v50, 0, v60
    v_mfma_f32_16x16x32_bf16 a[92:95], a[236:239], v[84:87], 0
    v_exp_f32 v69, v37
    v_sub_f32 v51, 0, v60
    v_mfma_f32_16x16x32_bf16 a[88:91], a[236:239], v[80:83], 0
    s_waitcnt lgkmcnt(10)
    ds_read_b128 a[144:147], v96 offset:256
    v_add_f32 v57, v57, v69
    v_mfma_f32_16x16x32_bf16 a[96:99], a[240:243], v[80:83], 0
    ds_read_b128 a[148:151], v97 offset:256
    v_cvt_pk_bf16_f32 v92, v68, v69
    v_mfma_f32_16x16x32_bf16 a[100:103], a[240:243], v[84:87], 0
    s_waitcnt lgkmcnt(10)
    buffer_store_dwordx4 v[212:215], v1, s[60:63], s74 offen offset:3072 sc1
    v_exp_f32 v70, v38
    v_mfma_f32_16x16x32_bf16 a[108:111], a[244:247], v[84:87], 0
    ds_read_b128 a[152:155], v98 offset:256
    v_add_f32 v57, v57, v70
    v_mfma_f32_16x16x32_bf16 a[104:107], a[244:247], v[80:83], 0
    s_waitcnt lgkmcnt(9)
    ds_read_b128 a[156:159], v99 offset:256
    buffer_load_dwordx4 v111, s[32:35], s82 offen offset:3072 lds
    v_sub_f32 v52, 0, v61
    v_sub_f32 v53, 0, v61
    v_sub_f32 v54, 0, v61
    v_sub_f32 v55, 0, v61
    v_mfma_f32_16x16x32_bf16 a[112:115], a[248:251], v[80:83], 0
    s_add_u32 s82, s82, 16384
    v_exp_f32 v71, v39
    v_mfma_f32_16x16x32_bf16 a[116:119], a[248:251], v[84:87], 0
    s_waitcnt lgkmcnt(8)
    ds_read_b128 a[160:163], v96 offset:8192
    v_add_f32 v57, v57, v71
    v_mfma_f32_16x16x32_bf16 a[124:127], a[252:255], v[84:87], 0
    ds_read_b128 a[164:167], v97 offset:8192
    v_cvt_pk_bf16_f32 v93, v70, v71
    v_mfma_f32_16x16x32_bf16 a[120:123], a[252:255], v[80:83], 0
    s_mov_b32 s70, 0
L_loopA:
    s_waitcnt lgkmcnt(9)
    v_exp_f32 v72, v40
    v_mfma_f32_16x16x32_bf16 v[16:19], a[128:131], v[128:131], v[48:51]
    s_waitcnt lgkmcnt(8)
    ds_read_b128 a[168:171], v98 offset:8192
    v_add_f32 v56, v56, v72
    v_mfma_f32_16x16x32_bf16 v[16:19], a[132:135], v[132:135], v[16:19]
    s_waitcnt lgkmcnt(8)
    s_add_u32 m0, s67, 98304
    ds_read_b128 a[172:175], v99 offset:8192
    v_mfma_f32_16x16x32_bf16 v[16:19], a[136:139], v[136:139], v[16:19]
    s_waitcnt lgkmcnt(8)
    buffer_load_dwordx4 v112, s[36:39], s83 offen offset:0 lds
    v_exp_f32 v73, v41
    v_mfma_f32_16x16x32_bf16 v[16:19], a[140:143], v[140:143], v[16:19]
    s_waitcnt lgkmcnt(7)
    ds_read_b128 a[176:179], v96 offset:8448
    v_add_f32 v56, v56, v73
    v_mfma_f32_16x16x32_bf16 v[16:19], a[144:147], v[144:147], v[16:19]
    s_waitcnt lgkmcnt(7)
    ds_read_b128 a[180:183], v97 offset:8448
    v_cvt_pk_bf16_f32 v90, v72, v73
    v_mfma_f32_16x16x32_bf16 v[16:19], a[148:151], v[148:151], v[16:19]
    s_waitcnt lgkmcnt(7)
    v_exp_f32 v74, v42
    v_mfma_f32_16x16x32_bf16 v[16:19], a[152:155], v[152:155], v[16:19]
    s_waitcnt lgkmcnt(6)
    ds_read_b128 a[184:187], v98 offset:8448
    v_add_f32 v56, v56, v74
    v_mfma_f32_16x16x32_bf16 v[16:19], a[156:159], v[156:159], v[16:19]
    ds_read_b128 a[188:191], v99 offset:8448
    buffer_load_dwordx4 v113, s[36:39], s83 offen offset:1024 lds
    v_mfma_f32_16x16x32_bf16 v[20:23], a[156:159], v[188:191], v[52:55]
    v_exp_f32 v75, v43
    v_mfma_f32_16x16x32_bf16 v[20:23], a[152:155], v[184:187], v[20:23]
    ds_read_b64_tr_b16 a[192:193], v100 offset:0
    v_add_f32 v56, v56, v75
    v_mfma_f32_16x16x32_bf16 v[20:23], a[148:151], v[180:183], v[20:23]
    ds_read_b64_tr_b16 a[194:195], v100 offset:8192
    v_cvt_pk_bf16_f32 v91, v74, v75
    v_mfma_f32_16x16x32_bf16 v[20:23], a[144:147], v[176:179], v[20:23]
    v_exp_f32 v76, v44
    v_mfma_f32_16x16x32_bf16 v[20:23], a[140:143], v[172:175], v[20:23]
    ds_read_b64_tr_b16 a[196:197], v101 offset:0
    v_add_f32 v57, v57, v76
    v_mfma_f32_16x16x32_bf16 v[20:23], a[136:139], v[168:171], v[20:23]
    ds_read_b64_tr_b16 a[198:199], v101 offset:8192
    buffer_load_dwordx4 v114, s[36:39], s83 offen offset:2048 lds
    v_mfma_f32_16x16x32_bf16 v[20:23], a[132:135], v[164:167], v[20:23]
    v_exp_f32 v77, v45
    v_mfma_f32_16x16x32_bf16 v[20:23], a[128:131], v[160:163], v[20:23]
    s_waitcnt lgkmcnt(11)
    ds_read_b64_tr_b16 a[200:201], v102 offset:0
    v_add_f32 v57, v57, v77
    v_mfma_f32_16x16x32_bf16 v[24:27], a[160:163], v[128:131], v[48:51]
    s_waitcnt lgkmcnt(11)
    ds_read_b64_tr_b16 a[202:203], v102 offset:8192
    v_cvt_pk_bf16_f32 v94, v76, v77
    v_mfma_f32_16x16x32_bf16 v[24:27], a[164:167], v[132:135], v[24:27]
    s_waitcnt lgkmcnt(11)
    v_exp_f32 v78, v46
    v_mfma_f32_16x16x32_bf16 v[24:27], a[168:171], v[136:139], v[24:27]
    s_waitcnt lgkmcnt(10)
    ds_read_b64_tr_b16 a[204:205], v103 offset:0
    v_add_f32 v57, v57, v78
    v_mfma_f32_16x16x32_bf16 v[24:27], a[172:175], v[140:143], v[24:27]
    s_waitcnt lgkmcnt(10)
    ds_read_b64_tr_b16 a[206:207], v103 offset:8192
    buffer_load_dwordx4 v115, s[36:39], s83 offen offset:3072 lds
    v_mfma_f32_16x16x32_bf16 v[24:27], a[176:179], v[144:147], v[24:27]
    s_waitcnt lgkmcnt(10)
    s_add_u32 s83, s83, 16384
    v_exp_f32 v79, v47
    v_mfma_f32_16x16x32_bf16 v[24:27], a[180:183], v[148:151], v[24:27]
    s_waitcnt lgkmcnt(9)
    ds_read_b64_tr_b16 a[208:209], v104 offset:0
    v_add_f32 v57, v57, v79
    v_mfma_f32_16x16x32_bf16 v[24:27], a[184:187], v[152:155], v[24:27]
    s_waitcnt lgkmcnt(9)
    ds_read_b64_tr_b16 a[210:211], v104 offset:8192
    v_cvt_pk_bf16_f32 v95, v78, v79
    v_mfma_f32_16x16x32_bf16 v[24:27], a[188:191], v[156:159], v[24:27]
    ds_read_b64_tr_b16 a[212:213], v105 offset:0
    v_add_f32 v62, v56, v57
    v_mfma_f32_16x16x32_bf16 v[28:31], a[188:191], v[188:191], v[52:55]
    ds_read_b64_tr_b16 a[214:215], v105 offset:8192
    v_cmp_nge_f32 vcc, s71, v62
    v_mfma_f32_16x16x32_bf16 v[28:31], a[184:187], v[184:187], v[28:31]
    s_cbranch_vccnz L_rare_1
L_back_1:
    ds_read_b64_tr_b16 a[216:217], v106 offset:0
    v_mfma_f32_16x16x32_bf16 v[28:31], a[180:183], v[180:183], v[28:31]
    ds_read_b64_tr_b16 a[218:219], v106 offset:8192
    buffer_load_dword v10, v12, s[56:59], s90 offen
    v_mfma_f32_16x16x32_bf16 v[28:31], a[176:179], v[176:179], v[28:31]
    s_waitcnt lgkmcnt(12)
    s_sub_u32 s90, s90, 0x400000
    ds_read_b64_tr_b16 a[220:221], v107 offset:0
    v_mfma_f32_16x16x32_bf16 v[28:31], a[172:175], v[172:175], v[28:31]
    ds_read_b64_tr_b16 a[222:223], v107 offset:8192
    v_mfma_f32_16x16x32_bf16 v[28:31], a[168:171], v[168:171], v[28:31]
    s_waitcnt lgkmcnt(12)
    ds_read_b64_tr_b16 a[224:225], v100 offset:256
    v_mfma_f32_16x16x32_bf16 v[28:31], a[164:167], v[164:167], v[28:31]
    ds_read_b64_tr_b16 a[226:227], v100 offset:8448
    v_mfma_f32_16x16x32_bf16 v[28:31], a[160:163], v[160:163], v[28:31]
    s_waitcnt lgkmcnt(12)
    ds_read_b64_tr_b16 a[228:229], v101 offset:256
    v_mfma_f32_16x16x32_bf16 a[0:3], a[192:195], v[88:91], a[0:3]
    ds_read_b64_tr_b16 a[230:231], v101 offset:8448
    v_mfma_f32_16x16x32_bf16 a[4:7], a[192:195], v[92:95], a[4:7]
    s_waitcnt lgkmcnt(12)
    ds_read_b64_tr_b16 a[232:233], v102 offset:256
    v_mfma_f32_16x16x32_bf16 a[12:15], a[196:199], v[92:95], a[12:15]
    ds_read_b64_tr_b16 a[234:235], v102 offset:8448
    v_mfma_f32_16x16x32_bf16 a[8:11], a[196:199], v[88:91], a[8:11]
    s_waitcnt lgkmcnt(12)
    ds_read_b64_tr_b16 a[236:237], v103 offset:256
    v_mfma_f32_16x16x32_bf16 a[16:19], a[200:203], v[88:91], a[16:19]
    ds_read_b64_tr_b16 a[238:239], v103 offset:8448
    v_mfma_f32_16x16x32_bf16 a[20:23], a[200:203], v[92:95], a[20:23]
    s_waitcnt lgkmcnt(12)
    ds_read_b64_tr_b16 a[240:241], v104 offset:256
    v_mfma_f32_16x16x32_bf16 a[28:31], a[204:207], v[92:95], a[28:31]
    s_waitcnt vmcnt(10)
    s_barrier
    ds_read_b64_tr_b16 a[242:243], v104 offset:8448
    v_mfma_f32_16x16x32_bf16 a[24:27], a[204:207], v[88:91], a[24:27]
    s_waitcnt lgkmcnt(12)
    v_exp_f32 v64, v16
    v_mfma_f32_16x16x32_bf16 a[32:35], a[208:211], v[88:91], a[32:35]
    s_add_u32 m0, s67, 49152
    ds_read_b64_tr_b16 a[244:245], v105 offset:256
    v_add_f32 v58, v56, v64
    v_mfma_f32_16x16x32_bf16 a[36:39], a[208:211], v[92:95], a[36:39]
    s_waitcnt lgkmcnt(12)
    ds_read_b64_tr_b16 a[246:247], v105 offset:8448
    buffer_load_dwordx4 v108, s[32:35], s82 offen offset:0 lds
    v_mfma_f32_16x16x32_bf16 a[44:47], a[212:215], v[92:95], a[44:47]
    v_exp_f32 v65, v17
    v_mfma_f32_16x16x32_bf16 a[40:43], a[212:215], v[88:91], a[40:43]
    s_waitcnt lgkmcnt(12)
    ds_read_b64_tr_b16 a[248:249], v106 offset:256
    v_add_f32 v58, v58, v65
    v_mfma_f32_16x16x32_bf16 a[48:51], a[216:219], v[88:91], a[48:51]
    ds_read_b64_tr_b16 a[250:251], v106 offset:8448
    v_cvt_pk_bf16_f32 v80, v64, v65
    v_mfma_f32_16x16x32_bf16 a[52:55], a[216:219], v[92:95], a[52:55]
    s_waitcnt lgkmcnt(12)
    v_exp_f32 v66, v18
    v_mfma_f32_16x16x32_bf16 a[60:63], a[220:223], v[92:95], a[60:63]
    ds_read_b64_tr_b16 a[252:253], v107 offset:256
    v_add_f32 v58, v58, v66
    v_mfma_f32_16x16x32_bf16 a[56:59], a[220:223], v[88:91], a[56:59]
    s_waitcnt lgkmcnt(12)
    ds_read_b64_tr_b16 a[254:255], v107 offset:8448
    buffer_load_dwordx4 v109, s[32:35], s82 offen offset:1024 lds
    v_mfma_f32_16x16x32_bf16 a[64:67], a[224:227], v[88:91], a[64:67]
    v_exp_f32 v67, v19
    v_mfma_f32_16x16x32_bf16 a[68:71], a[224:227], v[92:95], a[68:71]
    s_waitcnt lgkmcnt(12)
    ds_read_b128 a[128:131], v96 offset:16384
    v_add_f32 v58, v58, v67
    v_mfma_f32_16x16x32_bf16 a[76:79], a[228:231], v[92:95], a[76:79]
    ds_read_b128 a[132:135], v97 offset:16384
    v_cvt_pk_bf16_f32 v81, v66, v67
    v_mfma_f32_16x16x32_bf16 a[72:75], a[228:231], v[88:91], a[72:75]
    s_waitcnt lgkmcnt(12)
    v_exp_f32 v68, v20
    v_mfma_f32_16x16x32_bf16 a[80:83], a[232:235], v[88:91], a[80:83]
    ds_read_b128 a[136:139], v98 offset:16384
    v_add_f32 v59, v57, v68
    v_mfma_f32_16x16x32_bf16 a[84:87], a[232:235], v[92:95], a[84:87]
    s_waitcnt lgkmcnt(11)
    ds_read_b128 a[140:143], v99 offset:16384
    buffer_load_dwordx4 v110, s[32:35], s82 offen offset:2048 lds
    v_mfma_f32_16x16x32_bf16 a[92:95], a[236:239], v[92:95], a[92:95]
    v_exp_f32 v69, v21
    v_mfma_f32_16x16x32_bf16 a[88:91], a[236:239], v[88:91], a[88:91]
    s_waitcnt lgkmcnt(10)
    ds_read_b128 a[144:147], v96 offset:16640
    v_add_f32 v59, v59, v69
    v_mfma_f32_16x16x32_bf16 a[96:99], a[240:243], v[88:91], a[96:99]
    ds_read_b128 a[148:151], v97 offset:16640
    v_cvt_pk_bf16_f32 v84, v68, v69
    v_mfma_f32_16x16x32_bf16 a[100:103], a[240:243], v[92:95], a[100:103]
    s_waitcnt lgkmcnt(10)
    v_exp_f32 v70, v22
    v_mfma_f32_16x16x32_bf16 a[108:111], a[244:247], v[92:95], a[108:111]
    ds_read_b128 a[152:155], v98 offset:16640
    v_add_f32 v59, v59, v70
    v_mfma_f32_16x16x32_bf16 a[104:107], a[244:247], v[88:91], a[104:107]
    s_waitcnt lgkmcnt(9)
    ds_read_b128 a[156:159], v99 offset:16640
    buffer_load_dwordx4 v111, s[32:35], s82 offen offset:3072 lds
    v_mfma_f32_16x16x32_bf16 a[112:115], a[248:251], v[88:91], a[112:115]
    s_add_u32 s82, s82, 16384
    v_exp_f32 v71, v23
    v_mfma_f32_16x16x32_bf16 a[116:119], a[248:251], v[92:95], a[116:119]
    s_waitcnt lgkmcnt(8)
    ds_read_b128 a[160:163], v96 offset:24576
    v_add_f32 v59, v59, v71
    v_mfma_f32_16x16x32_bf16 a[124:127], a[252:255], v[92:95], a[124:127]
    ds_read_b128 a[164:167], v97 offset:24576
    v_cvt_pk_bf16_f32 v85, v70, v71
    v_mfma_f32_16x16x32_bf16 a[120:123], a[252:255], v[88:91], a[120:123]
    s_waitcnt lgkmcnt(9)
    v_exp_f32 v72, v24
    v_mfma_f32_16x16x32_bf16 v[32:35], a[128:131], v[128:131], v[48:51]
    s_waitcnt lgkmcnt(8)
    ds_read_b128 a[168:171], v98 offset:24576
    v_add_f32 v58, v58, v72
    v_mfma_f32_16x16x32_bf16 v[32:35], a[132:135], v[132:135], v[32:35]
    s_waitcnt lgkmcnt(8)
    s_add_u32 m0, s67, 114688
    ds_read_b128 a[172:175], v99 offset:24576
    v_mfma_f32_16x16x32_bf16 v[32:35], a[136:139], v[136:139], v[32:35]
    s_waitcnt lgkmcnt(8)
    buffer_load_dwordx4 v112, s[36:39], s83 offen offset:0 lds
    v_exp_f32 v73, v25
    v_mfma_f32_16x16x32_bf16 v[32:35], a[140:143], v[140:143], v[32:35]
    s_waitcnt lgkmcnt(7)
    ds_read_b128 a[176:179], v96 offset:24832
    v_add_f32 v58, v58, v73
    v_mfma_f32_16x16x32_bf16 v[32:35], a[144:147], v[144:147], v[32:35]
    s_waitcnt lgkmcnt(7)
    ds_read_b128 a[180:183], v97 offset:24832
    v_cvt_pk_bf16_f32 v82, v72, v73
    v_mfma_f32_16x16x32_bf16 v[32:35], a[148:151], v[148:151], v[32:35]
    s_waitcnt lgkmcnt(7)
    v_exp_f32 v74, v26
    v_mfma_f32_16x16x32_bf16 v[32:35], a[152:155], v[152:155], v[32:35]
    s_waitcnt lgkmcnt(6)
    ds_read_b128 a[184:187], v98 offset:24832
    v_add_f32 v58, v58, v74
    v_mfma_f32_16x16x32_bf16 v[32:35], a[156:159], v[156:159], v[32:35]
    ds_read_b128 a[188:191], v99 offset:24832
    buffer_load_dwordx4 v113, s[36:39], s83 offen offset:1024 lds
    v_mfma_f32_16x16x32_bf16 v[36:39], a[156:159], v[188:191], v[52:55]
    v_exp_f32 v75, v27
    v_mfma_f32_16x16x32_bf16 v[36:39], a[152:155], v[184:187], v[36:39]
    ds_read_b64_tr_b16 a[192:193], v100 offset:16384
    v_add_f32 v58, v58, v75
    v_mfma_f32_16x16x32_bf16 v[36:39], a[148:151], v[180:183], v[36:39]
    ds_read_b64_tr_b16 a[194:195], v100 offset:24576
    v_cvt_pk_bf16_f32 v83, v74, v75
    v_mfma_f32_16x16x32_bf16 v[36:39], a[144:147], v[176:179], v[36:39]
    v_exp_f32 v76, v28
    v_mfma_f32_16x16x32_bf16 v[36:39], a[140:143], v[172:175], v[36:39]
    ds_read_b64_tr_b16 a[196:197], v101 offset:16384
    v_add_f32 v59, v59, v76
    v_mfma_f32_16x16x32_bf16 v[36:39], a[136:139], v[168:171], v[36:39]
    ds_read_b64_tr_b16 a[198:199], v101 offset:24576
    buffer_load_dwordx4 v114, s[36:39], s83 offen offset:2048 lds
    v_mfma_f32_16x16x32_bf16 v[36:39], a[132:135], v[164:167], v[36:39]
    v_exp_f32 v77, v29
    v_mfma_f32_16x16x32_bf16 v[36:39], a[128:131], v[160:163], v[36:39]
    s_waitcnt lgkmcnt(11)
    ds_read_b64_tr_b16 a[200:201], v102 offset:16384
    v_add_f32 v59, v59, v77
    v_mfma_f32_16x16x32_bf16 v[40:43], a[160:163], v[128:131], v[48:51]
    s_waitcnt lgkmcnt(11)
    ds_read_b64_tr_b16 a[202:203], v102 offset:24576
    v_cvt_pk_bf16_f32 v86, v76, v77
    v_mfma_f32_16x16x32_bf16 v[40:43], a[164:167], v[132:135], v[40:43]
    s_waitcnt lgkmcnt(11)
    v_exp_f32 v78, v30
    v_mfma_f32_16x16x32_bf16 v[40:43], a[168:171], v[136:139], v[40:43]
    s_waitcnt lgkmcnt(10)
    ds_read_b64_tr_b16 a[204:205], v103 offset:16384
    v_add_f32 v59, v59, v78
    v_mfma_f32_16x16x32_bf16 v[40:43], a[172:175], v[140:143], v[40:43]
    s_waitcnt lgkmcnt(10)
    ds_read_b64_tr_b16 a[206:207], v103 offset:24576
    buffer_load_dwordx4 v115, s[36:39], s83 offen offset:3072 lds
    v_mfma_f32_16x16x32_bf16 v[40:43], a[176:179], v[144:147], v[40:43]
    s_waitcnt lgkmcnt(10)
    s_add_u32 s83, s83, 16384
    v_exp_f32 v79, v31
    v_mfma_f32_16x16x32_bf16 v[40:43], a[180:183], v[148:151], v[40:43]
    s_waitcnt lgkmcnt(9)
    ds_read_b64_tr_b16 a[208:209], v104 offset:16384
    v_add_f32 v59, v59, v79
    v_mfma_f32_16x16x32_bf16 v[40:43], a[184:187], v[152:155], v[40:43]
    s_waitcnt lgkmcnt(9)
    ds_read_b64_tr_b16 a[210:211], v104 offset:24576
    v_cvt_pk_bf16_f32 v87, v78, v79
    v_mfma_f32_16x16x32_bf16 v[40:43], a[188:191], v[156:159], v[40:43]
    ds_read_b64_tr_b16 a[212:213], v105 offset:16384
    v_add_f32 v62, v58, v59
    v_mfma_f32_16x16x32_bf16 v[44:47], a[188:191], v[188:191], v[52:55]
    ds_read_b64_tr_b16 a[214:215], v105 offset:24576
    v_cmp_nge_f32 vcc, s71, v62
    v_mfma_f32_16x16x32_bf16 v[44:47], a[184:187], v[184:187], v[44:47]
    s_cbranch_vccnz L_rare_2
L_back_2:
    ds_read_b64_tr_b16 a[216:217], v106 offset:16384
    v_mfma_f32_16x16x32_bf16 v[44:47], a[180:183], v[180:183], v[44:47]
    ds_read_b64_tr_b16 a[218:219], v106 offset:24576
    buffer_load_dword v10, v9, s[12:15], s16 offen
    v_mfma_f32_16x16x32_bf16 v[44:47], a[176:179], v[176:179], v[44:47]
    s_waitcnt lgkmcnt(12)
    s_add_u32 s16, s16, 0x40010000
    ds_read_b64_tr_b16 a[220:221], v107 offset:16384
    v_mfma_f32_16x16x32_bf16 v[44:47], a[172:175], v[172:175], v[44:47]
    ds_read_b64_tr_b16 a[222:223], v107 offset:24576
    v_mfma_f32_16x16x32_bf16 v[44:47], a[168:171], v[168:171], v[44:47]
    s_waitcnt lgkmcnt(12)
    ds_read_b64_tr_b16 a[224:225], v100 offset:16640
    v_mfma_f32_16x16x32_bf16 v[44:47], a[164:167], v[164:167], v[44:47]
    ds_read_b64_tr_b16 a[226:227], v100 offset:24832
    v_mfma_f32_16x16x32_bf16 v[44:47], a[160:163], v[160:163], v[44:47]
    s_waitcnt lgkmcnt(12)
    ds_read_b64_tr_b16 a[228:229], v101 offset:16640
    v_mfma_f32_16x16x32_bf16 a[0:3], a[192:195], v[80:83], a[0:3]
    ds_read_b64_tr_b16 a[230:231], v101 offset:24832
    v_mfma_f32_16x16x32_bf16 a[4:7], a[192:195], v[84:87], a[4:7]
    s_waitcnt lgkmcnt(12)
    ds_read_b64_tr_b16 a[232:233], v102 offset:16640
    v_mfma_f32_16x16x32_bf16 a[12:15], a[196:199], v[84:87], a[12:15]
    ds_read_b64_tr_b16 a[234:235], v102 offset:24832
    v_mfma_f32_16x16x32_bf16 a[8:11], a[196:199], v[80:83], a[8:11]
    s_waitcnt lgkmcnt(12)
    ds_read_b64_tr_b16 a[236:237], v103 offset:16640
    v_mfma_f32_16x16x32_bf16 a[16:19], a[200:203], v[80:83], a[16:19]
    ds_read_b64_tr_b16 a[238:239], v103 offset:24832
    v_mfma_f32_16x16x32_bf16 a[20:23], a[200:203], v[84:87], a[20:23]
    s_waitcnt lgkmcnt(12)
    ds_read_b64_tr_b16 a[240:241], v104 offset:16640
    v_mfma_f32_16x16x32_bf16 a[28:31], a[204:207], v[84:87], a[28:31]
    s_waitcnt vmcnt(10)
    s_barrier
    ds_read_b64_tr_b16 a[242:243], v104 offset:24832
    v_mfma_f32_16x16x32_bf16 a[24:27], a[204:207], v[80:83], a[24:27]
    s_waitcnt lgkmcnt(12)
    v_exp_f32 v64, v32
    v_mfma_f32_16x16x32_bf16 a[32:35], a[208:211], v[80:83], a[32:35]
    s_add_u32 m0, s67, 0
    ds_read_b64_tr_b16 a[244:245], v105 offset:16640
    v_add_f32 v56, v58, v64
    v_mfma_f32_16x16x32_bf16 a[36:39], a[208:211], v[84:87], a[36:39]
    s_waitcnt lgkmcnt(12)
    ds_read_b64_tr_b16 a[246:247], v105 offset:24832
    buffer_load_dwordx4 v108, s[32:35], s82 offen offset:0 lds
    v_mfma_f32_16x16x32_bf16 a[44:47], a[212:215], v[84:87], a[44:47]
    v_exp_f32 v65, v33
    v_mfma_f32_16x16x32_bf16 a[40:43], a[212:215], v[80:83], a[40:43]
    s_waitcnt lgkmcnt(12)
    ds_read_b64_tr_b16 a[248:249], v106 offset:16640
    v_add_f32 v56, v56, v65
    v_mfma_f32_16x16x32_bf16 a[48:51], a[216:219], v[80:83], a[48:51]
    ds_read_b64_tr_b16 a[250:251], v106 offset:24832
    v_cvt_pk_bf16_f32 v88, v64, v65
    v_mfma_f32_16x16x32_bf16 a[52:55], a[216:219], v[84:87], a[52:55]
    s_waitcnt lgkmcnt(12)
    v_exp_f32 v66, v34
    v_mfma_f32_16x16x32_bf16 a[60:63], a[220:223], v[84:87], a[60:63]
    ds_read_b64_tr_b16 a[252:253], v107 offset:16640
    v_add_f32 v56, v56, v66
    v_mfma_f32_16x16x32_bf16 a[56:59], a[220:223], v[80:83], a[56:59]
    s_waitcnt lgkmcnt(12)
    ds_read_b64_tr_b16 a[254:255], v107 offset:24832
    buffer_load_dwordx4 v109, s[32:35], s82 offen offset:1024 lds
    v_mfma_f32_16x16x32_bf16 a[64:67], a[224:227], v[80:83], a[64:67]
    v_exp_f32 v67, v35
    v_mfma_f32_16x16x32_bf16 a[68:71], a[224:227], v[84:87], a[68:71]
    s_waitcnt lgkmcnt(12)
    ds_read_b128 a[128:131], v96 offset:32768
    v_add_f32 v56, v56, v67
    v_mfma_f32_16x16x32_bf16 a[76:79], a[228:231], v[84:87], a[76:79]
    ds_read_b128 a[132:135], v97 offset:32768
    v_cvt_pk_bf16_f32 v89, v66, v67
    v_mfma_f32_16x16x32_bf16 a[72:75], a[228:231], v[80:83], a[72:75]
    s_waitcnt lgkmcnt(12)
    v_exp_f32 v68, v36
    v_mfma_f32_16x16x32_bf16 a[80:83], a[232:235], v[80:83], a[80:83]
    ds_read_b128 a[136:139], v98 offset:32768
    v_add_f32 v57, v59, v68
    v_mfma_f32_16x16x32_bf16 a[84:87], a[232:235], v[84:87], a[84:87]
    s_waitcnt lgkmcnt(11)
    ds_read_b128 a[140:143], v99 offset:32768
    buffer_load_dwordx4 v110, s[32:35], s82 offen offset:2048 lds
    v_mfma_f32_16x16x32_bf16 a[92:95], a[236:239], v[84:87], a[92:95]
    v_exp_f32 v69, v37
    v_mfma_f32_16x16x32_bf16 a[88:91], a[236:239], v[80:83], a[88:91]
    s_waitcnt lgkmcnt(10)
    ds_read_b128 a[144:147], v96 offset:33024
    v_add_f32 v57, v57, v69
    v_mfma_f32_16x16x32_bf16 a[96:99], a[240:243], v[80:83], a[96:99]
    ds_read_b128 a[148:151], v97 offset:33024
    v_cvt_pk_bf16_f32 v92, v68, v69
    v_mfma_f32_16x16x32_bf16 a[100:103], a[240:243], v[84:87], a[100:103]
    s_waitcnt lgkmcnt(10)
    v_exp_f32 v70, v38
    v_mfma_f32_16x16x32_bf16 a[108:111], a[244:247], v[84:87], a[108:111]
    ds_read_b128 a[152:155], v98 offset:33024
    v_add_f32 v57, v57, v70
    v_mfma_f32_16x16x32_bf16 a[104:107], a[244:247], v[80:83], a[104:107]
    s_waitcnt lgkmcnt(9)
    ds_read_b128 a[156:159], v99 offset:33024
    buffer_load_dwordx4 v111, s[32:35], s82 offen offset:3072 lds
    v_mfma_f32_16x16x32_bf16 a[112:115], a[248:251], v[80:83], a[112:115]
    s_add_u32 s82, s82, 16384
    v_exp_f32 v71, v39
    v_mfma_f32_16x16x32_bf16 a[116:119], a[248:251], v[84:87], a[116:119]
    s_waitcnt lgkmcnt(8)
    ds_read_b128 a[160:163], v96 offset:40960
    v_add_f32 v57, v57, v71
    v_mfma_f32_16x16x32_bf16 a[124:127], a[252:255], v[84:87], a[124:127]
    ds_read_b128 a[164:167], v97 offset:40960
    v_cvt_pk_bf16_f32 v93, v70, v71
    v_mfma_f32_16x16x32_bf16 a[120:123], a[252:255], v[80:83], a[120:123]
    s_waitcnt lgkmcnt(9)
    v_exp_f32 v72, v40
    v_mfma_f32_16x16x32_bf16 v[16:19], a[128:131], v[128:131], v[48:51]
    s_waitcnt lgkmcnt(8)
    ds_read_b128 a[168:171], v98 offset:40960
    v_add_f32 v56, v56, v72
    v_mfma_f32_16x16x32_bf16 v[16:19], a[132:135], v[132:135], v[16:19]
    s_waitcnt lgkmcnt(8)
    s_add_u32 m0, s67, 65536
    ds_read_b128 a[172:175], v99 offset:40960
    v_mfma_f32_16x16x32_bf16 v[16:19], a[136:139], v[136:139], v[16:19]
    s_waitcnt lgkmcnt(8)
    buffer_load_dwordx4 v112, s[36:39], s83 offen offset:0 lds
    v_exp_f32 v73, v41
    v_mfma_f32_16x16x32_bf16 v[16:19], a[140:143], v[140:143], v[16:19]
    s_waitcnt lgkmcnt(7)
    ds_read_b128 a[176:179], v96 offset:41216
    v_add_f32 v56, v56, v73
    v_mfma_f32_16x16x32_bf16 v[16:19], a[144:147], v[144:147], v[16:19]
    s_waitcnt lgkmcnt(7)
    ds_read_b128 a[180:183], v97 offset:41216
    v_cvt_pk_bf16_f32 v90, v72, v73
    v_mfma_f32_16x16x32_bf16 v[16:19], a[148:151], v[148:151], v[16:19]
    s_waitcnt lgkmcnt(7)
    v_exp_f32 v74, v42
    v_mfma_f32_16x16x32_bf16 v[16:19], a[152:155], v[152:155], v[16:19]
    s_waitcnt lgkmcnt(6)
    ds_read_b128 a[184:187], v98 offset:41216
    v_add_f32 v56, v56, v74
    v_mfma_f32_16x16x32_bf16 v[16:19], a[156:159], v[156:159], v[16:19]
    ds_read_b128 a[188:191], v99 offset:41216
    buffer_load_dwordx4 v113, s[36:39], s83 offen offset:1024 lds
    v_mfma_f32_16x16x32_bf16 v[20:23], a[156:159], v[188:191], v[52:55]
    v_exp_f32 v75, v43
    v_mfma_f32_16x16x32_bf16 v[20:23], a[152:155], v[184:187], v[20:23]
    ds_read_b64_tr_b16 a[192:193], v100 offset:32768
    v_add_f32 v56, v56, v75
    v_mfma_f32_16x16x32_bf16 v[20:23], a[148:151], v[180:183], v[20:23]
    ds_read_b64_tr_b16 a[194:195], v100 offset:40960
    v_cvt_pk_bf16_f32 v91, v74, v75
    v_mfma_f32_16x16x32_bf16 v[20:23], a[144:147], v[176:179], v[20:23]
    v_exp_f32 v76, v44
    v_mfma_f32_16x16x32_bf16 v[20:23], a[140:143], v[172:175], v[20:23]
    ds_read_b64_tr_b16 a[196:197], v101 offset:32768
    v_add_f32 v57, v57, v76
    v_mfma_f32_16x16x32_bf16 v[20:23], a[136:139], v[168:171], v[20:23]
    ds_read_b64_tr_b16 a[198:199], v101 offset:40960
    buffer_load_dwordx4 v114, s[36:39], s83 offen offset:2048 lds
    v_mfma_f32_16x16x32_bf16 v[20:23], a[132:135], v[164:167], v[20:23]
    v_exp_f32 v77, v45
    v_mfma_f32_16x16x32_bf16 v[20:23], a[128:131], v[160:163], v[20:23]
    s_waitcnt lgkmcnt(11)
    ds_read_b64_tr_b16 a[200:201], v102 offset:32768
    v_add_f32 v57, v57, v77
    v_mfma_f32_16x16x32_bf16 v[24:27], a[160:163], v[128:131], v[48:51]
    s_waitcnt lgkmcnt(11)
    ds_read_b64_tr_b16 a[202:203], v102 offset:40960
    v_cvt_pk_bf16_f32 v94, v76, v77
    v_mfma_f32_16x16x32_bf16 v[24:27], a[164:167], v[132:135], v[24:27]
    s_waitcnt lgkmcnt(11)
    v_exp_f32 v78, v46
    v_mfma_f32_16x16x32_bf16 v[24:27], a[168:171], v[136:139], v[24:27]
    s_waitcnt lgkmcnt(10)
    ds_read_b64_tr_b16 a[204:205], v103 offset:32768
    v_add_f32 v57, v57, v78
    v_mfma_f32_16x16x32_bf16 v[24:27], a[172:175], v[140:143], v[24:27]
    s_waitcnt lgkmcnt(10)
    ds_read_b64_tr_b16 a[206:207], v103 offset:40960
    buffer_load_dwordx4 v115, s[36:39], s83 offen offset:3072 lds
    v_mfma_f32_16x16x32_bf16 v[24:27], a[176:179], v[144:147], v[24:27]
    s_waitcnt lgkmcnt(10)
    s_add_u32 s83, s83, 16384
    v_exp_f32 v79, v47
    v_mfma_f32_16x16x32_bf16 v[24:27], a[180:183], v[148:151], v[24:27]
    s_waitcnt lgkmcnt(9)
    ds_read_b64_tr_b16 a[208:209], v104 offset:32768
    v_add_f32 v57, v57, v79
    v_mfma_f32_16x16x32_bf16 v[24:27], a[184:187], v[152:155], v[24:27]
    s_waitcnt lgkmcnt(9)
    ds_read_b64_tr_b16 a[210:211], v104 offset:40960
    v_cvt_pk_bf16_f32 v95, v78, v79
    v_mfma_f32_16x16x32_bf16 v[24:27], a[188:191], v[156:159], v[24:27]
    ds_read_b64_tr_b16 a[212:213], v105 offset:32768
    v_add_f32 v62, v56, v57
    v_mfma_f32_16x16x32_bf16 v[28:31], a[188:191], v[188:191], v[52:55]
    ds_read_b64_tr_b16 a[214:215], v105 offset:40960
    v_cmp_nge_f32 vcc, s71, v62
    v_mfma_f32_16x16x32_bf16 v[28:31], a[184:187], v[184:187], v[28:31]
    s_cbranch_vccnz L_rare_3
L_back_3:
    ds_read_b64_tr_b16 a[216:217], v106 offset:32768
    v_mfma_f32_16x16x32_bf16 v[28:31], a[180:183], v[180:183], v[28:31]
    ds_read_b64_tr_b16 a[218:219], v106 offset:40960
    buffer_atomic_add v3, v4, s[20:23], s87 offen offset:4
    v_mfma_f32_16x16x32_bf16 v[28:31], a[176:179], v[176:179], v[28:31]
    s_waitcnt lgkmcnt(12)
    s_sub_u32 s87, s87, 4096
    ds_read_b64_tr_b16 a[220:221], v107 offset:32768
    v_mfma_f32_16x16x32_bf16 v[28:31], a[172:175], v[172:175], v[28:31]
    ds_read_b64_tr_b16 a[222:223], v107 offset:40960
    v_mfma_f32_16x16x32_bf16 v[28:31], a[168:171], v[168:171], v[28:31]
    s_waitcnt lgkmcnt(12)
    ds_read_b64_tr_b16 a[224:225], v100 offset:33024
    v_mfma_f32_16x16x32_bf16 v[28:31], a[164:167], v[164:167], v[28:31]
    ds_read_b64_tr_b16 a[226:227], v100 offset:41216
    v_mfma_f32_16x16x32_bf16 v[28:31], a[160:163], v[160:163], v[28:31]
    s_waitcnt lgkmcnt(12)
    ds_read_b64_tr_b16 a[228:229], v101 offset:33024
    v_mfma_f32_16x16x32_bf16 a[0:3], a[192:195], v[88:91], a[0:3]
    ds_read_b64_tr_b16 a[230:231], v101 offset:41216
    v_mfma_f32_16x16x32_bf16 a[4:7], a[192:195], v[92:95], a[4:7]
    s_waitcnt lgkmcnt(12)
    ds_read_b64_tr_b16 a[232:233], v102 offset:33024
    v_mfma_f32_16x16x32_bf16 a[12:15], a[196:199], v[92:95], a[12:15]
    ds_read_b64_tr_b16 a[234:235], v102 offset:41216
    v_mfma_f32_16x16x32_bf16 a[8:11], a[196:199], v[88:91], a[8:11]
    s_waitcnt lgkmcnt(12)
    ds_read_b64_tr_b16 a[236:237], v103 offset:33024
    v_mfma_f32_16x16x32_bf16 a[16:19], a[200:203], v[88:91], a[16:19]
    ds_read_b64_tr_b16 a[238:239], v103 offset:41216
    v_mfma_f32_16x16x32_bf16 a[20:23], a[200:203], v[92:95], a[20:23]
    s_waitcnt lgkmcnt(12)
    ds_read_b64_tr_b16 a[240:241], v104 offset:33024
    v_mfma_f32_16x16x32_bf16 a[28:31], a[204:207], v[92:95], a[28:31]
    s_waitcnt vmcnt(10)
    s_barrier
    ds_read_b64_tr_b16 a[242:243], v104 offset:41216
    v_mfma_f32_16x16x32_bf16 a[24:27], a[204:207], v[88:91], a[24:27]
    s_waitcnt lgkmcnt(12)
    v_exp_f32 v64, v16
    v_mfma_f32_16x16x32_bf16 a[32:35], a[208:211], v[88:91], a[32:35]
    s_add_u32 m0, s67, 16384
    ds_read_b64_tr_b16 a[244:245], v105 offset:33024
    v_add_f32 v58, v56, v64
    v_mfma_f32_16x16x32_bf16 a[36:39], a[208:211], v[92:95], a[36:39]
    s_waitcnt lgkmcnt(12)
    ds_read_b64_tr_b16 a[246:247], v105 offset:41216
    buffer_load_dwordx4 v108, s[32:35], s82 offen offset:0 lds
    v_mfma_f32_16x16x32_bf16 a[44:47], a[212:215], v[92:95], a[44:47]
    v_exp_f32 v65, v17
    v_mfma_f32_16x16x32_bf16 a[40:43], a[212:215], v[88:91], a[40:43]
    s_waitcnt lgkmcnt(12)
    ds_read_b64_tr_b16 a[248:249], v106 offset:33024
    v_add_f32 v58, v58, v65
    v_mfma_f32_16x16x32_bf16 a[48:51], a[216:219], v[88:91], a[48:51]
    ds_read_b64_tr_b16 a[250:251], v106 offset:41216
    v_cvt_pk_bf16_f32 v80, v64, v65
    v_mfma_f32_16x16x32_bf16 a[52:55], a[216:219], v[92:95], a[52:55]
    s_waitcnt lgkmcnt(12)
    v_exp_f32 v66, v18
    v_mfma_f32_16x16x32_bf16 a[60:63], a[220:223], v[92:95], a[60:63]
    ds_read_b64_tr_b16 a[252:253], v107 offset:33024
    v_add_f32 v58, v58, v66
    v_mfma_f32_16x16x32_bf16 a[56:59], a[220:223], v[88:91], a[56:59]
    s_waitcnt lgkmcnt(12)
    ds_read_b64_tr_b16 a[254:255], v107 offset:41216
    buffer_load_dwordx4 v109, s[32:35], s82 offen offset:1024 lds
    v_mfma_f32_16x16x32_bf16 a[64:67], a[224:227], v[88:91], a[64:67]
    v_exp_f32 v67, v19
    v_mfma_f32_16x16x32_bf16 a[68:71], a[224:227], v[92:95], a[68:71]
    s_waitcnt lgkmcnt(12)
    ds_read_b128 a[128:131], v96 offset:49152
    v_add_f32 v58, v58, v67
    v_mfma_f32_16x16x32_bf16 a[76:79], a[228:231], v[92:95], a[76:79]
    ds_read_b128 a[132:135], v97 offset:49152
    v_cvt_pk_bf16_f32 v81, v66, v67
    v_mfma_f32_16x16x32_bf16 a[72:75], a[228:231], v[88:91], a[72:75]
    s_waitcnt lgkmcnt(12)
    v_exp_f32 v68, v20
    v_mfma_f32_16x16x32_bf16 a[80:83], a[232:235], v[88:91], a[80:83]
    ds_read_b128 a[136:139], v98 offset:49152
    v_add_f32 v59, v57, v68
    v_mfma_f32_16x16x32_bf16 a[84:87], a[232:235], v[92:95], a[84:87]
    s_waitcnt lgkmcnt(11)
    ds_read_b128 a[140:143], v99 offset:49152
    buffer_load_dwordx4 v110, s[32:35], s82 offen offset:2048 lds
    v_mfma_f32_16x16x32_bf16 a[92:95], a[236:239], v[92:95], a[92:95]
    v_exp_f32 v69, v21
    v_mfma_f32_16x16x32_bf16 a[88:91], a[236:239], v[88:91], a[88:91]
    s_waitcnt lgkmcnt(10)
    ds_read_b128 a[144:147], v96 offset:49408
    v_add_f32 v59, v59, v69
    v_mfma_f32_16x16x32_bf16 a[96:99], a[240:243], v[88:91], a[96:99]
    ds_read_b128 a[148:151], v97 offset:49408
    v_cvt_pk_bf16_f32 v84, v68, v69
    v_mfma_f32_16x16x32_bf16 a[100:103], a[240:243], v[92:95], a[100:103]
    s_waitcnt lgkmcnt(10)
    v_exp_f32 v70, v22
    v_mfma_f32_16x16x32_bf16 a[108:111], a[244:247], v[92:95], a[108:111]
    ds_read_b128 a[152:155], v98 offset:49408
    v_add_f32 v59, v59, v70
    v_mfma_f32_16x16x32_bf16 a[104:107], a[244:247], v[88:91], a[104:107]
    s_waitcnt lgkmcnt(9)
    ds_read_b128 a[156:159], v99 offset:49408
    buffer_load_dwordx4 v111, s[32:35], s82 offen offset:3072 lds
    v_mfma_f32_16x16x32_bf16 a[112:115], a[248:251], v[88:91], a[112:115]
    s_add_u32 s82, s82, 16384
    v_exp_f32 v71, v23
    v_mfma_f32_16x16x32_bf16 a[116:119], a[248:251], v[92:95], a[116:119]
    s_waitcnt lgkmcnt(8)
    ds_read_b128 a[160:163], v96 offset:57344
    v_add_f32 v59, v59, v71
    v_mfma_f32_16x16x32_bf16 a[124:127], a[252:255], v[92:95], a[124:127]
    ds_read_b128 a[164:167], v97 offset:57344
    v_cvt_pk_bf16_f32 v85, v70, v71
    v_mfma_f32_16x16x32_bf16 a[120:123], a[252:255], v[88:91], a[120:123]
    s_waitcnt lgkmcnt(9)
    v_exp_f32 v72, v24
    v_mfma_f32_16x16x32_bf16 v[32:35], a[128:131], v[128:131], v[48:51]
    s_waitcnt lgkmcnt(8)
    ds_read_b128 a[168:171], v98 offset:57344
    v_add_f32 v58, v58, v72
    v_mfma_f32_16x16x32_bf16 v[32:35], a[132:135], v[132:135], v[32:35]
    s_waitcnt lgkmcnt(8)
    s_add_u32 m0, s67, 81920
    ds_read_b128 a[172:175], v99 offset:57344
    v_mfma_f32_16x16x32_bf16 v[32:35], a[136:139], v[136:139], v[32:35]
    s_waitcnt lgkmcnt(8)
    buffer_load_dwordx4 v112, s[36:39], s83 offen offset:0 lds
    v_exp_f32 v73, v25
    v_mfma_f32_16x16x32_bf16 v[32:35], a[140:143], v[140:143], v[32:35]
    s_waitcnt lgkmcnt(7)
    ds_read_b128 a[176:179], v96 offset:57600
    v_add_f32 v58, v58, v73
    v_mfma_f32_16x16x32_bf16 v[32:35], a[144:147], v[144:147], v[32:35]
    s_waitcnt lgkmcnt(7)
    ds_read_b128 a[180:183], v97 offset:57600
    v_cvt_pk_bf16_f32 v82, v72, v73
    v_mfma_f32_16x16x32_bf16 v[32:35], a[148:151], v[148:151], v[32:35]
    s_waitcnt lgkmcnt(7)
    v_exp_f32 v74, v26
    v_mfma_f32_16x16x32_bf16 v[32:35], a[152:155], v[152:155], v[32:35]
    s_waitcnt lgkmcnt(6)
    ds_read_b128 a[184:187], v98 offset:57600
    v_add_f32 v58, v58, v74
    v_mfma_f32_16x16x32_bf16 v[32:35], a[156:159], v[156:159], v[32:35]
    ds_read_b128 a[188:191], v99 offset:57600
    buffer_load_dwordx4 v113, s[36:39], s83 offen offset:1024 lds
    v_mfma_f32_16x16x32_bf16 v[36:39], a[156:159], v[188:191], v[52:55]
    v_exp_f32 v75, v27
    v_mfma_f32_16x16x32_bf16 v[36:39], a[152:155], v[184:187], v[36:39]
    ds_read_b64_tr_b16 a[192:193], v100 offset:49152
    v_add_f32 v58, v58, v75
    v_mfma_f32_16x16x32_bf16 v[36:39], a[148:151], v[180:183], v[36:39]
    ds_read_b64_tr_b16 a[194:195], v100 offset:57344
    v_cvt_pk_bf16_f32 v83, v74, v75
    v_mfma_f32_16x16x32_bf16 v[36:39], a[144:147], v[176:179], v[36:39]
    v_exp_f32 v76, v28
    v_mfma_f32_16x16x32_bf16 v[36:39], a[140:143], v[172:175], v[36:39]
    ds_read_b64_tr_b16 a[196:197], v101 offset:49152
    v_add_f32 v59, v59, v76
    v_mfma_f32_16x16x32_bf16 v[36:39], a[136:139], v[168:171], v[36:39]
    ds_read_b64_tr_b16 a[198:199], v101 offset:57344
    buffer_load_dwordx4 v114, s[36:39], s83 offen offset:2048 lds
    v_mfma_f32_16x16x32_bf16 v[36:39], a[132:135], v[164:167], v[36:39]
    v_exp_f32 v77, v29
    v_mfma_f32_16x16x32_bf16 v[36:39], a[128:131], v[160:163], v[36:39]
    s_waitcnt lgkmcnt(11)
    ds_read_b64_tr_b16 a[200:201], v102 offset:49152
    v_add_f32 v59, v59, v77
    v_mfma_f32_16x16x32_bf16 v[40:43], a[160:163], v[128:131], v[48:51]
    s_waitcnt lgkmcnt(11)
    ds_read_b64_tr_b16 a[202:203], v102 offset:57344
    v_cvt_pk_bf16_f32 v86, v76, v77
    v_mfma_f32_16x16x32_bf16 v[40:43], a[164:167], v[132:135], v[40:43]
    s_waitcnt lgkmcnt(11)
    v_exp_f32 v78, v30
    v_mfma_f32_16x16x32_bf16 v[40:43], a[168:171], v[136:139], v[40:43]
    s_waitcnt lgkmcnt(10)
    ds_read_b64_tr_b16 a[204:205], v103 offset:49152
    v_add_f32 v59, v59, v78
    v_mfma_f32_16x16x32_bf16 v[40:43], a[172:175], v[140:143], v[40:43]
    s_waitcnt lgkmcnt(10)
    ds_read_b64_tr_b16 a[206:207], v103 offset:57344
    buffer_load_dwordx4 v115, s[36:39], s83 offen offset:3072 lds
    v_mfma_f32_16x16x32_bf16 v[40:43], a[176:179], v[144:147], v[40:43]
    s_waitcnt lgkmcnt(10)
    s_add_u32 s83, s83, 16384
    v_exp_f32 v79, v31
    v_mfma_f32_16x16x32_bf16 v[40:43], a[180:183], v[148:151], v[40:43]
    s_waitcnt lgkmcnt(9)
    ds_read_b64_tr_b16 a[208:209], v104 offset:49152
    v_add_f32 v59, v59, v79
    v_mfma_f32_16x16x32_bf16 v[40:43], a[184:187], v[152:155], v[40:43]
    s_waitcnt lgkmcnt(9)
    ds_read_b64_tr_b16 a[210:211], v104 offset:57344
    v_cvt_pk_bf16_f32 v87, v78, v79
    v_mfma_f32_16x16x32_bf16 v[40:43], a[188:191], v[156:159], v[40:43]
    ds_read_b64_tr_b16 a[212:213], v105 offset:49152
    v_add_f32 v62, v58, v59
    v_mfma_f32_16x16x32_bf16 v[44:47], a[188:191], v[188:191], v[52:55]
    ds_read_b64_tr_b16 a[214:215], v105 offset:57344
    v_cmp_nge_f32 vcc, s71, v62
    v_mfma_f32_16x16x32_bf16 v[44:47], a[184:187], v[184:187], v[44:47]
    s_cbranch_vccnz L_rare_4
L_back_4:
    ds_read_b64_tr_b16 a[216:217], v106 offset:49152
    v_mfma_f32_16x16x32_bf16 v[44:47], a[180:183], v[180:183], v[44:47]
    ds_read_b64_tr_b16 a[218:219], v106 offset:57344
    buffer_load_dword v10, v11, s[44:47], s91 offen
    v_mfma_f32_16x16x32_bf16 v[44:47], a[176:179], v[176:179], v[44:47]
    s_waitcnt lgkmcnt(12)
    s_sub_u32 s91, s91, 0x400000
    ds_read_b64_tr_b16 a[220:221], v107 offset:49152
    v_mfma_f32_16x16x32_bf16 v[44:47], a[172:175], v[172:175], v[44:47]
    ds_read_b64_tr_b16 a[222:223], v107 offset:57344
    v_mfma_f32_16x16x32_bf16 v[44:47], a[168:171], v[168:171], v[44:47]
    s_waitcnt lgkmcnt(12)
    ds_read_b64_tr_b16 a[224:225], v100 offset:49408
    v_mfma_f32_16x16x32_bf16 v[44:47], a[164:167], v[164:167], v[44:47]
    ds_read_b64_tr_b16 a[226:227], v100 offset:57600
    v_mfma_f32_16x16x32_bf16 v[44:47], a[160:163], v[160:163], v[44:47]
    s_waitcnt lgkmcnt(12)
    ds_read_b64_tr_b16 a[228:229], v101 offset:49408
    v_mfma_f32_16x16x32_bf16 a[0:3], a[192:195], v[80:83], a[0:3]
    ds_read_b64_tr_b16 a[230:231], v101 offset:57600
    v_mfma_f32_16x16x32_bf16 a[4:7], a[192:195], v[84:87], a[4:7]
    s_waitcnt lgkmcnt(12)
    ds_read_b64_tr_b16 a[232:233], v102 offset:49408
    v_mfma_f32_16x16x32_bf16 a[12:15], a[196:199], v[84:87], a[12:15]
    ds_read_b64_tr_b16 a[234:235], v102 offset:57600
    v_mfma_f32_16x16x32_bf16 a[8:11], a[196:199], v[80:83], a[8:11]
    s_waitcnt lgkmcnt(12)
    ds_read_b64_tr_b16 a[236:237], v103 offset:49408
    v_mfma_f32_16x16x32_bf16 a[16:19], a[200:203], v[80:83], a[16:19]
    ds_read_b64_tr_b16 a[238:239], v103 offset:57600
    v_mfma_f32_16x16x32_bf16 a[20:23], a[200:203], v[84:87], a[20:23]
    s_waitcnt lgkmcnt(12)
    ds_read_b64_tr_b16 a[240:241], v104 offset:49408
    v_mfma_f32_16x16x32_bf16 a[28:31], a[204:207], v[84:87], a[28:31]
    s_waitcnt vmcnt(10)
    s_barrier
    ds_read_b64_tr_b16 a[242:243], v104 offset:57600
    v_mfma_f32_16x16x32_bf16 a[24:27], a[204:207], v[80:83], a[24:27]
    s_waitcnt lgkmcnt(12)
    v_exp_f32 v64, v32
    v_mfma_f32_16x16x32_bf16 a[32:35], a[208:211], v[80:83], a[32:35]
    s_add_u32 m0, s67, 32768
    ds_read_b64_tr_b16 a[244:245], v105 offset:49408
    v_add_f32 v56, v58, v64
    v_mfma_f32_16x16x32_bf16 a[36:39], a[208:211], v[84:87], a[36:39]
    s_waitcnt lgkmcnt(12)
    ds_read_b64_tr_b16 a[246:247], v105 offset:57600
    buffer_load_dwordx4 v108, s[32:35], s82 offen offset:0 lds
    v_mfma_f32_16x16x32_bf16 a[44:47], a[212:215], v[84:87], a[44:47]
    v_exp_f32 v65, v33
    v_mfma_f32_16x16x32_bf16 a[40:43], a[212:215], v[80:83], a[40:43]
    s_waitcnt lgkmcnt(12)
    ds_read_b64_tr_b16 a[248:249], v106 offset:49408
    v_add_f32 v56, v56, v65
    v_mfma_f32_16x16x32_bf16 a[48:51], a[216:219], v[80:83], a[48:51]
    ds_read_b64_tr_b16 a[250:251], v106 offset:57600
    v_cvt_pk_bf16_f32 v88, v64, v65
    v_mfma_f32_16x16x32_bf16 a[52:55], a[216:219], v[84:87], a[52:55]
    s_waitcnt lgkmcnt(12)
    v_exp_f32 v66, v34
    v_mfma_f32_16x16x32_bf16 a[60:63], a[220:223], v[84:87], a[60:63]
    ds_read_b64_tr_b16 a[252:253], v107 offset:49408
    v_add_f32 v56, v56, v66
    v_mfma_f32_16x16x32_bf16 a[56:59], a[220:223], v[80:83], a[56:59]
    s_waitcnt lgkmcnt(12)
    ds_read_b64_tr_b16 a[254:255], v107 offset:57600
    buffer_load_dwordx4 v109, s[32:35], s82 offen offset:1024 lds
    v_mfma_f32_16x16x32_bf16 a[64:67], a[224:227], v[80:83], a[64:67]
    v_exp_f32 v67, v35
    v_mfma_f32_16x16x32_bf16 a[68:71], a[224:227], v[84:87], a[68:71]
    s_waitcnt lgkmcnt(12)
    ds_read_b128 a[128:131], v96 offset:0
    v_add_f32 v56, v56, v67
    v_mfma_f32_16x16x32_bf16 a[76:79], a[228:231], v[84:87], a[76:79]
    ds_read_b128 a[132:135], v97 offset:0
    v_cvt_pk_bf16_f32 v89, v66, v67
    v_mfma_f32_16x16x32_bf16 a[72:75], a[228:231], v[80:83], a[72:75]
    s_waitcnt lgkmcnt(12)
    v_exp_f32 v68, v36
    v_mfma_f32_16x16x32_bf16 a[80:83], a[232:235], v[80:83], a[80:83]
    ds_read_b128 a[136:139], v98 offset:0
    v_add_f32 v57, v59, v68
    v_mfma_f32_16x16x32_bf16 a[84:87], a[232:235], v[84:87], a[84:87]
    s_waitcnt lgkmcnt(11)
    ds_read_b128 a[140:143], v99 offset:0
    buffer_load_dwordx4 v110, s[32:35], s82 offen offset:2048 lds
    v_mfma_f32_16x16x32_bf16 a[92:95], a[236:239], v[84:87], a[92:95]
    v_exp_f32 v69, v37
    v_mfma_f32_16x16x32_bf16 a[88:91], a[236:239], v[80:83], a[88:91]
    s_waitcnt lgkmcnt(10)
    ds_read_b128 a[144:147], v96 offset:256
    v_add_f32 v57, v57, v69
    v_mfma_f32_16x16x32_bf16 a[96:99], a[240:243], v[80:83], a[96:99]
    ds_read_b128 a[148:151], v97 offset:256
    v_cvt_pk_bf16_f32 v92, v68, v69
    v_mfma_f32_16x16x32_bf16 a[100:103], a[240:243], v[84:87], a[100:103]
    s_waitcnt lgkmcnt(10)
    v_exp_f32 v70, v38
    v_mfma_f32_16x16x32_bf16 a[108:111], a[244:247], v[84:87], a[108:111]
    ds_read_b128 a[152:155], v98 offset:256
    v_add_f32 v57, v57, v70
    v_mfma_f32_16x16x32_bf16 a[104:107], a[244:247], v[80:83], a[104:107]
    s_waitcnt lgkmcnt(9)
    ds_read_b128 a[156:159], v99 offset:256
    buffer_load_dwordx4 v111, s[32:35], s82 offen offset:3072 lds
    v_mfma_f32_16x16x32_bf16 a[112:115], a[248:251], v[80:83], a[112:115]
    s_add_u32 s82, s82, 16384
    v_exp_f32 v71, v39
    v_mfma_f32_16x16x32_bf16 a[116:119], a[248:251], v[84:87], a[116:119]
    s_waitcnt lgkmcnt(8)
    ds_read_b128 a[160:163], v96 offset:8192
    v_add_f32 v57, v57, v71
    v_mfma_f32_16x16x32_bf16 a[124:127], a[252:255], v[84:87], a[124:127]
    ds_read_b128 a[164:167], v97 offset:8192
    v_cvt_pk_bf16_f32 v93, v70, v71
    v_mfma_f32_16x16x32_bf16 a[120:123], a[252:255], v[80:83], a[120:123]
    s_add_u32 s70, s70, 1
    s_cmp_lt_u32 s70, 14
    s_cbranch_scc1 L_loopA
    s_waitcnt lgkmcnt(9)
    v_exp_f32 v72, v40
    v_mfma_f32_16x16x32_bf16 v[16:19], a[128:131], v[128:131], v[48:51]
    s_waitcnt lgkmcnt(8)
    ds_read_b128 a[168:171], v98 offset:8192
    v_add_f32 v56, v56, v72
    v_mov_b32 v6, 0
    v_mfma_f32_16x16x32_bf16 v[16:19], a[132:135], v[132:135], v[16:19]
    s_waitcnt lgkmcnt(8)
    s_add_u32 m0, s67, 98304
    ds_read_b128 a[172:175], v99 offset:8192
    v_mov_b32 v5, 0x24000
    v_mfma_f32_16x16x32_bf16 v[16:19], a[136:139], v[136:139], v[16:19]
    s_waitcnt lgkmcnt(8)
    buffer_load_dwordx4 v112, s[36:39], s83 offen offset:0 lds
    v_exp_f32 v73, v41
    v_mfma_f32_16x16x32_bf16 v[16:19], a[140:143], v[140:143], v[16:19]
    s_waitcnt lgkmcnt(7)
    ds_read_b128 a[176:179], v96 offset:8448
    v_add_f32 v56, v56, v73
    v_add_u32 v7, v2, v5
    v_mfma_f32_16x16x32_bf16 v[16:19], a[144:147], v[144:147], v[16:19]
    s_waitcnt lgkmcnt(7)
    ds_read_b128 a[180:183], v97 offset:8448
    v_cvt_pk_bf16_f32 v90, v72, v73
    v_mfma_f32_16x16x32_bf16 v[16:19], a[148:151], v[148:151], v[16:19]
    s_waitcnt lgkmcnt(7)
    buffer_load_dword v6, v4, s[20:23], s73 offen offset:4 sc1
    v_exp_f32 v74, v42
    v_mfma_f32_16x16x32_bf16 v[16:19], a[152:155], v[152:155], v[16:19]
    s_waitcnt lgkmcnt(6)
    ds_read_b128 a[184:187], v98 offset:8448
    v_add_f32 v56, v56, v74
    v_mfma_f32_16x16x32_bf16 v[16:19], a[156:159], v[156:159], v[16:19]
    ds_read_b128 a[188:191], v99 offset:8448
    buffer_load_dwordx4 v113, s[36:39], s83 offen offset:1024 lds
    v_mfma_f32_16x16x32_bf16 v[20:23], a[156:159], v[188:191], v[52:55]
    v_exp_f32 v75, v43
    v_mfma_f32_16x16x32_bf16 v[20:23], a[152:155], v[184:187], v[20:23]
    ds_read_b64_tr_b16 a[192:193], v100 offset:0
    v_add_f32 v56, v56, v75
    v_mfma_f32_16x16x32_bf16 v[20:23], a[148:151], v[180:183], v[20:23]
    ds_read_b64_tr_b16 a[194:195], v100 offset:8192
    v_cvt_pk_bf16_f32 v91, v74, v75
    v_mfma_f32_16x16x32_bf16 v[20:23], a[144:147], v[176:179], v[20:23]
    v_exp_f32 v76, v44
    v_mfma_f32_16x16x32_bf16 v[20:23], a[140:143], v[172:175], v[20:23]
    ds_read_b64_tr_b16 a[196:197], v101 offset:0
    v_add_f32 v57, v57, v76
    v_mfma_f32_16x16x32_bf16 v[20:23], a[136:139], v[168:171], v[20:23]
    ds_read_b64_tr_b16 a[198:199], v101 offset:8192
    buffer_load_dwordx4 v114, s[36:39], s83 offen offset:2048 lds
    v_mfma_f32_16x16x32_bf16 v[20:23], a[132:135], v[164:167], v[20:23]
    v_exp_f32 v77, v45
    v_mfma_f32_16x16x32_bf16 v[20:23], a[128:131], v[160:163], v[20:23]
    s_waitcnt lgkmcnt(11)
    ds_read_b64_tr_b16 a[200:201], v102 offset:0
    v_add_f32 v57, v57, v77
    v_mfma_f32_16x16x32_bf16 v[24:27], a[160:163], v[128:131], v[48:51]
    s_waitcnt lgkmcnt(11)
    ds_read_b64_tr_b16 a[202:203], v102 offset:8192
    v_cvt_pk_bf16_f32 v94, v76, v77
    v_mfma_f32_16x16x32_bf16 v[24:27], a[164:167], v[132:135], v[24:27]
    s_waitcnt lgkmcnt(11)
    v_exp_f32 v78, v46
    v_mfma_f32_16x16x32_bf16 v[24:27], a[168:171], v[136:139], v[24:27]
    s_waitcnt lgkmcnt(10)
    ds_read_b64_tr_b16 a[204:205], v103 offset:0
    v_add_f32 v57, v57, v78
    v_mfma_f32_16x16x32_bf16 v[24:27], a[172:175], v[140:143], v[24:27]
    s_waitcnt lgkmcnt(10)
    ds_read_b64_tr_b16 a[206:207], v103 offset:8192
    buffer_load_dwordx4 v115, s[36:39], s83 offen offset:3072 lds
    v_mfma_f32_16x16x32_bf16 v[24:27], a[176:179], v[144:147], v[24:27]
    s_waitcnt lgkmcnt(10)
    s_add_u32 s83, s83, 16384
    v_exp_f32 v79, v47
    v_mfma_f32_16x16x32_bf16 v[24:27], a[180:183], v[148:151], v[24:27]
    s_waitcnt lgkmcnt(9)
    ds_read_b64_tr_b16 a[208:209], v104 offset:0
    v_add_f32 v57, v57, v79
    v_mfma_f32_16x16x32_bf16 v[24:27], a[184:187], v[152:155], v[24:27]
    s_waitcnt lgkmcnt(9)
    ds_read_b64_tr_b16 a[210:211], v104 offset:8192
    v_cvt_pk_bf16_f32 v95, v78, v79
    v_mfma_f32_16x16x32_bf16 v[24:27], a[188:191], v[156:159], v[24:27]
    ds_read_b64_tr_b16 a[212:213], v105 offset:0
    v_add_f32 v62, v56, v57
    v_mfma_f32_16x16x32_bf16 v[28:31], a[188:191], v[188:191], v[52:55]
    ds_read_b64_tr_b16 a[214:215], v105 offset:8192
    v_cmp_nge_f32 vcc, s71, v62
    v_mfma_f32_16x16x32_bf16 v[28:31], a[184:187], v[184:187], v[28:31]
    s_cbranch_vccnz L_rare_9
L_back_9:
    ds_read_b64_tr_b16 a[216:217], v106 offset:0
    v_mfma_f32_16x16x32_bf16 v[28:31], a[180:183], v[180:183], v[28:31]
    ds_read_b64_tr_b16 a[218:219], v106 offset:8192
    buffer_load_dword v10, v12, s[56:59], s90 offen
    v_mfma_f32_16x16x32_bf16 v[28:31], a[176:179], v[176:179], v[28:31]
    s_waitcnt lgkmcnt(12)
    s_sub_u32 s90, s90, 0x400000
    ds_read_b64_tr_b16 a[220:221], v107 offset:0
    v_mfma_f32_16x16x32_bf16 v[28:31], a[172:175], v[172:175], v[28:31]
    ds_read_b64_tr_b16 a[222:223], v107 offset:8192
    v_mfma_f32_16x16x32_bf16 v[28:31], a[168:171], v[168:171], v[28:31]
    s_waitcnt lgkmcnt(12)
    ds_read_b64_tr_b16 a[224:225], v100 offset:256
    v_mfma_f32_16x16x32_bf16 v[28:31], a[164:167], v[164:167], v[28:31]
    ds_read_b64_tr_b16 a[226:227], v100 offset:8448
    v_mfma_f32_16x16x32_bf16 v[28:31], a[160:163], v[160:163], v[28:31]
    s_waitcnt lgkmcnt(12)
    ds_read_b64_tr_b16 a[228:229], v101 offset:256
    v_mfma_f32_16x16x32_bf16 a[0:3], a[192:195], v[88:91], a[0:3]
    ds_read_b64_tr_b16 a[230:231], v101 offset:8448
    v_mfma_f32_16x16x32_bf16 a[4:7], a[192:195], v[92:95], a[4:7]
    s_waitcnt lgkmcnt(12)
    ds_read_b64_tr_b16 a[232:233], v102 offset:256
    v_mfma_f32_16x16x32_bf16 a[12:15], a[196:199], v[92:95], a[12:15]
    ds_read_b64_tr_b16 a[234:235], v102 offset:8448
    v_mfma_f32_16x16x32_bf16 a[8:11], a[196:199], v[88:91], a[8:11]
    s_waitcnt lgkmcnt(12)
    ds_read_b64_tr_b16 a[236:237], v103 offset:256
    v_mfma_f32_16x16x32_bf16 a[16:19], a[200:203], v[88:91], a[16:19]
    ds_read_b64_tr_b16 a[238:239], v103 offset:8448
    v_mfma_f32_16x16x32_bf16 a[20:23], a[200:203], v[92:95], a[20:23]
    s_waitcnt lgkmcnt(12)
    ds_read_b64_tr_b16 a[240:241], v104 offset:256
    v_mfma_f32_16x16x32_bf16 a[28:31], a[204:207], v[92:95], a[28:31]
    s_waitcnt vmcnt(11)
    s_barrier
    ds_read_b64_tr_b16 a[242:243], v104 offset:8448
    v_mfma_f32_16x16x32_bf16 a[24:27], a[204:207], v[88:91], a[24:27]
    s_waitcnt lgkmcnt(12)
    v_exp_f32 v64, v16
    v_mfma_f32_16x16x32_bf16 a[32:35], a[208:211], v[88:91], a[32:35]
    s_add_u32 m0, s67, 49152
    ds_read_b64_tr_b16 a[244:245], v105 offset:256
    v_add_f32 v58, v56, v64
    v_mfma_f32_16x16x32_bf16 a[36:39], a[208:211], v[92:95], a[36:39]
    s_waitcnt lgkmcnt(12)
    ds_read_b64_tr_b16 a[246:247], v105 offset:8448
    buffer_load_dwordx4 v108, s[32:35], s82 offen offset:0 lds
    v_mfma_f32_16x16x32_bf16 a[44:47], a[212:215], v[92:95], a[44:47]
    v_exp_f32 v65, v17
    v_mfma_f32_16x16x32_bf16 a[40:43], a[212:215], v[88:91], a[40:43]
    s_waitcnt lgkmcnt(12)
    ds_read_b64_tr_b16 a[248:249], v106 offset:256
    v_add_f32 v58, v58, v65
    v_mfma_f32_16x16x32_bf16 a[48:51], a[216:219], v[88:91], a[48:51]
    ds_read_b64_tr_b16 a[250:251], v106 offset:8448
    v_cvt_pk_bf16_f32 v80, v64, v65
    v_mfma_f32_16x16x32_bf16 a[52:55], a[216:219], v[92:95], a[52:55]
    s_waitcnt lgkmcnt(12)
    v_exp_f32 v66, v18
    v_mfma_f32_16x16x32_bf16 a[60:63], a[220:223], v[92:95], a[60:63]
    ds_read_b64_tr_b16 a[252:253], v107 offset:256
    v_add_f32 v58, v58, v66
    v_mfma_f32_16x16x32_bf16 a[56:59], a[220:223], v[88:91], a[56:59]
    s_waitcnt lgkmcnt(12)
    ds_read_b64_tr_b16 a[254:255], v107 offset:8448
    buffer_load_dwordx4 v109, s[32:35], s82 offen offset:1024 lds
    v_mfma_f32_16x16x32_bf16 a[64:67], a[224:227], v[88:91], a[64:67]
    v_exp_f32 v67, v19
    v_mfma_f32_16x16x32_bf16 a[68:71], a[224:227], v[92:95], a[68:71]
    s_waitcnt lgkmcnt(12)
    ds_read_b128 a[128:131], v96 offset:16384
    v_add_f32 v58, v58, v67
    v_mfma_f32_16x16x32_bf16 a[76:79], a[228:231], v[92:95], a[76:79]
    ds_read_b128 a[132:135], v97 offset:16384
    v_cvt_pk_bf16_f32 v81, v66, v67
    v_mfma_f32_16x16x32_bf16 a[72:75], a[228:231], v[88:91], a[72:75]
    s_waitcnt lgkmcnt(12)
    v_exp_f32 v68, v20
    v_mfma_f32_16x16x32_bf16 a[80:83], a[232:235], v[88:91], a[80:83]
    ds_read_b128 a[136:139], v98 offset:16384
    v_add_f32 v59, v57, v68
    v_mfma_f32_16x16x32_bf16 a[84:87], a[232:235], v[92:95], a[84:87]
    s_waitcnt lgkmcnt(11)
    ds_read_b128 a[140:143], v99 offset:16384
    buffer_load_dwordx4 v110, s[32:35], s82 offen offset:2048 lds
    v_mfma_f32_16x16x32_bf16 a[92:95], a[236:239], v[92:95], a[92:95]
    v_exp_f32 v69, v21
    v_mfma_f32_16x16x32_bf16 a[88:91], a[236:239], v[88:91], a[88:91]
    s_waitcnt lgkmcnt(10)
    ds_read_b128 a[144:147], v96 offset:16640
    v_add_f32 v59, v59, v69
    v_mfma_f32_16x16x32_bf16 a[96:99], a[240:243], v[88:91], a[96:99]
    ds_read_b128 a[148:151], v97 offset:16640
    v_cvt_pk_bf16_f32 v84, v68, v69
    v_mfma_f32_16x16x32_bf16 a[100:103], a[240:243], v[92:95], a[100:103]
    s_waitcnt lgkmcnt(10)
    v_exp_f32 v70, v22
    v_mfma_f32_16x16x32_bf16 a[108:111], a[244:247], v[92:95], a[108:111]
    ds_read_b128 a[152:155], v98 offset:16640
    v_add_f32 v59, v59, v70
    v_mfma_f32_16x16x32_bf16 a[104:107], a[244:247], v[88:91], a[104:107]
    s_waitcnt lgkmcnt(9)
    ds_read_b128 a[156:159], v99 offset:16640
    buffer_load_dwordx4 v111, s[32:35], s82 offen offset:3072 lds
    v_mfma_f32_16x16x32_bf16 a[112:115], a[248:251], v[88:91], a[112:115]
    s_add_u32 s82, s82, 16384
    v_exp_f32 v71, v23
    v_mfma_f32_16x16x32_bf16 a[116:119], a[248:251], v[92:95], a[116:119]
    s_waitcnt lgkmcnt(8)
    ds_read_b128 a[160:163], v96 offset:24576
    v_add_f32 v59, v59, v71
    v_mfma_f32_16x16x32_bf16 a[124:127], a[252:255], v[92:95], a[124:127]
    ds_read_b128 a[164:167], v97 offset:24576
    v_cvt_pk_bf16_f32 v85, v70, v71
    v_mfma_f32_16x16x32_bf16 a[120:123], a[252:255], v[88:91], a[120:123]
    s_waitcnt lgkmcnt(9)
    v_exp_f32 v72, v24
    v_mfma_f32_16x16x32_bf16 v[32:35], a[128:131], v[128:131], v[48:51]
    s_waitcnt lgkmcnt(8)
    ds_read_b128 a[168:171], v98 offset:24576
    v_add_f32 v58, v58, v72
    v_mfma_f32_16x16x32_bf16 v[32:35], a[132:135], v[132:135], v[32:35]
    s_waitcnt lgkmcnt(8)
    s_add_u32 m0, s67, 114688
    ds_read_b128 a[172:175], v99 offset:24576
    v_mfma_f32_16x16x32_bf16 v[32:35], a[136:139], v[136:139], v[32:35]
    s_waitcnt lgkmcnt(8)
    buffer_load_dwordx4 v112, s[36:39], s83 offen offset:0 lds
    v_exp_f32 v73, v25
    v_mfma_f32_16x16x32_bf16 v[32:35], a[140:143], v[140:143], v[32:35]
    s_waitcnt lgkmcnt(7)
    ds_read_b128 a[176:179], v96 offset:24832
    v_add_f32 v58, v58, v73
    v_mfma_f32_16x16x32_bf16 v[32:35], a[144:147], v[144:147], v[32:35]
    s_waitcnt lgkmcnt(7)
    ds_read_b128 a[180:183], v97 offset:24832
    v_cvt_pk_bf16_f32 v82, v72, v73
    v_mfma_f32_16x16x32_bf16 v[32:35], a[148:151], v[148:151], v[32:35]
    s_waitcnt lgkmcnt(7)
    v_exp_f32 v74, v26
    v_mfma_f32_16x16x32_bf16 v[32:35], a[152:155], v[152:155], v[32:35]
    s_waitcnt lgkmcnt(6)
    ds_read_b128 a[184:187], v98 offset:24832
    v_add_f32 v58, v58, v74
    v_mfma_f32_16x16x32_bf16 v[32:35], a[156:159], v[156:159], v[32:35]
    ds_read_b128 a[188:191], v99 offset:24832
    buffer_load_dwordx4 v113, s[36:39], s83 offen offset:1024 lds
    v_mfma_f32_16x16x32_bf16 v[36:39], a[156:159], v[188:191], v[52:55]
    v_exp_f32 v75, v27
    v_mfma_f32_16x16x32_bf16 v[36:39], a[152:155], v[184:187], v[36:39]
    ds_read_b64_tr_b16 a[192:193], v100 offset:16384
    v_add_f32 v58, v58, v75
    v_mfma_f32_16x16x32_bf16 v[36:39], a[148:151], v[180:183], v[36:39]
    ds_read_b64_tr_b16 a[194:195], v100 offset:24576
    v_cvt_pk_bf16_f32 v83, v74, v75
    v_mfma_f32_16x16x32_bf16 v[36:39], a[144:147], v[176:179], v[36:39]
    v_exp_f32 v76, v28
    v_mfma_f32_16x16x32_bf16 v[36:39], a[140:143], v[172:175], v[36:39]
    ds_read_b64_tr_b16 a[196:197], v101 offset:16384
    v_add_f32 v59, v59, v76
    v_mfma_f32_16x16x32_bf16 v[36:39], a[136:139], v[168:171], v[36:39]
    ds_read_b64_tr_b16 a[198:199], v101 offset:24576
    buffer_load_dwordx4 v114, s[36:39], s83 offen offset:2048 lds
    v_mfma_f32_16x16x32_bf16 v[36:39], a[132:135], v[164:167], v[36:39]
    v_exp_f32 v77, v29
    v_mfma_f32_16x16x32_bf16 v[36:39], a[128:131], v[160:163], v[36:39]
    s_waitcnt lgkmcnt(11)
    ds_read_b64_tr_b16 a[200:201], v102 offset:16384
    v_add_f32 v59, v59, v77
    v_mfma_f32_16x16x32_bf16 v[40:43], a[160:163], v[128:131], v[48:51]
    s_waitcnt lgkmcnt(11)
    ds_read_b64_tr_b16 a[202:203], v102 offset:24576
    v_cvt_pk_bf16_f32 v86, v76, v77
    v_mfma_f32_16x16x32_bf16 v[40:43], a[164:167], v[132:135], v[40:43]
    s_waitcnt lgkmcnt(11)
    v_exp_f32 v78, v30
    v_mfma_f32_16x16x32_bf16 v[40:43], a[168:171], v[136:139], v[40:43]
    s_waitcnt lgkmcnt(10)
    ds_read_b64_tr_b16 a[204:205], v103 offset:16384
    v_add_f32 v59, v59, v78
    v_mfma_f32_16x16x32_bf16 v[40:43], a[172:175], v[140:143], v[40:43]
    s_waitcnt lgkmcnt(10)
    ds_read_b64_tr_b16 a[206:207], v103 offset:24576
    buffer_load_dwordx4 v115, s[36:39], s83 offen offset:3072 lds
    v_mfma_f32_16x16x32_bf16 v[40:43], a[176:179], v[144:147], v[40:43]
    s_waitcnt lgkmcnt(10)
    s_add_u32 s83, s83, 16384
    v_exp_f32 v79, v31
    v_mfma_f32_16x16x32_bf16 v[40:43], a[180:183], v[148:151], v[40:43]
    s_waitcnt lgkmcnt(9)
    ds_read_b64_tr_b16 a[208:209], v104 offset:16384
    v_add_f32 v59, v59, v79
    v_mfma_f32_16x16x32_bf16 v[40:43], a[184:187], v[152:155], v[40:43]
    s_waitcnt lgkmcnt(9)
    ds_read_b64_tr_b16 a[210:211], v104 offset:24576
    v_cvt_pk_bf16_f32 v87, v78, v79
    v_mfma_f32_16x16x32_bf16 v[40:43], a[188:191], v[156:159], v[40:43]
    ds_read_b64_tr_b16 a[212:213], v105 offset:16384
    v_add_f32 v62, v58, v59
    v_mfma_f32_16x16x32_bf16 v[44:47], a[188:191], v[188:191], v[52:55]
    ds_read_b64_tr_b16 a[214:215], v105 offset:24576
    v_cmp_nge_f32 vcc, s71, v62
    v_mfma_f32_16x16x32_bf16 v[44:47], a[184:187], v[184:187], v[44:47]
    s_cbranch_vccnz L_rare_10
L_back_10:
    ds_read_b64_tr_b16 a[216:217], v106 offset:16384
    v_mfma_f32_16x16x32_bf16 v[44:47], a[180:183], v[180:183], v[44:47]
    ds_read_b64_tr_b16 a[218:219], v106 offset:24576
    v_mfma_f32_16x16x32_bf16 v[44:47], a[176:179], v[176:179], v[44:47]
    s_waitcnt lgkmcnt(12)
    ds_read_b64_tr_b16 a[220:221], v107 offset:16384
    v_mfma_f32_16x16x32_bf16 v[44:47], a[172:175], v[172:175], v[44:47]
    ds_read_b64_tr_b16 a[222:223], v107 offset:24576
    v_mfma_f32_16x16x32_bf16 v[44:47], a[168:171], v[168:171], v[44:47]
    s_waitcnt lgkmcnt(12)
    ds_read_b64_tr_b16 a[224:225], v100 offset:16640
    v_mfma_f32_16x16x32_bf16 v[44:47], a[164:167], v[164:167], v[44:47]
    s_waitcnt vmcnt(12)
    ds_read_b64_tr_b16 a[226:227], v100 offset:24832
    ds_write_b32 v7, v6
    v_mfma_f32_16x16x32_bf16 v[44:47], a[160:163], v[160:163], v[44:47]
    s_waitcnt lgkmcnt(12)
    ds_read_b64_tr_b16 a[228:229], v101 offset:16640
    v_mfma_f32_16x16x32_bf16 a[0:3], a[192:195], v[80:83], a[0:3]
    ds_read_b64_tr_b16 a[230:231], v101 offset:24832
    v_mfma_f32_16x16x32_bf16 a[4:7], a[192:195], v[84:87], a[4:7]
    s_waitcnt lgkmcnt(12)
    ds_read_b64_tr_b16 a[232:233], v102 offset:16640
    v_mfma_f32_16x16x32_bf16 a[12:15], a[196:199], v[84:87], a[12:15]
    ds_read_b64_tr_b16 a[234:235], v102 offset:24832
    v_mfma_f32_16x16x32_bf16 a[8:11], a[196:199], v[80:83], a[8:11]
    s_waitcnt lgkmcnt(12)
    ds_read_b64_tr_b16 a[236:237], v103 offset:16640
    v_mfma_f32_16x16x32_bf16 a[16:19], a[200:203], v[80:83], a[16:19]
    ds_read_b64_tr_b16 a[238:239], v103 offset:24832
    v_mfma_f32_16x16x32_bf16 a[20:23], a[200:203], v[84:87], a[20:23]
    s_waitcnt lgkmcnt(12)
    s_waitcnt lgkmcnt(6)
    ds_read_b64_tr_b16 a[240:241], v104 offset:16640
    v_mfma_f32_16x16x32_bf16 a[28:31], a[204:207], v[84:87], a[28:31]
    s_waitcnt vmcnt(9)
    s_barrier
    ds_read_b64_tr_b16 a[242:243], v104 offset:24832
    v_mfma_f32_16x16x32_bf16 a[24:27], a[204:207], v[80:83], a[24:27]
    ds_read_b32 v6, v5
    v_exp_f32 v64, v32
    v_mfma_f32_16x16x32_bf16 a[32:35], a[208:211], v[80:83], a[32:35]
    s_add_u32 m0, s67, 0
    ds_read_b64_tr_b16 a[244:245], v105 offset:16640
    v_add_f32 v56, v58, v64
    v_mfma_f32_16x16x32_bf16 a[36:39], a[208:211], v[84:87], a[36:39]
    ds_read_b64_tr_b16 a[246:247], v105 offset:24832
    buffer_load_dwordx4 v108, s[32:35], s82 offen offset:0 lds
    v_mfma_f32_16x16x32_bf16 a[44:47], a[212:215], v[84:87], a[44:47]
    v_exp_f32 v65, v33
    v_mfma_f32_16x16x32_bf16 a[40:43], a[212:215], v[80:83], a[40:43]
    ds_read_b64_tr_b16 a[248:249], v106 offset:16640
    v_add_f32 v56, v56, v65
    v_mfma_f32_16x16x32_bf16 a[48:51], a[216:219], v[80:83], a[48:51]
    ds_read_b64_tr_b16 a[250:251], v106 offset:24832
    v_cvt_pk_bf16_f32 v88, v64, v65
    v_mfma_f32_16x16x32_bf16 a[52:55], a[216:219], v[84:87], a[52:55]
    s_waitcnt lgkmcnt(12)
    v_exp_f32 v66, v34
    v_mfma_f32_16x16x32_bf16 a[60:63], a[220:223], v[84:87], a[60:63]
    ds_read_b64_tr_b16 a[252:253], v107 offset:16640
    v_add_f32 v56, v56, v66
    v_mfma_f32_16x16x32_bf16 a[56:59], a[220:223], v[80:83], a[56:59]
    s_waitcnt lgkmcnt(12)
    ds_read_b64_tr_b16 a[254:255], v107 offset:24832
    buffer_load_dwordx4 v109, s[32:35], s82 offen offset:1024 lds
    v_mfma_f32_16x16x32_bf16 a[64:67], a[224:227], v[80:83], a[64:67]
    v_exp_f32 v67, v35
    v_mfma_f32_16x16x32_bf16 a[68:71], a[224:227], v[84:87], a[68:71]
    s_waitcnt lgkmcnt(12)
    ds_read_b128 a[128:131], v96 offset:32768
    v_add_f32 v56, v56, v67
    v_mfma_f32_16x16x32_bf16 a[76:79], a[228:231], v[84:87], a[76:79]
    s_mov_b32 s77, s64
    ds_read_b128 a[132:135], v97 offset:32768
    v_cvt_pk_bf16_f32 v89, v66, v67
    v_mfma_f32_16x16x32_bf16 a[72:75], a[228:231], v[80:83], a[72:75]
    s_waitcnt lgkmcnt(12)
    v_exp_f32 v68, v36
    v_mfma_f32_16x16x32_bf16 a[80:83], a[232:235], v[80:83], a[80:83]
    s_lshr_b32 s16, s77, 2
    ds_read_b128 a[136:139], v98 offset:32768
    v_add_f32 v57, v59, v68
    v_mfma_f32_16x16x32_bf16 a[84:87], a[232:235], v[84:87], a[84:87]
    s_waitcnt lgkmcnt(12)
    ds_read_b128 a[140:143], v99 offset:32768
    buffer_load_dwordx4 v110, s[32:35], s82 offen offset:2048 lds
    v_mfma_f32_16x16x32_bf16 a[92:95], a[236:239], v[84:87], a[92:95]
    s_lshl_b32 s17, s65, 2
    s_add_u32 s16, s16, s17
    s_lshl_b32 s18, s16, 4
    s_lshl_b32 s17, s66, 2
    s_add_u32 s18, s18, s17
    s_lshl_b32 s18, s18, 13
    s_add_u32 s18, s18, 0x2000000
    s_and_b32 s19, s77, 3
    s_mul_i32 s80, s66, 401408
    s_lshl_b32 s17, s19, 8
    s_add_u32 s80, s80, s17
    s_lshl_b32 s93, s16, 7
    s_add_u32 s93, s93, 0x4000000
    s_cmp_eq_u32 s19, 3
    s_cselect_b32 s17, 3, 7
    s_waitcnt lgkmcnt(10)
    v_exp_f32 v69, v37
    v_readfirstlane_b32 s76, v6
    v_mfma_f32_16x16x32_bf16 a[88:91], a[236:239], v[80:83], a[88:91]
    ds_read_b128 a[144:147], v96 offset:33024
    v_add_f32 v57, v57, v69
    v_mfma_f32_16x16x32_bf16 a[96:99], a[240:243], v[80:83], a[96:99]
    ds_read_b128 a[148:151], v97 offset:33024
    v_cvt_pk_bf16_f32 v92, v68, v69
    v_mfma_f32_16x16x32_bf16 a[100:103], a[240:243], v[84:87], a[100:103]
    s_waitcnt lgkmcnt(10)
    v_exp_f32 v70, v38
    v_mfma_f32_16x16x32_bf16 a[108:111], a[244:247], v[84:87], a[108:111]
    ds_read_b128 a[152:155], v98 offset:33024
    v_add_f32 v57, v57, v70
    v_mfma_f32_16x16x32_bf16 a[104:107], a[244:247], v[80:83], a[104:107]
    s_waitcnt lgkmcnt(9)
    ds_read_b128 a[156:159], v99 offset:33024
    buffer_load_dwordx4 v111, s[32:35], s82 offen offset:3072 lds
    v_mfma_f32_16x16x32_bf16 a[112:115], a[248:251], v[80:83], a[112:115]
    s_add_u32 s82, s82, 16384
    v_exp_f32 v71, v39
    v_mfma_f32_16x16x32_bf16 a[116:119], a[248:251], v[84:87], a[116:119]
    s_waitcnt lgkmcnt(8)
    v_add_f32 v57, v57, v71
    v_cvt_pk_bf16_f32 v93, v70, v71
    v_mfma_f32_16x16x32_bf16 a[124:127], a[252:255], v[84:87], a[124:127]
    s_cmp_eq_u32 s76, 16
    s_cselect_b32 s18, s18, 0x40000000
    v_mfma_f32_16x16x32_bf16 a[120:123], a[252:255], v[80:83], a[120:123]
    s_waitcnt lgkmcnt(7)
    v_exp_f32 v72, v40
    v_mfma_f32_16x16x32_bf16 v[16:19], a[128:131], v[128:131], v[48:51]
    s_waitcnt lgkmcnt(6)
    s_mul_i32 s92, s16, 458752
    ds_read_b128 a[160:163], v96 offset:40960
    buffer_load_dword v10, v13, s[60:63], s92 offen sc1
    v_add_f32 v56, v56, v72
    v_mfma_f32_16x16x32_bf16 v[16:19], a[132:135], v[132:135], v[16:19]
    s_waitcnt lgkmcnt(6)
    s_add_u32 m0, s67, 65536
    ds_read_b128 a[164:167], v97 offset:40960
    v_mfma_f32_16x16x32_bf16 v[16:19], a[136:139], v[136:139], v[16:19]
    s_waitcnt lgkmcnt(6)
    buffer_load_dwordx4 v112, s[36:39], s83 offen offset:0 lds
    v_exp_f32 v73, v41
    v_mfma_f32_16x16x32_bf16 v[16:19], a[140:143], v[140:143], v[16:19]
    s_waitcnt lgkmcnt(5)
    ds_read_b128 a[168:171], v98 offset:40960
    v_add_f32 v56, v56, v73
    v_mfma_f32_16x16x32_bf16 v[16:19], a[144:147], v[144:147], v[16:19]
    s_waitcnt lgkmcnt(5)
    ds_read_b128 a[172:175], v99 offset:40960
    v_cvt_pk_bf16_f32 v90, v72, v73
    v_mfma_f32_16x16x32_bf16 v[16:19], a[148:151], v[148:151], v[16:19]
    s_waitcnt lgkmcnt(5)
    s_add_u32 s92, s92, 458688
    buffer_load_dword v10, v13, s[60:63], s92 offen sc1
    v_exp_f32 v74, v42
    v_mfma_f32_16x16x32_bf16 v[16:19], a[152:155], v[152:155], v[16:19]
    s_waitcnt lgkmcnt(4)
    ds_read_b128 a[176:179], v96 offset:41216
    v_add_f32 v56, v56, v74
    v_mfma_f32_16x16x32_bf16 v[16:19], a[156:159], v[156:159], v[16:19]
    ds_read_b128 a[180:183], v97 offset:41216
    buffer_load_dwordx4 v113, s[36:39], s83 offen offset:1024 lds
    v_mfma_f32_16x16x32_bf16 v[20:23], a[156:159], v[188:191], v[52:55]
    v_exp_f32 v75, v43
    v_mfma_f32_16x16x32_bf16 v[20:23], a[152:155], v[184:187], v[20:23]
    ds_read_b128 a[184:187], v98 offset:41216
    v_add_f32 v56, v56, v75
    v_mfma_f32_16x16x32_bf16 v[20:23], a[148:151], v[180:183], v[20:23]
    ds_read_b128 a[188:191], v99 offset:41216
    buffer_load_dword v10, v13, s[60:63], s75 offen sc1
    v_cvt_pk_bf16_f32 v91, v74, v75
    v_mfma_f32_16x16x32_bf16 v[20:23], a[144:147], v[176:179], v[20:23]
    v_exp_f32 v76, v44
    v_mfma_f32_16x16x32_bf16 v[20:23], a[140:143], v[172:175], v[20:23]
    ds_read_b64_tr_b16 a[192:193], v100 offset:32768
    v_add_f32 v57, v57, v76
    v_mfma_f32_16x16x32_bf16 v[20:23], a[136:139], v[168:171], v[20:23]
    ds_read_b64_tr_b16 a[194:195], v100 offset:40960
    buffer_load_dwordx4 v114, s[36:39], s83 offen offset:2048 lds
    v_mfma_f32_16x16x32_bf16 v[20:23], a[132:135], v[164:167], v[20:23]
    v_exp_f32 v77, v45
    v_mfma_f32_16x16x32_bf16 v[20:23], a[128:131], v[160:163], v[20:23]
    s_waitcnt lgkmcnt(9)
    ds_read_b64_tr_b16 a[196:197], v101 offset:32768
    v_add_f32 v57, v57, v77
    v_mfma_f32_16x16x32_bf16 v[24:27], a[160:163], v[128:131], v[48:51]
    s_waitcnt lgkmcnt(9)
    s_add_u32 s92, s75, 442368
    ds_read_b64_tr_b16 a[198:199], v101 offset:40960
    buffer_load_dword v10, v13, s[60:63], s92 offen sc1
    v_cvt_pk_bf16_f32 v94, v76, v77
    v_mfma_f32_16x16x32_bf16 v[24:27], a[164:167], v[132:135], v[24:27]
    s_waitcnt lgkmcnt(9)
    v_exp_f32 v78, v46
    v_mfma_f32_16x16x32_bf16 v[24:27], a[168:171], v[136:139], v[24:27]
    s_waitcnt lgkmcnt(8)
    ds_read_b64_tr_b16 a[200:201], v102 offset:32768
    v_add_f32 v57, v57, v78
    v_mfma_f32_16x16x32_bf16 v[24:27], a[172:175], v[140:143], v[24:27]
    s_waitcnt lgkmcnt(8)
    ds_read_b64_tr_b16 a[202:203], v102 offset:40960
    buffer_load_dwordx4 v115, s[36:39], s83 offen offset:3072 lds
    v_mfma_f32_16x16x32_bf16 v[24:27], a[176:179], v[144:147], v[24:27]
    s_waitcnt lgkmcnt(8)
    s_add_u32 s83, s83, 16384
    v_exp_f32 v79, v47
    v_mfma_f32_16x16x32_bf16 v[24:27], a[180:183], v[148:151], v[24:27]
    s_waitcnt lgkmcnt(7)
    s_mul_i32 s92, s16, 28672
    ds_read_b64_tr_b16 a[204:205], v103 offset:32768
    buffer_load_dword v10, v13, s[24:27], s92 offen sc1
    v_add_f32 v57, v57, v79
    v_mfma_f32_16x16x32_bf16 v[24:27], a[184:187], v[152:155], v[24:27]
    s_waitcnt lgkmcnt(7)
    ds_read_b64_tr_b16 a[206:207], v103 offset:40960
    v_cvt_pk_bf16_f32 v95, v78, v79
    v_mfma_f32_16x16x32_bf16 v[24:27], a[188:191], v[156:159], v[24:27]
    ds_read_b64_tr_b16 a[208:209], v104 offset:32768
    v_add_f32 v62, v56, v57
    v_mfma_f32_16x16x32_bf16 v[28:31], a[188:191], v[188:191], v[52:55]
    ds_read_b64_tr_b16 a[210:211], v104 offset:40960
    v_cmp_nge_f32 vcc, s71, v62
    v_mfma_f32_16x16x32_bf16 v[28:31], a[184:187], v[184:187], v[28:31]
    s_cbranch_vccnz L_rare_11
L_back_11:
    ds_read_b64_tr_b16 a[212:213], v105 offset:32768
    v_mfma_f32_16x16x32_bf16 v[28:31], a[180:183], v[180:183], v[28:31]
    ds_read_b64_tr_b16 a[214:215], v105 offset:40960
    v_mfma_f32_16x16x32_bf16 v[28:31], a[176:179], v[176:179], v[28:31]
    ds_read_b64_tr_b16 a[216:217], v106 offset:32768
    buffer_load_dword v10, v13, s[28:31], s92 offen
    v_mfma_f32_16x16x32_bf16 v[28:31], a[172:175], v[172:175], v[28:31]
    ds_read_b64_tr_b16 a[218:219], v106 offset:40960
    v_mfma_f32_16x16x32_bf16 v[28:31], a[168:171], v[168:171], v[28:31]
    s_waitcnt lgkmcnt(12)
    ds_read_b64_tr_b16 a[220:221], v107 offset:32768
    v_mfma_f32_16x16x32_bf16 v[28:31], a[164:167], v[164:167], v[28:31]
    ds_read_b64_tr_b16 a[222:223], v107 offset:40960
    v_mfma_f32_16x16x32_bf16 v[28:31], a[160:163], v[160:163], v[28:31]
    s_waitcnt lgkmcnt(12)
    ds_read_b64_tr_b16 a[224:225], v100 offset:33024
    v_mfma_f32_16x16x32_bf16 a[0:3], a[192:195], v[88:91], a[0:3]
    ds_read_b64_tr_b16 a[226:227], v100 offset:41216
    buffer_load_dword v10, v13, s[60:63], s93 offen sc1
    v_mfma_f32_16x16x32_bf16 a[4:7], a[192:195], v[92:95], a[4:7]
    s_waitcnt lgkmcnt(12)
    ds_read_b64_tr_b16 a[228:229], v101 offset:33024
    v_mfma_f32_16x16x32_bf16 a[12:15], a[196:199], v[92:95], a[12:15]
    ds_read_b64_tr_b16 a[230:231], v101 offset:41216
    buffer_load_dwordx4 v[192:195], v1, s[60:63], s18 offen offset:0 sc1
    v_mfma_f32_16x16x32_bf16 a[8:11], a[196:199], v[88:91], a[8:11]
    s_waitcnt lgkmcnt(12)
    ds_read_b64_tr_b16 a[232:233], v102 offset:33024
    v_mfma_f32_16x16x32_bf16 a[16:19], a[200:203], v[88:91], a[16:19]
    ds_read_b64_tr_b16 a[234:235], v102 offset:41216
    v_mfma_f32_16x16x32_bf16 a[20:23], a[200:203], v[92:95], a[20:23]
    s_waitcnt lgkmcnt(12)
    ds_read_b64_tr_b16 a[236:237], v103 offset:33024
    v_mfma_f32_16x16x32_bf16 a[28:31], a[204:207], v[92:95], a[28:31]
    s_waitcnt vmcnt(16)
    s_barrier
    ds_read_b64_tr_b16 a[238:239], v103 offset:41216
    v_mfma_f32_16x16x32_bf16 a[24:27], a[204:207], v[88:91], a[24:27]
    s_waitcnt lgkmcnt(12)
    v_exp_f32 v64, v16
    v_mfma_f32_16x16x32_bf16 a[32:35], a[208:211], v[88:91], a[32:35]
    s_add_u32 m0, s67, 16384
    ds_read_b64_tr_b16 a[240:241], v104 offset:33024
    v_add_f32 v58, v56, v64
    v_mfma_f32_16x16x32_bf16 a[36:39], a[208:211], v[92:95], a[36:39]
    s_waitcnt lgkmcnt(12)
    ds_read_b64_tr_b16 a[242:243], v104 offset:41216
    buffer_load_dwordx4 v108, s[32:35], s82 offen offset:0 lds
    buffer_load_dwordx4 v[196:199], v1, s[60:63], s18 offen offset:1024 sc1
    v_mfma_f32_16x16x32_bf16 a[44:47], a[212:215], v[92:95], a[44:47]
    v_exp_f32 v65, v17
    v_mfma_f32_16x16x32_bf16 a[40:43], a[212:215], v[88:91], a[40:43]
    s_waitcnt lgkmcnt(12)
    ds_read_b64_tr_b16 a[244:245], v105 offset:33024
    v_add_f32 v58, v58, v65
    v_mfma_f32_16x16x32_bf16 a[48:51], a[216:219], v[88:91], a[48:51]
    ds_read_b64_tr_b16 a[246:247], v105 offset:41216
    v_cvt_pk_bf16_f32 v80, v64, v65
    v_mfma_f32_16x16x32_bf16 a[52:55], a[216:219], v[92:95], a[52:55]
    s_waitcnt lgkmcnt(12)
    v_exp_f32 v66, v18
    v_mfma_f32_16x16x32_bf16 a[60:63], a[220:223], v[92:95], a[60:63]
    ds_read_b64_tr_b16 a[248:249], v106 offset:33024
    v_add_f32 v58, v58, v66
    v_mfma_f32_16x16x32_bf16 a[56:59], a[220:223], v[88:91], a[56:59]
    s_waitcnt lgkmcnt(11)
    ds_read_b64_tr_b16 a[250:251], v106 offset:41216
    buffer_load_dwordx4 v109, s[32:35], s82 offen offset:1024 lds
    v_mfma_f32_16x16x32_bf16 a[64:67], a[224:227], v[88:91], a[64:67]
    v_exp_f32 v67, v19
    v_mfma_f32_16x16x32_bf16 a[68:71], a[224:227], v[92:95], a[68:71]
    s_waitcnt lgkmcnt(10)
    ds_read_b64_tr_b16 a[252:253], v107 offset:33024
    buffer_load_dwordx4 v[200:203], v1, s[60:63], s18 offen offset:2048 sc1
    v_add_f32 v58, v58, v67
    v_mfma_f32_16x16x32_bf16 a[76:79], a[228:231], v[92:95], a[76:79]
    ds_read_b64_tr_b16 a[254:255], v107 offset:41216
    v_cvt_pk_bf16_f32 v81, v66, v67
    v_mfma_f32_16x16x32_bf16 a[72:75], a[228:231], v[88:91], a[72:75]
    s_waitcnt lgkmcnt(10)
    v_exp_f32 v68, v20
    v_mfma_f32_16x16x32_bf16 a[80:83], a[232:235], v[88:91], a[80:83]
    ds_read_b128 a[192:195], v96 offset:49152
    v_add_f32 v59, v57, v68
    v_mfma_f32_16x16x32_bf16 a[84:87], a[232:235], v[92:95], a[84:87]
    s_waitcnt lgkmcnt(9)
    ds_read_b128 a[196:199], v97 offset:49152
    buffer_load_dwordx4 v110, s[32:35], s82 offen offset:2048 lds
    v_mfma_f32_16x16x32_bf16 a[92:95], a[236:239], v[92:95], a[92:95]
    v_exp_f32 v69, v21
    v_mfma_f32_16x16x32_bf16 a[88:91], a[236:239], v[88:91], a[88:91]
    s_waitcnt lgkmcnt(8)
    ds_read_b128 a[200:203], v98 offset:49152
    v_add_f32 v59, v59, v69
    v_mfma_f32_16x16x32_bf16 a[96:99], a[240:243], v[88:91], a[96:99]
    ds_read_b128 a[204:207], v99 offset:49152
    v_cvt_pk_bf16_f32 v84, v68, v69
    v_mfma_f32_16x16x32_bf16 a[100:103], a[240:243], v[92:95], a[100:103]
    s_waitcnt lgkmcnt(8)
    buffer_load_dwordx4 v[204:207], v1, s[60:63], s18 offen offset:3072 sc1
    v_exp_f32 v70, v22
    v_mfma_f32_16x16x32_bf16 a[108:111], a[244:247], v[92:95], a[108:111]
    s_add_u32 s18, s18, 4096
    ds_read_b128 a[208:211], v96 offset:49408
    v_add_f32 v59, v59, v70
    v_mfma_f32_16x16x32_bf16 a[104:107], a[244:247], v[88:91], a[104:107]
    s_waitcnt lgkmcnt(7)
    ds_read_b128 a[212:215], v97 offset:49408
    buffer_load_dwordx4 v111, s[32:35], s82 offen offset:3072 lds
    v_mfma_f32_16x16x32_bf16 a[112:115], a[248:251], v[88:91], a[112:115]
    s_add_u32 s82, s82, 16384
    v_exp_f32 v71, v23
    v_mfma_f32_16x16x32_bf16 a[116:119], a[248:251], v[92:95], a[116:119]
    s_waitcnt lgkmcnt(6)
    ds_read_b128 a[216:219], v98 offset:49408
    v_add_f32 v59, v59, v71
    v_mfma_f32_16x16x32_bf16 a[124:127], a[252:255], v[92:95], a[124:127]
    ds_read_b128 a[220:223], v99 offset:49408
    v_cvt_pk_bf16_f32 v85, v70, v71
    v_mfma_f32_16x16x32_bf16 a[120:123], a[252:255], v[88:91], a[120:123]
    s_waitcnt lgkmcnt(7)
    v_exp_f32 v72, v24
    v_mfma_f32_16x16x32_bf16 v[32:35], a[192:195], v[128:131], v[48:51]
    s_add_u32 m0, s67, 81920
    ds_read_b128 a[224:227], v96 offset:57344
    buffer_load_dwordx4 v[208:211], v1, s[60:63], s18 offen offset:0 sc1
    v_add_f32 v58, v58, v72
    v_mfma_f32_16x16x32_bf16 v[36:39], a[192:195], v[160:163], v[52:55]
    s_waitcnt lgkmcnt(7)
    ds_read_b128 a[228:231], v97 offset:57344
    buffer_load_dwordx4 v112, s[36:39], s83 offen offset:0 lds
    v_mfma_f32_16x16x32_bf16 v[36:39], a[196:199], v[164:167], v[36:39]
    v_exp_f32 v73, v25
    v_mfma_f32_16x16x32_bf16 v[32:35], a[196:199], v[132:135], v[32:35]
    s_waitcnt lgkmcnt(7)
    ds_read_b128 a[232:235], v98 offset:57344
    v_add_f32 v58, v58, v73
    v_mfma_f32_16x16x32_bf16 v[32:35], a[200:203], v[136:139], v[32:35]
    ds_read_b128 a[236:239], v99 offset:57344
    v_cvt_pk_bf16_f32 v82, v72, v73
    v_mfma_f32_16x16x32_bf16 v[36:39], a[200:203], v[168:171], v[36:39]
    s_waitcnt lgkmcnt(8)
    v_exp_f32 v74, v26
    v_mfma_f32_16x16x32_bf16 v[36:39], a[204:207], v[172:175], v[36:39]
    ds_read_b128 a[240:243], v96 offset:57600
    v_add_f32 v58, v58, v74
    v_mfma_f32_16x16x32_bf16 v[32:35], a[204:207], v[140:143], v[32:35]
    s_waitcnt lgkmcnt(8)
    ds_read_b128 a[244:247], v97 offset:57600
    buffer_load_dwordx4 v113, s[36:39], s83 offen offset:1024 lds
    v_mfma_f32_16x16x32_bf16 v[32:35], a[208:211], v[144:147], v[32:35]
    buffer_load_dwordx4 v[212:215], v1, s[60:63], s18 offen offset:1024 sc1
    v_exp_f32 v75, v27
    v_mfma_f32_16x16x32_bf16 v[36:39], a[208:211], v[176:179], v[36:39]
    s_waitcnt lgkmcnt(8)
    ds_read_b128 a[248:251], v98 offset:57600
    v_add_f32 v58, v58, v75
    v_mfma_f32_16x16x32_bf16 v[36:39], a[212:215], v[180:183], v[36:39]
    ds_read_b128 a[252:255], v99 offset:57600
    v_cvt_pk_bf16_f32 v83, v74, v75
    v_mfma_f32_16x16x32_bf16 v[32:35], a[212:215], v[148:151], v[32:35]
    s_waitcnt lgkmcnt(9)
    v_exp_f32 v76, v28
    v_mfma_f32_16x16x32_bf16 v[32:35], a[216:219], v[152:155], v[32:35]
    ds_read_b64_tr_b16 a[192:193], v100 offset:49152
    v_add_f32 v59, v59, v76
    v_mfma_f32_16x16x32_bf16 v[36:39], a[216:219], v[184:187], v[36:39]
    s_waitcnt lgkmcnt(9)
    ds_read_b64_tr_b16 a[194:195], v100 offset:57344
    buffer_load_dwordx4 v114, s[36:39], s83 offen offset:2048 lds
    v_mfma_f32_16x16x32_bf16 v[36:39], a[220:223], v[188:191], v[36:39]
    v_exp_f32 v77, v29
    v_mfma_f32_16x16x32_bf16 v[32:35], a[220:223], v[156:159], v[32:35]
    s_waitcnt lgkmcnt(9)
    ds_read_b64_tr_b16 a[196:197], v101 offset:49152
    v_add_f32 v59, v59, v77
    v_mfma_f32_16x16x32_bf16 v[40:43], a[224:227], v[128:131], v[48:51]
    ds_read_b64_tr_b16 a[198:199], v101 offset:57344
    buffer_load_dwordx4 v[216:219], v1, s[60:63], s18 offen offset:2048 sc1
    v_cvt_pk_bf16_f32 v86, v76, v77
    v_mfma_f32_16x16x32_bf16 v[44:47], a[224:227], v[160:163], v[52:55]
    s_waitcnt lgkmcnt(10)
    v_exp_f32 v78, v30
    v_mfma_f32_16x16x32_bf16 v[44:47], a[228:231], v[164:167], v[44:47]
    ds_read_b64_tr_b16 a[200:201], v102 offset:49152
    v_add_f32 v59, v59, v78
    v_mfma_f32_16x16x32_bf16 v[40:43], a[228:231], v[132:135], v[40:43]
    s_waitcnt lgkmcnt(10)
    ds_read_b64_tr_b16 a[202:203], v102 offset:57344
    buffer_load_dwordx4 v115, s[36:39], s83 offen offset:3072 lds
    v_mfma_f32_16x16x32_bf16 v[40:43], a[232:235], v[136:139], v[40:43]
    s_add_u32 s83, s83, 16384
    v_exp_f32 v79, v31
    v_mfma_f32_16x16x32_bf16 v[44:47], a[232:235], v[168:171], v[44:47]
    s_waitcnt lgkmcnt(10)
    ds_read_b64_tr_b16 a[204:205], v103 offset:49152
    v_add_f32 v59, v59, v79
    v_mfma_f32_16x16x32_bf16 v[44:47], a[236:239], v[172:175], v[44:47]
    ds_read_b64_tr_b16 a[206:207], v103 offset:57344
    v_cvt_pk_bf16_f32 v87, v78, v79
    v_mfma_f32_16x16x32_bf16 v[40:43], a[236:239], v[140:143], v[40:43]
    s_waitcnt lgkmcnt(11)
    ds_read_b64_tr_b16 a[208:209], v104 offset:49152
    v_add_f32 v62, v58, v59
    v_mfma_f32_16x16x32_bf16 v[40:43], a[240:243], v[144:147], v[40:43]
    ds_read_b64_tr_b16 a[210:211], v104 offset:57344
    v_cmp_nge_f32 vcc, s71, v62
    v_mfma_f32_16x16x32_bf16 v[44:47], a[240:243], v[176:179], v[44:47]
    s_waitcnt lgkmcnt(12)
    s_cbranch_vccnz L_rare_12
L_back_12:
    ds_read_b64_tr_b16 a[212:213], v105 offset:49152
    v_mfma_f32_16x16x32_bf16 v[44:47], a[244:247], v[180:183], v[44:47]
    ds_read_b64_tr_b16 a[214:215], v105 offset:57344
    buffer_load_dwordx4 v[220:223], v1, s[60:63], s18 offen offset:3072 sc1
    v_mfma_f32_16x16x32_bf16 v[40:43], a[244:247], v[148:151], v[40:43]
    s_waitcnt lgkmcnt(12)
    s_add_u32 s18, s18, 4096
    ds_read_b64_tr_b16 a[216:217], v106 offset:49152
    v_mfma_f32_16x16x32_bf16 v[40:43], a[248:251], v[152:155], v[40:43]
    ds_read_b64_tr_b16 a[218:219], v106 offset:57344
    v_mfma_f32_16x16x32_bf16 v[44:47], a[248:251], v[184:187], v[44:47]
    s_waitcnt lgkmcnt(12)
    ds_read_b64_tr_b16 a[220:221], v107 offset:49152
    v_mfma_f32_16x16x32_bf16 v[44:47], a[252:255], v[188:191], v[44:47]
    ds_read_b64_tr_b16 a[222:223], v107 offset:57344
    v_mfma_f32_16x16x32_bf16 v[40:43], a[252:255], v[156:159], v[40:43]
    s_waitcnt lgkmcnt(12)
    ds_read_b64_tr_b16 a[224:225], v100 offset:49408
    buffer_load_dwordx4 v[224:227], v1, s[60:63], s18 offen offset:0 sc1
    v_mfma_f32_16x16x32_bf16 a[0:3], a[192:195], v[80:83], a[0:3]
    ds_read_b64_tr_b16 a[226:227], v100 offset:57600
    v_mfma_f32_16x16x32_bf16 a[4:7], a[192:195], v[84:87], a[4:7]
    s_waitcnt lgkmcnt(12)
    ds_read_b64_tr_b16 a[228:229], v101 offset:49408
    v_mfma_f32_16x16x32_bf16 a[12:15], a[196:199], v[84:87], a[12:15]
    ds_read_b64_tr_b16 a[230:231], v101 offset:57600
    v_mfma_f32_16x16x32_bf16 a[8:11], a[196:199], v[80:83], a[8:11]
    s_waitcnt lgkmcnt(12)
    ds_read_b64_tr_b16 a[232:233], v102 offset:49408
    v_mfma_f32_16x16x32_bf16 a[16:19], a[200:203], v[80:83], a[16:19]
    ds_read_b64_tr_b16 a[234:235], v102 offset:57600
    v_mfma_f32_16x16x32_bf16 a[20:23], a[200:203], v[84:87], a[20:23]
    s_waitcnt lgkmcnt(12)
    ds_read_b64_tr_b16 a[236:237], v103 offset:49408
    v_mfma_f32_16x16x32_bf16 a[28:31], a[204:207], v[84:87], a[28:31]
    s_waitcnt vmcnt(20)
    s_barrier
    ds_read_b64_tr_b16 a[238:239], v103 offset:57600
    v_mfma_f32_16x16x32_bf16 a[24:27], a[204:207], v[80:83], a[24:27]
    s_waitcnt lgkmcnt(12)
    buffer_load_dwordx4 v[228:231], v1, s[60:63], s18 offen offset:1024 sc1
    v_exp_f32 v64, v32
    v_mfma_f32_16x16x32_bf16 a[32:35], a[208:211], v[80:83], a[32:35]
    s_add_u32 m0, s67, 98304
    ds_read_b64_tr_b16 a[240:241], v104 offset:49408
    v_add_f32 v56, v58, v64
    v_mfma_f32_16x16x32_bf16 a[36:39], a[208:211], v[84:87], a[36:39]
    s_waitcnt lgkmcnt(12)
    ds_read_b64_tr_b16 a[242:243], v104 offset:57600
    buffer_load_dwordx4 v112, s[36:39], s83 offen offset:0 lds
    v_mfma_f32_16x16x32_bf16 a[44:47], a[212:215], v[84:87], a[44:47]
    v_exp_f32 v65, v33
    v_mfma_f32_16x16x32_bf16 a[40:43], a[212:215], v[80:83], a[40:43]
    s_waitcnt lgkmcnt(12)
    ds_read_b64_tr_b16 a[244:245], v105 offset:49408
    v_add_f32 v56, v56, v65
    v_mfma_f32_16x16x32_bf16 a[48:51], a[216:219], v[80:83], a[48:51]
    ds_read_b64_tr_b16 a[246:247], v105 offset:57600
    v_cvt_pk_bf16_f32 v88, v64, v65
    v_mfma_f32_16x16x32_bf16 a[52:55], a[216:219], v[84:87], a[52:55]
    s_waitcnt lgkmcnt(12)
    v_exp_f32 v66, v34
    v_mfma_f32_16x16x32_bf16 a[60:63], a[220:223], v[84:87], a[60:63]
    ds_read_b64_tr_b16 a[248:249], v106 offset:49408
    v_add_f32 v56, v56, v66
    v_mfma_f32_16x16x32_bf16 a[56:59], a[220:223], v[80:83], a[56:59]
    s_waitcnt lgkmcnt(11)
    ds_read_b64_tr_b16 a[250:251], v106 offset:57600
    buffer_load_dwordx4 v113, s[36:39], s83 offen offset:1024 lds
    buffer_load_dwordx4 v[232:235], v1, s[60:63], s18 offen offset:2048 sc1
    v_mfma_f32_16x16x32_bf16 a[64:67], a[224:227], v[80:83], a[64:67]
    v_exp_f32 v67, v35
    v_mfma_f32_16x16x32_bf16 a[68:71], a[224:227], v[84:87], a[68:71]
    s_waitcnt lgkmcnt(10)
    ds_read_b64_tr_b16 a[252:253], v107 offset:49408
    v_add_f32 v56, v56, v67
    v_mfma_f32_16x16x32_bf16 a[76:79], a[228:231], v[84:87], a[76:79]
    ds_read_b64_tr_b16 a[254:255], v107 offset:57600
    v_cvt_pk_bf16_f32 v89, v66, v67
    v_mfma_f32_16x16x32_bf16 a[72:75], a[228:231], v[80:83], a[72:75]
    s_waitcnt lgkmcnt(10)
    v_exp_f32 v68, v36
    v_mfma_f32_16x16x32_bf16 a[80:83], a[232:235], v[80:83], a[80:83]
    ds_read_b128 a[192:195], v96 offset:0
    v_add_f32 v57, v59, v68
    v_mfma_f32_16x16x32_bf16 a[84:87], a[232:235], v[84:87], a[84:87]
    s_waitcnt lgkmcnt(9)
    ds_read_b128 a[196:199], v97 offset:0
    buffer_load_dwordx4 v114, s[36:39], s83 offen offset:2048 lds
    v_mfma_f32_16x16x32_bf16 a[92:95], a[236:239], v[84:87], a[92:95]
    buffer_load_dwordx4 v[236:239], v1, s[60:63], s18 offen offset:3072 sc1
    v_exp_f32 v69, v37
    v_mfma_f32_16x16x32_bf16 a[88:91], a[236:239], v[80:83], a[88:91]
    s_waitcnt lgkmcnt(8)
    ds_read_b128 a[200:203], v98 offset:0
    v_add_f32 v57, v57, v69
    v_mfma_f32_16x16x32_bf16 a[96:99], a[240:243], v[80:83], a[96:99]
    s_add_u32 s18, s18, 4096
    ds_read_b128 a[204:207], v99 offset:0
    v_cvt_pk_bf16_f32 v92, v68, v69
    v_mfma_f32_16x16x32_bf16 a[100:103], a[240:243], v[84:87], a[100:103]
    s_waitcnt lgkmcnt(8)
    v_exp_f32 v70, v38
    v_mfma_f32_16x16x32_bf16 a[108:111], a[244:247], v[84:87], a[108:111]
    ds_read_b128 a[208:211], v96 offset:256
    v_add_f32 v57, v57, v70
    v_mfma_f32_16x16x32_bf16 a[104:107], a[244:247], v[80:83], a[104:107]
    s_waitcnt lgkmcnt(7)
    ds_read_b128 a[212:215], v97 offset:256
    buffer_load_dwordx4 v115, s[36:39], s83 offen offset:3072 lds
    v_mfma_f32_16x16x32_bf16 a[112:115], a[248:251], v[80:83], a[112:115]
    s_add_u32 s83, s83, 16384
    v_exp_f32 v71, v39
    v_mfma_f32_16x16x32_bf16 a[116:119], a[248:251], v[84:87], a[116:119]
    s_waitcnt lgkmcnt(6)
    ds_read_b128 a[216:219], v98 offset:256
    v_add_f32 v57, v57, v71
    v_mfma_f32_16x16x32_bf16 a[124:127], a[252:255], v[84:87], a[124:127]
    ds_read_b128 a[220:223], v99 offset:256
    v_cvt_pk_bf16_f32 v93, v70, v71
    v_mfma_f32_16x16x32_bf16 a[120:123], a[252:255], v[80:83], a[120:123]
    s_waitcnt lgkmcnt(7)
    v_exp_f32 v72, v40
    v_mfma_f32_16x16x32_bf16 v[16:19], a[192:195], v[128:131], v[48:51]
    ds_read_b128 a[224:227], v96 offset:8192
    v_add_f32 v56, v56, v72
    v_mfma_f32_16x16x32_bf16 v[20:23], a[192:195], v[160:163], v[52:55]
    s_waitcnt lgkmcnt(7)
    ds_read_b128 a[228:231], v97 offset:8192
    buffer_load_dwordx4 v[240:243], v1, s[60:63], s18 offen offset:0 sc1
    v_mfma_f32_16x16x32_bf16 v[20:23], a[196:199], v[164:167], v[20:23]
    v_exp_f32 v73, v41
    v_mfma_f32_16x16x32_bf16 v[16:19], a[196:199], v[132:135], v[16:19]
    s_waitcnt lgkmcnt(7)
    ds_read_b128 a[232:235], v98 offset:8192
    v_add_f32 v56, v56, v73
    v_mfma_f32_16x16x32_bf16 v[16:19], a[200:203], v[136:139], v[16:19]
    ds_read_b128 a[236:239], v99 offset:8192
    v_cvt_pk_bf16_f32 v90, v72, v73
    v_mfma_f32_16x16x32_bf16 v[20:23], a[200:203], v[168:171], v[20:23]
    s_waitcnt lgkmcnt(8)
    v_exp_f32 v74, v42
    v_mfma_f32_16x16x32_bf16 v[20:23], a[204:207], v[172:175], v[20:23]
    ds_read_b128 a[240:243], v96 offset:8448
    v_add_f32 v56, v56, v74
    v_mfma_f32_16x16x32_bf16 v[16:19], a[204:207], v[140:143], v[16:19]
    s_waitcnt lgkmcnt(8)
    ds_read_b128 a[244:247], v97 offset:8448
    buffer_load_dwordx4 v[244:247], v1, s[60:63], s18 offen offset:1024 sc1
    v_mfma_f32_16x16x32_bf16 v[16:19], a[208:211], v[144:147], v[16:19]
    v_exp_f32 v75, v43
    v_mfma_f32_16x16x32_bf16 v[20:23], a[208:211], v[176:179], v[20:23]
    s_waitcnt lgkmcnt(8)
    ds_read_b128 a[248:251], v98 offset:8448
    v_add_f32 v56, v56, v75
    v_mfma_f32_16x16x32_bf16 v[20:23], a[212:215], v[180:183], v[20:23]
    ds_read_b128 a[252:255], v99 offset:8448
    v_cvt_pk_bf16_f32 v91, v74, v75
    v_mfma_f32_16x16x32_bf16 v[16:19], a[212:215], v[148:151], v[16:19]
    s_waitcnt lgkmcnt(9)
    v_exp_f32 v76, v44
    v_mfma_f32_16x16x32_bf16 v[16:19], a[216:219], v[152:155], v[16:19]
    ds_read_b64_tr_b16 a[192:193], v100 offset:0
    v_add_f32 v57, v57, v76
    v_mfma_f32_16x16x32_bf16 v[20:23], a[216:219], v[184:187], v[20:23]
    s_waitcnt lgkmcnt(9)
    ds_read_b64_tr_b16 a[194:195], v100 offset:8192
    v_mfma_f32_16x16x32_bf16 v[20:23], a[220:223], v[188:191], v[20:23]
    buffer_load_dwordx4 v[248:251], v1, s[60:63], s18 offen offset:2048 sc1
    v_exp_f32 v77, v45
    v_mfma_f32_16x16x32_bf16 v[16:19], a[220:223], v[156:159], v[16:19]
    s_waitcnt lgkmcnt(9)
    ds_read_b64_tr_b16 a[196:197], v101 offset:0
    v_add_f32 v57, v57, v77
    v_mfma_f32_16x16x32_bf16 v[24:27], a[224:227], v[128:131], v[48:51]
    ds_read_b64_tr_b16 a[198:199], v101 offset:8192
    v_cvt_pk_bf16_f32 v94, v76, v77
    v_mfma_f32_16x16x32_bf16 v[28:31], a[224:227], v[160:163], v[52:55]
    s_waitcnt lgkmcnt(10)
    v_exp_f32 v78, v46
    v_mfma_f32_16x16x32_bf16 v[28:31], a[228:231], v[164:167], v[28:31]
    ds_read_b64_tr_b16 a[200:201], v102 offset:0
    v_add_f32 v57, v57, v78
    v_mfma_f32_16x16x32_bf16 v[24:27], a[228:231], v[132:135], v[24:27]
    s_waitcnt lgkmcnt(10)
    ds_read_b64_tr_b16 a[202:203], v102 offset:8192
    v_mfma_f32_16x16x32_bf16 v[24:27], a[232:235], v[136:139], v[24:27]
    v_exp_f32 v79, v47
    v_mfma_f32_16x16x32_bf16 v[28:31], a[232:235], v[168:171], v[28:31]
    s_waitcnt lgkmcnt(10)
    ds_read_b64_tr_b16 a[204:205], v103 offset:0
    buffer_load_dwordx4 v[252:255], v1, s[60:63], s18 offen offset:3072 sc1
    v_add_f32 v57, v57, v79
    v_mfma_f32_16x16x32_bf16 v[28:31], a[236:239], v[172:175], v[28:31]
    s_add_u32 s18, s18, 4096
    ds_read_b64_tr_b16 a[206:207], v103 offset:8192
    v_cvt_pk_bf16_f32 v95, v78, v79
    v_mfma_f32_16x16x32_bf16 v[24:27], a[236:239], v[140:143], v[24:27]
    s_waitcnt lgkmcnt(11)
    ds_read_b64_tr_b16 a[208:209], v104 offset:0
    v_add_f32 v62, v56, v57
    v_mfma_f32_16x16x32_bf16 v[24:27], a[240:243], v[144:147], v[24:27]
    ds_read_b64_tr_b16 a[210:211], v104 offset:8192
    v_cmp_nge_f32 vcc, s71, v62
    v_mfma_f32_16x16x32_bf16 v[28:31], a[240:243], v[176:179], v[28:31]
    s_waitcnt lgkmcnt(12)
    s_cbranch_vccnz L_rare_13
L_back_13:
    ds_read_b64_tr_b16 a[212:213], v105 offset:0
    v_mfma_f32_16x16x32_bf16 v[28:31], a[244:247], v[180:183], v[28:31]
    ds_read_b64_tr_b16 a[214:215], v105 offset:8192
    v_mfma_f32_16x16x32_bf16 v[24:27], a[244:247], v[148:151], v[24:27]
    s_waitcnt lgkmcnt(12)
    ds_read_b64_tr_b16 a[216:217], v106 offset:0
    v_mfma_f32_16x16x32_bf16 v[24:27], a[248:251], v[152:155], v[24:27]
    ds_read_b64_tr_b16 a[218:219], v106 offset:8192
    v_mfma_f32_16x16x32_bf16 v[28:31], a[248:251], v[184:187], v[28:31]
    s_waitcnt lgkmcnt(12)
    ds_read_b64_tr_b16 a[220:221], v107 offset:0
    buffer_load_dwordx4 a[128:131], v1, s[60:63], s18 offen offset:0 sc1
    v_mfma_f32_16x16x32_bf16 v[28:31], a[252:255], v[188:191], v[28:31]
    ds_read_b64_tr_b16 a[222:223], v107 offset:8192
    v_mfma_f32_16x16x32_bf16 v[24:27], a[252:255], v[156:159], v[24:27]
    s_waitcnt lgkmcnt(12)
    ds_read_b64_tr_b16 a[224:225], v100 offset:256
    v_mfma_f32_16x16x32_bf16 a[0:3], a[192:195], v[88:91], a[0:3]
    ds_read_b64_tr_b16 a[226:227], v100 offset:8448
    v_mfma_f32_16x16x32_bf16 a[4:7], a[192:195], v[92:95], a[4:7]
    s_waitcnt lgkmcnt(12)
    ds_read_b64_tr_b16 a[228:229], v101 offset:256
    v_mfma_f32_16x16x32_bf16 a[12:15], a[196:199], v[92:95], a[12:15]
    ds_read_b64_tr_b16 a[230:231], v101 offset:8448
    v_mfma_f32_16x16x32_bf16 a[8:11], a[196:199], v[88:91], a[8:11]
    s_waitcnt lgkmcnt(12)
    ds_read_b64_tr_b16 a[232:233], v102 offset:256
    v_mfma_f32_16x16x32_bf16 a[16:19], a[200:203], v[88:91], a[16:19]
    ds_read_b64_tr_b16 a[234:235], v102 offset:8448
    v_mfma_f32_16x16x32_bf16 a[20:23], a[200:203], v[92:95], a[20:23]
    s_waitcnt lgkmcnt(12)
    ds_read_b64_tr_b16 a[236:237], v103 offset:256
    buffer_load_dwordx4 a[132:135], v1, s[60:63], s18 offen offset:1024 sc1
    v_mfma_f32_16x16x32_bf16 a[28:31], a[204:207], v[92:95], a[28:31]
    s_waitcnt vmcnt(15)
    s_barrier
    ds_read_b64_tr_b16 a[238:239], v103 offset:8448
    v_mfma_f32_16x16x32_bf16 a[24:27], a[204:207], v[88:91], a[24:27]
    s_waitcnt lgkmcnt(12)
    v_exp_f32 v64, v16
    v_mfma_f32_16x16x32_bf16 a[32:35], a[208:211], v[88:91], a[32:35]
    s_add_u32 m0, s67, 49152
    ds_read_b64_tr_b16 a[240:241], v104 offset:256
    v_add_f32 v58, v56, v64
    v_mfma_f32_16x16x32_bf16 a[36:39], a[208:211], v[92:95], a[36:39]
    s_waitcnt lgkmcnt(12)
    s_add_u32 s68, s81, 0
    ds_read_b64_tr_b16 a[242:243], v104 offset:8448
    v_mfma_f32_16x16x32_bf16 a[44:47], a[212:215], v[92:95], a[44:47]
    buffer_load_dwordx4 v124, s[44:47], s68 offen offset:0 lds
    v_exp_f32 v65, v17
    v_mfma_f32_16x16x32_bf16 a[40:43], a[212:215], v[88:91], a[40:43]
    s_waitcnt lgkmcnt(12)
    ds_read_b64_tr_b16 a[244:245], v105 offset:256
    v_add_f32 v58, v58, v65
    v_mfma_f32_16x16x32_bf16 a[48:51], a[216:219], v[88:91], a[48:51]
    ds_read_b64_tr_b16 a[246:247], v105 offset:8448
    buffer_load_dwordx4 a[136:139], v1, s[60:63], s18 offen offset:2048 sc1
    v_cvt_pk_bf16_f32 v80, v64, v65
    v_mfma_f32_16x16x32_bf16 a[52:55], a[216:219], v[92:95], a[52:55]
    s_waitcnt lgkmcnt(12)
    v_exp_f32 v66, v18
    v_mfma_f32_16x16x32_bf16 a[60:63], a[220:223], v[92:95], a[60:63]
    ds_read_b64_tr_b16 a[248:249], v106 offset:256
    v_add_f32 v58, v58, v66
    v_mfma_f32_16x16x32_bf16 a[56:59], a[220:223], v[88:91], a[56:59]
    s_waitcnt lgkmcnt(11)
    ds_read_b64_tr_b16 a[250:251], v106 offset:8448
    buffer_load_dwordx4 v125, s[44:47], s68 offen offset:1024 lds
    v_mfma_f32_16x16x32_bf16 a[64:67], a[224:227], v[88:91], a[64:67]
    v_exp_f32 v67, v19
    v_mfma_f32_16x16x32_bf16 a[68:71], a[224:227], v[92:95], a[68:71]
    s_waitcnt lgkmcnt(10)
    ds_read_b64_tr_b16 a[252:253], v107 offset:256
    v_add_f32 v58, v58, v67
    v_mfma_f32_16x16x32_bf16 a[76:79], a[228:231], v[92:95], a[76:79]
    ds_read_b64_tr_b16 a[254:255], v107 offset:8448
    v_cvt_pk_bf16_f32 v81, v66, v67
    v_mfma_f32_16x16x32_bf16 a[72:75], a[228:231], v[88:91], a[72:75]
    s_waitcnt lgkmcnt(10)
    v_exp_f32 v68, v20
    v_mfma_f32_16x16x32_bf16 a[80:83], a[232:235], v[88:91], a[80:83]
    buffer_load_dwordx4 a[140:143], v1, s[60:63], s18 offen offset:3072 sc1
    v_add_f32 v59, v57, v68
    v_mfma_f32_16x16x32_bf16 a[84:87], a[232:235], v[92:95], a[84:87]
    s_waitcnt lgkmcnt(8)
    ds_read_b128 a[192:195], v96 offset:16384
    buffer_load_dwordx4 v126, s[44:47], s68 offen offset:2048 lds
    v_mfma_f32_16x16x32_bf16 a[92:95], a[236:239], v[92:95], a[92:95]
    s_add_u32 s18, s18, 4096
    v_exp_f32 v69, v21
    v_mfma_f32_16x16x32_bf16 a[88:91], a[236:239], v[88:91], a[88:91]
    s_waitcnt lgkmcnt(7)
    ds_read_b128 a[196:199], v97 offset:16384
    v_add_f32 v59, v59, v69
    v_mfma_f32_16x16x32_bf16 a[96:99], a[240:243], v[88:91], a[96:99]
    ds_read_b128 a[200:203], v98 offset:16384
    v_cvt_pk_bf16_f32 v84, v68, v69
    v_mfma_f32_16x16x32_bf16 a[100:103], a[240:243], v[92:95], a[100:103]
    s_waitcnt lgkmcnt(7)
    v_exp_f32 v70, v22
    v_mfma_f32_16x16x32_bf16 a[108:111], a[244:247], v[92:95], a[108:111]
    v_add_f32 v59, v59, v70
    v_mfma_f32_16x16x32_bf16 a[104:107], a[244:247], v[88:91], a[104:107]
    s_waitcnt lgkmcnt(5)
    ds_read_b128 a[204:207], v99 offset:16384
    buffer_load_dwordx4 v127, s[44:47], s68 offen offset:3072 lds
    v_mfma_f32_16x16x32_bf16 a[112:115], a[248:251], v[88:91], a[112:115]
    buffer_load_dwordx4 a[144:147], v1, s[60:63], s18 offen offset:0 sc1
    v_exp_f32 v71, v23
    v_mfma_f32_16x16x32_bf16 a[116:119], a[248:251], v[92:95], a[116:119]
    s_waitcnt lgkmcnt(4)
    ds_read_b128 a[208:211], v96 offset:16640
    v_add_f32 v59, v59, v71
    v_mfma_f32_16x16x32_bf16 a[124:127], a[252:255], v[92:95], a[124:127]
    ds_read_b128 a[212:215], v97 offset:16640
    v_cvt_pk_bf16_f32 v85, v70, v71
    v_mfma_f32_16x16x32_bf16 a[120:123], a[252:255], v[88:91], a[120:123]
    s_waitcnt lgkmcnt(5)
    v_exp_f32 v72, v24
    v_mfma_f32_16x16x32_bf16 v[32:35], a[192:195], v[128:131], v[48:51]
    s_add_u32 m0, s67, 114688
    ds_read_b128 a[216:219], v98 offset:16640
    v_add_f32 v58, v58, v72
    v_mfma_f32_16x16x32_bf16 v[36:39], a[192:195], v[160:163], v[52:55]
    s_waitcnt lgkmcnt(5)
    s_add_u32 s69, s81, 114688
    ds_read_b128 a[220:223], v99 offset:16640
    v_mfma_f32_16x16x32_bf16 v[36:39], a[196:199], v[164:167], v[36:39]
    buffer_load_dwordx4 v124, s[44:47], s69 offen offset:0 lds
    v_exp_f32 v73, v25
    v_mfma_f32_16x16x32_bf16 v[32:35], a[196:199], v[132:135], v[32:35]
    s_waitcnt lgkmcnt(5)
    ds_read_b128 a[224:227], v96 offset:24576
    v_add_f32 v58, v58, v73
    v_mfma_f32_16x16x32_bf16 v[32:35], a[200:203], v[136:139], v[32:35]
    ds_read_b128 a[228:231], v97 offset:24576
    buffer_load_dwordx4 a[148:151], v1, s[60:63], s18 offen offset:1024 sc1
    v_cvt_pk_bf16_f32 v82, v72, v73
    v_mfma_f32_16x16x32_bf16 v[36:39], a[200:203], v[168:171], v[36:39]
    s_waitcnt lgkmcnt(6)
    v_exp_f32 v74, v26
    v_mfma_f32_16x16x32_bf16 v[36:39], a[204:207], v[172:175], v[36:39]
    ds_read_b128 a[232:235], v98 offset:24576
    v_add_f32 v58, v58, v74
    v_mfma_f32_16x16x32_bf16 v[32:35], a[204:207], v[140:143], v[32:35]
    s_waitcnt lgkmcnt(6)
    ds_read_b128 a[236:239], v99 offset:24576
    buffer_load_dwordx4 v125, s[44:47], s69 offen offset:1024 lds
    v_mfma_f32_16x16x32_bf16 v[32:35], a[208:211], v[144:147], v[32:35]
    v_exp_f32 v75, v27
    v_mfma_f32_16x16x32_bf16 v[36:39], a[208:211], v[176:179], v[36:39]
    s_waitcnt lgkmcnt(6)
    ds_read_b128 a[240:243], v96 offset:24832
    v_add_f32 v58, v58, v75
    v_mfma_f32_16x16x32_bf16 v[36:39], a[212:215], v[180:183], v[36:39]
    ds_read_b128 a[244:247], v97 offset:24832
    v_cvt_pk_bf16_f32 v83, v74, v75
    v_mfma_f32_16x16x32_bf16 v[32:35], a[212:215], v[148:151], v[32:35]
    s_waitcnt lgkmcnt(7)
    buffer_load_dwordx4 a[152:155], v1, s[60:63], s18 offen offset:2048 sc1
    v_exp_f32 v76, v28
    v_mfma_f32_16x16x32_bf16 v[32:35], a[216:219], v[152:155], v[32:35]
    ds_read_b128 a[248:251], v98 offset:24832
    v_add_f32 v59, v59, v76
    v_mfma_f32_16x16x32_bf16 v[36:39], a[216:219], v[184:187], v[36:39]
    s_waitcnt lgkmcnt(7)
    ds_read_b128 a[252:255], v99 offset:24832
    buffer_load_dwordx4 v126, s[44:47], s69 offen offset:2048 lds
    v_mfma_f32_16x16x32_bf16 v[36:39], a[220:223], v[188:191], v[36:39]
    v_exp_f32 v77, v29
    v_mfma_f32_16x16x32_bf16 v[32:35], a[220:223], v[156:159], v[32:35]
    s_waitcnt lgkmcnt(7)
    ds_read_b64_tr_b16 a[192:193], v100 offset:16384
    v_add_f32 v59, v59, v77
    v_mfma_f32_16x16x32_bf16 v[40:43], a[224:227], v[128:131], v[48:51]
    ds_read_b64_tr_b16 a[194:195], v100 offset:24576
    v_cvt_pk_bf16_f32 v86, v76, v77
    v_mfma_f32_16x16x32_bf16 v[44:47], a[224:227], v[160:163], v[52:55]
    s_waitcnt lgkmcnt(8)
    v_exp_f32 v78, v30
    v_mfma_f32_16x16x32_bf16 v[44:47], a[228:231], v[164:167], v[44:47]
    ds_read_b64_tr_b16 a[196:197], v101 offset:16384
    v_add_f32 v59, v59, v78
    v_mfma_f32_16x16x32_bf16 v[40:43], a[228:231], v[132:135], v[40:43]
    s_waitcnt lgkmcnt(8)
    ds_read_b64_tr_b16 a[198:199], v101 offset:24576
    buffer_load_dwordx4 v127, s[44:47], s69 offen offset:3072 lds
    buffer_load_dwordx4 a[156:159], v1, s[60:63], s18 offen offset:3072 sc1
    v_mfma_f32_16x16x32_bf16 v[40:43], a[232:235], v[136:139], v[40:43]
    s_add_u32 s18, s18, 4096
    v_exp_f32 v79, v31
    v_mfma_f32_16x16x32_bf16 v[44:47], a[232:235], v[168:171], v[44:47]
    s_waitcnt lgkmcnt(8)
    ds_read_b64_tr_b16 a[200:201], v102 offset:16384
    v_add_f32 v59, v59, v79
    v_mfma_f32_16x16x32_bf16 v[44:47], a[236:239], v[172:175], v[44:47]
    ds_read_b64_tr_b16 a[202:203], v102 offset:24576
    v_cvt_pk_bf16_f32 v87, v78, v79
    v_mfma_f32_16x16x32_bf16 v[40:43], a[236:239], v[140:143], v[40:43]
    s_waitcnt lgkmcnt(9)
    ds_read_b64_tr_b16 a[204:205], v103 offset:16384
    v_add_f32 v62, v58, v59
    v_mfma_f32_16x16x32_bf16 v[40:43], a[240:243], v[144:147], v[40:43]
    ds_read_b64_tr_b16 a[206:207], v103 offset:24576
    v_cmp_nge_f32 vcc, s71, v62
    v_mfma_f32_16x16x32_bf16 v[44:47], a[240:243], v[176:179], v[44:47]
    s_waitcnt lgkmcnt(10)
    s_cbranch_vccnz L_rare_14
L_back_14:
    ds_read_b64_tr_b16 a[208:209], v104 offset:16384
    v_mfma_f32_16x16x32_bf16 v[44:47], a[244:247], v[180:183], v[44:47]
    ds_read_b64_tr_b16 a[210:211], v104 offset:24576
    v_mfma_f32_16x16x32_bf16 v[40:43], a[244:247], v[148:151], v[40:43]
    s_waitcnt lgkmcnt(11)
    ds_read_b64_tr_b16 a[212:213], v105 offset:16384
    buffer_load_dwordx4 a[160:163], v1, s[60:63], s18 offen offset:0 sc1
    v_mfma_f32_16x16x32_bf16 v[40:43], a[248:251], v[152:155], v[40:43]
    ds_read_b64_tr_b16 a[214:215], v105 offset:24576
    v_mfma_f32_16x16x32_bf16 v[44:47], a[248:251], v[184:187], v[44:47]
    s_waitcnt lgkmcnt(12)
    ds_read_b64_tr_b16 a[216:217], v106 offset:16384
    v_mfma_f32_16x16x32_bf16 v[44:47], a[252:255], v[188:191], v[44:47]
    ds_read_b64_tr_b16 a[218:219], v106 offset:24576
    v_mfma_f32_16x16x32_bf16 v[40:43], a[252:255], v[156:159], v[40:43]
    s_waitcnt lgkmcnt(12)
    ds_read_b64_tr_b16 a[220:221], v107 offset:16384
    v_mfma_f32_16x16x32_bf16 a[0:3], a[192:195], v[80:83], a[0:3]
    ds_read_b64_tr_b16 a[222:223], v107 offset:24576
    v_mfma_f32_16x16x32_bf16 a[4:7], a[192:195], v[84:87], a[4:7]
    s_waitcnt lgkmcnt(12)
    ds_read_b64_tr_b16 a[224:225], v100 offset:16640
    v_mfma_f32_16x16x32_bf16 a[12:15], a[196:199], v[84:87], a[12:15]
    ds_read_b64_tr_b16 a[226:227], v100 offset:24832
    buffer_load_dwordx4 a[164:167], v1, s[60:63], s18 offen offset:1024 sc1
    v_mfma_f32_16x16x32_bf16 a[8:11], a[196:199], v[80:83], a[8:11]
    s_waitcnt lgkmcnt(12)
    ds_read_b64_tr_b16 a[228:229], v101 offset:16640
    v_mfma_f32_16x16x32_bf16 a[16:19], a[200:203], v[80:83], a[16:19]
    ds_read_b64_tr_b16 a[230:231], v101 offset:24832
    v_mfma_f32_16x16x32_bf16 a[20:23], a[200:203], v[84:87], a[20:23]
    s_waitcnt lgkmcnt(12)
    ds_read_b64_tr_b16 a[232:233], v102 offset:16640
    v_exp_f32 v64, v32
    v_mfma_f32_16x16x32_bf16 a[28:31], a[204:207], v[84:87], a[28:31]
    s_waitcnt vmcnt(22)
    s_barrier
    ds_read_b64_tr_b16 a[234:235], v102 offset:24832
    v_exp_f32 v65, v33
    v_add_f32 v56, v58, v64
    v_mfma_f32_16x16x32_bf16 a[24:27], a[204:207], v[80:83], a[24:27]
    s_waitcnt lgkmcnt(12)
    ds_read_b64_tr_b16 a[236:237], v103 offset:16640
    v_exp_f32 v66, v34
    v_mfma_f32_16x16x32_bf16 a[32:35], a[208:211], v[80:83], a[32:35]
    s_add_u32 m0, s67, 0
    ds_read_b64_tr_b16 a[238:239], v103 offset:24832
    v_add_f32 v56, v56, v65
    v_cvt_pk_bf16_f32 v88, v64, v65
    v_add_f32 v56, v56, v66
    v_mfma_f32_16x16x32_bf16 a[36:39], a[208:211], v[84:87], a[36:39]
    s_waitcnt lgkmcnt(12)
    ds_read_b64_tr_b16 a[240:241], v104 offset:16640
    v_exp_f32 v67, v35
    v_mfma_f32_16x16x32_bf16 a[44:47], a[212:215], v[84:87], a[44:47]
    s_add_u32 s68, s81, 128
    ds_read_b64_tr_b16 a[242:243], v104 offset:24832
    buffer_load_dwordx4 a[168:171], v1, s[60:63], s18 offen offset:2048 sc1
    v_exp_f32 v68, v36
    v_mfma_f32_16x16x32_bf16 a[40:43], a[212:215], v[80:83], a[40:43]
    s_waitcnt lgkmcnt(12)
    ds_read_b64_tr_b16 a[244:245], v105 offset:16640
    buffer_load_dwordx4 v124, s[44:47], s68 offen offset:0 lds
    v_add_f32 v56, v56, v67
    v_cvt_pk_bf16_f32 v89, v66, v67
    v_add_f32 v57, v59, v68
    v_mfma_f32_16x16x32_bf16 a[48:51], a[216:219], v[80:83], a[48:51]
    ds_read_b64_tr_b16 a[246:247], v105 offset:24832
    v_exp_f32 v69, v37
    v_mfma_f32_16x16x32_bf16 a[52:55], a[216:219], v[84:87], a[52:55]
    s_waitcnt lgkmcnt(12)
    ds_read_b64_tr_b16 a[248:249], v106 offset:16640
    v_exp_f32 v70, v38
    v_add_f32 v57, v57, v69
    v_cvt_pk_bf16_f32 v92, v68, v69
    v_mfma_f32_16x16x32_bf16 a[60:63], a[220:223], v[84:87], a[60:63]
    ds_read_b64_tr_b16 a[250:251], v106 offset:24832
    buffer_load_dwordx4 v125, s[44:47], s68 offen offset:1024 lds
    v_exp_f32 v71, v39
    v_mfma_f32_16x16x32_bf16 a[56:59], a[220:223], v[80:83], a[56:59]
    s_waitcnt lgkmcnt(12)
    ds_read_b64_tr_b16 a[252:253], v107 offset:16640
    v_add_f32 v57, v57, v70
    v_add_f32 v57, v57, v71
    v_cvt_pk_bf16_f32 v93, v70, v71
    v_mfma_f32_16x16x32_bf16 a[64:67], a[224:227], v[80:83], a[64:67]
    ds_read_b64_tr_b16 a[254:255], v107 offset:24832
    v_exp_f32 v72, v40
    v_mfma_f32_16x16x32_bf16 a[68:71], a[224:227], v[84:87], a[68:71]
    s_waitcnt lgkmcnt(12)
    ds_read_b64_tr_b16 a[192:193], v100 offset:32768
    buffer_load_dwordx4 v126, s[44:47], s68 offen offset:2048 lds
    v_exp_f32 v73, v41
    v_mfma_f32_16x16x32_bf16 a[76:79], a[228:231], v[84:87], a[76:79]
    ds_read_b64_tr_b16 a[194:195], v100 offset:40960
    buffer_load_dwordx4 a[172:175], v1, s[60:63], s18 offen offset:3072 sc1
    v_add_f32 v56, v56, v72
    v_add_f32 v56, v56, v73
    v_cvt_pk_bf16_f32 v90, v72, v73
    v_mfma_f32_16x16x32_bf16 a[72:75], a[228:231], v[80:83], a[72:75]
    s_waitcnt lgkmcnt(12)
    ds_read_b64_tr_b16 a[196:197], v101 offset:32768
    v_exp_f32 v74, v42
    v_mfma_f32_16x16x32_bf16 a[80:83], a[232:235], v[80:83], a[80:83]
    s_add_u32 s18, s18, 4096
    ds_read_b64_tr_b16 a[198:199], v101 offset:40960
    buffer_load_dwordx4 v127, s[44:47], s68 offen offset:3072 lds
    v_exp_f32 v75, v43
    v_add_f32 v56, v56, v74
    v_mfma_f32_16x16x32_bf16 a[84:87], a[232:235], v[84:87], a[84:87]
    s_waitcnt lgkmcnt(12)
    ds_read_b64_tr_b16 a[200:201], v102 offset:32768
    v_exp_f32 v76, v44
    v_mfma_f32_16x16x32_bf16 a[92:95], a[236:239], v[84:87], a[92:95]
    s_add_u32 m0, s67, 65536
    ds_read_b64_tr_b16 a[202:203], v102 offset:40960
    v_add_f32 v56, v56, v75
    v_cvt_pk_bf16_f32 v91, v74, v75
    v_add_f32 v57, v57, v76
    v_mfma_f32_16x16x32_bf16 a[88:91], a[236:239], v[80:83], a[88:91]
    s_waitcnt lgkmcnt(12)
    ds_read_b64_tr_b16 a[204:205], v103 offset:32768
    v_exp_f32 v77, v45
    v_mfma_f32_16x16x32_bf16 a[96:99], a[240:243], v[80:83], a[96:99]
    s_add_u32 s69, s81, 114816
    ds_read_b64_tr_b16 a[206:207], v103 offset:40960
    v_exp_f32 v78, v46
    v_mfma_f32_16x16x32_bf16 a[100:103], a[240:243], v[84:87], a[100:103]
    s_waitcnt lgkmcnt(12)
    ds_read_b64_tr_b16 a[208:209], v104 offset:32768
    buffer_load_dwordx4 v124, s[44:47], s69 offen offset:0 lds
    v_add_f32 v57, v57, v77
    v_cvt_pk_bf16_f32 v94, v76, v77
    v_add_f32 v57, v57, v78
    v_mfma_f32_16x16x32_bf16 a[108:111], a[244:247], v[84:87], a[108:111]
    ds_read_b64_tr_b16 a[210:211], v104 offset:40960
    buffer_load_dwordx4 a[176:179], v1, s[60:63], s18 offen offset:0 sc1
    v_exp_f32 v79, v47
    v_mfma_f32_16x16x32_bf16 a[104:107], a[244:247], v[80:83], a[104:107]
    s_waitcnt lgkmcnt(12)
    ds_read_b64_tr_b16 a[212:213], v105 offset:32768
    v_add_f32 v57, v57, v79
    v_mfma_f32_16x16x32_bf16 a[112:115], a[248:251], v[80:83], a[112:115]
    ds_read_b64_tr_b16 a[214:215], v105 offset:40960
    buffer_load_dwordx4 v125, s[44:47], s69 offen offset:1024 lds
    v_cvt_pk_bf16_f32 v95, v78, v79
    v_mfma_f32_16x16x32_bf16 a[116:119], a[248:251], v[84:87], a[116:119]
    s_waitcnt lgkmcnt(12)
    ds_read_b64_tr_b16 a[216:217], v106 offset:32768
    v_add_f32 v62, v56, v57
    v_mfma_f32_16x16x32_bf16 a[124:127], a[252:255], v[84:87], a[124:127]
    ds_read_b64_tr_b16 a[218:219], v106 offset:40960
    v_cmp_nge_f32 vcc, s71, v62
    v_mfma_f32_16x16x32_bf16 a[120:123], a[252:255], v[80:83], a[120:123]
    s_waitcnt lgkmcnt(12)
    s_cbranch_vccnz L_rare_15
L_back_15:
    ds_read_b64_tr_b16 a[220:221], v107 offset:32768
    v_mfma_f32_16x16x32_bf16 a[0:3], a[192:195], v[88:91], a[0:3]
    ds_read_b64_tr_b16 a[222:223], v107 offset:40960
    buffer_load_dwordx4 v126, s[44:47], s69 offen offset:2048 lds
    v_mfma_f32_16x16x32_bf16 a[4:7], a[192:195], v[92:95], a[4:7]
    s_waitcnt lgkmcnt(12)
    ds_read_b64_tr_b16 a[224:225], v100 offset:33024
    buffer_load_dwordx4 a[180:183], v1, s[60:63], s18 offen offset:1024 sc1
    v_mfma_f32_16x16x32_bf16 a[12:15], a[196:199], v[92:95], a[12:15]
    ds_read_b64_tr_b16 a[226:227], v100 offset:41216
    v_mov_b32 v63, v56
    v_mfma_f32_16x16x32_bf16 a[8:11], a[196:199], v[88:91], a[8:11]
    s_waitcnt lgkmcnt(12)
    ds_read_b64_tr_b16 a[228:229], v101 offset:33024
    buffer_load_dwordx4 v127, s[44:47], s69 offen offset:3072 lds
    v_mfma_f32_16x16x32_bf16 a[16:19], a[200:203], v[88:91], a[16:19]
    ds_read_b64_tr_b16 a[230:231], v101 offset:41216
    v_permlane32_swap_b32 v56, v63
    v_mfma_f32_16x16x32_bf16 a[20:23], a[200:203], v[92:95], a[20:23]
    s_waitcnt lgkmcnt(12)
    ds_read_b64_tr_b16 a[232:233], v102 offset:33024
    v_add_f32 v56, v56, v63
    v_mov_b32 v63, v56
    s_nop 1
    v_permlane16_swap_b32 v56, v63
    v_add_f32 v56, v56, v63
    v_rcp_f32 v60, v56
    v_mov_b32 v63, v57
    s_nop 1
    v_permlane32_swap_b32 v57, v63
    v_add_f32 v57, v57, v63
    v_mfma_f32_16x16x32_bf16 a[28:31], a[204:207], v[92:95], a[28:31]
    s_waitcnt vmcnt(15)
    s_barrier
    ds_read_b64_tr_b16 a[234:235], v102 offset:41216
    v_mov_b32 v63, v57
    s_nop 1
    v_permlane16_swap_b32 v57, v63
    v_mfma_f32_16x16x32_bf16 a[24:27], a[204:207], v[88:91], a[24:27]
    s_waitcnt lgkmcnt(12)
    ds_read_b64_tr_b16 a[236:237], v103 offset:33024
    v_mov_b32 v54, v13
    v_add_f32 v57, v57, v63
    v_mfma_f32_16x16x32_bf16 a[32:35], a[208:211], v[88:91], a[32:35]
    s_add_u32 m0, s67, 16384
    s_add_u32 s68, s81, 256
    ds_read_b64_tr_b16 a[238:239], v103 offset:41216
    v_rcp_f32 v61, v57
    v_accvgpr_read_b32 v64, a0
    v_accvgpr_read_b32 v65, a1
    v_accvgpr_read_b32 v66, a2
    v_mfma_f32_16x16x32_bf16 a[36:39], a[208:211], v[92:95], a[36:39]
    s_waitcnt lgkmcnt(12)
    ds_read_b64_tr_b16 a[240:241], v104 offset:33024
    buffer_load_dwordx4 v124, s[44:47], s68 offen offset:0 lds
    v_accvgpr_read_b32 v67, a3
    v_cvt_pk_bf16_f32 v128, v64, v65
    v_mfma_f32_16x16x32_bf16 a[44:47], a[212:215], v[92:95], a[44:47]
    ds_read_b64_tr_b16 a[242:243], v104 offset:41216
    buffer_load_dwordx4 a[184:187], v1, s[60:63], s18 offen offset:2048 sc1
    v_mfma_f32_16x16x32_bf16 a[40:43], a[212:215], v[88:91], a[40:43]
    s_waitcnt lgkmcnt(12)
    ds_read_b64_tr_b16 a[244:245], v105 offset:33024
    v_cvt_pk_bf16_f32 v129, v66, v67
    v_accvgpr_read_b32 v68, a8
    v_mfma_f32_16x16x32_bf16 a[48:51], a[216:219], v[88:91], a[48:51]
    ds_read_b64_tr_b16 a[246:247], v105 offset:41216
    v_accvgpr_read_b32 v69, a9
    v_accvgpr_read_b32 v70, a10
    v_mfma_f32_16x16x32_bf16 a[52:55], a[216:219], v[92:95], a[52:55]
    s_waitcnt lgkmcnt(12)
    ds_read_b64_tr_b16 a[248:249], v106 offset:33024
    v_accvgpr_read_b32 v71, a11
    v_cvt_pk_bf16_f32 v130, v68, v69
    v_mfma_f32_16x16x32_bf16 a[60:63], a[220:223], v[92:95], a[60:63]
    ds_read_b64_tr_b16 a[250:251], v106 offset:41216
    v_cvt_pk_bf16_f32 v131, v70, v71
    v_accvgpr_read_b32 v72, a4
    v_accvgpr_read_b32 v73, a5
    v_accvgpr_read_b32 v74, a6
    v_accvgpr_read_b32 v75, a7
    v_mfma_f32_16x16x32_bf16 a[56:59], a[220:223], v[88:91], a[56:59]
    s_waitcnt lgkmcnt(12)
    ds_read_b64_tr_b16 a[252:253], v107 offset:33024
    buffer_load_dwordx4 v125, s[44:47], s68 offen offset:1024 lds
    v_mfma_f32_16x16x32_bf16 a[64:67], a[224:227], v[88:91], a[64:67]
    ds_read_b64_tr_b16 a[254:255], v107 offset:41216
    v_cvt_pk_bf16_f32 v132, v72, v73
    v_cvt_pk_bf16_f32 v133, v74, v75
    v_accvgpr_read_b32 v76, a12
    v_accvgpr_read_b32 v77, a13
    v_mfma_f32_16x16x32_bf16 a[68:71], a[224:227], v[92:95], a[68:71]
    s_waitcnt lgkmcnt(12)
    ds_read_b64_tr_b16 a[192:193], v116 offset:49152
    buffer_load_dwordx4 a[188:191], v1, s[60:63], s18 offen offset:3072 sc1
    v_mfma_f32_16x16x32_bf16 a[76:79], a[228:231], v[92:95], a[76:79]
    s_add_u32 s18, s18, 4096
    ds_read_b64_tr_b16 a[194:195], v116 offset:51200
    v_accvgpr_read_b32 v78, a14
    v_accvgpr_read_b32 v79, a15
    v_mfma_f32_16x16x32_bf16 a[72:75], a[228:231], v[88:91], a[72:75]
    s_waitcnt lgkmcnt(12)
    ds_read_b64_tr_b16 a[196:197], v117 offset:49152
    v_cvt_pk_bf16_f32 v134, v76, v77
    v_cvt_pk_bf16_f32 v135, v78, v79
    v_mfma_f32_16x16x32_bf16 a[80:83], a[232:235], v[88:91], a[80:83]
    ds_read_b64_tr_b16 a[198:199], v117 offset:51200
    v_accvgpr_read_b32 v64, a16
    v_accvgpr_read_b32 v65, a17
    v_accvgpr_read_b32 v66, a18
    v_accvgpr_read_b32 v67, a19
    v_cvt_pk_bf16_f32 v136, v64, v65
    v_mfma_f32_16x16x32_bf16 a[84:87], a[232:235], v[92:95], a[84:87]
    s_waitcnt lgkmcnt(12)
    ds_read_b64_tr_b16 a[200:201], v118 offset:49152
    buffer_load_dwordx4 v126, s[44:47], s68 offen offset:2048 lds
    v_mfma_f32_16x16x32_bf16 a[92:95], a[236:239], v[92:95], a[92:95]
    ds_read_b64_tr_b16 a[202:203], v118 offset:51200
    v_cvt_pk_bf16_f32 v137, v66, v67
    v_accvgpr_read_b32 v68, a24
    v_accvgpr_read_b32 v69, a25
    v_mfma_f32_16x16x32_bf16 a[88:91], a[236:239], v[88:91], a[88:91]
    s_waitcnt lgkmcnt(12)
    ds_read_b64_tr_b16 a[204:205], v119 offset:49152
    v_accvgpr_read_b32 v70, a26
    v_accvgpr_read_b32 v71, a27
    v_mfma_f32_16x16x32_bf16 a[96:99], a[240:243], v[88:91], a[96:99]
    ds_read_b64_tr_b16 a[206:207], v119 offset:51200
    v_cvt_pk_bf16_f32 v138, v68, v69
    v_cvt_pk_bf16_f32 v139, v70, v71
    v_mfma_f32_16x16x32_bf16 a[100:103], a[240:243], v[92:95], a[100:103]
    s_waitcnt lgkmcnt(12)
    ds_read_b64_tr_b16 a[208:209], v116 offset:53248
    v_accvgpr_read_b32 v72, a20
    v_accvgpr_read_b32 v73, a21
    v_accvgpr_read_b32 v74, a22
    v_mfma_f32_16x16x32_bf16 a[108:111], a[244:247], v[92:95], a[108:111]
    ds_read_b64_tr_b16 a[210:211], v116 offset:55296
    v_accvgpr_read_b32 v75, a23
    v_cvt_pk_bf16_f32 v140, v72, v73
    v_cvt_pk_bf16_f32 v141, v74, v75
    v_accvgpr_read_b32 v76, a28
    v_accvgpr_read_b32 v77, a29
    v_mfma_f32_16x16x32_bf16 a[104:107], a[244:247], v[88:91], a[104:107]
    s_waitcnt lgkmcnt(12)
    ds_read_b64_tr_b16 a[212:213], v117 offset:53248
    buffer_load_dwordx4 v127, s[44:47], s68 offen offset:3072 lds
    v_mfma_f32_16x16x32_bf16 a[112:115], a[248:251], v[88:91], a[112:115]
    ds_read_b64_tr_b16 a[214:215], v117 offset:55296
    v_accvgpr_read_b32 v78, a30
    v_accvgpr_read_b32 v79, a31
    v_mfma_f32_16x16x32_bf16 a[116:119], a[248:251], v[92:95], a[116:119]
    s_waitcnt lgkmcnt(12)
    ds_read_b64_tr_b16 a[216:217], v118 offset:53248
    v_cvt_pk_bf16_f32 v142, v76, v77
    v_cvt_pk_bf16_f32 v143, v78, v79
    v_mfma_f32_16x16x32_bf16 a[124:127], a[252:255], v[92:95], a[124:127]
    ds_read_b64_tr_b16 a[218:219], v118 offset:55296
    v_accvgpr_read_b32 v64, a32
    v_accvgpr_read_b32 v65, a33
    v_accvgpr_read_b32 v66, a34
    v_mfma_f32_16x16x32_bf16 a[120:123], a[252:255], v[88:91], a[120:123]
    s_waitcnt lgkmcnt(12)
    ds_read_b64_tr_b16 a[220:221], v119 offset:53248
    v_accvgpr_read_b32 v67, a35
    v_cvt_pk_bf16_f32 v144, v64, v65
    v_cvt_pk_bf16_f32 v145, v66, v67
    v_accvgpr_read_b32 v68, a40
    v_accvgpr_read_b32 v69, a41
    v_mfma_f32_16x16x32_bf16 v[16:19], a[192:195], v[128:131], 0
    s_add_u32 m0, s67, 81920
    s_add_u32 s69, s81, 114944
    ds_read_b64_tr_b16 a[222:223], v119 offset:55296
    v_accvgpr_read_b32 v70, a42
    v_accvgpr_read_b32 v71, a43
    v_mfma_f32_16x16x32_bf16 v[20:23], a[192:195], v[132:135], 0
    s_waitcnt lgkmcnt(12)
    ds_read_b64_tr_b16 a[224:225], v116 offset:57344
    buffer_load_dwordx4 v124, s[44:47], s69 offen offset:0 lds
    v_mfma_f32_16x16x32_bf16 v[28:31], a[196:199], v[132:135], 0
    ds_read_b64_tr_b16 a[226:227], v116 offset:59392
    v_cvt_pk_bf16_f32 v146, v68, v69
    v_cvt_pk_bf16_f32 v147, v70, v71
    v_mfma_f32_16x16x32_bf16 v[24:27], a[196:199], v[128:131], 0
    s_waitcnt lgkmcnt(12)
    ds_read_b64_tr_b16 a[228:229], v117 offset:57344
    v_accvgpr_read_b32 v72, a36
    v_accvgpr_read_b32 v73, a37
    v_accvgpr_read_b32 v74, a38
    v_mfma_f32_16x16x32_bf16 v[32:35], a[200:203], v[128:131], 0
    ds_read_b64_tr_b16 a[230:231], v117 offset:59392
    v_accvgpr_read_b32 v75, a39
    v_cvt_pk_bf16_f32 v148, v72, v73
    v_mfma_f32_16x16x32_bf16 v[36:39], a[200:203], v[132:135], 0
    s_waitcnt lgkmcnt(12)
    ds_read_b64_tr_b16 a[232:233], v118 offset:57344
    v_cvt_pk_bf16_f32 v149, v74, v75
    v_accvgpr_read_b32 v76, a44
    v_accvgpr_read_b32 v77, a45
    v_mfma_f32_16x16x32_bf16 v[44:47], a[204:207], v[132:135], 0
    ds_read_b64_tr_b16 a[234:235], v118 offset:59392
    v_accvgpr_read_b32 v78, a46
    v_accvgpr_read_b32 v79, a47
    v_cvt_pk_bf16_f32 v150, v76, v77
    v_cvt_pk_bf16_f32 v151, v78, v79
    v_accvgpr_read_b32 v64, a48
    v_accvgpr_read_b32 v65, a49
    v_accvgpr_read_b32 v66, a50
    v_mfma_f32_16x16x32_bf16 v[40:43], a[204:207], v[128:131], 0
    s_waitcnt lgkmcnt(12)
    ds_read_b64_tr_b16 a[236:237], v119 offset:57344
    buffer_load_dwordx4 v125, s[44:47], s69 offen offset:1024 lds
    v_mfma_f32_16x16x32_bf16 v[16:19], a[208:211], v[136:139], v[16:19]
    ds_read_b64_tr_b16 a[238:239], v119 offset:59392
    v_accvgpr_read_b32 v67, a51
    v_cvt_pk_bf16_f32 v152, v64, v65
    v_mfma_f32_16x16x32_bf16 v[20:23], a[208:211], v[140:143], v[20:23]
    s_waitcnt lgkmcnt(12)
    ds_read_b64_tr_b16 a[240:241], v116 offset:61440
    v_cvt_pk_bf16_f32 v153, v66, v67
    v_accvgpr_read_b32 v68, a56
    v_mfma_f32_16x16x32_bf16 v[28:31], a[212:215], v[140:143], v[28:31]
    ds_read_b64_tr_b16 a[242:243], v116 offset:63488
    v_accvgpr_read_b32 v69, a57
    v_accvgpr_read_b32 v70, a58
    v_mfma_f32_16x16x32_bf16 v[24:27], a[212:215], v[136:139], v[24:27]
    s_waitcnt lgkmcnt(12)
    ds_read_b64_tr_b16 a[244:245], v117 offset:61440
    v_accvgpr_read_b32 v71, a59
    v_cvt_pk_bf16_f32 v154, v68, v69
    v_mfma_f32_16x16x32_bf16 v[32:35], a[216:219], v[136:139], v[32:35]
    ds_read_b64_tr_b16 a[246:247], v117 offset:63488
    v_cvt_pk_bf16_f32 v155, v70, v71
    v_accvgpr_read_b32 v72, a52
    v_accvgpr_read_b32 v73, a53
    v_accvgpr_read_b32 v74, a54
    v_accvgpr_read_b32 v75, a55
    v_mfma_f32_16x16x32_bf16 v[36:39], a[216:219], v[140:143], v[36:39]
    s_waitcnt lgkmcnt(12)
    ds_read_b64_tr_b16 a[248:249], v118 offset:61440
    buffer_load_dwordx4 v126, s[44:47], s69 offen offset:2048 lds
    v_mfma_f32_16x16x32_bf16 v[44:47], a[220:223], v[140:143], v[44:47]
    ds_read_b64_tr_b16 a[250:251], v118 offset:63488
    v_cvt_pk_bf16_f32 v156, v72, v73
    v_cvt_pk_bf16_f32 v157, v74, v75
    v_mfma_f32_16x16x32_bf16 v[40:43], a[220:223], v[136:139], v[40:43]
    s_waitcnt lgkmcnt(12)
    ds_read_b64_tr_b16 a[252:253], v119 offset:61440
    v_accvgpr_read_b32 v76, a60
    v_accvgpr_read_b32 v77, a61
    v_mfma_f32_16x16x32_bf16 v[16:19], a[224:227], v[144:147], v[16:19]
    ds_read_b64_tr_b16 a[254:255], v119 offset:63488
    v_accvgpr_read_b32 v78, a62
    v_accvgpr_read_b32 v79, a63
    v_mfma_f32_16x16x32_bf16 v[20:23], a[224:227], v[148:151], v[20:23]
    s_waitcnt lgkmcnt(12)
    ds_read_b64_tr_b16 a[192:193], v120 offset:49152
    v_cvt_pk_bf16_f32 v158, v76, v77
    v_cvt_pk_bf16_f32 v159, v78, v79
    v_mfma_f32_16x16x32_bf16 v[28:31], a[228:231], v[148:151], v[28:31]
    ds_read_b64_tr_b16 a[194:195], v120 offset:51200
    v_accvgpr_read_b32 v64, a64
    v_accvgpr_read_b32 v65, a65
    v_accvgpr_read_b32 v66, a66
    v_accvgpr_read_b32 v67, a67
    v_cvt_pk_bf16_f32 v160, v64, v65
    v_mfma_f32_16x16x32_bf16 v[24:27], a[228:231], v[144:147], v[24:27]
    s_waitcnt lgkmcnt(12)
    ds_read_b64_tr_b16 a[196:197], v121 offset:49152
    buffer_load_dwordx4 v127, s[44:47], s69 offen offset:3072 lds
    v_mfma_f32_16x16x32_bf16 v[32:35], a[232:235], v[144:147], v[32:35]
    ds_read_b64_tr_b16 a[198:199], v121 offset:51200
    v_cvt_pk_bf16_f32 v161, v66, v67
    v_accvgpr_read_b32 v68, a72
    v_accvgpr_read_b32 v69, a73
    v_mfma_f32_16x16x32_bf16 v[36:39], a[232:235], v[148:151], v[36:39]
    s_waitcnt lgkmcnt(12)
    ds_read_b64_tr_b16 a[200:201], v122 offset:49152
    v_accvgpr_read_b32 v70, a74
    v_accvgpr_read_b32 v71, a75
    v_mfma_f32_16x16x32_bf16 v[44:47], a[236:239], v[148:151], v[44:47]
    ds_read_b64_tr_b16 a[202:203], v122 offset:51200
    v_cvt_pk_bf16_f32 v162, v68, v69
    v_cvt_pk_bf16_f32 v163, v70, v71
    v_mfma_f32_16x16x32_bf16 v[40:43], a[236:239], v[144:147], v[40:43]
    s_waitcnt lgkmcnt(12)
    ds_read_b64_tr_b16 a[204:205], v123 offset:49152
    v_accvgpr_read_b32 v72, a68
    v_accvgpr_read_b32 v73, a69
    v_accvgpr_read_b32 v74, a70
    v_mfma_f32_16x16x32_bf16 v[16:19], a[240:243], v[152:155], v[16:19]
    ds_read_b64_tr_b16 a[206:207], v123 offset:51200
    v_accvgpr_read_b32 v75, a71
    v_cvt_pk_bf16_f32 v164, v72, v73
    v_mfma_f32_16x16x32_bf16 v[20:23], a[240:243], v[156:159], v[20:23]
    s_waitcnt lgkmcnt(12)
    ds_read_b64_tr_b16 a[208:209], v120 offset:53248
    v_cvt_pk_bf16_f32 v165, v74, v75
    v_accvgpr_read_b32 v76, a76
    v_accvgpr_read_b32 v77, a77
    v_mfma_f32_16x16x32_bf16 v[28:31], a[244:247], v[156:159], v[28:31]
    ds_read_b64_tr_b16 a[210:211], v120 offset:55296
    v_accvgpr_read_b32 v78, a78
    v_accvgpr_read_b32 v79, a79
    v_mfma_f32_16x16x32_bf16 v[24:27], a[244:247], v[152:155], v[24:27]
    s_waitcnt lgkmcnt(12)
    ds_read_b64_tr_b16 a[212:213], v121 offset:53248
    v_cvt_pk_bf16_f32 v166, v76, v77
    v_cvt_pk_bf16_f32 v167, v78, v79
    v_mfma_f32_16x16x32_bf16 v[32:35], a[248:251], v[152:155], v[32:35]
    ds_read_b64_tr_b16 a[214:215], v121 offset:55296
    v_accvgpr_read_b32 v64, a80
    v_accvgpr_read_b32 v65, a81
    v_accvgpr_read_b32 v66, a82
    v_mfma_f32_16x16x32_bf16 v[36:39], a[248:251], v[156:159], v[36:39]
    s_waitcnt lgkmcnt(12)
    ds_read_b64_tr_b16 a[216:217], v122 offset:53248
    v_accvgpr_read_b32 v67, a83
    v_cvt_pk_bf16_f32 v168, v64, v65
    v_mfma_f32_16x16x32_bf16 v[44:47], a[252:255], v[156:159], v[44:47]
    ds_read_b64_tr_b16 a[218:219], v122 offset:55296
    v_cvt_pk_bf16_f32 v169, v66, v67
    v_accvgpr_read_b32 v68, a88
    v_accvgpr_read_b32 v69, a89
    v_mfma_f32_16x16x32_bf16 v[40:43], a[252:255], v[152:155], v[40:43]
    s_waitcnt lgkmcnt(12)
    ds_read_b64_tr_b16 a[220:221], v123 offset:53248
    v_accvgpr_read_b32 v70, a90
    v_accvgpr_read_b32 v71, a91
    v_mfma_f32_16x16x32_bf16 v[16:19], a[192:195], v[160:163], v[16:19]
    ds_read_b64_tr_b16 a[222:223], v123 offset:55296
    v_cvt_pk_bf16_f32 v170, v68, v69
    v_cvt_pk_bf16_f32 v171, v70, v71
    v_mfma_f32_16x16x32_bf16 v[20:23], a[192:195], v[164:167], v[20:23]
    s_waitcnt lgkmcnt(12)
    ds_read_b64_tr_b16 a[224:225], v120 offset:57344
    v_accvgpr_read_b32 v72, a84
    v_accvgpr_read_b32 v73, a85
    v_accvgpr_read_b32 v74, a86
    v_mfma_f32_16x16x32_bf16 v[28:31], a[196:199], v[164:167], v[28:31]
    ds_read_b64_tr_b16 a[226:227], v120 offset:59392
    v_accvgpr_read_b32 v75, a87
    v_cvt_pk_bf16_f32 v172, v72, v73
    v_mfma_f32_16x16x32_bf16 v[24:27], a[196:199], v[160:163], v[24:27]
    s_waitcnt lgkmcnt(12)
    ds_read_b64_tr_b16 a[228:229], v121 offset:57344
    v_cvt_pk_bf16_f32 v173, v74, v75
    v_accvgpr_read_b32 v76, a92
    v_accvgpr_read_b32 v77, a93
    v_mfma_f32_16x16x32_bf16 v[32:35], a[200:203], v[160:163], v[32:35]
    ds_read_b64_tr_b16 a[230:231], v121 offset:59392
    v_accvgpr_read_b32 v78, a94
    v_accvgpr_read_b32 v79, a95
    v_mfma_f32_16x16x32_bf16 v[36:39], a[200:203], v[164:167], v[36:39]
    s_waitcnt lgkmcnt(12)
    ds_read_b64_tr_b16 a[232:233], v122 offset:57344
    v_cvt_pk_bf16_f32 v174, v76, v77
    v_cvt_pk_bf16_f32 v175, v78, v79
    v_accvgpr_read_b32 v64, a96
    v_accvgpr_read_b32 v65, a97
    v_accvgpr_read_b32 v66, a98
    v_mfma_f32_16x16x32_bf16 v[44:47], a[204:207], v[164:167], v[44:47]
    s_waitcnt vmcnt(10)
    s_barrier
    ds_read_b64_tr_b16 a[234:235], v122 offset:59392
    v_mfma_f32_16x16x32_bf16 v[40:43], a[204:207], v[160:163], v[40:43]
    s_waitcnt lgkmcnt(12)
    ds_read_b64_tr_b16 a[236:237], v123 offset:57344
    v_accvgpr_read_b32 v67, a99
    v_cvt_pk_bf16_f32 v176, v64, v65
    v_cvt_pk_bf16_f32 v177, v66, v67
    v_accvgpr_read_b32 v68, a104
    v_accvgpr_read_b32 v69, a105
    v_mfma_f32_16x16x32_bf16 v[16:19], a[208:211], v[168:171], v[16:19]
    s_add_u32 m0, s67, 32768
    s_add_u32 s68, s81, 384
    ds_read_b64_tr_b16 a[238:239], v123 offset:59392
    v_accvgpr_read_b32 v70, a106
    v_accvgpr_read_b32 v71, a107
    v_cvt_pk_bf16_f32 v178, v68, v69
    v_mfma_f32_16x16x32_bf16 v[20:23], a[208:211], v[172:175], v[20:23]
    s_waitcnt lgkmcnt(12)
    ds_read_b64_tr_b16 a[240:241], v120 offset:61440
    buffer_load_dwordx4 v124, s[44:47], s68 offen offset:0 lds
    v_mfma_f32_16x16x32_bf16 v[28:31], a[212:215], v[172:175], v[28:31]
    ds_read_b64_tr_b16 a[242:243], v120 offset:63488
    v_cvt_pk_bf16_f32 v179, v70, v71
    v_accvgpr_read_b32 v72, a100
    v_accvgpr_read_b32 v73, a101
    v_mfma_f32_16x16x32_bf16 v[24:27], a[212:215], v[168:171], v[24:27]
    s_waitcnt lgkmcnt(12)
    ds_read_b64_tr_b16 a[244:245], v121 offset:61440
    v_accvgpr_read_b32 v74, a102
    v_accvgpr_read_b32 v75, a103
    v_mfma_f32_16x16x32_bf16 v[32:35], a[216:219], v[168:171], v[32:35]
    ds_read_b64_tr_b16 a[246:247], v121 offset:63488
    v_cvt_pk_bf16_f32 v180, v72, v73
    v_cvt_pk_bf16_f32 v181, v74, v75
    v_accvgpr_read_b32 v76, a108
    v_mfma_f32_16x16x32_bf16 v[36:39], a[216:219], v[172:175], v[36:39]
    s_waitcnt lgkmcnt(12)
    ds_read_b64_tr_b16 a[248:249], v122 offset:61440
    v_accvgpr_read_b32 v77, a109
    v_accvgpr_read_b32 v78, a110
    v_accvgpr_read_b32 v79, a111
    v_mfma_f32_16x16x32_bf16 v[44:47], a[220:223], v[172:175], v[44:47]
    ds_read_b64_tr_b16 a[250:251], v122 offset:63488
    v_cvt_pk_bf16_f32 v182, v76, v77
    v_cvt_pk_bf16_f32 v183, v78, v79
    v_accvgpr_read_b32 v64, a112
    v_accvgpr_read_b32 v65, a113
    v_accvgpr_read_b32 v66, a114
    v_mfma_f32_16x16x32_bf16 v[40:43], a[220:223], v[168:171], v[40:43]
    s_waitcnt lgkmcnt(12)
    ds_read_b64_tr_b16 a[252:253], v123 offset:61440
    buffer_load_dwordx4 v125, s[44:47], s68 offen offset:1024 lds
    v_mfma_f32_16x16x32_bf16 v[16:19], a[224:227], v[176:179], v[16:19]
    ds_read_b64_tr_b16 a[254:255], v123 offset:63488
    v_accvgpr_read_b32 v67, a115
    v_cvt_pk_bf16_f32 v184, v64, v65
    v_cvt_pk_bf16_f32 v185, v66, v67
    v_mfma_f32_16x16x32_bf16 v[20:23], a[224:227], v[180:183], v[20:23]
    s_waitcnt lgkmcnt(12)
    ds_read_b64_tr_b16 a[192:193], v116 offset:0
    v_accvgpr_read_b32 v68, a120
    v_accvgpr_read_b32 v69, a121
    v_accvgpr_read_b32 v70, a122
    v_mfma_f32_16x16x32_bf16 v[28:31], a[228:231], v[180:183], v[28:31]
    ds_read_b64_tr_b16 a[194:195], v116 offset:2048
    v_accvgpr_read_b32 v71, a123
    v_cvt_pk_bf16_f32 v186, v68, v69
    v_cvt_pk_bf16_f32 v187, v70, v71
    v_mfma_f32_16x16x32_bf16 v[24:27], a[228:231], v[176:179], v[24:27]
    s_waitcnt lgkmcnt(12)
    ds_read_b64_tr_b16 a[196:197], v116 offset:4096
    v_accvgpr_read_b32 v72, a116
    v_accvgpr_read_b32 v73, a117
    v_accvgpr_read_b32 v74, a118
    v_mfma_f32_16x16x32_bf16 v[32:35], a[232:235], v[176:179], v[32:35]
    ds_read_b64_tr_b16 a[198:199], v116 offset:6144
    v_accvgpr_read_b32 v75, a119
    v_cvt_pk_bf16_f32 v188, v72, v73
    v_cvt_pk_bf16_f32 v189, v74, v75
    v_accvgpr_read_b32 v76, a124
    v_accvgpr_read_b32 v77, a125
    v_accvgpr_read_b32 v78, a126
    v_mfma_f32_16x16x32_bf16 v[36:39], a[232:235], v[180:183], v[36:39]
    s_waitcnt lgkmcnt(12)
    ds_read_b64_tr_b16 a[200:201], v116 offset:8192
    buffer_load_dwordx4 v126, s[44:47], s68 offen offset:2048 lds
    v_mfma_f32_16x16x32_bf16 v[44:47], a[236:239], v[180:183], v[44:47]
    ds_read_b64_tr_b16 a[202:203], v116 offset:10240
    v_accvgpr_read_b32 v79, a127
    v_cvt_pk_bf16_f32 v190, v76, v77
    v_cvt_pk_bf16_f32 v191, v78, v79
    v_mfma_f32_16x16x32_bf16 v[40:43], a[236:239], v[176:179], v[40:43]
    s_waitcnt lgkmcnt(12)
    ds_read_b64_tr_b16 a[204:205], v116 offset:12288
    v_mfma_f32_16x16x32_bf16 v[16:19], a[240:243], v[184:187], v[16:19]
    ds_read_b64_tr_b16 a[206:207], v116 offset:14336
    v_mfma_f32_16x16x32_bf16 v[20:23], a[240:243], v[188:191], v[20:23]
    s_waitcnt lgkmcnt(12)
    ds_read_b64_tr_b16 a[208:209], v120 offset:0
    v_mfma_f32_16x16x32_bf16 v[28:31], a[244:247], v[188:191], v[28:31]
    ds_read_b64_tr_b16 a[210:211], v120 offset:2048
    v_mfma_f32_16x16x32_bf16 v[24:27], a[244:247], v[184:187], v[24:27]
    s_waitcnt lgkmcnt(12)
    ds_read_b64_tr_b16 a[212:213], v120 offset:4096
    buffer_load_dwordx4 v127, s[44:47], s68 offen offset:3072 lds
    v_mfma_f32_16x16x32_bf16 v[32:35], a[248:251], v[184:187], v[32:35]
    ds_read_b64_tr_b16 a[214:215], v120 offset:6144
    v_mfma_f32_16x16x32_bf16 v[36:39], a[248:251], v[188:191], v[36:39]
    s_waitcnt lgkmcnt(12)
    ds_read_b64_tr_b16 a[216:217], v120 offset:8192
    v_mfma_f32_16x16x32_bf16 v[44:47], a[252:255], v[188:191], v[44:47]
    ds_read_b64_tr_b16 a[218:219], v120 offset:10240
    v_mul_f32 v16, v16, v60
    v_mfma_f32_16x16x32_bf16 v[40:43], a[252:255], v[184:187], v[40:43]
    s_waitcnt lgkmcnt(12)
    ds_read_b64_tr_b16 a[220:221], v120 offset:12288
    v_mul_f32 v17, v17, v60
    v_mul_f32 v18, v18, v60
    v_mfma_f32_16x16x32_bf16 v[64:67], a[192:195], v[128:131], 0
    s_waitcnt lgkmcnt(11)
    s_add_u32 m0, s67, 98304
    ds_read_b64_tr_b16 a[222:223], v120 offset:14336
    v_mul_f32 v19, v19, v60
    v_mfma_f32_16x16x32_bf16 v[64:67], a[196:199], v[136:139], v[64:67]
    s_waitcnt lgkmcnt(10)
    s_add_u32 s69, s81, 115072
    ds_read_b64_tr_b16 a[224:225], v117 offset:0
    v_mfma_f32_16x16x32_bf16 v[64:67], a[200:203], v[144:147], v[64:67]
    s_waitcnt lgkmcnt(9)
    ds_read_b64_tr_b16 a[226:227], v117 offset:2048
    buffer_load_dwordx4 v124, s[44:47], s69 offen offset:0 lds
    v_mfma_f32_16x16x32_bf16 v[64:67], a[204:207], v[152:155], v[64:67]
    ds_read_b64_tr_b16 a[228:229], v117 offset:4096
    v_lshrrev_b32 v100, 8, v1
    v_mfma_f32_16x16x32_bf16 v[68:71], a[204:207], v[156:159], 0
    ds_read_b64_tr_b16 a[230:231], v117 offset:6144
    v_bfe_u32 v101, v1, 5, 3
    v_mfma_f32_16x16x32_bf16 v[68:71], a[200:203], v[148:151], v[68:71]
    ds_read_b64_tr_b16 a[232:233], v117 offset:8192
    v_mul_f32 v20, v20, v61
    v_mfma_f32_16x16x32_bf16 v[68:71], a[196:199], v[140:143], v[68:71]
    ds_read_b64_tr_b16 a[234:235], v117 offset:10240
    v_mul_f32 v21, v21, v61
    v_mul_f32 v22, v22, v61
    v_mul_f32 v23, v23, v61
    v_mfma_f32_16x16x32_bf16 v[68:71], a[192:195], v[132:135], v[68:71]
    s_waitcnt lgkmcnt(12)
    ds_read_b64_tr_b16 a[236:237], v117 offset:12288
    buffer_load_dwordx4 v125, s[44:47], s69 offen offset:1024 lds
    v_mfma_f32_16x16x32_bf16 v[64:67], a[208:211], v[160:163], v[64:67]
    s_waitcnt lgkmcnt(11)
    ds_read_b64_tr_b16 a[238:239], v117 offset:14336
    v_mul_u32_u24 v102, 896, v100
    v_mfma_f32_16x16x32_bf16 v[64:67], a[212:215], v[168:171], v[64:67]
    s_waitcnt lgkmcnt(10)
    ds_read_b64_tr_b16 a[240:241], v121 offset:0
    v_cvt_pk_bf16_f32 v8, v16, v17
    v_cvt_pk_bf16_f32 v9, v18, v19
    v_mfma_f32_16x16x32_bf16 v[64:67], a[216:219], v[176:179], v[64:67]
    s_waitcnt lgkmcnt(9)
    ds_read_b64_tr_b16 a[242:243], v121 offset:2048
    v_and_b32 v103, 16, v1
    v_mfma_f32_16x16x32_bf16 v[64:67], a[220:223], v[184:187], v[64:67]
    ds_read_b64_tr_b16 a[244:245], v121 offset:4096
    v_cvt_pk_bf16_f32 v10, v20, v21
    v_cvt_pk_bf16_f32 v11, v22, v23
    buffer_store_dwordx4 v[8:11], v1, s[60:63], s75 offen sc1
    s_add_u32 s75, s75, 16384
    v_mfma_f32_16x16x32_bf16 v[68:71], a[220:223], v[188:191], v[68:71]
    ds_read_b64_tr_b16 a[246:247], v121 offset:6144
    v_mul_f32 v24, v24, v60
    v_mfma_f32_16x16x32_bf16 v[68:71], a[216:219], v[180:183], v[68:71]
    ds_read_b64_tr_b16 a[248:249], v121 offset:8192
    buffer_load_dwordx4 v126, s[44:47], s69 offen offset:2048 lds
    v_mfma_f32_16x16x32_bf16 v[68:71], a[212:215], v[172:175], v[68:71]
    ds_read_b64_tr_b16 a[250:251], v121 offset:10240
    v_add_u32 v102, v102, v103
    v_mfma_f32_16x16x32_bf16 v[68:71], a[208:211], v[164:167], v[68:71]
    s_waitcnt lgkmcnt(12)
    ds_read_b64_tr_b16 a[252:253], v121 offset:12288
    v_mul_f32 v25, v25, v60
    v_mfma_f32_16x16x32_bf16 v[72:75], a[224:227], v[128:131], 0
    s_waitcnt lgkmcnt(11)
    ds_read_b64_tr_b16 a[254:255], v121 offset:14336
    v_mul_f32 v26, v26, v60
    v_mfma_f32_16x16x32_bf16 v[72:75], a[228:231], v[136:139], v[72:75]
    s_waitcnt lgkmcnt(10)
    ds_read_b64_tr_b16 a[192:193], v118 offset:0
    v_add_u32 v103, 0, v100
    v_mfma_f32_16x16x32_bf16 v[72:75], a[232:235], v[144:147], v[72:75]
    s_waitcnt lgkmcnt(9)
    ds_read_b64_tr_b16 a[194:195], v118 offset:2048
    v_mul_f32 v27, v27, v60
    v_mul_f32 v28, v28, v61
    v_mul_f32 v29, v29, v61
    v_mfma_f32_16x16x32_bf16 v[72:75], a[236:239], v[152:155], v[72:75]
    ds_read_b64_tr_b16 a[196:197], v118 offset:4096
    buffer_load_dwordx4 v127, s[44:47], s69 offen offset:3072 lds
    v_mfma_f32_16x16x32_bf16 v[76:79], a[236:239], v[156:159], 0
    ds_read_b64_tr_b16 a[198:199], v118 offset:6144
    v_xor_b32 v103, v103, v101
    v_mfma_f32_16x16x32_bf16 v[76:79], a[232:235], v[148:151], v[76:79]
    ds_read_b64_tr_b16 a[200:201], v118 offset:8192
    v_mul_f32 v30, v30, v61
    v_mfma_f32_16x16x32_bf16 v[76:79], a[228:231], v[140:143], v[76:79]
    ds_read_b64_tr_b16 a[202:203], v118 offset:10240
    v_mul_f32 v31, v31, v61
    v_cvt_pk_bf16_f32 v12, v24, v25
    v_mfma_f32_16x16x32_bf16 v[76:79], a[224:227], v[132:135], v[76:79]
    s_waitcnt lgkmcnt(12)
    ds_read_b64_tr_b16 a[204:205], v118 offset:12288
    v_and_b32 v103, s17, v103
    v_mfma_f32_16x16x32_bf16 v[72:75], a[240:243], v[160:163], v[72:75]
    s_waitcnt lgkmcnt(11)
    ds_read_b64_tr_b16 a[206:207], v118 offset:14336
    v_cvt_pk_bf16_f32 v13, v26, v27
    v_mfma_f32_16x16x32_bf16 v[72:75], a[244:247], v[168:171], v[72:75]
    s_waitcnt lgkmcnt(10)
    ds_read_b64_tr_b16 a[208:209], v122 offset:0
    v_cvt_pk_bf16_f32 v14, v28, v29
    v_cvt_pk_bf16_f32 v15, v30, v31
    buffer_store_dwordx4 v[12:15], v1, s[60:63], s75 offen sc1
    s_add_u32 s75, s75, 16384
    v_mfma_f32_16x16x32_bf16 v[72:75], a[248:251], v[176:179], v[72:75]
    s_waitcnt lgkmcnt(9)
    ds_read_b64_tr_b16 a[210:211], v122 offset:2048
    v_mul_f32 v32, v32, v60
    v_mfma_f32_16x16x32_bf16 v[72:75], a[252:255], v[184:187], v[72:75]
    ds_read_b64_tr_b16 a[212:213], v122 offset:4096
    v_lshl_add_u32 v103, v103, 5, v102
    v_mfma_f32_16x16x32_bf16 v[76:79], a[252:255], v[188:191], v[76:79]
    ds_read_b64_tr_b16 a[214:215], v122 offset:6144
    v_mul_f32 v33, v33, v60
    v_mfma_f32_16x16x32_bf16 v[76:79], a[248:251], v[180:183], v[76:79]
    ds_read_b64_tr_b16 a[216:217], v122 offset:8192
    v_mul_f32 v34, v34, v60
    v_mfma_f32_16x16x32_bf16 v[76:79], a[244:247], v[172:175], v[76:79]
    ds_read_b64_tr_b16 a[218:219], v122 offset:10240
    v_add_u32 v96, 0, v103
    v_mfma_f32_16x16x32_bf16 v[76:79], a[240:243], v[164:167], v[76:79]
    s_waitcnt lgkmcnt(12)
    ds_read_b64_tr_b16 a[220:221], v122 offset:12288
    v_mul_f32 v35, v35, v60
    v_mfma_f32_16x16x32_bf16 v[80:83], a[192:195], v[128:131], 0
    s_waitcnt lgkmcnt(11)
    ds_read_b64_tr_b16 a[222:223], v122 offset:14336
    v_mul_f32 v36, v36, v61
    v_mfma_f32_16x16x32_bf16 v[80:83], a[196:199], v[136:139], v[80:83]
    s_waitcnt lgkmcnt(10)
    ds_read_b64_tr_b16 a[224:225], v119 offset:0
    v_add_u32 v103, 4, v100
    v_mfma_f32_16x16x32_bf16 v[80:83], a[200:203], v[144:147], v[80:83]
    s_waitcnt lgkmcnt(9)
    ds_read_b64_tr_b16 a[226:227], v119 offset:2048
    v_mul_f32 v37, v37, v61
    v_mfma_f32_16x16x32_bf16 v[80:83], a[204:207], v[152:155], v[80:83]
    ds_read_b64_tr_b16 a[228:229], v119 offset:4096
    v_mul_f32 v38, v38, v61
    v_mfma_f32_16x16x32_bf16 v[84:87], a[204:207], v[156:159], 0
    ds_read_b64_tr_b16 a[230:231], v119 offset:6144
    v_mul_f32 v39, v39, v61
    v_cvt_pk_bf16_f32 v8, v32, v33
    v_cvt_pk_bf16_f32 v9, v34, v35
    v_mfma_f32_16x16x32_bf16 v[84:87], a[200:203], v[148:151], v[84:87]
    ds_read_b64_tr_b16 a[232:233], v119 offset:8192
    v_xor_b32 v103, v103, v101
    v_mfma_f32_16x16x32_bf16 v[84:87], a[196:199], v[140:143], v[84:87]
    s_waitcnt vmcnt(10)
    s_barrier
    ds_read_b64_tr_b16 a[234:235], v119 offset:10240
    v_mfma_f32_16x16x32_bf16 v[84:87], a[192:195], v[132:135], v[84:87]
    s_waitcnt lgkmcnt(12)
    ds_read_b64_tr_b16 a[236:237], v119 offset:12288
    v_cvt_pk_bf16_f32 v10, v36, v37
    v_cvt_pk_bf16_f32 v11, v38, v39
    buffer_store_dwordx4 v[8:11], v1, s[60:63], s75 offen sc1
    s_add_u32 s75, s75, 16384
    v_mfma_f32_16x16x32_bf16 v[80:83], a[208:211], v[160:163], v[80:83]
    s_waitcnt lgkmcnt(11)
    s_add_u32 m0, s67, 49152
    ds_read_b64_tr_b16 a[238:239], v119 offset:14336
    v_mul_f32 v40, v40, v60
    v_mul_f32 v41, v41, v60
    v_mfma_f32_16x16x32_bf16 v[80:83], a[212:215], v[168:171], v[80:83]
    s_waitcnt lgkmcnt(10)
    s_add_u32 s68, s81, 512
    ds_read_b64_tr_b16 a[240:241], v123 offset:0
    v_mfma_f32_16x16x32_bf16 v[80:83], a[216:219], v[176:179], v[80:83]
    s_waitcnt lgkmcnt(9)
    ds_read_b64_tr_b16 a[242:243], v123 offset:2048
    buffer_load_dwordx4 v124, s[44:47], s68 offen offset:0 lds
    v_mfma_f32_16x16x32_bf16 v[80:83], a[220:223], v[184:187], v[80:83]
    ds_read_b64_tr_b16 a[244:245], v123 offset:4096
    v_and_b32 v103, s17, v103
    v_mfma_f32_16x16x32_bf16 v[84:87], a[220:223], v[188:191], v[84:87]
    ds_read_b64_tr_b16 a[246:247], v123 offset:6144
    v_lshl_add_u32 v103, v103, 5, v102
    v_mfma_f32_16x16x32_bf16 v[84:87], a[216:219], v[180:183], v[84:87]
    ds_read_b64_tr_b16 a[248:249], v123 offset:8192
    v_mul_f32 v42, v42, v60
    v_mul_f32 v43, v43, v60
    v_mul_f32 v44, v44, v61
    v_mfma_f32_16x16x32_bf16 v[84:87], a[212:215], v[172:175], v[84:87]
    ds_read_b64_tr_b16 a[250:251], v123 offset:10240
    v_add_u32 v97, 2560, v103
    v_mfma_f32_16x16x32_bf16 v[84:87], a[208:211], v[164:167], v[84:87]
    s_waitcnt lgkmcnt(12)
    ds_read_b64_tr_b16 a[252:253], v123 offset:12288
    buffer_load_dwordx4 v125, s[44:47], s68 offen offset:1024 lds
    v_mfma_f32_16x16x32_bf16 v[88:91], a[224:227], v[128:131], 0
    s_waitcnt lgkmcnt(11)
    ds_read_b64_tr_b16 a[254:255], v123 offset:14336
    v_mul_f32 v45, v45, v61
    v_mfma_f32_16x16x32_bf16 v[88:91], a[228:231], v[136:139], v[88:91]
    s_waitcnt lgkmcnt(10)
    ds_read_b64_tr_b16 a[192:193], v116 offset:16384
    v_mul_f32 v46, v46, v61
    v_mul_f32 v47, v47, v61
    v_mfma_f32_16x16x32_bf16 v[88:91], a[232:235], v[144:147], v[88:91]
    s_waitcnt lgkmcnt(9)
    ds_read_b64_tr_b16 a[194:195], v116 offset:18432
    v_add_u32 v103, 0, v100
    v_mfma_f32_16x16x32_bf16 v[88:91], a[236:239], v[152:155], v[88:91]
    ds_read_b64_tr_b16 a[196:197], v116 offset:20480
    v_cvt_pk_bf16_f32 v12, v40, v41
    v_mfma_f32_16x16x32_bf16 v[92:95], a[236:239], v[156:159], 0
    ds_read_b64_tr_b16 a[198:199], v116 offset:22528
    v_cvt_pk_bf16_f32 v13, v42, v43
    v_cvt_pk_bf16_f32 v14, v44, v45
    v_cvt_pk_bf16_f32 v15, v46, v47
    v_mfma_f32_16x16x32_bf16 v[92:95], a[232:235], v[148:151], v[92:95]
    ds_read_b64_tr_b16 a[200:201], v116 offset:24576
    buffer_load_dwordx4 v126, s[44:47], s68 offen offset:2048 lds
    buffer_store_dwordx4 v[12:15], v1, s[60:63], s75 offen sc1
    s_add_u32 s75, s75, 16384
    v_mfma_f32_16x16x32_bf16 v[92:95], a[228:231], v[140:143], v[92:95]
    ds_read_b64_tr_b16 a[202:203], v116 offset:26624
    v_xor_b32 v103, v103, v101
    v_mfma_f32_16x16x32_bf16 v[92:95], a[224:227], v[132:135], v[92:95]
    s_waitcnt lgkmcnt(12)
    ds_read_b64_tr_b16 a[204:205], v116 offset:28672
    v_mul_f32 v64, v64, v60
    v_mfma_f32_16x16x32_bf16 v[88:91], a[240:243], v[160:163], v[88:91]
    s_waitcnt lgkmcnt(11)
    ds_read_b64_tr_b16 a[206:207], v116 offset:30720
    v_and_b32 v103, s17, v103
    v_mfma_f32_16x16x32_bf16 v[88:91], a[244:247], v[168:171], v[88:91]
    s_waitcnt lgkmcnt(10)
    ds_read_b64_tr_b16 a[208:209], v120 offset:16384
    v_mul_f32 v65, v65, v60
    v_mfma_f32_16x16x32_bf16 v[88:91], a[248:251], v[176:179], v[88:91]
    s_waitcnt lgkmcnt(9)
    ds_read_b64_tr_b16 a[210:211], v120 offset:18432
    v_mul_f32 v66, v66, v60
    v_mul_f32 v67, v67, v60
    v_mfma_f32_16x16x32_bf16 v[88:91], a[252:255], v[184:187], v[88:91]
    ds_read_b64_tr_b16 a[212:213], v120 offset:20480
    buffer_load_dwordx4 v127, s[44:47], s68 offen offset:3072 lds
    v_mfma_f32_16x16x32_bf16 v[92:95], a[252:255], v[188:191], v[92:95]
    ds_read_b64_tr_b16 a[214:215], v120 offset:22528
    v_lshl_add_u32 v103, v103, 5, v102
    v_mfma_f32_16x16x32_bf16 v[92:95], a[248:251], v[180:183], v[92:95]
    ds_read_b64_tr_b16 a[216:217], v120 offset:24576
    v_mul_f32 v68, v68, v61
    v_mfma_f32_16x16x32_bf16 v[92:95], a[244:247], v[172:175], v[92:95]
    ds_read_b64_tr_b16 a[218:219], v120 offset:26624
    v_mul_f32 v69, v69, v61
    v_mul_f32 v70, v70, v61
    v_mul_f32 v71, v71, v61
    v_cvt_pk_bf16_f32 v8, v64, v65
    v_cvt_pk_bf16_f32 v9, v66, v67
    v_mfma_f32_16x16x32_bf16 v[92:95], a[240:243], v[164:167], v[92:95]
    s_waitcnt lgkmcnt(12)
    ds_read_b64_tr_b16 a[220:221], v120 offset:28672
    v_add_u32 v98, 5120, v103
    v_cvt_pk_bf16_f32 v10, v68, v69
    v_mfma_f32_16x16x32_bf16 v[16:19], a[192:195], v[128:131], 0
    s_waitcnt lgkmcnt(11)
    s_add_u32 m0, s67, 114688
    ds_read_b64_tr_b16 a[222:223], v120 offset:30720
    v_cvt_pk_bf16_f32 v11, v70, v71
    v_mfma_f32_16x16x32_bf16 v[16:19], a[196:199], v[136:139], v[16:19]
    s_waitcnt lgkmcnt(10)
    s_add_u32 s69, s81, 115200
    ds_read_b64_tr_b16 a[224:225], v117 offset:16384
    buffer_store_dwordx4 v[8:11], v1, s[60:63], s75 offen sc1
    v_mfma_f32_16x16x32_bf16 v[16:19], a[200:203], v[144:147], v[16:19]
    s_waitcnt lgkmcnt(9)
    ds_read_b64_tr_b16 a[226:227], v117 offset:18432
    buffer_load_dwordx4 v124, s[44:47], s69 offen offset:0 lds
    v_mfma_f32_16x16x32_bf16 v[16:19], a[204:207], v[152:155], v[16:19]
    s_add_u32 s75, s75, 16384
    ds_read_b64_tr_b16 a[228:229], v117 offset:20480
    v_add_u32 v103, 4, v100
    v_mfma_f32_16x16x32_bf16 v[20:23], a[204:207], v[156:159], 0
    ds_read_b64_tr_b16 a[230:231], v117 offset:22528
    v_mul_f32 v72, v72, v60
    v_mfma_f32_16x16x32_bf16 v[20:23], a[200:203], v[148:151], v[20:23]
    ds_read_b64_tr_b16 a[232:233], v117 offset:24576
    v_xor_b32 v103, v103, v101
    v_mfma_f32_16x16x32_bf16 v[20:23], a[196:199], v[140:143], v[20:23]
    ds_read_b64_tr_b16 a[234:235], v117 offset:26624
    v_mul_f32 v73, v73, v60
    v_mfma_f32_16x16x32_bf16 v[20:23], a[192:195], v[132:135], v[20:23]
    s_waitcnt lgkmcnt(12)
    ds_read_b64_tr_b16 a[236:237], v117 offset:28672
    buffer_load_dwordx4 v125, s[44:47], s69 offen offset:1024 lds
    v_mfma_f32_16x16x32_bf16 v[16:19], a[208:211], v[160:163], v[16:19]
    s_waitcnt lgkmcnt(11)
    ds_read_b64_tr_b16 a[238:239], v117 offset:30720
    v_mul_f32 v74, v74, v60
    v_mfma_f32_16x16x32_bf16 v[16:19], a[212:215], v[168:171], v[16:19]
    s_waitcnt lgkmcnt(10)
    ds_read_b64_tr_b16 a[240:241], v121 offset:16384
    v_and_b32 v103, s17, v103
    v_mfma_f32_16x16x32_bf16 v[16:19], a[216:219], v[176:179], v[16:19]
    s_waitcnt lgkmcnt(9)
    ds_read_b64_tr_b16 a[242:243], v121 offset:18432
    v_mul_f32 v75, v75, v60
    v_mfma_f32_16x16x32_bf16 v[16:19], a[220:223], v[184:187], v[16:19]
    ds_read_b64_tr_b16 a[244:245], v121 offset:20480
    v_mul_f32 v76, v76, v61
    v_mul_f32 v77, v77, v61
    v_mul_f32 v78, v78, v61
    v_mfma_f32_16x16x32_bf16 v[20:23], a[220:223], v[188:191], v[20:23]
    ds_read_b64_tr_b16 a[246:247], v121 offset:22528
    v_lshl_add_u32 v103, v103, 5, v102
    v_mfma_f32_16x16x32_bf16 v[20:23], a[216:219], v[180:183], v[20:23]
    ds_read_b64_tr_b16 a[248:249], v121 offset:24576
    buffer_load_dwordx4 v126, s[44:47], s69 offen offset:2048 lds
    v_mfma_f32_16x16x32_bf16 v[20:23], a[212:215], v[172:175], v[20:23]
    ds_read_b64_tr_b16 a[250:251], v121 offset:26624
    v_mul_f32 v79, v79, v61
    v_cvt_pk_bf16_f32 v12, v72, v73
    v_mfma_f32_16x16x32_bf16 v[20:23], a[208:211], v[164:167], v[20:23]
    s_waitcnt lgkmcnt(12)
    ds_read_b64_tr_b16 a[252:253], v121 offset:28672
    v_add_u32 v99, 7680, v103
    v_mfma_f32_16x16x32_bf16 v[24:27], a[224:227], v[128:131], 0
    s_waitcnt lgkmcnt(11)
    ds_read_b64_tr_b16 a[254:255], v121 offset:30720
    v_cvt_pk_bf16_f32 v13, v74, v75
    v_mfma_f32_16x16x32_bf16 v[24:27], a[228:231], v[136:139], v[24:27]
    s_waitcnt lgkmcnt(10)
    ds_read_b64_tr_b16 a[192:193], v118 offset:16384
    v_cvt_pk_bf16_f32 v14, v76, v77
    v_cvt_pk_bf16_f32 v15, v78, v79
    buffer_store_dwordx4 v[12:15], v1, s[60:63], s75 offen sc1
    s_add_u32 s75, s75, 16384
    v_mfma_f32_16x16x32_bf16 v[24:27], a[232:235], v[144:147], v[24:27]
    s_waitcnt lgkmcnt(9)
    ds_read_b64_tr_b16 a[194:195], v118 offset:18432
    v_mul_f32 v80, v80, v60
    v_mfma_f32_16x16x32_bf16 v[24:27], a[236:239], v[152:155], v[24:27]
    ds_read_b64_tr_b16 a[196:197], v118 offset:20480
    buffer_load_dwordx4 v127, s[44:47], s69 offen offset:3072 lds
    v_mfma_f32_16x16x32_bf16 v[28:31], a[236:239], v[156:159], 0
    ds_read_b64_tr_b16 a[198:199], v118 offset:22528
    v_mul_f32 v81, v81, v60
    v_mfma_f32_16x16x32_bf16 v[28:31], a[232:235], v[148:151], v[28:31]
    ds_read_b64_tr_b16 a[200:201], v118 offset:24576
    v_mul_f32 v82, v82, v60
    v_mfma_f32_16x16x32_bf16 v[28:31], a[228:231], v[140:143], v[28:31]
    ds_read_b64_tr_b16 a[202:203], v118 offset:26624
    v_mul_f32 v83, v83, v60
    v_mfma_f32_16x16x32_bf16 v[28:31], a[224:227], v[132:135], v[28:31]
    s_waitcnt lgkmcnt(12)
    ds_read_b64_tr_b16 a[204:205], v118 offset:28672
    v_mul_f32 v84, v84, v61
    v_mfma_f32_16x16x32_bf16 v[24:27], a[240:243], v[160:163], v[24:27]
    s_waitcnt lgkmcnt(11)
    ds_read_b64_tr_b16 a[206:207], v118 offset:30720
    v_mul_f32 v85, v85, v61
    v_mfma_f32_16x16x32_bf16 v[24:27], a[244:247], v[168:171], v[24:27]
    s_waitcnt lgkmcnt(10)
    ds_read_b64_tr_b16 a[208:209], v122 offset:16384
    v_mul_f32 v86, v86, v61
    v_mfma_f32_16x16x32_bf16 v[24:27], a[248:251], v[176:179], v[24:27]
    s_waitcnt lgkmcnt(9)
    ds_read_b64_tr_b16 a[210:211], v122 offset:18432
    v_mul_f32 v87, v87, v61
    v_mfma_f32_16x16x32_bf16 v[24:27], a[252:255], v[184:187], v[24:27]
    ds_read_b64_tr_b16 a[212:213], v122 offset:20480
    v_cvt_pk_bf16_f32 v8, v80, v81
    v_mfma_f32_16x16x32_bf16 v[28:31], a[252:255], v[188:191], v[28:31]
    ds_read_b64_tr_b16 a[214:215], v122 offset:22528
    v_cvt_pk_bf16_f32 v9, v82, v83
    v_mfma_f32_16x16x32_bf16 v[28:31], a[248:251], v[180:183], v[28:31]
    ds_read_b64_tr_b16 a[216:217], v122 offset:24576
    v_cvt_pk_bf16_f32 v10, v84, v85
    v_mfma_f32_16x16x32_bf16 v[28:31], a[244:247], v[172:175], v[28:31]
    ds_read_b64_tr_b16 a[218:219], v122 offset:26624
    v_cvt_pk_bf16_f32 v11, v86, v87
    v_mfma_f32_16x16x32_bf16 v[28:31], a[240:243], v[164:167], v[28:31]
    s_waitcnt lgkmcnt(12)
    ds_read_b64_tr_b16 a[220:221], v122 offset:28672
    buffer_store_dwordx4 v[8:11], v1, s[60:63], s75 offen sc1
    s_add_u32 s75, s75, 16384
    v_mfma_f32_16x16x32_bf16 v[32:35], a[192:195], v[128:131], 0
    s_waitcnt lgkmcnt(11)
    ds_read_b64_tr_b16 a[222:223], v122 offset:30720
    v_mul_f32 v88, v88, v60
    v_mfma_f32_16x16x32_bf16 v[32:35], a[196:199], v[136:139], v[32:35]
    s_waitcnt lgkmcnt(10)
    ds_read_b64_tr_b16 a[224:225], v119 offset:16384
    v_mul_f32 v89, v89, v60
    v_mfma_f32_16x16x32_bf16 v[32:35], a[200:203], v[144:147], v[32:35]
    s_waitcnt lgkmcnt(9)
    ds_read_b64_tr_b16 a[226:227], v119 offset:18432
    v_mul_f32 v90, v90, v60
    v_mfma_f32_16x16x32_bf16 v[32:35], a[204:207], v[152:155], v[32:35]
    ds_read_b64_tr_b16 a[228:229], v119 offset:20480
    v_mul_f32 v91, v91, v60
    v_mfma_f32_16x16x32_bf16 v[36:39], a[204:207], v[156:159], 0
    ds_read_b64_tr_b16 a[230:231], v119 offset:22528
    v_mul_f32 v92, v92, v61
    v_mfma_f32_16x16x32_bf16 v[36:39], a[200:203], v[148:151], v[36:39]
    ds_read_b64_tr_b16 a[232:233], v119 offset:24576
    v_mul_f32 v93, v93, v61
    v_mfma_f32_16x16x32_bf16 v[36:39], a[196:199], v[140:143], v[36:39]
    s_waitcnt vmcnt(14)
    s_barrier
    ds_read_b64_tr_b16 a[234:235], v119 offset:26624
    v_mov_b32 v3, 1
    v_mfma_f32_16x16x32_bf16 v[36:39], a[192:195], v[132:135], v[36:39]
    s_waitcnt lgkmcnt(12)
    s_waitcnt vmcnt(8)
    ds_read_b64_tr_b16 a[236:237], v119 offset:28672
    buffer_store_dword v3, v54, s[60:63], s3 offen sc1
    v_mul_f32 v94, v94, v61
    v_mul_f32 v95, v95, v61
    v_mfma_f32_16x16x32_bf16 v[32:35], a[208:211], v[160:163], v[32:35]
    s_waitcnt lgkmcnt(11)
    s_add_u32 m0, s67, 0
    ds_read_b64_tr_b16 a[238:239], v119 offset:30720
    v_mfma_f32_16x16x32_bf16 v[32:35], a[212:215], v[168:171], v[32:35]
    s_waitcnt lgkmcnt(10)
    s_add_u32 s68, s81, 640
    ds_read_b64_tr_b16 a[240:241], v123 offset:16384
    v_mfma_f32_16x16x32_bf16 v[32:35], a[216:219], v[176:179], v[32:35]
    s_waitcnt lgkmcnt(9)
    ds_read_b64_tr_b16 a[242:243], v123 offset:18432
    buffer_load_dwordx4 v124, s[44:47], s68 offen offset:0 lds
    v_mfma_f32_16x16x32_bf16 v[32:35], a[220:223], v[184:187], v[32:35]
    ds_read_b64_tr_b16 a[244:245], v123 offset:20480
    v_cvt_pk_bf16_f32 v12, v88, v89
    v_mfma_f32_16x16x32_bf16 v[36:39], a[220:223], v[188:191], v[36:39]
    ds_read_b64_tr_b16 a[246:247], v123 offset:22528
    v_cvt_pk_bf16_f32 v13, v90, v91
    v_mfma_f32_16x16x32_bf16 v[36:39], a[216:219], v[180:183], v[36:39]
    ds_read_b64_tr_b16 a[248:249], v123 offset:24576
    v_cvt_pk_bf16_f32 v14, v92, v93
    v_cvt_pk_bf16_f32 v15, v94, v95
    buffer_store_dwordx4 v[12:15], v1, s[60:63], s75 offen sc1
    s_add_u32 s75, s75, 16384
    v_mfma_f32_16x16x32_bf16 v[36:39], a[212:215], v[172:175], v[36:39]
    ds_read_b64_tr_b16 a[250:251], v123 offset:26624
    v_mul_f32 v16, v16, v60
    v_mfma_f32_16x16x32_bf16 v[36:39], a[208:211], v[164:167], v[36:39]
    s_waitcnt lgkmcnt(12)
    ds_read_b64_tr_b16 a[252:253], v123 offset:28672
    buffer_load_dwordx4 v125, s[44:47], s68 offen offset:1024 lds
    v_mfma_f32_16x16x32_bf16 v[40:43], a[224:227], v[128:131], 0
    s_waitcnt lgkmcnt(11)
    ds_read_b64_tr_b16 a[254:255], v123 offset:30720
    v_mul_f32 v17, v17, v60
    v_mfma_f32_16x16x32_bf16 v[40:43], a[228:231], v[136:139], v[40:43]
    s_waitcnt lgkmcnt(10)
    ds_read_b64_tr_b16 a[192:193], v116 offset:32768
    v_mul_f32 v18, v18, v60
    v_mfma_f32_16x16x32_bf16 v[40:43], a[232:235], v[144:147], v[40:43]
    s_waitcnt lgkmcnt(9)
    ds_read_b64_tr_b16 a[194:195], v116 offset:34816
    v_mul_f32 v19, v19, v60
    v_mfma_f32_16x16x32_bf16 v[40:43], a[236:239], v[152:155], v[40:43]
    ds_read_b64_tr_b16 a[196:197], v116 offset:36864
    v_mul_f32 v20, v20, v61
    v_mfma_f32_16x16x32_bf16 v[44:47], a[236:239], v[156:159], 0
    ds_read_b64_tr_b16 a[198:199], v116 offset:38912
    v_mul_f32 v21, v21, v61
    v_mfma_f32_16x16x32_bf16 v[44:47], a[232:235], v[148:151], v[44:47]
    ds_read_b64_tr_b16 a[200:201], v116 offset:40960
    buffer_load_dwordx4 v126, s[44:47], s68 offen offset:2048 lds
    v_mfma_f32_16x16x32_bf16 v[44:47], a[228:231], v[140:143], v[44:47]
    ds_read_b64_tr_b16 a[202:203], v116 offset:43008
    v_mul_f32 v22, v22, v61
    v_mfma_f32_16x16x32_bf16 v[44:47], a[224:227], v[132:135], v[44:47]
    s_waitcnt lgkmcnt(12)
    ds_read_b64_tr_b16 a[204:205], v116 offset:45056
    v_mul_f32 v23, v23, v61
    v_mfma_f32_16x16x32_bf16 v[40:43], a[240:243], v[160:163], v[40:43]
    s_waitcnt lgkmcnt(11)
    ds_read_b64_tr_b16 a[206:207], v116 offset:47104
    v_cvt_pk_bf16_f32 v8, v16, v17
    v_mfma_f32_16x16x32_bf16 v[40:43], a[244:247], v[168:171], v[40:43]
    s_waitcnt lgkmcnt(10)
    ds_read_b64_tr_b16 a[208:209], v120 offset:32768
    v_cvt_pk_bf16_f32 v9, v18, v19
    v_mfma_f32_16x16x32_bf16 v[40:43], a[248:251], v[176:179], v[40:43]
    s_waitcnt lgkmcnt(9)
    ds_read_b64_tr_b16 a[210:211], v120 offset:34816
    v_cvt_pk_bf16_f32 v10, v20, v21
    v_cvt_pk_bf16_f32 v11, v22, v23
    v_mfma_f32_16x16x32_bf16 v[40:43], a[252:255], v[184:187], v[40:43]
    ds_read_b64_tr_b16 a[212:213], v120 offset:36864
    buffer_load_dwordx4 v127, s[44:47], s68 offen offset:3072 lds
    buffer_store_dwordx4 v[8:11], v1, s[60:63], s75 offen sc1
    s_add_u32 s75, s75, 16384
    v_mfma_f32_16x16x32_bf16 v[44:47], a[252:255], v[188:191], v[44:47]
    ds_read_b64_tr_b16 a[214:215], v120 offset:38912
    v_mul_f32 v24, v24, v60
    v_mfma_f32_16x16x32_bf16 v[44:47], a[248:251], v[180:183], v[44:47]
    ds_read_b64_tr_b16 a[216:217], v120 offset:40960
    v_mul_f32 v25, v25, v60
    v_mfma_f32_16x16x32_bf16 v[44:47], a[244:247], v[172:175], v[44:47]
    ds_read_b64_tr_b16 a[218:219], v120 offset:43008
    v_mul_f32 v26, v26, v60
    v_mfma_f32_16x16x32_bf16 v[44:47], a[240:243], v[164:167], v[44:47]
    s_waitcnt lgkmcnt(12)
    ds_read_b64_tr_b16 a[220:221], v120 offset:45056
    v_mul_f32 v27, v27, v60
    v_mfma_f32_16x16x32_bf16 v[64:67], a[192:195], v[128:131], 0
    s_waitcnt lgkmcnt(11)
    s_add_u32 m0, s67, 65536
    ds_read_b64_tr_b16 a[222:223], v120 offset:47104
    v_mfma_f32_16x16x32_bf16 v[64:67], a[196:199], v[136:139], v[64:67]
    s_waitcnt lgkmcnt(10)
    s_add_u32 s69, s81, 115328
    ds_read_b64_tr_b16 a[224:225], v117 offset:32768
    v_mfma_f32_16x16x32_bf16 v[64:67], a[200:203], v[144:147], v[64:67]
    s_waitcnt lgkmcnt(9)
    ds_read_b64_tr_b16 a[226:227], v117 offset:34816
    buffer_load_dwordx4 v124, s[44:47], s69 offen offset:0 lds
    v_mfma_f32_16x16x32_bf16 v[64:67], a[204:207], v[152:155], v[64:67]
    ds_read_b64_tr_b16 a[228:229], v117 offset:36864
    v_mul_f32 v28, v28, v61
    v_mfma_f32_16x16x32_bf16 v[68:71], a[204:207], v[156:159], 0
    ds_read_b64_tr_b16 a[230:231], v117 offset:38912
    v_mul_f32 v29, v29, v61
    v_mfma_f32_16x16x32_bf16 v[68:71], a[200:203], v[148:151], v[68:71]
    ds_read_b64_tr_b16 a[232:233], v117 offset:40960
    v_mul_f32 v30, v30, v61
    v_mfma_f32_16x16x32_bf16 v[68:71], a[196:199], v[140:143], v[68:71]
    ds_read_b64_tr_b16 a[234:235], v117 offset:43008
    v_mul_f32 v31, v31, v61
    v_cvt_pk_bf16_f32 v12, v24, v25
    v_mfma_f32_16x16x32_bf16 v[68:71], a[192:195], v[132:135], v[68:71]
    s_waitcnt lgkmcnt(12)
    ds_read_b64_tr_b16 a[236:237], v117 offset:45056
    buffer_load_dwordx4 v125, s[44:47], s69 offen offset:1024 lds
    v_mfma_f32_16x16x32_bf16 v[64:67], a[208:211], v[160:163], v[64:67]
    s_waitcnt lgkmcnt(11)
    ds_read_b64_tr_b16 a[238:239], v117 offset:47104
    v_cvt_pk_bf16_f32 v13, v26, v27
    v_mfma_f32_16x16x32_bf16 v[64:67], a[212:215], v[168:171], v[64:67]
    s_waitcnt lgkmcnt(10)
    ds_read_b64_tr_b16 a[240:241], v121 offset:32768
    v_cvt_pk_bf16_f32 v14, v28, v29
    v_cvt_pk_bf16_f32 v15, v30, v31
    buffer_store_dwordx4 v[12:15], v1, s[60:63], s75 offen sc1
    s_add_u32 s75, s75, 16384
    v_mfma_f32_16x16x32_bf16 v[64:67], a[216:219], v[176:179], v[64:67]
    s_waitcnt lgkmcnt(9)
    ds_read_b64_tr_b16 a[242:243], v121 offset:34816
    v_mul_f32 v32, v32, v60
    v_mfma_f32_16x16x32_bf16 v[64:67], a[220:223], v[184:187], v[64:67]
    ds_read_b64_tr_b16 a[244:245], v121 offset:36864
    v_mul_f32 v33, v33, v60
    v_mfma_f32_16x16x32_bf16 v[68:71], a[220:223], v[188:191], v[68:71]
    ds_read_b64_tr_b16 a[246:247], v121 offset:38912
    v_mul_f32 v34, v34, v60
    v_mfma_f32_16x16x32_bf16 v[68:71], a[216:219], v[180:183], v[68:71]
    ds_read_b64_tr_b16 a[248:249], v121 offset:40960
    buffer_load_dwordx4 v126, s[44:47], s69 offen offset:2048 lds
    v_mfma_f32_16x16x32_bf16 v[68:71], a[212:215], v[172:175], v[68:71]
    ds_read_b64_tr_b16 a[250:251], v121 offset:43008
    v_mul_f32 v35, v35, v60
    v_mfma_f32_16x16x32_bf16 v[68:71], a[208:211], v[164:167], v[68:71]
    s_waitcnt lgkmcnt(12)
    ds_read_b64_tr_b16 a[252:253], v121 offset:45056
    v_mul_f32 v36, v36, v61
    v_mfma_f32_16x16x32_bf16 v[72:75], a[224:227], v[128:131], 0
    s_waitcnt lgkmcnt(11)
    ds_read_b64_tr_b16 a[254:255], v121 offset:47104
    v_mul_f32 v37, v37, v61
    v_mfma_f32_16x16x32_bf16 v[72:75], a[228:231], v[136:139], v[72:75]
    s_waitcnt lgkmcnt(10)
    ds_read_b64_tr_b16 a[192:193], v118 offset:32768
    v_mul_f32 v38, v38, v61
    v_mfma_f32_16x16x32_bf16 v[72:75], a[232:235], v[144:147], v[72:75]
    s_waitcnt lgkmcnt(9)
    ds_read_b64_tr_b16 a[194:195], v118 offset:34816
    v_mul_f32 v39, v39, v61
    v_mfma_f32_16x16x32_bf16 v[72:75], a[236:239], v[152:155], v[72:75]
    ds_read_b64_tr_b16 a[196:197], v118 offset:36864
    buffer_load_dwordx4 v127, s[44:47], s69 offen offset:3072 lds
    v_mfma_f32_16x16x32_bf16 v[76:79], a[236:239], v[156:159], 0
    ds_read_b64_tr_b16 a[198:199], v118 offset:38912
    v_cvt_pk_bf16_f32 v8, v32, v33
    v_cvt_pk_bf16_f32 v9, v34, v35
    v_mfma_f32_16x16x32_bf16 v[76:79], a[232:235], v[148:151], v[76:79]
    s_add_u32 m0, s67, 131072
    ds_read_b64_tr_b16 a[200:201], v118 offset:40960
    v_mfma_f32_16x16x32_bf16 v[76:79], a[228:231], v[140:143], v[76:79]
    ds_read_b64_tr_b16 a[202:203], v118 offset:43008
    buffer_load_dwordx4 v96, s[56:59], s80 offen offset:0 lds
    v_mfma_f32_16x16x32_bf16 v[76:79], a[224:227], v[132:135], v[76:79]
    s_waitcnt lgkmcnt(12)
    ds_read_b64_tr_b16 a[204:205], v118 offset:45056
    v_cvt_pk_bf16_f32 v10, v36, v37
    v_cvt_pk_bf16_f32 v11, v38, v39
    buffer_store_dwordx4 v[8:11], v1, s[60:63], s75 offen sc1
    s_add_u32 s75, s75, 16384
    v_mfma_f32_16x16x32_bf16 v[72:75], a[240:243], v[160:163], v[72:75]
    s_waitcnt lgkmcnt(11)
    ds_read_b64_tr_b16 a[206:207], v118 offset:47104
    v_mul_f32 v40, v40, v60
    v_mfma_f32_16x16x32_bf16 v[72:75], a[244:247], v[168:171], v[72:75]
    s_waitcnt lgkmcnt(10)
    ds_read_b64_tr_b16 a[208:209], v122 offset:32768
    buffer_load_dwordx4 v97, s[56:59], s80 offen offset:1024 lds
    v_mfma_f32_16x16x32_bf16 v[72:75], a[248:251], v[176:179], v[72:75]
    s_waitcnt lgkmcnt(9)
    ds_read_b64_tr_b16 a[210:211], v122 offset:34816
    v_mul_f32 v41, v41, v60
    v_mfma_f32_16x16x32_bf16 v[72:75], a[252:255], v[184:187], v[72:75]
    ds_read_b64_tr_b16 a[212:213], v122 offset:36864
    v_mul_f32 v42, v42, v60
    v_mfma_f32_16x16x32_bf16 v[76:79], a[252:255], v[188:191], v[76:79]
    ds_read_b64_tr_b16 a[214:215], v122 offset:38912
    buffer_load_dwordx4 v98, s[56:59], s80 offen offset:2048 lds
    v_mfma_f32_16x16x32_bf16 v[76:79], a[248:251], v[180:183], v[76:79]
    ds_read_b64_tr_b16 a[216:217], v122 offset:40960
    v_mul_f32 v43, v43, v60
    v_mfma_f32_16x16x32_bf16 v[76:79], a[244:247], v[172:175], v[76:79]
    ds_read_b64_tr_b16 a[218:219], v122 offset:43008
    v_mul_f32 v44, v44, v61
    v_mul_f32 v45, v45, v61
    v_mov_b32 v3, 2
    v_mfma_f32_16x16x32_bf16 v[76:79], a[240:243], v[164:167], v[76:79]
    s_waitcnt lgkmcnt(12)
    s_waitcnt vmcnt(13)
    ds_read_b64_tr_b16 a[220:221], v122 offset:45056
    buffer_load_dwordx4 v99, s[56:59], s80 offen offset:3072 lds
    buffer_store_dword v3, v54, s[60:63], s3 offen sc1
    v_mfma_f32_16x16x32_bf16 v[80:83], a[192:195], v[128:131], 0
    s_waitcnt lgkmcnt(11)
    s_add_u32 s80, s80, 14336
    ds_read_b64_tr_b16 a[222:223], v122 offset:47104
    v_mfma_f32_16x16x32_bf16 v[80:83], a[196:199], v[136:139], v[80:83]
    s_waitcnt lgkmcnt(10)
    ds_read_b64_tr_b16 a[224:225], v119 offset:32768
    v_mul_f32 v46, v46, v61
    v_mfma_f32_16x16x32_bf16 v[80:83], a[200:203], v[144:147], v[80:83]
    s_waitcnt lgkmcnt(9)
    ds_read_b64_tr_b16 a[226:227], v119 offset:34816
    v_mul_f32 v47, v47, v61
    v_mfma_f32_16x16x32_bf16 v[80:83], a[204:207], v[152:155], v[80:83]
    ds_read_b64_tr_b16 a[228:229], v119 offset:36864
    v_cvt_pk_bf16_f32 v12, v40, v41
    v_mfma_f32_16x16x32_bf16 v[84:87], a[204:207], v[156:159], 0
    ds_read_b64_tr_b16 a[230:231], v119 offset:38912
    v_cvt_pk_bf16_f32 v13, v42, v43
    v_mfma_f32_16x16x32_bf16 v[84:87], a[200:203], v[148:151], v[84:87]
    ds_read_b64_tr_b16 a[232:233], v119 offset:40960
    v_cvt_pk_bf16_f32 v14, v44, v45
    v_cvt_pk_bf16_f32 v15, v46, v47
    buffer_store_dwordx4 v[12:15], v1, s[60:63], s75 offen sc1
    s_add_u32 s75, s75, 16384
    v_mfma_f32_16x16x32_bf16 v[84:87], a[196:199], v[140:143], v[84:87]
    s_barrier
    ds_read_b64_tr_b16 a[234:235], v119 offset:43008
    v_mfma_f32_16x16x32_bf16 v[84:87], a[192:195], v[132:135], v[84:87]
    s_waitcnt lgkmcnt(12)
    ds_read_b64_tr_b16 a[236:237], v119 offset:45056
    v_mul_f32 v64, v64, v60
    v_mul_f32 v65, v65, v60
    v_mfma_f32_16x16x32_bf16 v[80:83], a[208:211], v[160:163], v[80:83]
    s_waitcnt lgkmcnt(11)
    s_add_u32 m0, s67, 16384
    ds_read_b64_tr_b16 a[238:239], v119 offset:47104
    v_mfma_f32_16x16x32_bf16 v[80:83], a[212:215], v[168:171], v[80:83]
    s_waitcnt lgkmcnt(10)
    s_add_u32 s68, s81, 768
    ds_read_b64_tr_b16 a[240:241], v123 offset:32768
    v_mfma_f32_16x16x32_bf16 v[80:83], a[216:219], v[176:179], v[80:83]
    s_waitcnt lgkmcnt(9)
    ds_read_b64_tr_b16 a[242:243], v123 offset:34816
    buffer_load_dwordx4 v124, s[44:47], s68 offen offset:0 lds
    v_mfma_f32_16x16x32_bf16 v[80:83], a[220:223], v[184:187], v[80:83]
    ds_read_b64_tr_b16 a[244:245], v123 offset:36864
    v_mul_f32 v66, v66, v60
    v_mfma_f32_16x16x32_bf16 v[84:87], a[220:223], v[188:191], v[84:87]
    ds_read_b64_tr_b16 a[246:247], v123 offset:38912
    v_mul_f32 v67, v67, v60
    v_mfma_f32_16x16x32_bf16 v[84:87], a[216:219], v[180:183], v[84:87]
    ds_read_b64_tr_b16 a[248:249], v123 offset:40960
    v_mul_f32 v68, v68, v61
    v_mfma_f32_16x16x32_bf16 v[84:87], a[212:215], v[172:175], v[84:87]
    ds_read_b64_tr_b16 a[250:251], v123 offset:43008
    v_mul_f32 v69, v69, v61
    v_mul_f32 v70, v70, v61
    v_mfma_f32_16x16x32_bf16 v[84:87], a[208:211], v[164:167], v[84:87]
    s_waitcnt lgkmcnt(12)
    ds_read_b64_tr_b16 a[252:253], v123 offset:45056
    buffer_load_dwordx4 v125, s[44:47], s68 offen offset:1024 lds
    v_mfma_f32_16x16x32_bf16 v[88:91], a[224:227], v[128:131], 0
    s_waitcnt lgkmcnt(11)
    ds_read_b64_tr_b16 a[254:255], v123 offset:47104
    v_mul_f32 v71, v71, v61
    v_mfma_f32_16x16x32_bf16 v[88:91], a[228:231], v[136:139], v[88:91]
    s_waitcnt lgkmcnt(10)
    ds_read_b64_tr_b16 a[192:193], v116 offset:49152
    v_cvt_pk_bf16_f32 v8, v64, v65
    v_mfma_f32_16x16x32_bf16 v[88:91], a[232:235], v[144:147], v[88:91]
    s_waitcnt lgkmcnt(9)
    ds_read_b64_tr_b16 a[194:195], v116 offset:51200
    v_cvt_pk_bf16_f32 v9, v66, v67
    v_mfma_f32_16x16x32_bf16 v[88:91], a[236:239], v[152:155], v[88:91]
    ds_read_b64_tr_b16 a[196:197], v116 offset:53248
    v_cvt_pk_bf16_f32 v10, v68, v69
    v_cvt_pk_bf16_f32 v11, v70, v71
    buffer_store_dwordx4 v[8:11], v1, s[60:63], s75 offen sc1
    s_add_u32 s75, s75, 16384
    v_mfma_f32_16x16x32_bf16 v[92:95], a[236:239], v[156:159], 0
    ds_read_b64_tr_b16 a[198:199], v116 offset:55296
    v_mul_f32 v72, v72, v60
    v_mfma_f32_16x16x32_bf16 v[92:95], a[232:235], v[148:151], v[92:95]
    ds_read_b64_tr_b16 a[200:201], v116 offset:57344
    buffer_load_dwordx4 v126, s[44:47], s68 offen offset:2048 lds
    v_mfma_f32_16x16x32_bf16 v[92:95], a[228:231], v[140:143], v[92:95]
    ds_read_b64_tr_b16 a[202:203], v116 offset:59392
    v_mul_f32 v73, v73, v60
    v_mfma_f32_16x16x32_bf16 v[92:95], a[224:227], v[132:135], v[92:95]
    s_waitcnt lgkmcnt(12)
    ds_read_b64_tr_b16 a[204:205], v116 offset:61440
    v_mul_f32 v74, v74, v60
    v_mfma_f32_16x16x32_bf16 v[88:91], a[240:243], v[160:163], v[88:91]
    s_waitcnt lgkmcnt(11)
    ds_read_b64_tr_b16 a[206:207], v116 offset:63488
    v_mul_f32 v75, v75, v60
    v_mfma_f32_16x16x32_bf16 v[88:91], a[244:247], v[168:171], v[88:91]
    s_waitcnt lgkmcnt(10)
    ds_read_b64_tr_b16 a[208:209], v120 offset:49152
    v_mul_f32 v76, v76, v61
    v_mfma_f32_16x16x32_bf16 v[88:91], a[248:251], v[176:179], v[88:91]
    s_waitcnt lgkmcnt(9)
    ds_read_b64_tr_b16 a[210:211], v120 offset:51200
    v_mul_f32 v77, v77, v61
    v_mfma_f32_16x16x32_bf16 v[88:91], a[252:255], v[184:187], v[88:91]
    ds_read_b64_tr_b16 a[212:213], v120 offset:53248
    buffer_load_dwordx4 v127, s[44:47], s68 offen offset:3072 lds
    v_mfma_f32_16x16x32_bf16 v[92:95], a[252:255], v[188:191], v[92:95]
    ds_read_b64_tr_b16 a[214:215], v120 offset:55296
    v_mul_f32 v78, v78, v61
    v_mfma_f32_16x16x32_bf16 v[92:95], a[248:251], v[180:183], v[92:95]
    ds_read_b64_tr_b16 a[216:217], v120 offset:57344
    v_mul_f32 v79, v79, v61
    v_mfma_f32_16x16x32_bf16 v[92:95], a[244:247], v[172:175], v[92:95]
    ds_read_b64_tr_b16 a[218:219], v120 offset:59392
    v_cvt_pk_bf16_f32 v12, v72, v73
    v_mfma_f32_16x16x32_bf16 v[92:95], a[240:243], v[164:167], v[92:95]
    s_waitcnt lgkmcnt(12)
    ds_read_b64_tr_b16 a[220:221], v120 offset:61440
    v_cvt_pk_bf16_f32 v13, v74, v75
    v_cvt_pk_bf16_f32 v14, v76, v77
    v_cvt_pk_bf16_f32 v15, v78, v79
    v_mfma_f32_16x16x32_bf16 v[16:19], a[192:195], v[128:131], 0
    s_waitcnt lgkmcnt(11)
    s_add_u32 m0, s67, 81920
    ds_read_b64_tr_b16 a[222:223], v120 offset:63488
    buffer_store_dwordx4 v[12:15], v1, s[60:63], s75 offen sc1
    v_mfma_f32_16x16x32_bf16 v[16:19], a[196:199], v[136:139], v[16:19]
    s_waitcnt lgkmcnt(10)
    s_add_u32 s69, s81, 115456
    s_add_u32 s75, s75, 16384
    ds_read_b64_tr_b16 a[224:225], v117 offset:49152
    v_mfma_f32_16x16x32_bf16 v[16:19], a[200:203], v[144:147], v[16:19]
    s_waitcnt lgkmcnt(9)
    ds_read_b64_tr_b16 a[226:227], v117 offset:51200
    buffer_load_dwordx4 v124, s[44:47], s69 offen offset:0 lds
    v_mfma_f32_16x16x32_bf16 v[16:19], a[204:207], v[152:155], v[16:19]
    ds_read_b64_tr_b16 a[228:229], v117 offset:53248
    v_mul_f32 v80, v80, v60
    v_mfma_f32_16x16x32_bf16 v[20:23], a[204:207], v[156:159], 0
    ds_read_b64_tr_b16 a[230:231], v117 offset:55296
    v_mul_f32 v81, v81, v60
    v_mfma_f32_16x16x32_bf16 v[20:23], a[200:203], v[148:151], v[20:23]
    ds_read_b64_tr_b16 a[232:233], v117 offset:57344
    v_mul_f32 v82, v82, v60
    v_mfma_f32_16x16x32_bf16 v[20:23], a[196:199], v[140:143], v[20:23]
    ds_read_b64_tr_b16 a[234:235], v117 offset:59392
    v_mul_f32 v83, v83, v60
    v_mfma_f32_16x16x32_bf16 v[20:23], a[192:195], v[132:135], v[20:23]
    s_waitcnt lgkmcnt(12)
    ds_read_b64_tr_b16 a[236:237], v117 offset:61440
    buffer_load_dwordx4 v125, s[44:47], s69 offen offset:1024 lds
    v_mfma_f32_16x16x32_bf16 v[16:19], a[208:211], v[160:163], v[16:19]
    s_waitcnt lgkmcnt(11)
    ds_read_b64_tr_b16 a[238:239], v117 offset:63488
    v_mul_f32 v84, v84, v61
    v_mfma_f32_16x16x32_bf16 v[16:19], a[212:215], v[168:171], v[16:19]
    s_waitcnt lgkmcnt(10)
    ds_read_b64_tr_b16 a[240:241], v121 offset:49152
    v_mul_f32 v85, v85, v61
    v_mfma_f32_16x16x32_bf16 v[16:19], a[216:219], v[176:179], v[16:19]
    s_waitcnt lgkmcnt(9)
    ds_read_b64_tr_b16 a[242:243], v121 offset:51200
    v_mul_f32 v86, v86, v61
    v_mfma_f32_16x16x32_bf16 v[16:19], a[220:223], v[184:187], v[16:19]
    ds_read_b64_tr_b16 a[244:245], v121 offset:53248
    v_mul_f32 v87, v87, v61
    v_mfma_f32_16x16x32_bf16 v[20:23], a[220:223], v[188:191], v[20:23]
    ds_read_b64_tr_b16 a[246:247], v121 offset:55296
    v_cvt_pk_bf16_f32 v8, v80, v81
    v_mfma_f32_16x16x32_bf16 v[20:23], a[216:219], v[180:183], v[20:23]
    ds_read_b64_tr_b16 a[248:249], v121 offset:57344
    buffer_load_dwordx4 v126, s[44:47], s69 offen offset:2048 lds
    v_mfma_f32_16x16x32_bf16 v[20:23], a[212:215], v[172:175], v[20:23]
    ds_read_b64_tr_b16 a[250:251], v121 offset:59392
    v_cvt_pk_bf16_f32 v9, v82, v83
    v_mfma_f32_16x16x32_bf16 v[20:23], a[208:211], v[164:167], v[20:23]
    s_waitcnt lgkmcnt(12)
    ds_read_b64_tr_b16 a[252:253], v121 offset:61440
    v_cvt_pk_bf16_f32 v10, v84, v85
    v_cvt_pk_bf16_f32 v11, v86, v87
    buffer_store_dwordx4 v[8:11], v1, s[60:63], s75 offen sc1
    s_add_u32 s75, s75, 16384
    v_mfma_f32_16x16x32_bf16 v[24:27], a[224:227], v[128:131], 0
    s_waitcnt lgkmcnt(11)
    ds_read_b64_tr_b16 a[254:255], v121 offset:63488
    v_mul_f32 v88, v88, v60
    v_mfma_f32_16x16x32_bf16 v[24:27], a[228:231], v[136:139], v[24:27]
    s_waitcnt lgkmcnt(10)
    ds_read_b64_tr_b16 a[192:193], v118 offset:49152
    v_mul_f32 v89, v89, v60
    v_mfma_f32_16x16x32_bf16 v[24:27], a[232:235], v[144:147], v[24:27]
    s_waitcnt lgkmcnt(9)
    ds_read_b64_tr_b16 a[194:195], v118 offset:51200
    v_mul_f32 v90, v90, v60
    v_mfma_f32_16x16x32_bf16 v[24:27], a[236:239], v[152:155], v[24:27]
    ds_read_b64_tr_b16 a[196:197], v118 offset:53248
    buffer_load_dwordx4 v127, s[44:47], s69 offen offset:3072 lds
    v_mfma_f32_16x16x32_bf16 v[28:31], a[236:239], v[156:159], 0
    ds_read_b64_tr_b16 a[198:199], v118 offset:55296
    v_mul_f32 v91, v91, v60
    v_mfma_f32_16x16x32_bf16 v[28:31], a[232:235], v[148:151], v[28:31]
    s_add_u32 m0, s67, 147456
    ds_read_b64_tr_b16 a[200:201], v118 offset:57344
    v_mfma_f32_16x16x32_bf16 v[28:31], a[228:231], v[140:143], v[28:31]
    ds_read_b64_tr_b16 a[202:203], v118 offset:59392
    buffer_load_dwordx4 v96, s[56:59], s80 offen offset:0 lds
    v_mov_b32 v3, 3
    v_mfma_f32_16x16x32_bf16 v[28:31], a[224:227], v[132:135], v[28:31]
    s_waitcnt lgkmcnt(12)
    s_waitcnt vmcnt(12)
    ds_read_b64_tr_b16 a[204:205], v118 offset:61440
    buffer_store_dword v3, v54, s[60:63], s3 offen sc1
    v_mul_f32 v92, v92, v61
    v_mfma_f32_16x16x32_bf16 v[24:27], a[240:243], v[160:163], v[24:27]
    s_waitcnt lgkmcnt(11)
    ds_read_b64_tr_b16 a[206:207], v118 offset:63488
    v_mul_f32 v93, v93, v61
    v_mul_f32 v94, v94, v61
    v_mfma_f32_16x16x32_bf16 v[24:27], a[244:247], v[168:171], v[24:27]
    s_waitcnt lgkmcnt(10)
    ds_read_b64_tr_b16 a[208:209], v122 offset:49152
    buffer_load_dwordx4 v97, s[56:59], s80 offen offset:1024 lds
    v_mfma_f32_16x16x32_bf16 v[24:27], a[248:251], v[176:179], v[24:27]
    s_waitcnt lgkmcnt(9)
    ds_read_b64_tr_b16 a[210:211], v122 offset:51200
    v_mul_f32 v95, v95, v61
    v_mfma_f32_16x16x32_bf16 v[24:27], a[252:255], v[184:187], v[24:27]
    ds_read_b64_tr_b16 a[212:213], v122 offset:53248
    v_cvt_pk_bf16_f32 v12, v88, v89
    v_cvt_pk_bf16_f32 v13, v90, v91
    v_mfma_f32_16x16x32_bf16 v[28:31], a[252:255], v[188:191], v[28:31]
    ds_read_b64_tr_b16 a[214:215], v122 offset:55296
    buffer_load_dwordx4 v98, s[56:59], s80 offen offset:2048 lds
    v_mfma_f32_16x16x32_bf16 v[28:31], a[248:251], v[180:183], v[28:31]
    ds_read_b64_tr_b16 a[216:217], v122 offset:57344
    v_cvt_pk_bf16_f32 v14, v92, v93
    v_cvt_pk_bf16_f32 v15, v94, v95
    buffer_store_dwordx4 v[12:15], v1, s[60:63], s75 offen sc1
    s_add_u32 s75, s75, 16384
    v_mfma_f32_16x16x32_bf16 v[28:31], a[244:247], v[172:175], v[28:31]
    ds_read_b64_tr_b16 a[218:219], v122 offset:59392
    v_mul_f32 v16, v16, v60
    v_mfma_f32_16x16x32_bf16 v[28:31], a[240:243], v[164:167], v[28:31]
    s_waitcnt lgkmcnt(12)
    ds_read_b64_tr_b16 a[220:221], v122 offset:61440
    buffer_load_dwordx4 v99, s[56:59], s80 offen offset:3072 lds
    v_mfma_f32_16x16x32_bf16 v[32:35], a[192:195], v[128:131], 0
    s_waitcnt lgkmcnt(11)
    s_add_u32 s80, s80, 14336
    ds_read_b64_tr_b16 a[222:223], v122 offset:63488
    v_mfma_f32_16x16x32_bf16 v[32:35], a[196:199], v[136:139], v[32:35]
    s_waitcnt lgkmcnt(10)
    ds_read_b64_tr_b16 a[224:225], v119 offset:49152
    v_mul_f32 v17, v17, v60
    v_mfma_f32_16x16x32_bf16 v[32:35], a[200:203], v[144:147], v[32:35]
    s_waitcnt lgkmcnt(9)
    ds_read_b64_tr_b16 a[226:227], v119 offset:51200
    v_mul_f32 v18, v18, v60
    v_mfma_f32_16x16x32_bf16 v[32:35], a[204:207], v[152:155], v[32:35]
    ds_read_b64_tr_b16 a[228:229], v119 offset:53248
    v_mul_f32 v19, v19, v60
    v_mfma_f32_16x16x32_bf16 v[36:39], a[204:207], v[156:159], 0
    ds_read_b64_tr_b16 a[230:231], v119 offset:55296
    v_mul_f32 v20, v20, v61
    v_mfma_f32_16x16x32_bf16 v[36:39], a[200:203], v[148:151], v[36:39]
    ds_read_b64_tr_b16 a[232:233], v119 offset:57344
    v_mul_f32 v21, v21, v61
    v_mfma_f32_16x16x32_bf16 v[36:39], a[196:199], v[140:143], v[36:39]
    s_barrier
    ds_read_b64_tr_b16 a[234:235], v119 offset:59392
    v_mfma_f32_16x16x32_bf16 v[36:39], a[192:195], v[132:135], v[36:39]
    s_waitcnt lgkmcnt(12)
    ds_read_b64_tr_b16 a[236:237], v119 offset:61440
    v_mul_f32 v22, v22, v61
    v_mul_f32 v23, v23, v61
    v_cvt_pk_bf16_f32 v8, v16, v17
    v_mfma_f32_16x16x32_bf16 v[32:35], a[208:211], v[160:163], v[32:35]
    s_waitcnt lgkmcnt(11)
    s_add_u32 m0, s67, 32768
    ds_read_b64_tr_b16 a[238:239], v119 offset:63488
    v_mfma_f32_16x16x32_bf16 v[32:35], a[212:215], v[168:171], v[32:35]
    s_waitcnt lgkmcnt(10)
    ds_read_b64_tr_b16 a[240:241], v123 offset:49152
    buffer_load_dwordx4 v96, s[56:59], s80 offen offset:0 lds
    v_mfma_f32_16x16x32_bf16 v[32:35], a[216:219], v[176:179], v[32:35]
    s_waitcnt lgkmcnt(9)
    ds_read_b64_tr_b16 a[242:243], v123 offset:51200
    v_cvt_pk_bf16_f32 v9, v18, v19
    v_mfma_f32_16x16x32_bf16 v[32:35], a[220:223], v[184:187], v[32:35]
    ds_read_b64_tr_b16 a[244:245], v123 offset:53248
    v_cvt_pk_bf16_f32 v10, v20, v21
    v_cvt_pk_bf16_f32 v11, v22, v23
    buffer_store_dwordx4 v[8:11], v1, s[60:63], s75 offen sc1
    s_add_u32 s75, s75, 16384
    v_mfma_f32_16x16x32_bf16 v[36:39], a[220:223], v[188:191], v[36:39]
    ds_read_b64_tr_b16 a[246:247], v123 offset:55296
    v_mul_f32 v24, v24, v60
    v_mfma_f32_16x16x32_bf16 v[36:39], a[216:219], v[180:183], v[36:39]
    ds_read_b64_tr_b16 a[248:249], v123 offset:57344
    v_mul_f32 v25, v25, v60
    v_mfma_f32_16x16x32_bf16 v[36:39], a[212:215], v[172:175], v[36:39]
    ds_read_b64_tr_b16 a[250:251], v123 offset:59392
    buffer_load_dwordx4 v97, s[56:59], s80 offen offset:1024 lds
    v_mfma_f32_16x16x32_bf16 v[36:39], a[208:211], v[164:167], v[36:39]
    s_waitcnt lgkmcnt(12)
    ds_read_b64_tr_b16 a[252:253], v123 offset:61440
    v_mul_f32 v26, v26, v60
    v_mfma_f32_16x16x32_bf16 v[40:43], a[224:227], v[128:131], 0
    s_waitcnt lgkmcnt(11)
    ds_read_b64_tr_b16 a[254:255], v123 offset:63488
    v_mul_f32 v27, v27, v60
    v_mfma_f32_16x16x32_bf16 v[40:43], a[228:231], v[136:139], v[40:43]
    s_waitcnt lgkmcnt(10)
    ds_read_b64_tr_b16 a[192:193], v116 offset:0
    v_mul_f32 v28, v28, v61
    v_mfma_f32_16x16x32_bf16 v[40:43], a[232:235], v[144:147], v[40:43]
    s_waitcnt lgkmcnt(9)
    ds_read_b64_tr_b16 a[194:195], v116 offset:2048
    v_mul_f32 v29, v29, v61
    v_mfma_f32_16x16x32_bf16 v[40:43], a[236:239], v[152:155], v[40:43]
    ds_read_b64_tr_b16 a[196:197], v116 offset:4096
    buffer_load_dwordx4 v98, s[56:59], s80 offen offset:2048 lds
    v_mfma_f32_16x16x32_bf16 v[44:47], a[236:239], v[156:159], 0
    ds_read_b64_tr_b16 a[198:199], v116 offset:6144
    v_mul_f32 v30, v30, v61
    v_mfma_f32_16x16x32_bf16 v[44:47], a[232:235], v[148:151], v[44:47]
    ds_read_b64_tr_b16 a[200:201], v116 offset:8192
    v_mul_f32 v31, v31, v61
    v_mfma_f32_16x16x32_bf16 v[44:47], a[228:231], v[140:143], v[44:47]
    ds_read_b64_tr_b16 a[202:203], v116 offset:10240
    v_cvt_pk_bf16_f32 v12, v24, v25
    v_mfma_f32_16x16x32_bf16 v[44:47], a[224:227], v[132:135], v[44:47]
    s_waitcnt lgkmcnt(12)
    ds_read_b64_tr_b16 a[204:205], v116 offset:12288
    v_cvt_pk_bf16_f32 v13, v26, v27
    v_cvt_pk_bf16_f32 v14, v28, v29
    v_cvt_pk_bf16_f32 v15, v30, v31
    v_mfma_f32_16x16x32_bf16 v[40:43], a[240:243], v[160:163], v[40:43]
    s_waitcnt lgkmcnt(11)
    ds_read_b64_tr_b16 a[206:207], v116 offset:14336
    buffer_load_dwordx4 v99, s[56:59], s80 offen offset:3072 lds
    buffer_store_dwordx4 v[12:15], v1, s[60:63], s75 offen sc1
    v_mfma_f32_16x16x32_bf16 v[40:43], a[244:247], v[168:171], v[40:43]
    s_waitcnt lgkmcnt(10)
    s_add_u32 s80, s80, 14336
    s_add_u32 s75, s75, 16384
    ds_read_b64_tr_b16 a[208:209], v120 offset:0
    v_mfma_f32_16x16x32_bf16 v[40:43], a[248:251], v[176:179], v[40:43]
    s_waitcnt lgkmcnt(9)
    ds_read_b64_tr_b16 a[210:211], v120 offset:2048
    v_mul_f32 v32, v32, v60
    v_mfma_f32_16x16x32_bf16 v[40:43], a[252:255], v[184:187], v[40:43]
    ds_read_b64_tr_b16 a[212:213], v120 offset:4096
    v_mul_f32 v33, v33, v60
    v_mfma_f32_16x16x32_bf16 v[44:47], a[252:255], v[188:191], v[44:47]
    s_add_u32 m0, s67, 98304
    ds_read_b64_tr_b16 a[214:215], v120 offset:6144
    v_mul_f32 v34, v34, v60
    v_mfma_f32_16x16x32_bf16 v[44:47], a[248:251], v[180:183], v[44:47]
    ds_read_b64_tr_b16 a[216:217], v120 offset:8192
    buffer_load_dwordx4 v96, s[56:59], s80 offen offset:0 lds
    v_mfma_f32_16x16x32_bf16 v[44:47], a[244:247], v[172:175], v[44:47]
    ds_read_b64_tr_b16 a[218:219], v120 offset:10240
    v_mul_f32 v35, v35, v60
    v_mfma_f32_16x16x32_bf16 v[44:47], a[240:243], v[164:167], v[44:47]
    s_waitcnt lgkmcnt(12)
    ds_read_b64_tr_b16 a[220:221], v120 offset:12288
    v_mul_f32 v36, v36, v61
    v_mfma_f32_16x16x32_bf16 v[64:67], a[192:195], v[128:131], 0
    s_waitcnt lgkmcnt(11)
    ds_read_b64_tr_b16 a[222:223], v120 offset:14336
    v_mul_f32 v37, v37, v61
    v_mfma_f32_16x16x32_bf16 v[64:67], a[196:199], v[136:139], v[64:67]
    s_waitcnt lgkmcnt(10)
    ds_read_b64_tr_b16 a[224:225], v117 offset:0
    v_mul_f32 v38, v38, v61
    v_mfma_f32_16x16x32_bf16 v[64:67], a[200:203], v[144:147], v[64:67]
    s_waitcnt lgkmcnt(9)
    ds_read_b64_tr_b16 a[226:227], v117 offset:2048
    buffer_load_dwordx4 v97, s[56:59], s80 offen offset:1024 lds
    v_mfma_f32_16x16x32_bf16 v[64:67], a[204:207], v[152:155], v[64:67]
    ds_read_b64_tr_b16 a[228:229], v117 offset:4096
    v_mul_f32 v39, v39, v61
    v_mfma_f32_16x16x32_bf16 v[68:71], a[204:207], v[156:159], 0
    ds_read_b64_tr_b16 a[230:231], v117 offset:6144
    v_cvt_pk_bf16_f32 v8, v32, v33
    v_mfma_f32_16x16x32_bf16 v[68:71], a[200:203], v[148:151], v[68:71]
    ds_read_b64_tr_b16 a[232:233], v117 offset:8192
    v_cvt_pk_bf16_f32 v9, v34, v35
    v_mfma_f32_16x16x32_bf16 v[68:71], a[196:199], v[140:143], v[68:71]
    ds_read_b64_tr_b16 a[234:235], v117 offset:10240
    v_cvt_pk_bf16_f32 v10, v36, v37
    v_cvt_pk_bf16_f32 v11, v38, v39
    v_mfma_f32_16x16x32_bf16 v[68:71], a[192:195], v[132:135], v[68:71]
    s_waitcnt lgkmcnt(12)
    ds_read_b64_tr_b16 a[236:237], v117 offset:12288
    buffer_load_dwordx4 v98, s[56:59], s80 offen offset:2048 lds
    buffer_store_dwordx4 v[8:11], v1, s[60:63], s75 offen sc1
    s_add_u32 s75, s75, 16384
    v_mfma_f32_16x16x32_bf16 v[64:67], a[208:211], v[160:163], v[64:67]
    s_waitcnt lgkmcnt(11)
    ds_read_b64_tr_b16 a[238:239], v117 offset:14336
    v_mul_f32 v40, v40, v60
    v_mfma_f32_16x16x32_bf16 v[64:67], a[212:215], v[168:171], v[64:67]
    s_waitcnt lgkmcnt(10)
    ds_read_b64_tr_b16 a[240:241], v121 offset:0
    v_mul_f32 v41, v41, v60
    v_mfma_f32_16x16x32_bf16 v[64:67], a[216:219], v[176:179], v[64:67]
    s_waitcnt lgkmcnt(9)
    ds_read_b64_tr_b16 a[242:243], v121 offset:2048
    v_mul_f32 v42, v42, v60
    v_mfma_f32_16x16x32_bf16 v[64:67], a[220:223], v[184:187], v[64:67]
    ds_read_b64_tr_b16 a[244:245], v121 offset:4096
    v_mul_f32 v43, v43, v60
    v_mfma_f32_16x16x32_bf16 v[68:71], a[220:223], v[188:191], v[68:71]
    ds_read_b64_tr_b16 a[246:247], v121 offset:6144
    buffer_load_dwordx4 v99, s[56:59], s80 offen offset:3072 lds
    v_mfma_f32_16x16x32_bf16 v[68:71], a[216:219], v[180:183], v[68:71]
    s_add_u32 s80, s80, 14336
    ds_read_b64_tr_b16 a[248:249], v121 offset:8192
    v_mfma_f32_16x16x32_bf16 v[68:71], a[212:215], v[172:175], v[68:71]
    ds_read_b64_tr_b16 a[250:251], v121 offset:10240
    v_mul_f32 v44, v44, v61
    v_mov_b32 v3, 4
    v_mfma_f32_16x16x32_bf16 v[68:71], a[208:211], v[164:167], v[68:71]
    s_waitcnt lgkmcnt(12)
    s_waitcnt vmcnt(12)
    ds_read_b64_tr_b16 a[252:253], v121 offset:12288
    buffer_store_dword v3, v54, s[60:63], s3 offen sc1
    v_mul_f32 v45, v45, v61
    v_mfma_f32_16x16x32_bf16 v[72:75], a[224:227], v[128:131], 0
    s_waitcnt lgkmcnt(11)
    ds_read_b64_tr_b16 a[254:255], v121 offset:14336
    v_mul_f32 v46, v46, v61
    v_mfma_f32_16x16x32_bf16 v[72:75], a[228:231], v[136:139], v[72:75]
    s_waitcnt lgkmcnt(10)
    ds_read_b64_tr_b16 a[192:193], v118 offset:0
    v_mul_f32 v47, v47, v61
    v_mfma_f32_16x16x32_bf16 v[72:75], a[232:235], v[144:147], v[72:75]
    s_waitcnt lgkmcnt(9)
    ds_read_b64_tr_b16 a[194:195], v118 offset:2048
    v_cvt_pk_bf16_f32 v12, v40, v41
    v_mfma_f32_16x16x32_bf16 v[72:75], a[236:239], v[152:155], v[72:75]
    ds_read_b64_tr_b16 a[196:197], v118 offset:4096
    v_cvt_pk_bf16_f32 v13, v42, v43
    v_mfma_f32_16x16x32_bf16 v[76:79], a[236:239], v[156:159], 0
    ds_read_b64_tr_b16 a[198:199], v118 offset:6144
    v_cvt_pk_bf16_f32 v14, v44, v45
    v_mfma_f32_16x16x32_bf16 v[76:79], a[232:235], v[148:151], v[76:79]
    ds_read_b64_tr_b16 a[200:201], v118 offset:8192
    v_cvt_pk_bf16_f32 v15, v46, v47
    buffer_store_dwordx4 v[12:15], v1, s[60:63], s75 offen sc1
    s_add_u32 s75, s75, 16384
    v_mfma_f32_16x16x32_bf16 v[76:79], a[228:231], v[140:143], v[76:79]
    ds_read_b64_tr_b16 a[202:203], v118 offset:10240
    v_mul_f32 v64, v64, v60
    v_mfma_f32_16x16x32_bf16 v[76:79], a[224:227], v[132:135], v[76:79]
    s_waitcnt lgkmcnt(12)
    ds_read_b64_tr_b16 a[204:205], v118 offset:12288
    v_mul_f32 v65, v65, v60
    v_mfma_f32_16x16x32_bf16 v[72:75], a[240:243], v[160:163], v[72:75]
    s_waitcnt lgkmcnt(11)
    ds_read_b64_tr_b16 a[206:207], v118 offset:14336
    v_mul_f32 v66, v66, v60
    v_mfma_f32_16x16x32_bf16 v[72:75], a[244:247], v[168:171], v[72:75]
    s_waitcnt lgkmcnt(10)
    ds_read_b64_tr_b16 a[208:209], v122 offset:0
    v_mul_f32 v67, v67, v60
    v_mfma_f32_16x16x32_bf16 v[72:75], a[248:251], v[176:179], v[72:75]
    s_waitcnt lgkmcnt(9)
    ds_read_b64_tr_b16 a[210:211], v122 offset:2048
    v_mul_f32 v68, v68, v61
    v_mfma_f32_16x16x32_bf16 v[72:75], a[252:255], v[184:187], v[72:75]
    ds_read_b64_tr_b16 a[212:213], v122 offset:4096
    v_mul_f32 v69, v69, v61
    v_mfma_f32_16x16x32_bf16 v[76:79], a[252:255], v[188:191], v[76:79]
    ds_read_b64_tr_b16 a[214:215], v122 offset:6144
    v_mul_f32 v70, v70, v61
    v_mfma_f32_16x16x32_bf16 v[76:79], a[248:251], v[180:183], v[76:79]
    ds_read_b64_tr_b16 a[216:217], v122 offset:8192
    v_mul_f32 v71, v71, v61
    v_mfma_f32_16x16x32_bf16 v[76:79], a[244:247], v[172:175], v[76:79]
    ds_read_b64_tr_b16 a[218:219], v122 offset:10240
    v_cvt_pk_bf16_f32 v8, v64, v65
    v_mfma_f32_16x16x32_bf16 v[76:79], a[240:243], v[164:167], v[76:79]
    s_waitcnt lgkmcnt(12)
    ds_read_b64_tr_b16 a[220:221], v122 offset:12288
    v_cvt_pk_bf16_f32 v9, v66, v67
    v_mfma_f32_16x16x32_bf16 v[80:83], a[192:195], v[128:131], 0
    s_waitcnt lgkmcnt(11)
    ds_read_b64_tr_b16 a[222:223], v122 offset:14336
    v_cvt_pk_bf16_f32 v10, v68, v69
    v_mfma_f32_16x16x32_bf16 v[80:83], a[196:199], v[136:139], v[80:83]
    s_waitcnt lgkmcnt(10)
    ds_read_b64_tr_b16 a[224:225], v119 offset:0
    v_cvt_pk_bf16_f32 v11, v70, v71
    v_mfma_f32_16x16x32_bf16 v[80:83], a[200:203], v[144:147], v[80:83]
    s_waitcnt lgkmcnt(9)
    ds_read_b64_tr_b16 a[226:227], v119 offset:2048
    buffer_store_dwordx4 v[8:11], v1, s[60:63], s75 offen sc1
    v_mfma_f32_16x16x32_bf16 v[80:83], a[204:207], v[152:155], v[80:83]
    s_add_u32 s75, s75, 16384
    ds_read_b64_tr_b16 a[228:229], v119 offset:4096
    v_mfma_f32_16x16x32_bf16 v[84:87], a[204:207], v[156:159], 0
    ds_read_b64_tr_b16 a[230:231], v119 offset:6144
    v_mul_f32 v72, v72, v60
    v_mfma_f32_16x16x32_bf16 v[84:87], a[200:203], v[148:151], v[84:87]
    ds_read_b64_tr_b16 a[232:233], v119 offset:8192
    v_mul_f32 v73, v73, v60
    v_mfma_f32_16x16x32_bf16 v[84:87], a[196:199], v[140:143], v[84:87]
    s_barrier
    ds_read_b64_tr_b16 a[234:235], v119 offset:10240
    v_mfma_f32_16x16x32_bf16 v[84:87], a[192:195], v[132:135], v[84:87]
    s_waitcnt lgkmcnt(12)
    ds_read_b64_tr_b16 a[236:237], v119 offset:12288
    v_mul_f32 v74, v74, v60
    v_mfma_f32_16x16x32_bf16 v[80:83], a[208:211], v[160:163], v[80:83]
    s_waitcnt lgkmcnt(11)
    s_add_u32 m0, s67, 49152
    ds_read_b64_tr_b16 a[238:239], v119 offset:14336
    v_mfma_f32_16x16x32_bf16 v[80:83], a[212:215], v[168:171], v[80:83]
    s_waitcnt lgkmcnt(10)
    ds_read_b64_tr_b16 a[240:241], v123 offset:0
    buffer_load_dwordx4 v96, s[56:59], s80 offen offset:0 lds
    v_mfma_f32_16x16x32_bf16 v[80:83], a[216:219], v[176:179], v[80:83]
    s_waitcnt lgkmcnt(9)
    ds_read_b64_tr_b16 a[242:243], v123 offset:2048
    v_mul_f32 v75, v75, v60
    v_mfma_f32_16x16x32_bf16 v[80:83], a[220:223], v[184:187], v[80:83]
    ds_read_b64_tr_b16 a[244:245], v123 offset:4096
    v_mul_f32 v76, v76, v61
    v_mfma_f32_16x16x32_bf16 v[84:87], a[220:223], v[188:191], v[84:87]
    ds_read_b64_tr_b16 a[246:247], v123 offset:6144
    v_mul_f32 v77, v77, v61
    v_mfma_f32_16x16x32_bf16 v[84:87], a[216:219], v[180:183], v[84:87]
    ds_read_b64_tr_b16 a[248:249], v123 offset:8192
    v_mul_f32 v78, v78, v61
    v_mul_f32 v79, v79, v61
    v_mfma_f32_16x16x32_bf16 v[84:87], a[212:215], v[172:175], v[84:87]
    ds_read_b64_tr_b16 a[250:251], v123 offset:10240
    buffer_load_dwordx4 v97, s[56:59], s80 offen offset:1024 lds
    v_mfma_f32_16x16x32_bf16 v[84:87], a[208:211], v[164:167], v[84:87]
    s_waitcnt lgkmcnt(12)
    ds_read_b64_tr_b16 a[252:253], v123 offset:12288
    v_cvt_pk_bf16_f32 v12, v72, v73
    v_mfma_f32_16x16x32_bf16 v[88:91], a[224:227], v[128:131], 0
    s_waitcnt lgkmcnt(11)
    ds_read_b64_tr_b16 a[254:255], v123 offset:14336
    v_cvt_pk_bf16_f32 v13, v74, v75
    v_mfma_f32_16x16x32_bf16 v[88:91], a[228:231], v[136:139], v[88:91]
    s_waitcnt lgkmcnt(10)
    ds_read_b64_tr_b16 a[192:193], v116 offset:16384
    v_cvt_pk_bf16_f32 v14, v76, v77
    v_cvt_pk_bf16_f32 v15, v78, v79
    buffer_store_dwordx4 v[12:15], v1, s[60:63], s75 offen sc1
    s_add_u32 s75, s75, 16384
    v_mfma_f32_16x16x32_bf16 v[88:91], a[232:235], v[144:147], v[88:91]
    s_waitcnt lgkmcnt(9)
    ds_read_b64_tr_b16 a[194:195], v116 offset:18432
    v_mfma_f32_16x16x32_bf16 v[88:91], a[236:239], v[152:155], v[88:91]
    ds_read_b64_tr_b16 a[196:197], v116 offset:20480
    buffer_load_dwordx4 v98, s[56:59], s80 offen offset:2048 lds
    v_mfma_f32_16x16x32_bf16 v[92:95], a[236:239], v[156:159], 0
    ds_read_b64_tr_b16 a[198:199], v116 offset:22528
    v_mul_f32 v80, v80, v60
    v_mfma_f32_16x16x32_bf16 v[92:95], a[232:235], v[148:151], v[92:95]
    ds_read_b64_tr_b16 a[200:201], v116 offset:24576
    v_mul_f32 v81, v81, v60
    v_mfma_f32_16x16x32_bf16 v[92:95], a[228:231], v[140:143], v[92:95]
    ds_read_b64_tr_b16 a[202:203], v116 offset:26624
    v_mul_f32 v82, v82, v60
    v_mfma_f32_16x16x32_bf16 v[92:95], a[224:227], v[132:135], v[92:95]
    s_waitcnt lgkmcnt(12)
    ds_read_b64_tr_b16 a[204:205], v116 offset:28672
    v_mul_f32 v83, v83, v60
    v_mfma_f32_16x16x32_bf16 v[88:91], a[240:243], v[160:163], v[88:91]
    s_waitcnt lgkmcnt(11)
    ds_read_b64_tr_b16 a[206:207], v116 offset:30720
    buffer_load_dwordx4 v99, s[56:59], s80 offen offset:3072 lds
    v_mfma_f32_16x16x32_bf16 v[88:91], a[244:247], v[168:171], v[88:91]
    s_waitcnt lgkmcnt(10)
    s_add_u32 s80, s80, 14336
    ds_read_b64_tr_b16 a[208:209], v120 offset:16384
    v_mfma_f32_16x16x32_bf16 v[88:91], a[248:251], v[176:179], v[88:91]
    s_waitcnt lgkmcnt(9)
    ds_read_b64_tr_b16 a[210:211], v120 offset:18432
    v_mul_f32 v84, v84, v61
    v_mfma_f32_16x16x32_bf16 v[88:91], a[252:255], v[184:187], v[88:91]
    ds_read_b64_tr_b16 a[212:213], v120 offset:20480
    v_mul_f32 v85, v85, v61
    v_mfma_f32_16x16x32_bf16 v[92:95], a[252:255], v[188:191], v[92:95]
    s_add_u32 m0, s67, 114688
    ds_read_b64_tr_b16 a[214:215], v120 offset:22528
    v_mul_f32 v86, v86, v61
    v_mfma_f32_16x16x32_bf16 v[92:95], a[248:251], v[180:183], v[92:95]
    ds_read_b64_tr_b16 a[216:217], v120 offset:24576
    buffer_load_dwordx4 v96, s[56:59], s80 offen offset:0 lds
    v_mfma_f32_16x16x32_bf16 v[92:95], a[244:247], v[172:175], v[92:95]
    ds_read_b64_tr_b16 a[218:219], v120 offset:26624
    v_mul_f32 v87, v87, v61
    v_mfma_f32_16x16x32_bf16 v[92:95], a[240:243], v[164:167], v[92:95]
    s_waitcnt lgkmcnt(12)
    ds_read_b64_tr_b16 a[220:221], v120 offset:28672
    v_cvt_pk_bf16_f32 v8, v80, v81
    v_mfma_f32_16x16x32_bf16 v[16:19], a[192:195], v[128:131], 0
    s_waitcnt lgkmcnt(11)
    ds_read_b64_tr_b16 a[222:223], v120 offset:30720
    v_cvt_pk_bf16_f32 v9, v82, v83
    v_mfma_f32_16x16x32_bf16 v[16:19], a[196:199], v[136:139], v[16:19]
    s_waitcnt lgkmcnt(10)
    ds_read_b64_tr_b16 a[224:225], v117 offset:16384
    v_cvt_pk_bf16_f32 v10, v84, v85
    v_cvt_pk_bf16_f32 v11, v86, v87
    buffer_store_dwordx4 v[8:11], v1, s[60:63], s75 offen sc1
    s_add_u32 s75, s75, 16384
    v_mfma_f32_16x16x32_bf16 v[16:19], a[200:203], v[144:147], v[16:19]
    s_waitcnt lgkmcnt(9)
    ds_read_b64_tr_b16 a[226:227], v117 offset:18432
    buffer_load_dwordx4 v97, s[56:59], s80 offen offset:1024 lds
    v_mfma_f32_16x16x32_bf16 v[16:19], a[204:207], v[152:155], v[16:19]
    ds_read_b64_tr_b16 a[228:229], v117 offset:20480
    v_mfma_f32_16x16x32_bf16 v[20:23], a[204:207], v[156:159], 0
    ds_read_b64_tr_b16 a[230:231], v117 offset:22528
    v_mul_f32 v88, v88, v60
    v_mfma_f32_16x16x32_bf16 v[20:23], a[200:203], v[148:151], v[20:23]
    ds_read_b64_tr_b16 a[232:233], v117 offset:24576
    v_mul_f32 v89, v89, v60
    v_mfma_f32_16x16x32_bf16 v[20:23], a[196:199], v[140:143], v[20:23]
    ds_read_b64_tr_b16 a[234:235], v117 offset:26624
    v_mul_f32 v90, v90, v60
    v_mov_b32 v3, 5
    v_mfma_f32_16x16x32_bf16 v[20:23], a[192:195], v[132:135], v[20:23]
    s_waitcnt lgkmcnt(12)
    s_waitcnt vmcnt(9)
    ds_read_b64_tr_b16 a[236:237], v117 offset:28672
    buffer_load_dwordx4 v98, s[56:59], s80 offen offset:2048 lds
    buffer_store_dword v3, v54, s[60:63], s3 offen sc1
    v_mfma_f32_16x16x32_bf16 v[16:19], a[208:211], v[160:163], v[16:19]
    s_waitcnt lgkmcnt(11)
    ds_read_b64_tr_b16 a[238:239], v117 offset:30720
    v_mul_f32 v91, v91, v60
    v_mfma_f32_16x16x32_bf16 v[16:19], a[212:215], v[168:171], v[16:19]
    s_waitcnt lgkmcnt(10)
    ds_read_b64_tr_b16 a[240:241], v121 offset:16384
    v_mul_f32 v92, v92, v61
    v_mfma_f32_16x16x32_bf16 v[16:19], a[216:219], v[176:179], v[16:19]
    s_waitcnt lgkmcnt(9)
    ds_read_b64_tr_b16 a[242:243], v121 offset:18432
    v_mul_f32 v93, v93, v61
    v_mfma_f32_16x16x32_bf16 v[16:19], a[220:223], v[184:187], v[16:19]
    ds_read_b64_tr_b16 a[244:245], v121 offset:20480
    v_mul_f32 v94, v94, v61
    v_mfma_f32_16x16x32_bf16 v[20:23], a[220:223], v[188:191], v[20:23]
    ds_read_b64_tr_b16 a[246:247], v121 offset:22528
    buffer_load_dwordx4 v99, s[56:59], s80 offen offset:3072 lds
    v_mfma_f32_16x16x32_bf16 v[20:23], a[216:219], v[180:183], v[20:23]
    s_add_u32 s80, s80, 14336
    ds_read_b64_tr_b16 a[248:249], v121 offset:24576
    v_mfma_f32_16x16x32_bf16 v[20:23], a[212:215], v[172:175], v[20:23]
    ds_read_b64_tr_b16 a[250:251], v121 offset:26624
    v_mul_f32 v95, v95, v61
    v_mfma_f32_16x16x32_bf16 v[20:23], a[208:211], v[164:167], v[20:23]
    s_waitcnt lgkmcnt(12)
    ds_read_b64_tr_b16 a[252:253], v121 offset:28672
    v_cvt_pk_bf16_f32 v12, v88, v89
    v_mfma_f32_16x16x32_bf16 v[24:27], a[224:227], v[128:131], 0
    s_waitcnt lgkmcnt(11)
    ds_read_b64_tr_b16 a[254:255], v121 offset:30720
    v_cvt_pk_bf16_f32 v13, v90, v91
    v_mfma_f32_16x16x32_bf16 v[24:27], a[228:231], v[136:139], v[24:27]
    s_waitcnt lgkmcnt(10)
    ds_read_b64_tr_b16 a[192:193], v118 offset:16384
    v_cvt_pk_bf16_f32 v14, v92, v93
    v_cvt_pk_bf16_f32 v15, v94, v95
    buffer_store_dwordx4 v[12:15], v1, s[60:63], s75 offen sc1
    s_add_u32 s75, s75, 16384
    v_mfma_f32_16x16x32_bf16 v[24:27], a[232:235], v[144:147], v[24:27]
    s_waitcnt lgkmcnt(9)
    ds_read_b64_tr_b16 a[194:195], v118 offset:18432
    v_mfma_f32_16x16x32_bf16 v[24:27], a[236:239], v[152:155], v[24:27]
    ds_read_b64_tr_b16 a[196:197], v118 offset:20480
    v_mfma_f32_16x16x32_bf16 v[28:31], a[236:239], v[156:159], 0
    ds_read_b64_tr_b16 a[198:199], v118 offset:22528
    v_mul_f32 v16, v16, v60
    v_mfma_f32_16x16x32_bf16 v[28:31], a[232:235], v[148:151], v[28:31]
    ds_read_b64_tr_b16 a[200:201], v118 offset:24576
    v_mul_f32 v17, v17, v60
    v_mfma_f32_16x16x32_bf16 v[28:31], a[228:231], v[140:143], v[28:31]
    ds_read_b64_tr_b16 a[202:203], v118 offset:26624
    v_mul_f32 v18, v18, v60
    v_mfma_f32_16x16x32_bf16 v[28:31], a[224:227], v[132:135], v[28:31]
    s_waitcnt lgkmcnt(12)
    ds_read_b64_tr_b16 a[204:205], v118 offset:28672
    v_mul_f32 v19, v19, v60
    v_mfma_f32_16x16x32_bf16 v[24:27], a[240:243], v[160:163], v[24:27]
    s_waitcnt lgkmcnt(11)
    ds_read_b64_tr_b16 a[206:207], v118 offset:30720
    v_mul_f32 v20, v20, v61
    v_mfma_f32_16x16x32_bf16 v[24:27], a[244:247], v[168:171], v[24:27]
    s_waitcnt lgkmcnt(10)
    ds_read_b64_tr_b16 a[208:209], v122 offset:16384
    v_mul_f32 v21, v21, v61
    v_mfma_f32_16x16x32_bf16 v[24:27], a[248:251], v[176:179], v[24:27]
    s_waitcnt lgkmcnt(9)
    ds_read_b64_tr_b16 a[210:211], v122 offset:18432
    v_mul_f32 v22, v22, v61
    v_mfma_f32_16x16x32_bf16 v[24:27], a[252:255], v[184:187], v[24:27]
    ds_read_b64_tr_b16 a[212:213], v122 offset:20480
    v_mul_f32 v23, v23, v61
    v_mfma_f32_16x16x32_bf16 v[28:31], a[252:255], v[188:191], v[28:31]
    ds_read_b64_tr_b16 a[214:215], v122 offset:22528
    v_cvt_pk_bf16_f32 v8, v16, v17
    v_mfma_f32_16x16x32_bf16 v[28:31], a[248:251], v[180:183], v[28:31]
    ds_read_b64_tr_b16 a[216:217], v122 offset:24576
    v_cvt_pk_bf16_f32 v9, v18, v19
    v_mfma_f32_16x16x32_bf16 v[28:31], a[244:247], v[172:175], v[28:31]
    ds_read_b64_tr_b16 a[218:219], v122 offset:26624
    v_cvt_pk_bf16_f32 v10, v20, v21
    v_mfma_f32_16x16x32_bf16 v[28:31], a[240:243], v[164:167], v[28:31]
    s_waitcnt lgkmcnt(12)
    ds_read_b64_tr_b16 a[220:221], v122 offset:28672
    v_cvt_pk_bf16_f32 v11, v22, v23
    v_mfma_f32_16x16x32_bf16 v[32:35], a[192:195], v[128:131], 0
    s_waitcnt lgkmcnt(11)
    ds_read_b64_tr_b16 a[222:223], v122 offset:30720
    buffer_store_dwordx4 v[8:11], v1, s[60:63], s75 offen sc1
    v_mfma_f32_16x16x32_bf16 v[32:35], a[196:199], v[136:139], v[32:35]
    s_waitcnt lgkmcnt(10)
    s_add_u32 s75, s75, 16384
    ds_read_b64_tr_b16 a[224:225], v119 offset:16384
    v_mfma_f32_16x16x32_bf16 v[32:35], a[200:203], v[144:147], v[32:35]
    s_waitcnt lgkmcnt(9)
    ds_read_b64_tr_b16 a[226:227], v119 offset:18432
    v_mfma_f32_16x16x32_bf16 v[32:35], a[204:207], v[152:155], v[32:35]
    ds_read_b64_tr_b16 a[228:229], v119 offset:20480
    v_mfma_f32_16x16x32_bf16 v[36:39], a[204:207], v[156:159], 0
    ds_read_b64_tr_b16 a[230:231], v119 offset:22528
    v_mul_f32 v24, v24, v60
    v_mfma_f32_16x16x32_bf16 v[36:39], a[200:203], v[148:151], v[36:39]
    ds_read_b64_tr_b16 a[232:233], v119 offset:24576
    v_mul_f32 v25, v25, v60
    v_mfma_f32_16x16x32_bf16 v[36:39], a[196:199], v[140:143], v[36:39]
    s_barrier
    ds_read_b64_tr_b16 a[234:235], v119 offset:26624
    v_mfma_f32_16x16x32_bf16 v[36:39], a[192:195], v[132:135], v[36:39]
    s_waitcnt lgkmcnt(12)
    ds_read_b64_tr_b16 a[236:237], v119 offset:28672
    v_mul_f32 v26, v26, v60
    v_mfma_f32_16x16x32_bf16 v[32:35], a[208:211], v[160:163], v[32:35]
    s_waitcnt lgkmcnt(11)
    s_add_u32 m0, s67, 0
    ds_read_b64_tr_b16 a[238:239], v119 offset:30720
    v_mfma_f32_16x16x32_bf16 v[32:35], a[212:215], v[168:171], v[32:35]
    s_waitcnt lgkmcnt(10)
    ds_read_b64_tr_b16 a[240:241], v123 offset:16384
    buffer_load_dwordx4 v96, s[56:59], s80 offen offset:0 lds
    v_mfma_f32_16x16x32_bf16 v[32:35], a[216:219], v[176:179], v[32:35]
    s_waitcnt lgkmcnt(9)
    ds_read_b64_tr_b16 a[242:243], v123 offset:18432
    v_mul_f32 v27, v27, v60
    v_mfma_f32_16x16x32_bf16 v[32:35], a[220:223], v[184:187], v[32:35]
    ds_read_b64_tr_b16 a[244:245], v123 offset:20480
    v_mul_f32 v28, v28, v61
    v_mul_f32 v29, v29, v61
    v_mfma_f32_16x16x32_bf16 v[36:39], a[220:223], v[188:191], v[36:39]
    ds_read_b64_tr_b16 a[246:247], v123 offset:22528
    buffer_load_dwordx4 v97, s[56:59], s80 offen offset:1024 lds
    v_mfma_f32_16x16x32_bf16 v[36:39], a[216:219], v[180:183], v[36:39]
    ds_read_b64_tr_b16 a[248:249], v123 offset:24576
    v_mul_f32 v30, v30, v61
    v_mfma_f32_16x16x32_bf16 v[36:39], a[212:215], v[172:175], v[36:39]
    ds_read_b64_tr_b16 a[250:251], v123 offset:26624
    v_mul_f32 v31, v31, v61
    v_mfma_f32_16x16x32_bf16 v[36:39], a[208:211], v[164:167], v[36:39]
    s_waitcnt lgkmcnt(12)
    ds_read_b64_tr_b16 a[252:253], v123 offset:28672
    v_cvt_pk_bf16_f32 v12, v24, v25
    v_mfma_f32_16x16x32_bf16 v[40:43], a[224:227], v[128:131], 0
    s_waitcnt lgkmcnt(11)
    ds_read_b64_tr_b16 a[254:255], v123 offset:30720
    v_cvt_pk_bf16_f32 v13, v26, v27
    v_cvt_pk_bf16_f32 v14, v28, v29
    v_cvt_pk_bf16_f32 v15, v30, v31
    v_mfma_f32_16x16x32_bf16 v[40:43], a[228:231], v[136:139], v[40:43]
    s_waitcnt lgkmcnt(10)
    buffer_load_dwordx4 v98, s[56:59], s80 offen offset:2048 lds
    buffer_store_dwordx4 v[12:15], v1, s[60:63], s75 offen sc1
    s_add_u32 s75, s75, 16384
    v_mfma_f32_16x16x32_bf16 v[40:43], a[232:235], v[144:147], v[40:43]
    s_waitcnt lgkmcnt(8)
    v_mfma_f32_16x16x32_bf16 v[40:43], a[236:239], v[152:155], v[40:43]
    v_mfma_f32_16x16x32_bf16 v[44:47], a[236:239], v[156:159], 0
    buffer_load_dwordx4 v99, s[56:59], s80 offen offset:3072 lds
    v_mfma_f32_16x16x32_bf16 v[44:47], a[232:235], v[148:151], v[44:47]
    s_add_u32 s80, s80, 14336
    v_mul_f32 v32, v32, v60
    v_mfma_f32_16x16x32_bf16 v[44:47], a[228:231], v[140:143], v[44:47]
    s_add_u32 m0, s67, 65536
    v_mul_f32 v33, v33, v60
    v_mul_f32 v34, v34, v60
    v_mfma_f32_16x16x32_bf16 v[44:47], a[224:227], v[132:135], v[44:47]
    s_waitcnt lgkmcnt(6)
    buffer_load_dwordx4 v96, s[56:59], s80 offen offset:0 lds
    v_mfma_f32_16x16x32_bf16 v[40:43], a[240:243], v[160:163], v[40:43]
    s_waitcnt lgkmcnt(4)
    v_mul_f32 v35, v35, v60
    v_mul_f32 v36, v36, v61
    v_mfma_f32_16x16x32_bf16 v[40:43], a[244:247], v[168:171], v[40:43]
    s_waitcnt lgkmcnt(2)
    v_bfe_u32 v104, v1, 4, 4
    v_mul_f32 v37, v37, v61
    v_mfma_f32_16x16x32_bf16 v[40:43], a[248:251], v[176:179], v[40:43]
    s_waitcnt lgkmcnt(0)
    buffer_load_dwordx4 v97, s[56:59], s80 offen offset:1024 lds
    v_mfma_f32_16x16x32_bf16 v[40:43], a[252:255], v[184:187], v[40:43]
    v_lshlrev_b32 v104, 2, v104
    v_mul_f32 v38, v38, v61
    v_mfma_f32_16x16x32_bf16 v[44:47], a[252:255], v[188:191], v[44:47]
    v_mul_f32 v39, v39, v61
    v_cvt_pk_bf16_f32 v8, v32, v33
    v_mfma_f32_16x16x32_bf16 v[44:47], a[248:251], v[180:183], v[44:47]
    buffer_load_dword v6, v104, s[60:63], s93 offen sc1
    v_mfma_f32_16x16x32_bf16 v[44:47], a[244:247], v[172:175], v[44:47]
    buffer_load_dwordx4 v98, s[56:59], s80 offen offset:2048 lds
    v_mfma_f32_16x16x32_bf16 v[44:47], a[240:243], v[164:167], v[44:47]
    v_cvt_pk_bf16_f32 v9, v34, v35
    v_cvt_pk_bf16_f32 v10, v36, v37
    v_cvt_pk_bf16_f32 v11, v38, v39
    buffer_load_dwordx4 v99, s[56:59], s80 offen offset:3072 lds
    buffer_store_dwordx4 v[8:11], v1, s[60:63], s75 offen sc1
    s_add_u32 s75, s75, 16384
    s_add_u32 s80, s80, 14336
    v_mov_b32 v3, 6
    s_waitcnt vmcnt(12)
    buffer_store_dword v3, v54, s[60:63], s3 offen sc1
    v_mul_f32 v40, v40, v60
    v_mul_f32 v41, v41, v60
    v_mul_f32 v42, v42, v60
    v_mul_f32 v43, v43, v60
    v_mul_f32 v44, v44, v61
    v_mul_f32 v45, v45, v61
    v_mul_f32 v46, v46, v61
    v_mul_f32 v47, v47, v61
    v_cvt_pk_bf16_f32 v12, v40, v41
    v_cvt_pk_bf16_f32 v13, v42, v43
    v_cvt_pk_bf16_f32 v14, v44, v45
    v_cvt_pk_bf16_f32 v15, v46, v47
    buffer_store_dwordx4 v[12:15], v1, s[60:63], s75 offen sc1
    s_add_u32 s75, s75, 16384
    v_mov_b32 v3, 7
    v_mov_b32 v7, 1
    v_mov_b32 v5, 0x10000
    s_mov_b32 s83, 0
    s_mov_b32 s78, 0
    s_barrier
    s_cmp_eq_u32 s76, 16
    s_cbranch_scc1 L_hot
    v_lshrrev_b32 v107, 4, v1
    v_and_b32 v108, 15, v107
    v_lshrrev_b32 v109, 4, v107
    v_bfe_u32 v110, v107, 2, 4
    v_and_b32 v111, 3, v107
    v_and_b32 v112, 7, v110
    v_lshlrev_b32 v113, 8, v110
    v_lshl_add_u32 v113, v111, 3, v113
    v_add_u32 v113, s67, v113
    v_xor_b32 v111, 0, v112
    v_lshl_add_u32 v64, v111, 5, v113
    v_add_u32 v72, 0x10000, v64
    v_add_u32 v80, 0x20000, v64
    v_xor_b32 v111, 1, v112
    v_lshl_add_u32 v65, v111, 5, v113
    v_add_u32 v73, 0x10000, v65
    v_add_u32 v81, 0x20000, v65
    v_xor_b32 v111, 2, v112
    v_lshl_add_u32 v66, v111, 5, v113
    v_add_u32 v74, 0x10000, v66
    v_add_u32 v82, 0x20000, v66
    v_xor_b32 v111, 3, v112
    v_lshl_add_u32 v67, v111, 5, v113
    v_add_u32 v75, 0x10000, v67
    v_add_u32 v83, 0x20000, v67
    v_xor_b32 v111, 4, v112
    v_lshl_add_u32 v68, v111, 5, v113
    v_add_u32 v76, 0x10000, v68
    v_add_u32 v84, 0x20000, v68
    v_xor_b32 v111, 5, v112
    v_lshl_add_u32 v69, v111, 5, v113
    v_add_u32 v77, 0x10000, v69
    v_add_u32 v85, 0x20000, v69
    v_xor_b32 v111, 6, v112
    v_lshl_add_u32 v70, v111, 5, v113
    v_add_u32 v78, 0x10000, v70
    v_add_u32 v86, 0x20000, v70
    v_xor_b32 v111, 7, v112
    v_lshl_add_u32 v71, v111, 5, v113
    v_add_u32 v79, 0x10000, v71
    v_add_u32 v87, 0x20000, v71
    v_lshrrev_b32 v110, 2, v108
    v_cmp_eq_u32 vcc, v110, v109
    v_and_b32 v111, 1, v108
    v_lshlrev_b32 v111, 4, v111
    v_mov_b32 v112, 0x3f80
    v_lshlrev_b32 v112, v111, v112
    v_cndmask_b32 v112, 0, v112, vcc
    v_and_b32 v111, 2, v108
    v_cmp_eq_u32 vcc, 0, v111
    v_mov_b32 v48, 0
    v_mov_b32 v49, 0
    v_mov_b32 v52, 0
    v_mov_b32 v53, 0
    v_cndmask_b32 v50, 0, v112, vcc
    v_cndmask_b32 v51, v112, 0, vcc
    v_and_b32 v55, 1, v109
    v_mul_u32_u24 v88, 896, v108
    v_lshl_add_u32 v88, v109, 3, v88
    v_add_u32 v89, 14336, v88
    v_add_u32 v92, 0, v1
    v_add_u32 v93, 4096, v1
    v_add_u32 v94, 8192, v1
    v_add_u32 v95, 12288, v1
    v_add_u32 v105, s67, v1
    s_lshr_b32 s84, s66, 1
    s_lshl_b32 s84, s84, 14
    s_and_b32 s82, s66, 1
    s_lshl_b32 s82, s82, 11
    s_add_u32 s82, s82, s84
    v_add_u32 v106, s82, v1
    s_waitcnt vmcnt(0)
    buffer_store_dword v3, v54, s[60:63], s3 offen sc1
    s_barrier
    v_mov_b32 v7, 0x101
    buffer_atomic_add v7, v4, s[20:23], s73 offen sc0
    s_branch L_done
L_hot:
    s_add_u32 m0, s67, 16384
    s_nop 0
    buffer_load_dwordx4 v96, s[56:59], s80 offen offset:0 lds
    buffer_load_dwordx4 v97, s[56:59], s80 offen offset:1024 lds
    buffer_load_dwordx4 v98, s[56:59], s80 offen offset:2048 lds
    buffer_load_dwordx4 v99, s[56:59], s80 offen offset:3072 lds
    s_add_u32 s80, s80, 14336
    s_add_u32 m0, s67, 81920
    s_nop 0
    buffer_load_dwordx4 v96, s[56:59], s80 offen offset:0 lds
    buffer_load_dwordx4 v97, s[56:59], s80 offen offset:1024 lds
    buffer_load_dwordx4 v98, s[56:59], s80 offen offset:2048 lds
    buffer_load_dwordx4 v99, s[56:59], s80 offen offset:3072 lds
    s_add_u32 s80, s80, 14336
    v_lshrrev_b32 v107, 4, v1
    v_and_b32 v108, 15, v107
    v_lshrrev_b32 v109, 4, v107
    v_bfe_u32 v110, v107, 2, 4
    v_and_b32 v111, 3, v107
    v_and_b32 v112, 7, v110
    v_lshlrev_b32 v113, 8, v110
    v_lshl_add_u32 v113, v111, 3, v113
    v_add_u32 v113, s67, v113
    v_xor_b32 v111, 0, v112
    v_lshl_add_u32 v64, v111, 5, v113
    v_add_u32 v72, 0x10000, v64
    v_add_u32 v80, 0x20000, v64
    v_xor_b32 v111, 1, v112
    v_lshl_add_u32 v65, v111, 5, v113
    v_add_u32 v73, 0x10000, v65
    v_add_u32 v81, 0x20000, v65
    v_xor_b32 v111, 2, v112
    v_lshl_add_u32 v66, v111, 5, v113
    v_add_u32 v74, 0x10000, v66
    v_add_u32 v82, 0x20000, v66
    v_xor_b32 v111, 3, v112
    v_lshl_add_u32 v67, v111, 5, v113
    v_add_u32 v75, 0x10000, v67
    v_add_u32 v83, 0x20000, v67
    v_xor_b32 v111, 4, v112
    v_lshl_add_u32 v68, v111, 5, v113
    v_add_u32 v76, 0x10000, v68
    v_add_u32 v84, 0x20000, v68
    v_xor_b32 v111, 5, v112
    v_lshl_add_u32 v69, v111, 5, v113
    v_add_u32 v77, 0x10000, v69
    v_add_u32 v85, 0x20000, v69
    v_xor_b32 v111, 6, v112
    v_lshl_add_u32 v70, v111, 5, v113
    v_add_u32 v78, 0x10000, v70
    v_add_u32 v86, 0x20000, v70
    v_xor_b32 v111, 7, v112
    v_lshl_add_u32 v71, v111, 5, v113
    v_add_u32 v79, 0x10000, v71
    v_add_u32 v87, 0x20000, v71
    v_lshrrev_b32 v110, 2, v108
    v_cmp_eq_u32 vcc, v110, v109
    v_and_b32 v111, 1, v108
    v_lshlrev_b32 v111, 4, v111
    v_mov_b32 v112, 0x3f80
    v_lshlrev_b32 v112, v111, v112
    v_cndmask_b32 v112, 0, v112, vcc
    v_and_b32 v111, 2, v108
    v_cmp_eq_u32 vcc, 0, v111
    v_mov_b32 v48, 0
    v_mov_b32 v49, 0
    v_mov_b32 v52, 0
    v_mov_b32 v53, 0
    v_cndmask_b32 v50, 0, v112, vcc
    v_cndmask_b32 v51, v112, 0, vcc
    v_and_b32 v55, 1, v109
    v_mul_u32_u24 v88, 896, v108
    v_lshl_add_u32 v88, v109, 3, v88
    v_add_u32 v89, 14336, v88
    v_add_u32 v92, 0, v1
    v_add_u32 v93, 4096, v1
    v_add_u32 v94, 8192, v1
    v_add_u32 v95, 12288, v1
    v_add_u32 v105, s67, v1
    s_lshr_b32 s84, s66, 1
    s_lshl_b32 s84, s84, 14
    s_and_b32 s82, s66, 1
    s_lshl_b32 s82, s82, 11
    s_add_u32 s82, s82, s84
    v_add_u32 v106, s82, v1
L_roles:
    s_mul_i32 s84, s16, 28672
    s_lshl_b32 s85, s19, 8
    s_add_u32 s84, s84, s85
    s_lshl_b32 s85, s66, 5
    s_add_u32 s10, s84, s85
    s_add_u32 s11, s10, 128
    s_mul_i32 s82, s16, 28
    s_lshl_b32 s84, s19, 3
    s_add_u32 s82, s82, s84
    s_add_u32 s82, s82, s66
    s_lshl_b32 s8, s82, 14
    s_add_u32 s9, s8, 0x10000
    s_cmp_eq_u32 s19, 3
    s_cselect_b32 s4, 0xffff, -1
    s_cselect_b32 s11, 0x40000000, s11
    s_mov_b32 s79, 3000
    s_lshl_b32 s82, s19, 1
    v_add_u32 v90, s82, v55
    v_mov_b32 v24, 0
    v_mov_b32 v25, 0
    v_mov_b32 v26, 0
    v_mov_b32 v27, 0
    v_mov_b32 v28, 0
    v_mov_b32 v29, 0
    v_mov_b32 v30, 0
    v_mov_b32 v31, 0
    v_mov_b32 v32, 0
    v_mov_b32 v33, 0
    v_mov_b32 v34, 0
    v_mov_b32 v35, 0
    v_mov_b32 v36, 0
    v_mov_b32 v37, 0
    v_mov_b32 v38, 0
    v_mov_b32 v39, 0
    s_waitcnt vmcnt(13)
    ds_read_b64_tr_b16 a[192:193], v80 offset:0
    ds_read_b64_tr_b16 a[194:195], v80 offset:16384
    ds_read_b64_tr_b16 a[196:197], v81 offset:0
    ds_read_b64_tr_b16 a[198:199], v81 offset:16384
    ds_read_b64_tr_b16 a[200:201], v82 offset:0
    ds_read_b64_tr_b16 a[202:203], v82 offset:16384
    ds_read_b64_tr_b16 a[204:205], v83 offset:0
    ds_read_b64_tr_b16 a[206:207], v83 offset:16384
    ds_read_b64_tr_b16 a[208:209], v84 offset:0
    ds_read_b64_tr_b16 a[210:211], v84 offset:16384
    ds_read_b64_tr_b16 a[212:213], v85 offset:0
    ds_read_b64_tr_b16 a[214:215], v85 offset:16384
    s_waitcnt lgkmcnt(10)
    v_mfma_f32_16x16x32_bf16 a[0:3], a[192:195], v[192:195], 0
    ds_read_b64_tr_b16 a[216:217], v86 offset:0
    v_mfma_f32_16x16x32_bf16 a[4:7], a[192:195], v[196:199], 0
    ds_read_b64_tr_b16 a[218:219], v86 offset:16384
    s_waitcnt lgkmcnt(10)
    v_mfma_f32_16x16x32_bf16 a[8:11], a[196:199], v[192:195], 0
    ds_read_b64_tr_b16 a[220:221], v87 offset:0
    v_mfma_f32_16x16x32_bf16 a[12:15], a[196:199], v[196:199], 0
    ds_read_b64_tr_b16 a[222:223], v87 offset:16384
    s_waitcnt lgkmcnt(10)
    v_mfma_f32_16x16x32_bf16 a[16:19], a[200:203], v[192:195], 0
    ds_read_b64_tr_b16 a[224:225], v64 offset:32768
    v_mfma_f32_16x16x32_bf16 a[20:23], a[200:203], v[196:199], 0
    ds_read_b64_tr_b16 a[226:227], v72 offset:32768
    s_waitcnt lgkmcnt(10)
    v_mfma_f32_16x16x32_bf16 a[24:27], a[204:207], v[192:195], 0
    ds_read_b64_tr_b16 a[228:229], v65 offset:32768
    v_mfma_f32_16x16x32_bf16 a[28:31], a[204:207], v[196:199], 0
    ds_read_b64_tr_b16 a[230:231], v73 offset:32768
    s_waitcnt lgkmcnt(10)
    v_mfma_f32_16x16x32_bf16 a[32:35], a[208:211], v[192:195], 0
    ds_read_b64_tr_b16 a[232:233], v66 offset:32768
    v_mfma_f32_16x16x32_bf16 a[36:39], a[208:211], v[196:199], 0
    ds_read_b64_tr_b16 a[234:235], v74 offset:32768
    s_waitcnt lgkmcnt(10)
    v_mfma_f32_16x16x32_bf16 a[40:43], a[212:215], v[192:195], 0
    ds_read_b64_tr_b16 a[236:237], v67 offset:32768
    v_mfma_f32_16x16x32_bf16 a[44:47], a[212:215], v[196:199], 0
    ds_read_b64_tr_b16 a[238:239], v75 offset:32768
    s_waitcnt lgkmcnt(10)
    v_mfma_f32_16x16x32_bf16 a[48:51], a[216:219], v[192:195], 0
    ds_read_b64_tr_b16 a[240:241], v68 offset:32768
    v_mfma_f32_16x16x32_bf16 a[52:55], a[216:219], v[196:199], 0
    ds_read_b64_tr_b16 a[242:243], v76 offset:32768
    s_waitcnt lgkmcnt(10)
    v_mfma_f32_16x16x32_bf16 a[56:59], a[220:223], v[192:195], 0
    ds_read_b64_tr_b16 a[244:245], v69 offset:32768
    v_mfma_f32_16x16x32_bf16 a[60:63], a[220:223], v[196:199], 0
    ds_read_b64_tr_b16 a[246:247], v77 offset:32768
    s_add_u32 m0, s67, 131072
    s_nop 0
    buffer_load_dwordx4 v96, s[56:59], s80 offen offset:0 lds
    s_waitcnt lgkmcnt(10)
    v_mfma_f32_16x16x32_bf16 a[0:3], a[224:227], v[200:203], a[0:3]
    ds_read_b64_tr_b16 a[248:249], v70 offset:32768
    v_mfma_f32_16x16x32_bf16 a[4:7], a[224:227], v[204:207], a[4:7]
    ds_read_b64_tr_b16 a[250:251], v78 offset:32768
    buffer_load_dwordx4 v97, s[56:59], s80 offen offset:1024 lds
    s_waitcnt lgkmcnt(10)
    v_mfma_f32_16x16x32_bf16 a[8:11], a[228:231], v[200:203], a[8:11]
    ds_read_b64_tr_b16 a[252:253], v71 offset:32768
    v_mfma_f32_16x16x32_bf16 a[12:15], a[228:231], v[204:207], a[12:15]
    ds_read_b64_tr_b16 a[254:255], v79 offset:32768
    buffer_load_dwordx4 v98, s[56:59], s80 offen offset:2048 lds
    s_waitcnt lgkmcnt(10)
    v_mfma_f32_16x16x32_bf16 a[16:19], a[232:235], v[200:203], a[16:19]
    ds_read_b64_tr_b16 a[192:193], v64 offset:49152
    v_mfma_f32_16x16x32_bf16 a[20:23], a[232:235], v[204:207], a[20:23]
    ds_read_b64_tr_b16 a[194:195], v72 offset:49152
    s_waitcnt vmcnt(11)
    buffer_store_dword v3, v54, s[60:63], s3 offen sc1
    buffer_load_dwordx4 v99, s[56:59], s80 offen offset:3072 lds
    s_add_u32 s80, s80, 14336
    s_waitcnt lgkmcnt(10)
    v_mfma_f32_16x16x32_bf16 a[24:27], a[236:239], v[200:203], a[24:27]
    ds_read_b64_tr_b16 a[196:197], v65 offset:49152
    v_mfma_f32_16x16x32_bf16 a[28:31], a[236:239], v[204:207], a[28:31]
    ds_read_b64_tr_b16 a[198:199], v73 offset:49152
    v_cmp_lt_u32 vcc, v90, v6
    s_cmp_eq_u32 s83, 1
    s_cselect_b32 s14, -1, vcc_lo
    s_and_b32 s14, s14, s4
    s_and_b32 s14, s14, 0xffffff
    s_andn2_b32 s4, s4, s14
    s_call_b64 s[88:89], L_loadpass
    s_add_u32 m0, s67, 147456
    s_nop 0
    buffer_load_dwordx4 v96, s[56:59], s80 offen offset:0 lds
    s_waitcnt lgkmcnt(10)
    v_mfma_f32_16x16x32_bf16 a[32:35], a[240:243], v[200:203], a[32:35]
    ds_read_b64_tr_b16 a[200:201], v66 offset:49152
    v_mfma_f32_16x16x32_bf16 a[36:39], a[240:243], v[204:207], a[36:39]
    ds_read_b64_tr_b16 a[202:203], v74 offset:49152
    buffer_load_dwordx4 v97, s[56:59], s80 offen offset:1024 lds
    s_waitcnt lgkmcnt(10)
    v_mfma_f32_16x16x32_bf16 a[40:43], a[244:247], v[200:203], a[40:43]
    ds_read_b64_tr_b16 a[204:205], v67 offset:49152
    v_mfma_f32_16x16x32_bf16 a[44:47], a[244:247], v[204:207], a[44:47]
    ds_read_b64_tr_b16 a[206:207], v75 offset:49152
    buffer_load_dwordx4 v98, s[56:59], s80 offen offset:2048 lds
    s_waitcnt lgkmcnt(10)
    v_mfma_f32_16x16x32_bf16 a[48:51], a[248:251], v[200:203], a[48:51]
    ds_read_b64_tr_b16 a[208:209], v68 offset:49152
    v_mfma_f32_16x16x32_bf16 a[52:55], a[248:251], v[204:207], a[52:55]
    ds_read_b64_tr_b16 a[210:211], v76 offset:49152
    buffer_load_dwordx4 v99, s[56:59], s80 offen offset:3072 lds
    s_add_u32 s80, s80, 14336
    s_waitcnt lgkmcnt(10)
    v_mfma_f32_16x16x32_bf16 a[56:59], a[252:255], v[200:203], a[56:59]
    ds_read_b64_tr_b16 a[212:213], v69 offset:49152
    v_mfma_f32_16x16x32_bf16 a[60:63], a[252:255], v[204:207], a[60:63]
    ds_read_b64_tr_b16 a[214:215], v77 offset:49152
    s_add_u32 m0, s67, 32768
    s_nop 0
    buffer_load_dwordx4 v96, s[56:59], s80 offen offset:0 lds
    s_waitcnt lgkmcnt(10)
    v_mfma_f32_16x16x32_bf16 a[0:3], a[192:195], v[208:211], a[0:3]
    ds_read_b64_tr_b16 a[216:217], v70 offset:49152
    v_mfma_f32_16x16x32_bf16 a[4:7], a[192:195], v[212:215], a[4:7]
    ds_read_b64_tr_b16 a[218:219], v78 offset:49152
    buffer_load_dwordx4 v97, s[56:59], s80 offen offset:1024 lds
    s_waitcnt lgkmcnt(10)
    v_mfma_f32_16x16x32_bf16 a[8:11], a[196:199], v[208:211], a[8:11]
    ds_read_b64_tr_b16 a[220:221], v71 offset:49152
    v_mfma_f32_16x16x32_bf16 a[12:15], a[196:199], v[212:215], a[12:15]
    ds_read_b64_tr_b16 a[222:223], v79 offset:49152
    buffer_load_dwordx4 v98, s[56:59], s80 offen offset:2048 lds
    s_waitcnt lgkmcnt(10)
    v_mfma_f32_16x16x32_bf16 a[16:19], a[200:203], v[208:211], a[16:19]
    ds_read_b64_tr_b16 a[224:225], v64 offset:0
    v_mfma_f32_16x16x32_bf16 a[20:23], a[200:203], v[212:215], a[20:23]
    ds_read_b64_tr_b16 a[226:227], v64 offset:0
    buffer_load_dwordx4 v99, s[56:59], s80 offen offset:3072 lds
    s_add_u32 s80, s80, 14336
    s_waitcnt lgkmcnt(10)
    v_mfma_f32_16x16x32_bf16 a[24:27], a[204:207], v[208:211], a[24:27]
    ds_read_b64_tr_b16 a[228:229], v65 offset:0
    v_mfma_f32_16x16x32_bf16 a[28:31], a[204:207], v[212:215], a[28:31]
    ds_read_b64_tr_b16 a[230:231], v65 offset:0
    s_add_u32 m0, s67, 98304
    s_nop 0
    buffer_load_dwordx4 v96, s[56:59], s80 offen offset:0 lds
    s_waitcnt lgkmcnt(10)
    v_mfma_f32_16x16x32_bf16 a[32:35], a[208:211], v[208:211], a[32:35]
    ds_read_b64_tr_b16 a[232:233], v66 offset:0
    v_mfma_f32_16x16x32_bf16 a[36:39], a[208:211], v[212:215], a[36:39]
    ds_read_b64_tr_b16 a[234:235], v66 offset:0
    buffer_load_dwordx4 v97, s[56:59], s80 offen offset:1024 lds
    s_waitcnt lgkmcnt(10)
    v_mfma_f32_16x16x32_bf16 a[40:43], a[212:215], v[208:211], a[40:43]
    ds_read_b64_tr_b16 a[236:237], v67 offset:0
    v_mfma_f32_16x16x32_bf16 a[44:47], a[212:215], v[212:215], a[44:47]
    ds_read_b64_tr_b16 a[238:239], v67 offset:0
    buffer_load_dwordx4 v98, s[56:59], s80 offen offset:2048 lds
    s_waitcnt lgkmcnt(10)
    v_mfma_f32_16x16x32_bf16 a[48:51], a[216:219], v[208:211], a[48:51]
    ds_read_b64_tr_b16 a[240:241], v68 offset:0
    v_mfma_f32_16x16x32_bf16 a[52:55], a[216:219], v[212:215], a[52:55]
    ds_read_b64_tr_b16 a[242:243], v68 offset:0
    buffer_load_dwordx4 v99, s[56:59], s80 offen offset:3072 lds
    s_add_u32 s80, s80, 14336
    s_waitcnt lgkmcnt(10)
    v_mfma_f32_16x16x32_bf16 a[56:59], a[220:223], v[208:211], a[56:59]
    ds_read_b64_tr_b16 a[244:245], v69 offset:0
    v_mfma_f32_16x16x32_bf16 a[60:63], a[220:223], v[212:215], a[60:63]
    ds_read_b64_tr_b16 a[246:247], v69 offset:0
    s_add_u32 m0, s67, 49152
    s_nop 0
    buffer_load_dwordx4 v96, s[56:59], s80 offen offset:0 lds
    s_waitcnt lgkmcnt(10)
    v_mfma_f32_16x16x32_bf16 a[0:3], a[224:227], v[216:219], a[0:3]
    ds_read_b64_tr_b16 a[248:249], v70 offset:0
    v_mfma_f32_16x16x32_bf16 a[4:7], a[224:227], v[220:223], a[4:7]
    ds_read_b64_tr_b16 a[250:251], v70 offset:0
    buffer_load_dwordx4 v97, s[56:59], s80 offen offset:1024 lds
    s_waitcnt lgkmcnt(10)
    v_mfma_f32_16x16x32_bf16 a[8:11], a[228:231], v[216:219], a[8:11]
    ds_read_b64_tr_b16 a[252:253], v71 offset:0
    v_mfma_f32_16x16x32_bf16 a[12:15], a[228:231], v[220:223], a[12:15]
    ds_read_b64_tr_b16 a[254:255], v71 offset:0
    buffer_load_dwordx4 v98, s[56:59], s80 offen offset:2048 lds
    s_waitcnt lgkmcnt(10)
    v_mfma_f32_16x16x32_bf16 a[16:19], a[232:235], v[216:219], a[16:19]
    ds_read_b64_tr_b16 a[192:193], v72 offset:0
    v_mfma_f32_16x16x32_bf16 a[20:23], a[232:235], v[220:223], a[20:23]
    s_waitcnt vmcnt(24)
    ds_read_b64_tr_b16 a[194:195], v64 offset:16384
    buffer_load_dwordx4 v99, s[56:59], s80 offen offset:3072 lds
    s_add_u32 s80, s80, 14336
    s_waitcnt lgkmcnt(10)
    v_mfma_f32_16x16x32_bf16 a[24:27], a[236:239], v[216:219], a[24:27]
    ds_read_b64_tr_b16 a[196:197], v73 offset:0
    v_mfma_f32_16x16x32_bf16 a[28:31], a[236:239], v[220:223], a[28:31]
    ds_read_b64_tr_b16 a[198:199], v65 offset:16384
    s_add_u32 m0, s67, 114688
    s_nop 0
    buffer_load_dwordx4 v96, s[56:59], s80 offen offset:0 lds
    s_waitcnt lgkmcnt(10)
    v_mfma_f32_16x16x32_bf16 a[32:35], a[240:243], v[216:219], a[32:35]
    ds_read_b64_tr_b16 a[200:201], v74 offset:0
    v_mfma_f32_16x16x32_bf16 a[36:39], a[240:243], v[220:223], a[36:39]
    ds_read_b64_tr_b16 a[202:203], v66 offset:16384
    buffer_load_dwordx4 v97, s[56:59], s80 offen offset:1024 lds
    s_waitcnt lgkmcnt(10)
    v_mfma_f32_16x16x32_bf16 a[40:43], a[244:247], v[216:219], a[40:43]
    ds_read_b64_tr_b16 a[204:205], v75 offset:0
    v_mfma_f32_16x16x32_bf16 a[44:47], a[244:247], v[220:223], a[44:47]
    ds_read_b64_tr_b16 a[206:207], v67 offset:16384
    buffer_load_dwordx4 v98, s[56:59], s80 offen offset:2048 lds
    s_waitcnt lgkmcnt(10)
    v_mfma_f32_16x16x32_bf16 a[48:51], a[248:251], v[216:219], a[48:51]
    ds_read_b64_tr_b16 a[208:209], v76 offset:0
    v_mfma_f32_16x16x32_bf16 a[52:55], a[248:251], v[220:223], a[52:55]
    ds_read_b64_tr_b16 a[210:211], v68 offset:16384
    buffer_load_dwordx4 v99, s[56:59], s80 offen offset:3072 lds
    s_add_u32 s80, s80, 14336
    s_waitcnt lgkmcnt(10)
    v_mfma_f32_16x16x32_bf16 a[56:59], a[252:255], v[216:219], a[56:59]
    ds_read_b64_tr_b16 a[212:213], v77 offset:0
    v_mfma_f32_16x16x32_bf16 a[60:63], a[252:255], v[220:223], a[60:63]
    ds_read_b64_tr_b16 a[214:215], v69 offset:16384
    s_add_u32 m0, s67, 0
    s_nop 0
    buffer_load_dwordx4 v96, s[56:59], s80 offen offset:0 lds
    s_waitcnt lgkmcnt(10)
    v_mfma_f32_16x16x32_bf16 a[0:3], a[192:195], v[224:227], a[0:3]
    ds_read_b64_tr_b16 a[216:217], v78 offset:0
    v_mfma_f32_16x16x32_bf16 a[4:7], a[192:195], v[228:231], a[4:7]
    ds_read_b64_tr_b16 a[218:219], v70 offset:16384
    buffer_load_dwordx4 v97, s[56:59], s80 offen offset:1024 lds
    s_waitcnt lgkmcnt(10)
    v_mfma_f32_16x16x32_bf16 a[8:11], a[196:199], v[224:227], a[8:11]
    ds_read_b64_tr_b16 a[220:221], v79 offset:0
    v_mfma_f32_16x16x32_bf16 a[12:15], a[196:199], v[228:231], a[12:15]
    ds_read_b64_tr_b16 a[222:223], v71 offset:16384
    buffer_load_dwordx4 v98, s[56:59], s80 offen offset:2048 lds
    s_waitcnt lgkmcnt(10)
    v_mfma_f32_16x16x32_bf16 a[16:19], a[200:203], v[224:227], a[16:19]
    s_waitcnt vmcnt(28)
    ds_read_b64_tr_b16 a[224:225], v72 offset:16384
    v_mfma_f32_16x16x32_bf16 a[20:23], a[200:203], v[228:231], a[20:23]
    s_waitcnt vmcnt(23)
    ds_read_b64_tr_b16 a[226:227], v80 offset:0
    buffer_load_dwordx4 v99, s[56:59], s80 offen offset:3072 lds
    s_add_u32 s80, s80, 14336
    s_waitcnt lgkmcnt(10)
    v_mfma_f32_16x16x32_bf16 a[24:27], a[204:207], v[224:227], a[24:27]
    ds_read_b64_tr_b16 a[228:229], v73 offset:16384
    v_mfma_f32_16x16x32_bf16 a[28:31], a[204:207], v[228:231], a[28:31]
    ds_read_b64_tr_b16 a[230:231], v81 offset:0
    s_waitcnt lgkmcnt(10)
    v_mfma_f32_16x16x32_bf16 a[32:35], a[208:211], v[224:227], a[32:35]
    ds_read_b64_tr_b16 a[232:233], v74 offset:16384
    v_mfma_f32_16x16x32_bf16 a[36:39], a[208:211], v[228:231], a[36:39]
    ds_read_b64_tr_b16 a[234:235], v82 offset:0
    s_waitcnt lgkmcnt(10)
    v_mfma_f32_16x16x32_bf16 a[40:43], a[212:215], v[224:227], a[40:43]
    ds_read_b64_tr_b16 a[236:237], v75 offset:16384
    v_mfma_f32_16x16x32_bf16 a[44:47], a[212:215], v[228:231], a[44:47]
    ds_read_b64_tr_b16 a[238:239], v83 offset:0
    s_waitcnt lgkmcnt(10)
    v_mfma_f32_16x16x32_bf16 a[48:51], a[216:219], v[224:227], a[48:51]
    ds_read_b64_tr_b16 a[240:241], v76 offset:16384
    v_mfma_f32_16x16x32_bf16 a[52:55], a[216:219], v[228:231], a[52:55]
    ds_read_b64_tr_b16 a[242:243], v84 offset:0
    s_waitcnt lgkmcnt(10)
    v_mfma_f32_16x16x32_bf16 a[56:59], a[220:223], v[224:227], a[56:59]
    ds_read_b64_tr_b16 a[244:245], v77 offset:16384
    v_mfma_f32_16x16x32_bf16 a[60:63], a[220:223], v[228:231], a[60:63]
    ds_read_b64_tr_b16 a[246:247], v85 offset:0
    s_add_u32 m0, s67, 65536
    s_nop 0
    buffer_load_dwordx4 v96, s[56:59], s80 offen offset:0 lds
    s_waitcnt lgkmcnt(10)
    v_mfma_f32_16x16x32_bf16 a[0:3], a[224:227], v[232:235], a[0:3]
    ds_read_b64_tr_b16 a[248:249], v78 offset:16384
    v_mfma_f32_16x16x32_bf16 a[4:7], a[224:227], v[236:239], a[4:7]
    ds_read_b64_tr_b16 a[250:251], v86 offset:0
    buffer_load_dwordx4 v97, s[56:59], s80 offen offset:1024 lds
    s_waitcnt lgkmcnt(10)
    v_mfma_f32_16x16x32_bf16 a[8:11], a[228:231], v[232:235], a[8:11]
    ds_read_b64_tr_b16 a[252:253], v79 offset:16384
    v_mfma_f32_16x16x32_bf16 a[12:15], a[228:231], v[236:239], a[12:15]
    ds_read_b64_tr_b16 a[254:255], v87 offset:0
    buffer_load_dwordx4 v98, s[56:59], s80 offen offset:2048 lds
    s_waitcnt lgkmcnt(10)
    v_mfma_f32_16x16x32_bf16 a[16:19], a[232:235], v[232:235], a[16:19]
    s_waitcnt vmcnt(23)
    ds_read_b64_tr_b16 a[192:193], v80 offset:16384
    v_mfma_f32_16x16x32_bf16 a[20:23], a[232:235], v[236:239], a[20:23]
    s_waitcnt vmcnt(19)
    ds_read_b64_tr_b16 a[194:195], v64 offset:32768
    buffer_load_dwordx4 v99, s[56:59], s80 offen offset:3072 lds
    s_add_u32 s80, s80, 14336
    s_waitcnt lgkmcnt(10)
    v_mfma_f32_16x16x32_bf16 a[24:27], a[236:239], v[232:235], a[24:27]
    ds_read_b64_tr_b16 a[196:197], v81 offset:16384
    v_mfma_f32_16x16x32_bf16 a[28:31], a[236:239], v[236:239], a[28:31]
    ds_read_b64_tr_b16 a[198:199], v65 offset:32768
    s_add_u32 m0, s67, 16384
    s_nop 0
    buffer_load_dwordx4 v96, s[56:59], s80 offen offset:0 lds
    s_waitcnt lgkmcnt(10)
    v_mfma_f32_16x16x32_bf16 a[32:35], a[240:243], v[232:235], a[32:35]
    ds_read_b64_tr_b16 a[200:201], v82 offset:16384
    v_mfma_f32_16x16x32_bf16 a[36:39], a[240:243], v[236:239], a[36:39]
    ds_read_b64_tr_b16 a[202:203], v66 offset:32768
    buffer_load_dwordx4 v97, s[56:59], s80 offen offset:1024 lds
    s_waitcnt lgkmcnt(10)
    v_mfma_f32_16x16x32_bf16 a[40:43], a[244:247], v[232:235], a[40:43]
    ds_read_b64_tr_b16 a[204:205], v83 offset:16384
    v_mfma_f32_16x16x32_bf16 a[44:47], a[244:247], v[236:239], a[44:47]
    ds_read_b64_tr_b16 a[206:207], v67 offset:32768
    buffer_load_dwordx4 v98, s[56:59], s80 offen offset:2048 lds
    s_waitcnt lgkmcnt(10)
    v_mfma_f32_16x16x32_bf16 a[48:51], a[248:251], v[232:235], a[48:51]
    ds_read_b64_tr_b16 a[208:209], v84 offset:16384
    v_mfma_f32_16x16x32_bf16 a[52:55], a[248:251], v[236:239], a[52:55]
    ds_read_b64_tr_b16 a[210:211], v68 offset:32768
    buffer_load_dwordx4 v99, s[56:59], s80 offen offset:3072 lds
    s_add_u32 s80, s80, 14336
    s_waitcnt lgkmcnt(10)
    v_mfma_f32_16x16x32_bf16 a[56:59], a[252:255], v[232:235], a[56:59]
    ds_read_b64_tr_b16 a[212:213], v85 offset:16384
    v_mfma_f32_16x16x32_bf16 a[60:63], a[252:255], v[236:239], a[60:63]
    ds_read_b64_tr_b16 a[214:215], v69 offset:32768
    s_add_u32 m0, s67, 81920
    s_nop 0
    buffer_load_dwordx4 v96, s[56:59], s80 offen offset:0 lds
    s_waitcnt lgkmcnt(10)
    v_mfma_f32_16x16x32_bf16 a[0:3], a[192:195], v[240:243], a[0:3]
    ds_read_b64_tr_b16 a[216:217], v86 offset:16384
    v_mfma_f32_16x16x32_bf16 a[4:7], a[192:195], v[244:247], a[4:7]
    ds_read_b64_tr_b16 a[218:219], v70 offset:32768
    buffer_load_dwordx4 v97, s[56:59], s80 offen offset:1024 lds
    s_waitcnt lgkmcnt(10)
    v_mfma_f32_16x16x32_bf16 a[8:11], a[196:199], v[240:243], a[8:11]
    ds_read_b64_tr_b16 a[220:221], v87 offset:16384
    v_mfma_f32_16x16x32_bf16 a[12:15], a[196:199], v[244:247], a[12:15]
    ds_read_b64_tr_b16 a[222:223], v71 offset:32768
    buffer_load_dwordx4 v98, s[56:59], s80 offen offset:2048 lds
    s_waitcnt lgkmcnt(10)
    v_mfma_f32_16x16x32_bf16 a[16:19], a[200:203], v[240:243], a[16:19]
    s_waitcnt vmcnt(23)
    ds_read_b64_tr_b16 a[224:225], v72 offset:32768
    v_mfma_f32_16x16x32_bf16 a[20:23], a[200:203], v[244:247], a[20:23]
    ds_read_b64_tr_b16 a[226:227], v72 offset:32768
    buffer_load_dwordx4 v99, s[56:59], s80 offen offset:3072 lds
    s_add_u32 s80, s80, 14336
    s_waitcnt lgkmcnt(10)
    v_mfma_f32_16x16x32_bf16 a[24:27], a[204:207], v[240:243], a[24:27]
    ds_read_b64_tr_b16 a[228:229], v73 offset:32768
    v_mfma_f32_16x16x32_bf16 a[28:31], a[204:207], v[244:247], a[28:31]
    ds_read_b64_tr_b16 a[230:231], v73 offset:32768
    s_add_u32 m0, s67, 131072
    s_nop 0
    buffer_load_dwordx4 v96, s[56:59], s80 offen offset:0 lds
    s_waitcnt lgkmcnt(10)
    v_mfma_f32_16x16x32_bf16 a[32:35], a[208:211], v[240:243], a[32:35]
    ds_read_b64_tr_b16 a[232:233], v74 offset:32768
    v_mfma_f32_16x16x32_bf16 a[36:39], a[208:211], v[244:247], a[36:39]
    ds_read_b64_tr_b16 a[234:235], v74 offset:32768
    buffer_load_dwordx4 v97, s[56:59], s80 offen offset:1024 lds
    s_waitcnt lgkmcnt(10)
    v_mfma_f32_16x16x32_bf16 a[40:43], a[212:215], v[240:243], a[40:43]
    ds_read_b64_tr_b16 a[236:237], v75 offset:32768
    v_mfma_f32_16x16x32_bf16 a[44:47], a[212:215], v[244:247], a[44:47]
    ds_read_b64_tr_b16 a[238:239], v75 offset:32768
    buffer_load_dwordx4 v98, s[56:59], s80 offen offset:2048 lds
    s_waitcnt lgkmcnt(10)
    v_mfma_f32_16x16x32_bf16 a[48:51], a[216:219], v[240:243], a[48:51]
    ds_read_b64_tr_b16 a[240:241], v76 offset:32768
    v_mfma_f32_16x16x32_bf16 a[52:55], a[216:219], v[244:247], a[52:55]
    ds_read_b64_tr_b16 a[242:243], v76 offset:32768
    buffer_load_dwordx4 v99, s[56:59], s80 offen offset:3072 lds
    s_add_u32 s80, s80, 14336
    s_waitcnt lgkmcnt(10)
    v_mfma_f32_16x16x32_bf16 a[56:59], a[220:223], v[240:243], a[56:59]
    ds_read_b64_tr_b16 a[244:245], v77 offset:32768
    v_mfma_f32_16x16x32_bf16 a[60:63], a[220:223], v[244:247], a[60:63]
    ds_read_b64_tr_b16 a[246:247], v77 offset:32768
    s_add_u32 m0, s67, 147456
    s_nop 0
    buffer_load_dwordx4 v96, s[56:59], s80 offen offset:0 lds
    s_waitcnt lgkmcnt(10)
    v_mfma_f32_16x16x32_bf16 a[0:3], a[224:227], v[248:251], a[0:3]
    ds_read_b64_tr_b16 a[248:249], v78 offset:32768
    v_mfma_f32_16x16x32_bf16 a[4:7], a[224:227], v[252:255], a[4:7]
    ds_read_b64_tr_b16 a[250:251], v78 offset:32768
    buffer_load_dwordx4 v97, s[56:59], s80 offen offset:1024 lds
    s_waitcnt lgkmcnt(10)
    v_mfma_f32_16x16x32_bf16 a[8:11], a[228:231], v[248:251], a[8:11]
    ds_read_b64_tr_b16 a[252:253], v79 offset:32768
    v_mfma_f32_16x16x32_bf16 a[12:15], a[228:231], v[252:255], a[12:15]
    ds_read_b64_tr_b16 a[254:255], v79 offset:32768
    buffer_load_dwordx4 v98, s[56:59], s80 offen offset:2048 lds
    s_waitcnt lgkmcnt(10)
    v_mfma_f32_16x16x32_bf16 a[16:19], a[232:235], v[248:251], a[16:19]
    s_waitcnt vmcnt(27)
    ds_read_b64_tr_b16 a[192:193], v64 offset:49152
    v_mfma_f32_16x16x32_bf16 a[20:23], a[232:235], v[252:255], a[20:23]
    s_waitcnt vmcnt(23)
    ds_read_b64_tr_b16 a[194:195], v72 offset:49152
    buffer_load_dwordx4 v99, s[56:59], s80 offen offset:3072 lds
    s_add_u32 s80, s80, 14336
    s_waitcnt lgkmcnt(10)
    v_mfma_f32_16x16x32_bf16 a[24:27], a[236:239], v[248:251], a[24:27]
    ds_read_b64_tr_b16 a[196:197], v65 offset:49152
    v_mfma_f32_16x16x32_bf16 a[28:31], a[236:239], v[252:255], a[28:31]
    ds_read_b64_tr_b16 a[198:199], v73 offset:49152
    s_add_u32 m0, s67, 32768
    s_nop 0
    buffer_load_dwordx4 v96, s[56:59], s80 offen offset:0 lds
    s_waitcnt lgkmcnt(10)
    v_mfma_f32_16x16x32_bf16 a[32:35], a[240:243], v[248:251], a[32:35]
    ds_read_b64_tr_b16 a[200:201], v66 offset:49152
    v_mfma_f32_16x16x32_bf16 a[36:39], a[240:243], v[252:255], a[36:39]
    ds_read_b64_tr_b16 a[202:203], v74 offset:49152
    buffer_load_dwordx4 v97, s[56:59], s80 offen offset:1024 lds
    s_waitcnt lgkmcnt(10)
    v_mfma_f32_16x16x32_bf16 a[40:43], a[244:247], v[248:251], a[40:43]
    ds_read_b64_tr_b16 a[204:205], v67 offset:49152
    v_mfma_f32_16x16x32_bf16 a[44:47], a[244:247], v[252:255], a[44:47]
    ds_read_b64_tr_b16 a[206:207], v75 offset:49152
    buffer_load_dwordx4 v98, s[56:59], s80 offen offset:2048 lds
    s_waitcnt lgkmcnt(10)
    v_mfma_f32_16x16x32_bf16 a[48:51], a[248:251], v[248:251], a[48:51]
    ds_read_b64_tr_b16 a[208:209], v68 offset:49152
    v_mfma_f32_16x16x32_bf16 a[52:55], a[248:251], v[252:255], a[52:55]
    ds_read_b64_tr_b16 a[210:211], v76 offset:49152
    buffer_load_dwordx4 v99, s[56:59], s80 offen offset:3072 lds
    s_add_u32 s80, s80, 14336
    s_waitcnt lgkmcnt(10)
    v_mfma_f32_16x16x32_bf16 a[56:59], a[252:255], v[248:251], a[56:59]
    ds_read_b64_tr_b16 a[212:213], v69 offset:49152
    v_mfma_f32_16x16x32_bf16 a[60:63], a[252:255], v[252:255], a[60:63]
    ds_read_b64_tr_b16 a[214:215], v77 offset:49152
    s_add_u32 m0, s67, 98304
    s_nop 0
    buffer_load_dwordx4 v96, s[56:59], s80 offen offset:0 lds
    s_waitcnt lgkmcnt(10)
    v_mfma_f32_16x16x32_bf16 a[0:3], a[192:195], a[128:131], a[0:3]
    ds_read_b64_tr_b16 a[216:217], v70 offset:49152
    v_mfma_f32_16x16x32_bf16 a[4:7], a[192:195], a[132:135], a[4:7]
    ds_read_b64_tr_b16 a[218:219], v78 offset:49152
    s_call_b64 s[88:89], L_sumpass
    buffer_load_dwordx4 v97, s[56:59], s80 offen offset:1024 lds
    s_waitcnt lgkmcnt(10)
    v_mfma_f32_16x16x32_bf16 a[8:11], a[196:199], a[128:131], a[8:11]
    ds_read_b64_tr_b16 a[220:221], v71 offset:49152
    v_mfma_f32_16x16x32_bf16 a[12:15], a[196:199], a[132:135], a[12:15]
    ds_read_b64_tr_b16 a[222:223], v79 offset:49152
    buffer_load_dwordx4 v98, s[56:59], s80 offen offset:2048 lds
    s_waitcnt lgkmcnt(10)
    v_mfma_f32_16x16x32_bf16 a[16:19], a[200:203], a[128:131], a[16:19]
    s_waitcnt vmcnt(27)
    ds_read_b64_tr_b16 a[224:225], v64 offset:0
    v_mfma_f32_16x16x32_bf16 a[20:23], a[200:203], a[132:135], a[20:23]
    s_waitcnt vmcnt(23)
    ds_read_b64_tr_b16 a[226:227], v72 offset:0
    buffer_load_dwordx4 v99, s[56:59], s80 offen offset:3072 lds
    s_add_u32 s80, s80, 14336
    s_waitcnt lgkmcnt(10)
    v_mfma_f32_16x16x32_bf16 a[24:27], a[204:207], a[128:131], a[24:27]
    ds_read_b64_tr_b16 a[228:229], v65 offset:0
    v_mfma_f32_16x16x32_bf16 a[28:31], a[204:207], a[132:135], a[28:31]
    ds_read_b64_tr_b16 a[230:231], v73 offset:0
    s_waitcnt lgkmcnt(10)
    v_mfma_f32_16x16x32_bf16 a[32:35], a[208:211], a[128:131], a[32:35]
    ds_read_b64_tr_b16 a[232:233], v66 offset:0
    v_mfma_f32_16x16x32_bf16 a[36:39], a[208:211], a[132:135], a[36:39]
    ds_read_b64_tr_b16 a[234:235], v74 offset:0
    s_waitcnt lgkmcnt(10)
    v_mfma_f32_16x16x32_bf16 a[40:43], a[212:215], a[128:131], a[40:43]
    ds_read_b64_tr_b16 a[236:237], v67 offset:0
    v_mfma_f32_16x16x32_bf16 a[44:47], a[212:215], a[132:135], a[44:47]
    ds_read_b64_tr_b16 a[238:239], v75 offset:0
    s_waitcnt lgkmcnt(10)
    v_mfma_f32_16x16x32_bf16 a[48:51], a[216:219], a[128:131], a[48:51]
    ds_read_b64_tr_b16 a[240:241], v68 offset:0
    v_mfma_f32_16x16x32_bf16 a[52:55], a[216:219], a[132:135], a[52:55]
    ds_read_b64_tr_b16 a[242:243], v76 offset:0
    s_waitcnt lgkmcnt(10)
    v_mfma_f32_16x16x32_bf16 a[56:59], a[220:223], a[128:131], a[56:59]
    ds_read_b64_tr_b16 a[244:245], v69 offset:0
    v_mfma_f32_16x16x32_bf16 a[60:63], a[220:223], a[132:135], a[60:63]
    ds_read_b64_tr_b16 a[246:247], v77 offset:0
    s_add_u32 m0, s67, 49152
    s_nop 0
    buffer_load_dwordx4 v96, s[56:59], s80 offen offset:0 lds
    s_waitcnt lgkmcnt(10)
    v_mfma_f32_16x16x32_bf16 a[0:3], a[224:227], a[136:139], a[0:3]
    ds_read_b64_tr_b16 a[248:249], v70 offset:0
    v_mfma_f32_16x16x32_bf16 a[4:7], a[224:227], a[140:143], a[4:7]
    ds_read_b64_tr_b16 a[250:251], v78 offset:0
    buffer_load_dwordx4 v97, s[56:59], s80 offen offset:1024 lds
    s_waitcnt lgkmcnt(10)
    v_mfma_f32_16x16x32_bf16 a[8:11], a[228:231], a[136:139], a[8:11]
    ds_read_b64_tr_b16 a[252:253], v71 offset:0
    v_mfma_f32_16x16x32_bf16 a[12:15], a[228:231], a[140:143], a[12:15]
    ds_read_b64_tr_b16 a[254:255], v79 offset:0
    buffer_load_dwordx4 v98, s[56:59], s80 offen offset:2048 lds
    s_waitcnt lgkmcnt(10)
    v_mfma_f32_16x16x32_bf16 a[16:19], a[232:235], a[136:139], a[16:19]
    s_waitcnt vmcnt(23)
    ds_read_b64_tr_b16 a[192:193], v64 offset:16384
    v_mfma_f32_16x16x32_bf16 a[20:23], a[232:235], a[140:143], a[20:23]
    s_waitcnt vmcnt(19)
    ds_read_b64_tr_b16 a[194:195], v72 offset:16384
    buffer_load_dwordx4 v99, s[56:59], s80 offen offset:3072 lds
    s_add_u32 s80, s80, 14336
    s_waitcnt lgkmcnt(10)
    v_mfma_f32_16x16x32_bf16 a[24:27], a[236:239], a[136:139], a[24:27]
    ds_read_b64_tr_b16 a[196:197], v65 offset:16384
    v_mfma_f32_16x16x32_bf16 a[28:31], a[236:239], a[140:143], a[28:31]
    ds_read_b64_tr_b16 a[198:199], v73 offset:16384
    s_add_u32 m0, s67, 114688
    s_nop 0
    buffer_load_dwordx4 v96, s[56:59], s80 offen offset:0 lds
    s_waitcnt lgkmcnt(10)
    v_mfma_f32_16x16x32_bf16 a[32:35], a[240:243], a[136:139], a[32:35]
    ds_read_b64_tr_b16 a[200:201], v66 offset:16384
    v_mfma_f32_16x16x32_bf16 a[36:39], a[240:243], a[140:143], a[36:39]
    ds_read_b64_tr_b16 a[202:203], v74 offset:16384
    buffer_load_dwordx4 v97, s[56:59], s80 offen offset:1024 lds
    s_waitcnt lgkmcnt(10)
    v_mfma_f32_16x16x32_bf16 a[40:43], a[244:247], a[136:139], a[40:43]
    ds_read_b64_tr_b16 a[204:205], v67 offset:16384
    v_mfma_f32_16x16x32_bf16 a[44:47], a[244:247], a[140:143], a[44:47]
    ds_read_b64_tr_b16 a[206:207], v75 offset:16384
    buffer_load_dwordx4 v98, s[56:59], s80 offen offset:2048 lds
    s_waitcnt lgkmcnt(10)
    v_mfma_f32_16x16x32_bf16 a[48:51], a[248:251], a[136:139], a[48:51]
    ds_read_b64_tr_b16 a[208:209], v68 offset:16384
    v_mfma_f32_16x16x32_bf16 a[52:55], a[248:251], a[140:143], a[52:55]
    ds_read_b64_tr_b16 a[210:211], v76 offset:16384
    buffer_load_dwordx4 v99, s[56:59], s80 offen offset:3072 lds
    s_add_u32 s80, s80, 14336
    s_waitcnt lgkmcnt(10)
    v_mfma_f32_16x16x32_bf16 a[56:59], a[252:255], a[136:139], a[56:59]
    ds_read_b64_tr_b16 a[212:213], v69 offset:16384
    v_mfma_f32_16x16x32_bf16 a[60:63], a[252:255], a[140:143], a[60:63]
    ds_read_b64_tr_b16 a[214:215], v77 offset:16384
    s_add_u32 m0, s67, 0
    s_nop 0
    buffer_load_dwordx4 v96, s[56:59], s80 offen offset:0 lds
    s_waitcnt lgkmcnt(10)
    v_mfma_f32_16x16x32_bf16 a[0:3], a[192:195], a[144:147], a[0:3]
    ds_read_b64_tr_b16 a[216:217], v70 offset:16384
    v_mfma_f32_16x16x32_bf16 a[4:7], a[192:195], a[148:151], a[4:7]
    ds_read_b64_tr_b16 a[218:219], v78 offset:16384
    buffer_load_dwordx4 v97, s[56:59], s80 offen offset:1024 lds
    s_waitcnt lgkmcnt(10)
    v_mfma_f32_16x16x32_bf16 a[8:11], a[196:199], a[144:147], a[8:11]
    ds_read_b64_tr_b16 a[220:221], v71 offset:16384
    v_mfma_f32_16x16x32_bf16 a[12:15], a[196:199], a[148:151], a[12:15]
    ds_read_b64_tr_b16 a[222:223], v79 offset:16384
    buffer_load_dwordx4 v98, s[56:59], s80 offen offset:2048 lds
    s_waitcnt lgkmcnt(10)
    v_mfma_f32_16x16x32_bf16 a[16:19], a[200:203], a[144:147], a[16:19]
    s_waitcnt vmcnt(23)
    ds_read_b64_tr_b16 a[224:225], v80 offset:0
    v_mfma_f32_16x16x32_bf16 a[20:23], a[200:203], a[148:151], a[20:23]
    ds_read_b64_tr_b16 a[226:227], v80 offset:0
    buffer_load_dwordx4 v99, s[56:59], s80 offen offset:3072 lds
    s_add_u32 s80, s80, 14336
    s_waitcnt lgkmcnt(10)
    v_mfma_f32_16x16x32_bf16 a[24:27], a[204:207], a[144:147], a[24:27]
    ds_read_b64_tr_b16 a[228:229], v81 offset:0
    v_mfma_f32_16x16x32_bf16 a[28:31], a[204:207], a[148:151], a[28:31]
    ds_read_b64_tr_b16 a[230:231], v81 offset:0
    buffer_load_dword v6, v104, s[60:63], s93 offen sc1
    s_waitcnt lgkmcnt(10)
    v_mfma_f32_16x16x32_bf16 a[32:35], a[208:211], a[144:147], a[32:35]
    ds_read_b64_tr_b16 a[232:233], v82 offset:0
    v_mfma_f32_16x16x32_bf16 a[36:39], a[208:211], a[148:151], a[36:39]
    ds_read_b64_tr_b16 a[234:235], v82 offset:0
    s_add_u32 m0, s67, 65536
    s_nop 0
    buffer_load_dwordx4 v96, s[56:59], s80 offen offset:0 lds
    s_waitcnt lgkmcnt(10)
    v_mfma_f32_16x16x32_bf16 a[40:43], a[212:215], a[144:147], a[40:43]
    ds_read_b64_tr_b16 a[236:237], v83 offset:0
    v_mfma_f32_16x16x32_bf16 a[44:47], a[212:215], a[148:151], a[44:47]
    ds_read_b64_tr_b16 a[238:239], v83 offset:0
    buffer_load_dwordx4 v97, s[56:59], s80 offen offset:1024 lds
    s_waitcnt lgkmcnt(10)
    v_mfma_f32_16x16x32_bf16 a[48:51], a[216:219], a[144:147], a[48:51]
    ds_read_b64_tr_b16 a[240:241], v84 offset:0
    v_mfma_f32_16x16x32_bf16 a[52:55], a[216:219], a[148:151], a[52:55]
    ds_read_b64_tr_b16 a[242:243], v84 offset:0
    buffer_load_dwordx4 v98, s[56:59], s80 offen offset:2048 lds
    s_waitcnt lgkmcnt(10)
    v_mfma_f32_16x16x32_bf16 a[56:59], a[220:223], a[144:147], a[56:59]
    ds_read_b64_tr_b16 a[244:245], v85 offset:0
    v_mfma_f32_16x16x32_bf16 a[60:63], a[220:223], a[148:151], a[60:63]
    ds_read_b64_tr_b16 a[246:247], v85 offset:0
    buffer_load_dwordx4 v99, s[56:59], s80 offen offset:3072 lds
    s_add_u32 s80, s80, 14336
    s_waitcnt lgkmcnt(10)
    v_mfma_f32_16x16x32_bf16 a[0:3], a[224:227], a[152:155], a[0:3]
    ds_read_b64_tr_b16 a[248:249], v86 offset:0
    v_mfma_f32_16x16x32_bf16 a[4:7], a[224:227], a[156:159], a[4:7]
    ds_read_b64_tr_b16 a[250:251], v86 offset:0
    s_waitcnt lgkmcnt(10)
    v_mfma_f32_16x16x32_bf16 a[8:11], a[228:231], a[152:155], a[8:11]
    ds_read_b64_tr_b16 a[252:253], v87 offset:0
    v_mfma_f32_16x16x32_bf16 a[12:15], a[228:231], a[156:159], a[12:15]
    ds_read_b64_tr_b16 a[254:255], v87 offset:0
    s_waitcnt lgkmcnt(10)
    v_mfma_f32_16x16x32_bf16 a[16:19], a[232:235], a[152:155], a[16:19]
    s_waitcnt vmcnt(25)
    ds_read_b64_tr_b16 a[192:193], v80 offset:16384
    v_mfma_f32_16x16x32_bf16 a[20:23], a[232:235], a[156:159], a[20:23]
    s_waitcnt vmcnt(21)
    ds_read_b64_tr_b16 a[194:195], v64 offset:32768
    s_waitcnt lgkmcnt(10)
    v_mfma_f32_16x16x32_bf16 a[24:27], a[236:239], a[152:155], a[24:27]
    ds_read_b64_tr_b16 a[196:197], v81 offset:16384
    v_mfma_f32_16x16x32_bf16 a[28:31], a[236:239], a[156:159], a[28:31]
    ds_read_b64_tr_b16 a[198:199], v65 offset:32768
    s_waitcnt lgkmcnt(10)
    v_mfma_f32_16x16x32_bf16 a[32:35], a[240:243], a[152:155], a[32:35]
    ds_read_b64_tr_b16 a[200:201], v82 offset:16384
    v_mfma_f32_16x16x32_bf16 a[36:39], a[240:243], a[156:159], a[36:39]
    ds_read_b64_tr_b16 a[202:203], v66 offset:32768
    s_waitcnt lgkmcnt(10)
    v_mfma_f32_16x16x32_bf16 a[40:43], a[244:247], a[152:155], a[40:43]
    ds_read_b64_tr_b16 a[204:205], v83 offset:16384
    v_mfma_f32_16x16x32_bf16 a[44:47], a[244:247], a[156:159], a[44:47]
    ds_read_b64_tr_b16 a[206:207], v67 offset:32768
    s_waitcnt lgkmcnt(10)
    v_mfma_f32_16x16x32_bf16 a[48:51], a[248:251], a[152:155], a[48:51]
    ds_read_b64_tr_b16 a[208:209], v84 offset:16384
    v_mfma_f32_16x16x32_bf16 a[52:55], a[248:251], a[156:159], a[52:55]
    ds_read_b64_tr_b16 a[210:211], v68 offset:32768
    s_waitcnt lgkmcnt(10)
    v_mfma_f32_16x16x32_bf16 a[56:59], a[252:255], a[152:155], a[56:59]
    ds_read_b64_tr_b16 a[212:213], v85 offset:16384
    v_mfma_f32_16x16x32_bf16 a[60:63], a[252:255], a[156:159], a[60:63]
    ds_read_b64_tr_b16 a[214:215], v69 offset:32768
    s_waitcnt lgkmcnt(10)
    v_mfma_f32_16x16x32_bf16 a[0:3], a[192:195], a[160:163], a[0:3]
    ds_read_b64_tr_b16 a[216:217], v86 offset:16384
    v_mfma_f32_16x16x32_bf16 a[4:7], a[192:195], a[164:167], a[4:7]
    ds_read_b64_tr_b16 a[218:219], v70 offset:32768
    s_waitcnt lgkmcnt(10)
    v_mfma_f32_16x16x32_bf16 a[8:11], a[196:199], a[160:163], a[8:11]
    ds_read_b64_tr_b16 a[220:221], v87 offset:16384
    v_mfma_f32_16x16x32_bf16 a[12:15], a[196:199], a[164:167], a[12:15]
    ds_read_b64_tr_b16 a[222:223], v71 offset:32768
    s_waitcnt lgkmcnt(10)
    v_mfma_f32_16x16x32_bf16 a[16:19], a[200:203], a[160:163], a[16:19]
    s_waitcnt vmcnt(17)
    ds_read_b64_tr_b16 a[224:225], v72 offset:32768
    v_mfma_f32_16x16x32_bf16 a[20:23], a[200:203], a[164:167], a[20:23]
    s_waitcnt vmcnt(13)
    ds_read_b64_tr_b16 a[226:227], v64 offset:49152
    s_waitcnt lgkmcnt(10)
    v_mfma_f32_16x16x32_bf16 a[24:27], a[204:207], a[160:163], a[24:27]
    ds_read_b64_tr_b16 a[228:229], v73 offset:32768
    v_mfma_f32_16x16x32_bf16 a[28:31], a[204:207], a[164:167], a[28:31]
    ds_read_b64_tr_b16 a[230:231], v65 offset:49152
    s_waitcnt lgkmcnt(10)
    v_mfma_f32_16x16x32_bf16 a[32:35], a[208:211], a[160:163], a[32:35]
    ds_read_b64_tr_b16 a[232:233], v74 offset:32768
    v_mfma_f32_16x16x32_bf16 a[36:39], a[208:211], a[164:167], a[36:39]
    ds_read_b64_tr_b16 a[234:235], v66 offset:49152
    s_waitcnt vmcnt(0)
    v_cmp_lt_u32 vcc, v90, v6
    s_cmp_eq_u32 s83, 1
    s_cselect_b32 s14, -1, vcc_lo
    s_and_b32 s14, s14, s4
    s_andn2_b32 s4, s4, s14
    s_call_b64 s[88:89], L_loadpass
    buffer_load_dwordx2 v[16:17], v88, s[28:31], s10 offen
    buffer_load_dwordx2 v[18:19], v89, s[28:31], s10 offen
    buffer_load_dwordx2 v[20:21], v88, s[28:31], s11 offen
    buffer_load_dwordx2 v[22:23], v89, s[28:31], s11 offen
    buffer_load_dword v6, v104, s[60:63], s93 offen sc1
    s_waitcnt lgkmcnt(10)
    v_mfma_f32_16x16x32_bf16 a[40:43], a[212:215], a[160:163], a[40:43]
    ds_read_b64_tr_b16 a[236:237], v75 offset:32768
    v_mfma_f32_16x16x32_bf16 a[44:47], a[212:215], a[164:167], a[44:47]
    ds_read_b64_tr_b16 a[238:239], v67 offset:49152
    s_waitcnt lgkmcnt(10)
    v_mfma_f32_16x16x32_bf16 a[48:51], a[216:219], a[160:163], a[48:51]
    ds_read_b64_tr_b16 a[240:241], v76 offset:32768
    v_mfma_f32_16x16x32_bf16 a[52:55], a[216:219], a[164:167], a[52:55]
    ds_read_b64_tr_b16 a[242:243], v68 offset:49152
    s_waitcnt lgkmcnt(10)
    v_mfma_f32_16x16x32_bf16 a[56:59], a[220:223], a[160:163], a[56:59]
    ds_read_b64_tr_b16 a[244:245], v77 offset:32768
    v_mfma_f32_16x16x32_bf16 a[60:63], a[220:223], a[164:167], a[60:63]
    ds_read_b64_tr_b16 a[246:247], v69 offset:49152
    s_waitcnt lgkmcnt(10)
    v_mfma_f32_16x16x32_bf16 a[0:3], a[224:227], a[168:171], a[0:3]
    ds_read_b64_tr_b16 a[248:249], v78 offset:32768
    v_mfma_f32_16x16x32_bf16 a[4:7], a[224:227], a[172:175], a[4:7]
    ds_read_b64_tr_b16 a[250:251], v70 offset:49152
    s_waitcnt lgkmcnt(10)
    v_mfma_f32_16x16x32_bf16 a[8:11], a[228:231], a[168:171], a[8:11]
    ds_read_b64_tr_b16 a[252:253], v79 offset:32768
    v_mfma_f32_16x16x32_bf16 a[12:15], a[228:231], a[172:175], a[12:15]
    ds_read_b64_tr_b16 a[254:255], v71 offset:49152
    s_waitcnt lgkmcnt(10)
    v_mfma_f32_16x16x32_bf16 a[16:19], a[232:235], a[168:171], a[16:19]
    ds_read_b64_tr_b16 a[192:193], v72 offset:49152
    v_mfma_f32_16x16x32_bf16 a[20:23], a[232:235], a[172:175], a[20:23]
    ds_read_b64_tr_b16 a[194:195], v64 offset:0
    s_waitcnt lgkmcnt(10)
    v_mfma_f32_16x16x32_bf16 a[24:27], a[236:239], a[168:171], a[24:27]
    ds_read_b64_tr_b16 a[196:197], v73 offset:49152
    v_mfma_f32_16x16x32_bf16 a[28:31], a[236:239], a[172:175], a[28:31]
    ds_read_b64_tr_b16 a[198:199], v65 offset:0
    s_waitcnt lgkmcnt(10)
    v_mfma_f32_16x16x32_bf16 a[32:35], a[240:243], a[168:171], a[32:35]
    ds_read_b64_tr_b16 a[200:201], v74 offset:49152
    v_mfma_f32_16x16x32_bf16 a[36:39], a[240:243], a[172:175], a[36:39]
    ds_read_b64_tr_b16 a[202:203], v66 offset:0
    s_waitcnt lgkmcnt(10)
    v_mfma_f32_16x16x32_bf16 a[40:43], a[244:247], a[168:171], a[40:43]
    ds_read_b64_tr_b16 a[204:205], v75 offset:49152
    v_mfma_f32_16x16x32_bf16 a[44:47], a[244:247], a[172:175], a[44:47]
    ds_read_b64_tr_b16 a[206:207], v67 offset:0
    s_waitcnt lgkmcnt(10)
    v_mfma_f32_16x16x32_bf16 a[48:51], a[248:251], a[168:171], a[48:51]
    ds_read_b64_tr_b16 a[208:209], v76 offset:49152
    v_mfma_f32_16x16x32_bf16 a[52:55], a[248:251], a[172:175], a[52:55]
    ds_read_b64_tr_b16 a[210:211], v68 offset:0
    s_waitcnt lgkmcnt(10)
    v_mfma_f32_16x16x32_bf16 a[56:59], a[252:255], a[168:171], a[56:59]
    ds_read_b64_tr_b16 a[212:213], v77 offset:49152
    v_mfma_f32_16x16x32_bf16 a[60:63], a[252:255], a[172:175], a[60:63]
    ds_read_b64_tr_b16 a[214:215], v69 offset:0
    s_waitcnt lgkmcnt(10)
    v_mfma_f32_16x16x32_bf16 a[0:3], a[192:195], a[176:179], a[0:3]
    ds_read_b64_tr_b16 a[216:217], v78 offset:49152
    v_mfma_f32_16x16x32_bf16 a[4:7], a[192:195], a[180:183], a[4:7]
    ds_read_b64_tr_b16 a[218:219], v70 offset:0
    s_waitcnt lgkmcnt(10)
    v_mfma_f32_16x16x32_bf16 a[8:11], a[196:199], a[176:179], a[8:11]
    ds_read_b64_tr_b16 a[220:221], v79 offset:49152
    v_mfma_f32_16x16x32_bf16 a[12:15], a[196:199], a[180:183], a[12:15]
    ds_read_b64_tr_b16 a[222:223], v71 offset:0
    s_waitcnt lgkmcnt(10)
    v_mfma_f32_16x16x32_bf16 a[16:19], a[200:203], a[176:179], a[16:19]
    ds_read_b64_tr_b16 a[224:225], v72 offset:0
    v_mfma_f32_16x16x32_bf16 a[20:23], a[200:203], a[180:183], a[20:23]
    ds_read_b64_tr_b16 a[226:227], v72 offset:0
    s_waitcnt lgkmcnt(10)
    v_mfma_f32_16x16x32_bf16 a[24:27], a[204:207], a[176:179], a[24:27]
    ds_read_b64_tr_b16 a[228:229], v73 offset:0
    v_mfma_f32_16x16x32_bf16 a[28:31], a[204:207], a[180:183], a[28:31]
    ds_read_b64_tr_b16 a[230:231], v73 offset:0
    s_waitcnt lgkmcnt(10)
    v_mfma_f32_16x16x32_bf16 a[32:35], a[208:211], a[176:179], a[32:35]
    ds_read_b64_tr_b16 a[232:233], v74 offset:0
    v_mfma_f32_16x16x32_bf16 a[36:39], a[208:211], a[180:183], a[36:39]
    ds_read_b64_tr_b16 a[234:235], v74 offset:0
    s_waitcnt lgkmcnt(10)
    v_mfma_f32_16x16x32_bf16 a[40:43], a[212:215], a[176:179], a[40:43]
    ds_read_b64_tr_b16 a[236:237], v75 offset:0
    v_mfma_f32_16x16x32_bf16 a[44:47], a[212:215], a[180:183], a[44:47]
    ds_read_b64_tr_b16 a[238:239], v75 offset:0
    s_waitcnt lgkmcnt(10)
    v_mfma_f32_16x16x32_bf16 a[48:51], a[216:219], a[176:179], a[48:51]
    ds_read_b64_tr_b16 a[240:241], v76 offset:0
    v_mfma_f32_16x16x32_bf16 a[52:55], a[216:219], a[180:183], a[52:55]
    ds_read_b64_tr_b16 a[242:243], v76 offset:0
    s_waitcnt lgkmcnt(10)
    v_mfma_f32_16x16x32_bf16 a[56:59], a[220:223], a[176:179], a[56:59]
    ds_read_b64_tr_b16 a[244:245], v77 offset:0
    v_mfma_f32_16x16x32_bf16 a[60:63], a[220:223], a[180:183], a[60:63]
    ds_read_b64_tr_b16 a[246:247], v77 offset:0
    s_waitcnt lgkmcnt(10)
    v_mfma_f32_16x16x32_bf16 a[0:3], a[224:227], a[184:187], a[0:3]
    ds_read_b64_tr_b16 a[248:249], v78 offset:0
    v_mfma_f32_16x16x32_bf16 a[4:7], a[224:227], a[188:191], a[4:7]
    ds_read_b64_tr_b16 a[250:251], v78 offset:0
    s_waitcnt lgkmcnt(10)
    v_mfma_f32_16x16x32_bf16 a[8:11], a[228:231], a[184:187], a[8:11]
    ds_read_b64_tr_b16 a[252:253], v79 offset:0
    v_mfma_f32_16x16x32_bf16 a[12:15], a[228:231], a[188:191], a[12:15]
    ds_read_b64_tr_b16 a[254:255], v79 offset:0
    s_waitcnt lgkmcnt(10)
    v_mfma_f32_16x16x32_bf16 a[16:19], a[232:235], a[184:187], a[16:19]
    v_mfma_f32_16x16x32_bf16 a[20:23], a[232:235], a[188:191], a[20:23]
    s_waitcnt lgkmcnt(8)
    v_mfma_f32_16x16x32_bf16 a[24:27], a[236:239], a[184:187], a[24:27]
    v_mfma_f32_16x16x32_bf16 a[28:31], a[236:239], a[188:191], a[28:31]
    s_waitcnt lgkmcnt(6)
    v_mfma_f32_16x16x32_bf16 a[32:35], a[240:243], a[184:187], a[32:35]
    v_mfma_f32_16x16x32_bf16 a[36:39], a[240:243], a[188:191], a[36:39]
    s_waitcnt lgkmcnt(4)
    v_mfma_f32_16x16x32_bf16 a[40:43], a[244:247], a[184:187], a[40:43]
    v_mfma_f32_16x16x32_bf16 a[44:47], a[244:247], a[188:191], a[44:47]
    s_waitcnt lgkmcnt(2)
    v_mfma_f32_16x16x32_bf16 a[48:51], a[248:251], a[184:187], a[48:51]
    v_mfma_f32_16x16x32_bf16 a[52:55], a[248:251], a[188:191], a[52:55]
    s_waitcnt lgkmcnt(0)
    v_mfma_f32_16x16x32_bf16 a[56:59], a[252:255], a[184:187], a[56:59]
    v_mfma_f32_16x16x32_bf16 a[60:63], a[252:255], a[188:191], a[60:63]
    ds_write_b128 v105, a[0:3] offset:0
    ds_write_b128 v105, a[4:7] offset:1024
    ds_write_b128 v105, a[8:11] offset:2048
    ds_write_b128 v105, a[12:15] offset:3072
    ds_write_b128 v105, a[16:19] offset:16384
    ds_write_b128 v105, a[20:23] offset:17408
    ds_write_b128 v105, a[24:27] offset:18432
    ds_write_b128 v105, a[28:31] offset:19456
    ds_write_b128 v105, a[32:35] offset:32768
    ds_write_b128 v105, a[36:39] offset:33792
    ds_write_b128 v105, a[40:43] offset:34816
    ds_write_b128 v105, a[44:47] offset:35840
    ds_write_b128 v105, a[48:51] offset:49152
    ds_write_b128 v105, a[52:55] offset:50176
    ds_write_b128 v105, a[56:59] offset:51200
    ds_write_b128 v105, a[60:63] offset:52224
    s_waitcnt lgkmcnt(0)
    s_barrier
    s_cmp_lg_u32 s78, 0
    s_cbranch_scc1 L_noarr
    buffer_atomic_add v7, v4, s[20:23], s73 offen sc0
L_noarr:
    ds_read_b128 v[192:195], v106 offset:0
    ds_read_b128 v[196:199], v106 offset:1024
    ds_read_b128 v[200:203], v106 offset:4096
    ds_read_b128 v[204:207], v106 offset:5120
    ds_read_b128 v[208:211], v106 offset:8192
    ds_read_b128 v[212:215], v106 offset:9216
    ds_read_b128 v[216:219], v106 offset:12288
    ds_read_b128 v[220:223], v106 offset:13312
    s_waitcnt lgkmcnt(0)
    ds_read_b128 v[224:227], v106 offset:32768
    ds_read_b128 v[228:231], v106 offset:33792
    ds_read_b128 v[232:235], v106 offset:36864
    ds_read_b128 v[236:239], v106 offset:37888
    ds_read_b128 v[240:243], v106 offset:40960
    ds_read_b128 v[244:247], v106 offset:41984
    ds_read_b128 v[248:251], v106 offset:45056
    ds_read_b128 v[252:255], v106 offset:46080
    v_add_f32 v192, v192, v200
    v_add_f32 v193, v193, v201
    v_add_f32 v194, v194, v202
    v_add_f32 v195, v195, v203
    v_add_f32 v196, v196, v204
    v_add_f32 v197, v197, v205
    v_add_f32 v198, v198, v206
    v_add_f32 v199, v199, v207
    v_add_f32 v192, v192, v208
    v_add_f32 v193, v193, v209
    v_add_f32 v194, v194, v210
    v_add_f32 v195, v195, v211
    v_add_f32 v196, v196, v212
    v_add_f32 v197, v197, v213
    v_add_f32 v198, v198, v214
    v_add_f32 v199, v199, v215
    v_add_f32 v192, v192, v216
    v_add_f32 v193, v193, v217
    v_add_f32 v194, v194, v218
    v_add_f32 v195, v195, v219
    v_add_f32 v196, v196, v220
    v_add_f32 v197, v197, v221
    v_add_f32 v198, v198, v222
    v_add_f32 v199, v199, v223
    v_cvt_pk_bf16_f32 v56, v192, v193
    v_lshlrev_b32 v192, 16, v56
    v_and_b32 v193, s86, v56
    v_mul_f32 v57, 0xbfb8aa3b, v192
    v_mul_f32 v58, 0xbfb8aa3b, v193
    v_exp_f32 v57, v57
    v_exp_f32 v58, v58
    v_add_f32 v57, 1.0, v57
    v_add_f32 v58, 1.0, v58
    v_rcp_f32 v57, v57
    v_rcp_f32 v58, v58
    v_mul_f32 v192, v192, v57
    v_mul_f32 v193, v193, v58
    v_cvt_pk_bf16_f32 v56, v192, v193
    v_lshlrev_b32 v192, 16, v56
    v_and_b32 v193, s86, v56
    v_cvt_pk_bf16_f32 v56, v194, v195
    v_lshlrev_b32 v194, 16, v56
    v_and_b32 v195, s86, v56
    v_mul_f32 v57, 0xbfb8aa3b, v194
    v_mul_f32 v58, 0xbfb8aa3b, v195
    v_exp_f32 v57, v57
    v_exp_f32 v58, v58
    v_add_f32 v57, 1.0, v57
    v_add_f32 v58, 1.0, v58
    v_rcp_f32 v57, v57
    v_rcp_f32 v58, v58
    v_mul_f32 v194, v194, v57
    v_mul_f32 v195, v195, v58
    v_cvt_pk_bf16_f32 v56, v194, v195
    v_lshlrev_b32 v194, 16, v56
    v_and_b32 v195, s86, v56
    v_cvt_pk_bf16_f32 v56, v196, v197
    v_lshlrev_b32 v196, 16, v56
    v_and_b32 v197, s86, v56
    v_mul_f32 v57, 0xbfb8aa3b, v196
    v_mul_f32 v58, 0xbfb8aa3b, v197
    v_exp_f32 v57, v57
    v_exp_f32 v58, v58
    v_add_f32 v57, 1.0, v57
    v_add_f32 v58, 1.0, v58
    v_rcp_f32 v57, v57
    v_rcp_f32 v58, v58
    v_mul_f32 v196, v196, v57
    v_mul_f32 v197, v197, v58
    v_cvt_pk_bf16_f32 v56, v196, v197
    v_lshlrev_b32 v196, 16, v56
    v_and_b32 v197, s86, v56
    v_cvt_pk_bf16_f32 v56, v198, v199
    v_lshlrev_b32 v198, 16, v56
    v_and_b32 v199, s86, v56
    v_mul_f32 v57, 0xbfb8aa3b, v198
    v_mul_f32 v58, 0xbfb8aa3b, v199
    v_exp_f32 v57, v57
    v_exp_f32 v58, v58
    v_add_f32 v57, 1.0, v57
    v_add_f32 v58, 1.0, v58
    v_rcp_f32 v57, v57
    v_rcp_f32 v58, v58
    v_mul_f32 v198, v198, v57
    v_mul_f32 v199, v199, v58
    v_cvt_pk_bf16_f32 v56, v198, v199
    v_lshlrev_b32 v198, 16, v56
    v_and_b32 v199, s86, v56
    s_waitcnt lgkmcnt(0)
    v_add_f32 v224, v224, v232
    v_add_f32 v225, v225, v233
    v_add_f32 v226, v226, v234
    v_add_f32 v227, v227, v235
    v_add_f32 v228, v228, v236
    v_add_f32 v229, v229, v237
    v_add_f32 v230, v230, v238
    v_add_f32 v231, v231, v239
    v_add_f32 v224, v224, v240
    v_add_f32 v225, v225, v241
    v_add_f32 v226, v226, v242
    v_add_f32 v227, v227, v243
    v_add_f32 v228, v228, v244
    v_add_f32 v229, v229, v245
    v_add_f32 v230, v230, v246
    v_add_f32 v231, v231, v247
    v_add_f32 v224, v224, v248
    v_add_f32 v225, v225, v249
    v_add_f32 v226, v226, v250
    v_add_f32 v227, v227, v251
    v_add_f32 v228, v228, v252
    v_add_f32 v229, v229, v253
    v_add_f32 v230, v230, v254
    v_add_f32 v231, v231, v255
    v_cvt_pk_bf16_f32 v56, v224, v225
    v_lshlrev_b32 v224, 16, v56
    v_and_b32 v225, s86, v56
    v_mul_f32 v57, 0xbfb8aa3b, v224
    v_mul_f32 v58, 0xbfb8aa3b, v225
    v_exp_f32 v57, v57
    v_exp_f32 v58, v58
    v_add_f32 v57, 1.0, v57
    v_add_f32 v58, 1.0, v58
    v_rcp_f32 v57, v57
    v_rcp_f32 v58, v58
    v_mul_f32 v224, v224, v57
    v_mul_f32 v225, v225, v58
    v_cvt_pk_bf16_f32 v56, v224, v225
    v_lshlrev_b32 v224, 16, v56
    v_and_b32 v225, s86, v56
    v_cvt_pk_bf16_f32 v56, v226, v227
    v_lshlrev_b32 v226, 16, v56
    v_and_b32 v227, s86, v56
    v_mul_f32 v57, 0xbfb8aa3b, v226
    v_mul_f32 v58, 0xbfb8aa3b, v227
    v_exp_f32 v57, v57
    v_exp_f32 v58, v58
    v_add_f32 v57, 1.0, v57
    v_add_f32 v58, 1.0, v58
    v_rcp_f32 v57, v57
    v_rcp_f32 v58, v58
    v_mul_f32 v226, v226, v57
    v_mul_f32 v227, v227, v58
    v_cvt_pk_bf16_f32 v56, v226, v227
    v_lshlrev_b32 v226, 16, v56
    v_and_b32 v227, s86, v56
    v_cvt_pk_bf16_f32 v56, v228, v229
    v_lshlrev_b32 v228, 16, v56
    v_and_b32 v229, s86, v56
    v_mul_f32 v57, 0xbfb8aa3b, v228
    v_mul_f32 v58, 0xbfb8aa3b, v229
    v_exp_f32 v57, v57
    v_exp_f32 v58, v58
    v_add_f32 v57, 1.0, v57
    v_add_f32 v58, 1.0, v58
    v_rcp_f32 v57, v57
    v_rcp_f32 v58, v58
    v_mul_f32 v228, v228, v57
    v_mul_f32 v229, v229, v58
    v_cvt_pk_bf16_f32 v56, v228, v229
    v_lshlrev_b32 v228, 16, v56
    v_and_b32 v229, s86, v56
    v_cvt_pk_bf16_f32 v56, v230, v231
    v_lshlrev_b32 v230, 16, v56
    v_and_b32 v231, s86, v56
    v_mul_f32 v57, 0xbfb8aa3b, v230
    v_mul_f32 v58, 0xbfb8aa3b, v231
    v_exp_f32 v57, v57
    v_exp_f32 v58, v58
    v_add_f32 v57, 1.0, v57
    v_add_f32 v58, 1.0, v58
    v_rcp_f32 v57, v57
    v_rcp_f32 v58, v58
    v_mul_f32 v230, v230, v57
    v_mul_f32 v231, v231, v58
    v_cvt_pk_bf16_f32 v56, v230, v231
    v_lshlrev_b32 v230, 16, v56
    v_and_b32 v231, s86, v56
L_round:
    s_waitcnt vmcnt(0)
    s_call_b64 s[88:89], L_sumpass
    s_cmp_eq_u32 s4, 0
    s_cbranch_scc1 L_last
    v_cmp_lt_u32 vcc, v90, v6
    s_cmp_eq_u32 s83, 1
    s_cselect_b32 s14, -1, vcc_lo
    s_and_b32 s14, s14, s4
    s_andn2_b32 s4, s4, s14
    s_call_b64 s[88:89], L_loadpass
    buffer_load_dword v6, v104, s[60:63], s93 offen sc1
    s_sub_u32 s79, s79, 1
    s_cmp_lg_u32 s79, 0
    s_cbranch_scc1 L_round
L_giveup:
    v_mov_b32 v56, 0x100
    buffer_atomic_add v56, v54, s[20:23], s73 offen sc0
    s_waitcnt vmcnt(0)
    v_readfirstlane_b32 s82, v56
    s_nop 0
    s_and_b32 s82, s82, 31
    s_cmp_lg_u32 s82, 16
    s_cbranch_scc1 L_sdone
    s_mov_b32 s83, 1
    s_mov_b32 s79, 100
    s_branch L_round
L_last:
    s_nop 5
    v_cvt_pk_bf16_f32 v56, v24, v25
    v_lshlrev_b32 v24, 16, v56
    v_and_b32 v25, s86, v56
    v_mul_f32 v24, v24, v192
    v_mul_f32 v25, v25, v193
    v_cvt_pk_bf16_f32 v56, v24, v25
    v_lshlrev_b32 v24, 16, v56
    v_and_b32 v25, s86, v56
    v_lshlrev_b32 v57, 16, v16
    v_and_b32 v58, s86, v16
    v_add_f32 v24, v24, v57
    v_add_f32 v25, v25, v58
    v_cvt_pk_bf16_f32 v16, v24, v25
    v_cvt_pk_bf16_f32 v56, v26, v27
    v_lshlrev_b32 v26, 16, v56
    v_and_b32 v27, s86, v56
    v_mul_f32 v26, v26, v194
    v_mul_f32 v27, v27, v195
    v_cvt_pk_bf16_f32 v56, v26, v27
    v_lshlrev_b32 v26, 16, v56
    v_and_b32 v27, s86, v56
    v_lshlrev_b32 v57, 16, v17
    v_and_b32 v58, s86, v17
    v_add_f32 v26, v26, v57
    v_add_f32 v27, v27, v58
    v_cvt_pk_bf16_f32 v17, v26, v27
    buffer_store_dwordx2 v[16:17], v88, s[24:27], s10 offen
    v_cvt_pk_bf16_f32 v56, v28, v29
    v_lshlrev_b32 v28, 16, v56
    v_and_b32 v29, s86, v56
    v_mul_f32 v28, v28, v196
    v_mul_f32 v29, v29, v197
    v_cvt_pk_bf16_f32 v56, v28, v29
    v_lshlrev_b32 v28, 16, v56
    v_and_b32 v29, s86, v56
    v_lshlrev_b32 v57, 16, v18
    v_and_b32 v58, s86, v18
    v_add_f32 v28, v28, v57
    v_add_f32 v29, v29, v58
    v_cvt_pk_bf16_f32 v18, v28, v29
    v_cvt_pk_bf16_f32 v56, v30, v31
    v_lshlrev_b32 v30, 16, v56
    v_and_b32 v31, s86, v56
    v_mul_f32 v30, v30, v198
    v_mul_f32 v31, v31, v199
    v_cvt_pk_bf16_f32 v56, v30, v31
    v_lshlrev_b32 v30, 16, v56
    v_and_b32 v31, s86, v56
    v_lshlrev_b32 v57, 16, v19
    v_and_b32 v58, s86, v19
    v_add_f32 v30, v30, v57
    v_add_f32 v31, v31, v58
    v_cvt_pk_bf16_f32 v19, v30, v31
    buffer_store_dwordx2 v[18:19], v89, s[24:27], s10 offen
    v_cvt_pk_bf16_f32 v56, v32, v33
    v_lshlrev_b32 v32, 16, v56
    v_and_b32 v33, s86, v56
    v_mul_f32 v32, v32, v224
    v_mul_f32 v33, v33, v225
    v_cvt_pk_bf16_f32 v56, v32, v33
    v_lshlrev_b32 v32, 16, v56
    v_and_b32 v33, s86, v56
    v_lshlrev_b32 v57, 16, v20
    v_and_b32 v58, s86, v20
    v_add_f32 v32, v32, v57
    v_add_f32 v33, v33, v58
    v_cvt_pk_bf16_f32 v20, v32, v33
    v_cvt_pk_bf16_f32 v56, v34, v35
    v_lshlrev_b32 v34, 16, v56
    v_and_b32 v35, s86, v56
    v_mul_f32 v34, v34, v226
    v_mul_f32 v35, v35, v227
    v_cvt_pk_bf16_f32 v56, v34, v35
    v_lshlrev_b32 v34, 16, v56
    v_and_b32 v35, s86, v56
    v_lshlrev_b32 v57, 16, v21
    v_and_b32 v58, s86, v21
    v_add_f32 v34, v34, v57
    v_add_f32 v35, v35, v58
    v_cvt_pk_bf16_f32 v21, v34, v35
    buffer_store_dwordx2 v[20:21], v88, s[24:27], s11 offen
    v_cvt_pk_bf16_f32 v56, v36, v37
    v_lshlrev_b32 v36, 16, v56
    v_and_b32 v37, s86, v56
    v_mul_f32 v36, v36, v228
    v_mul_f32 v37, v37, v229
    v_cvt_pk_bf16_f32 v56, v36, v37
    v_lshlrev_b32 v36, 16, v56
    v_and_b32 v37, s86, v56
    v_lshlrev_b32 v57, 16, v22
    v_and_b32 v58, s86, v22
    v_add_f32 v36, v36, v57
    v_add_f32 v37, v37, v58
    v_cvt_pk_bf16_f32 v22, v36, v37
    v_cvt_pk_bf16_f32 v56, v38, v39
    v_lshlrev_b32 v38, 16, v56
    v_and_b32 v39, s86, v56
    v_mul_f32 v38, v38, v230
    v_mul_f32 v39, v39, v231
    v_cvt_pk_bf16_f32 v56, v38, v39
    v_lshlrev_b32 v38, 16, v56
    v_and_b32 v39, s86, v56
    v_lshlrev_b32 v57, 16, v23
    v_and_b32 v58, s86, v23
    v_add_f32 v38, v38, v57
    v_add_f32 v39, v39, v58
    v_cvt_pk_bf16_f32 v23, v38, v39
    buffer_store_dwordx2 v[22:23], v89, s[24:27], s11 offen
L_sdone:
    s_cmp_eq_u32 s78, 0
    s_cbranch_scc1 L_done
    s_add_u32 s77, s77, 1
    s_cmp_lt_u32 s77, 16
    s_cbranch_scc1 L_cold
    s_branch L_fin
L_loadpass:
    s_bfe_u32 s82, s14, 0x100000
    s_bcnt1_i32_b32 s5, s82
    s_cbranch_scc0 L_lp0
    s_ff1_i32_b32 s84, s82
    s_lshl_b32 s85, s84, 10
    s_add_u32 s85, s85, s8
    s_bitset0_b32 s82, s84
    buffer_load_dwordx4 a[64:67], v1, s[60:63], s85 offen sc1
    s_cmp_lg_u32 s82, 0
    s_cbranch_scc0 L_lp0
    s_ff1_i32_b32 s84, s82
    s_lshl_b32 s85, s84, 10
    s_add_u32 s85, s85, s8
    s_bitset0_b32 s82, s84
    buffer_load_dwordx4 a[68:71], v1, s[60:63], s85 offen sc1
    s_cmp_lg_u32 s82, 0
    s_cbranch_scc0 L_lp0
    s_ff1_i32_b32 s84, s82
    s_lshl_b32 s85, s84, 10
    s_add_u32 s85, s85, s8
    s_bitset0_b32 s82, s84
    buffer_load_dwordx4 a[72:75], v1, s[60:63], s85 offen sc1
    s_cmp_lg_u32 s82, 0
    s_cbranch_scc0 L_lp0
    s_ff1_i32_b32 s84, s82
    s_lshl_b32 s85, s84, 10
    s_add_u32 s85, s85, s8
    s_bitset0_b32 s82, s84
    buffer_load_dwordx4 a[76:79], v1, s[60:63], s85 offen sc1
    s_cmp_lg_u32 s82, 0
    s_cbranch_scc0 L_lp0
    s_ff1_i32_b32 s84, s82
    s_lshl_b32 s85, s84, 10
    s_add_u32 s85, s85, s8
    s_bitset0_b32 s82, s84
    buffer_load_dwordx4 a[80:83], v1, s[60:63], s85 offen sc1
    s_cmp_lg_u32 s82, 0
    s_cbranch_scc0 L_lp0
    s_ff1_i32_b32 s84, s82
    s_lshl_b32 s85, s84, 10
    s_add_u32 s85, s85, s8
    s_bitset0_b32 s82, s84
    buffer_load_dwordx4 a[84:87], v1, s[60:63], s85 offen sc1
    s_cmp_lg_u32 s82, 0
    s_cbranch_scc0 L_lp0
    s_ff1_i32_b32 s84, s82
    s_lshl_b32 s85, s84, 10
    s_add_u32 s85, s85, s8
    s_bitset0_b32 s82, s84
    buffer_load_dwordx4 a[88:91], v1, s[60:63], s85 offen sc1
    s_cmp_lg_u32 s82, 0
    s_cbranch_scc0 L_lp0
    s_ff1_i32_b32 s84, s82
    s_lshl_b32 s85, s84, 10
    s_add_u32 s85, s85, s8
    s_bitset0_b32 s82, s84
    buffer_load_dwordx4 a[92:95], v1, s[60:63], s85 offen sc1
    s_cmp_lg_u32 s82, 0
    s_cbranch_scc0 L_lp0
    s_ff1_i32_b32 s84, s82
    s_lshl_b32 s85, s84, 10
    s_add_u32 s85, s85, s8
    s_bitset0_b32 s82, s84
    buffer_load_dwordx4 a[96:99], v1, s[60:63], s85 offen sc1
    s_cmp_lg_u32 s82, 0
    s_cbranch_scc0 L_lp0
    s_ff1_i32_b32 s84, s82
    s_lshl_b32 s85, s84, 10
    s_add_u32 s85, s85, s8
    s_bitset0_b32 s82, s84
    buffer_load_dwordx4 a[100:103], v1, s[60:63], s85 offen sc1
    s_cmp_lg_u32 s82, 0
    s_cbranch_scc0 L_lp0
    s_ff1_i32_b32 s84, s82
    s_lshl_b32 s85, s84, 10
    s_add_u32 s85, s85, s8
    s_bitset0_b32 s82, s84
    buffer_load_dwordx4 a[104:107], v1, s[60:63], s85 offen sc1
    s_cmp_lg_u32 s82, 0
    s_cbranch_scc0 L_lp0
    s_ff1_i32_b32 s84, s82
    s_lshl_b32 s85, s84, 10
    s_add_u32 s85, s85, s8
    s_bitset0_b32 s82, s84
    buffer_load_dwordx4 a[108:111], v1, s[60:63], s85 offen sc1
    s_cmp_lg_u32 s82, 0
    s_cbranch_scc0 L_lp0
    s_ff1_i32_b32 s84, s82
    s_lshl_b32 s85, s84, 10
    s_add_u32 s85, s85, s8
    s_bitset0_b32 s82, s84
    buffer_load_dwordx4 a[112:115], v1, s[60:63], s85 offen sc1
    s_cmp_lg_u32 s82, 0
    s_cbranch_scc0 L_lp0
    s_ff1_i32_b32 s84, s82
    s_lshl_b32 s85, s84, 10
    s_add_u32 s85, s85, s8
    s_bitset0_b32 s82, s84
    buffer_load_dwordx4 a[116:119], v1, s[60:63], s85 offen sc1
    s_cmp_lg_u32 s82, 0
    s_cbranch_scc0 L_lp0
    s_ff1_i32_b32 s84, s82
    s_lshl_b32 s85, s84, 10
    s_add_u32 s85, s85, s8
    s_bitset0_b32 s82, s84
    buffer_load_dwordx4 a[120:123], v1, s[60:63], s85 offen sc1
    s_cmp_lg_u32 s82, 0
    s_cbranch_scc0 L_lp0
    s_ff1_i32_b32 s84, s82
    s_lshl_b32 s85, s84, 10
    s_add_u32 s85, s85, s8
    s_bitset0_b32 s82, s84
    buffer_load_dwordx4 a[124:127], v1, s[60:63], s85 offen sc1
    s_cmp_lg_u32 s82, 0
L_lp0:
    s_bfe_u32 s82, s14, 0x100010
    s_bcnt1_i32_b32 s6, s82
    s_cbranch_scc0 L_lp1
    s_ff1_i32_b32 s84, s82
    s_lshl_b32 s85, s84, 10
    s_add_u32 s85, s85, s9
    s_bitset0_b32 s82, s84
    buffer_load_dwordx4 v[128:131], v1, s[60:63], s85 offen sc1
    s_cmp_lg_u32 s82, 0
    s_cbranch_scc0 L_lp1
    s_ff1_i32_b32 s84, s82
    s_lshl_b32 s85, s84, 10
    s_add_u32 s85, s85, s9
    s_bitset0_b32 s82, s84
    buffer_load_dwordx4 v[132:135], v1, s[60:63], s85 offen sc1
    s_cmp_lg_u32 s82, 0
    s_cbranch_scc0 L_lp1
    s_ff1_i32_b32 s84, s82
    s_lshl_b32 s85, s84, 10
    s_add_u32 s85, s85, s9
    s_bitset0_b32 s82, s84
    buffer_load_dwordx4 v[136:139], v1, s[60:63], s85 offen sc1
    s_cmp_lg_u32 s82, 0
    s_cbranch_scc0 L_lp1
    s_ff1_i32_b32 s84, s82
    s_lshl_b32 s85, s84, 10
    s_add_u32 s85, s85, s9
    s_bitset0_b32 s82, s84
    buffer_load_dwordx4 v[140:143], v1, s[60:63], s85 offen sc1
    s_cmp_lg_u32 s82, 0
    s_cbranch_scc0 L_lp1
    s_ff1_i32_b32 s84, s82
    s_lshl_b32 s85, s84, 10
    s_add_u32 s85, s85, s9
    s_bitset0_b32 s82, s84
    buffer_load_dwordx4 v[144:147], v1, s[60:63], s85 offen sc1
    s_cmp_lg_u32 s82, 0
    s_cbranch_scc0 L_lp1
    s_ff1_i32_b32 s84, s82
    s_lshl_b32 s85, s84, 10
    s_add_u32 s85, s85, s9
    s_bitset0_b32 s82, s84
    buffer_load_dwordx4 v[148:151], v1, s[60:63], s85 offen sc1
    s_cmp_lg_u32 s82, 0
    s_cbranch_scc0 L_lp1
    s_ff1_i32_b32 s84, s82
    s_lshl_b32 s85, s84, 10
    s_add_u32 s85, s85, s9
    s_bitset0_b32 s82, s84
    buffer_load_dwordx4 v[152:155], v1, s[60:63], s85 offen sc1
    s_cmp_lg_u32 s82, 0
    s_cbranch_scc0 L_lp1
    s_ff1_i32_b32 s84, s82
    s_lshl_b32 s85, s84, 10
    s_add_u32 s85, s85, s9
    s_bitset0_b32 s82, s84
    buffer_load_dwordx4 v[156:159], v1, s[60:63], s85 offen sc1
    s_cmp_lg_u32 s82, 0
    s_cbranch_scc0 L_lp1
    s_ff1_i32_b32 s84, s82
    s_lshl_b32 s85, s84, 10
    s_add_u32 s85, s85, s9
    s_bitset0_b32 s82, s84
    buffer_load_dwordx4 v[160:163], v1, s[60:63], s85 offen sc1
    s_cmp_lg_u32 s82, 0
    s_cbranch_scc0 L_lp1
    s_ff1_i32_b32 s84, s82
    s_lshl_b32 s85, s84, 10
    s_add_u32 s85, s85, s9
    s_bitset0_b32 s82, s84
    buffer_load_dwordx4 v[164:167], v1, s[60:63], s85 offen sc1
    s_cmp_lg_u32 s82, 0
    s_cbranch_scc0 L_lp1
    s_ff1_i32_b32 s84, s82
    s_lshl_b32 s85, s84, 10
    s_add_u32 s85, s85, s9
    s_bitset0_b32 s82, s84
    buffer_load_dwordx4 v[168:171], v1, s[60:63], s85 offen sc1
    s_cmp_lg_u32 s82, 0
    s_cbranch_scc0 L_lp1
    s_ff1_i32_b32 s84, s82
    s_lshl_b32 s85, s84, 10
    s_add_u32 s85, s85, s9
    s_bitset0_b32 s82, s84
    buffer_load_dwordx4 v[172:175], v1, s[60:63], s85 offen sc1
    s_cmp_lg_u32 s82, 0
    s_cbranch_scc0 L_lp1
    s_ff1_i32_b32 s84, s82
    s_lshl_b32 s85, s84, 10
    s_add_u32 s85, s85, s9
    s_bitset0_b32 s82, s84
    buffer_load_dwordx4 v[176:179], v1, s[60:63], s85 offen sc1
    s_cmp_lg_u32 s82, 0
    s_cbranch_scc0 L_lp1
    s_ff1_i32_b32 s84, s82
    s_lshl_b32 s85, s84, 10
    s_add_u32 s85, s85, s9
    s_bitset0_b32 s82, s84
    buffer_load_dwordx4 v[180:183], v1, s[60:63], s85 offen sc1
    s_cmp_lg_u32 s82, 0
    s_cbranch_scc0 L_lp1
    s_ff1_i32_b32 s84, s82
    s_lshl_b32 s85, s84, 10
    s_add_u32 s85, s85, s9
    s_bitset0_b32 s82, s84
    buffer_load_dwordx4 v[184:187], v1, s[60:63], s85 offen sc1
    s_cmp_lg_u32 s82, 0
    s_cbranch_scc0 L_lp1
    s_ff1_i32_b32 s84, s82
    s_lshl_b32 s85, s84, 10
    s_add_u32 s85, s85, s9
    s_bitset0_b32 s82, s84
    buffer_load_dwordx4 v[188:191], v1, s[60:63], s85 offen sc1
    s_cmp_lg_u32 s82, 0
L_lp1:
    s_setpc_b64 s[88:89]
L_sumpass:
    s_cmp_le_u32 s5, 0
    s_cbranch_scc1 L_sp0
    v_mfma_f32_16x16x32_bf16 v[24:27], v[50:53], a[64:67], v[24:27]
    v_mfma_f32_16x16x32_bf16 v[28:31], v[48:51], a[64:67], v[28:31]
    s_cmp_le_u32 s5, 1
    s_cbranch_scc1 L_sp0
    v_mfma_f32_16x16x32_bf16 v[24:27], v[50:53], a[68:71], v[24:27]
    v_mfma_f32_16x16x32_bf16 v[28:31], v[48:51], a[68:71], v[28:31]
    s_cmp_le_u32 s5, 2
    s_cbranch_scc1 L_sp0
    v_mfma_f32_16x16x32_bf16 v[24:27], v[50:53], a[72:75], v[24:27]
    v_mfma_f32_16x16x32_bf16 v[28:31], v[48:51], a[72:75], v[28:31]
    s_cmp_le_u32 s5, 3
    s_cbranch_scc1 L_sp0
    v_mfma_f32_16x16x32_bf16 v[24:27], v[50:53], a[76:79], v[24:27]
    v_mfma_f32_16x16x32_bf16 v[28:31], v[48:51], a[76:79], v[28:31]
    s_cmp_le_u32 s5, 4
    s_cbranch_scc1 L_sp0
    v_mfma_f32_16x16x32_bf16 v[24:27], v[50:53], a[80:83], v[24:27]
    v_mfma_f32_16x16x32_bf16 v[28:31], v[48:51], a[80:83], v[28:31]
    s_cmp_le_u32 s5, 5
    s_cbranch_scc1 L_sp0
    v_mfma_f32_16x16x32_bf16 v[24:27], v[50:53], a[84:87], v[24:27]
    v_mfma_f32_16x16x32_bf16 v[28:31], v[48:51], a[84:87], v[28:31]
    s_cmp_le_u32 s5, 6
    s_cbranch_scc1 L_sp0
    v_mfma_f32_16x16x32_bf16 v[24:27], v[50:53], a[88:91], v[24:27]
    v_mfma_f32_16x16x32_bf16 v[28:31], v[48:51], a[88:91], v[28:31]
    s_cmp_le_u32 s5, 7
    s_cbranch_scc1 L_sp0
    v_mfma_f32_16x16x32_bf16 v[24:27], v[50:53], a[92:95], v[24:27]
    v_mfma_f32_16x16x32_bf16 v[28:31], v[48:51], a[92:95], v[28:31]
    s_cmp_le_u32 s5, 8
    s_cbranch_scc1 L_sp0
    v_mfma_f32_16x16x32_bf16 v[24:27], v[50:53], a[96:99], v[24:27]
    v_mfma_f32_16x16x32_bf16 v[28:31], v[48:51], a[96:99], v[28:31]
    s_cmp_le_u32 s5, 9
    s_cbranch_scc1 L_sp0
    v_mfma_f32_16x16x32_bf16 v[24:27], v[50:53], a[100:103], v[24:27]
    v_mfma_f32_16x16x32_bf16 v[28:31], v[48:51], a[100:103], v[28:31]
    s_cmp_le_u32 s5, 10
    s_cbranch_scc1 L_sp0
    v_mfma_f32_16x16x32_bf16 v[24:27], v[50:53], a[104:107], v[24:27]
    v_mfma_f32_16x16x32_bf16 v[28:31], v[48:51], a[104:107], v[28:31]
    s_cmp_le_u32 s5, 11
    s_cbranch_scc1 L_sp0
    v_mfma_f32_16x16x32_bf16 v[24:27], v[50:53], a[108:111], v[24:27]
    v_mfma_f32_16x16x32_bf16 v[28:31], v[48:51], a[108:111], v[28:31]
    s_cmp_le_u32 s5, 12
    s_cbranch_scc1 L_sp0
    v_mfma_f32_16x16x32_bf16 v[24:27], v[50:53], a[112:115], v[24:27]
    v_mfma_f32_16x16x32_bf16 v[28:31], v[48:51], a[112:115], v[28:31]
    s_cmp_le_u32 s5, 13
    s_cbranch_scc1 L_sp0
    v_mfma_f32_16x16x32_bf16 v[24:27], v[50:53], a[116:119], v[24:27]
    v_mfma_f32_16x16x32_bf16 v[28:31], v[48:51], a[116:119], v[28:31]
    s_cmp_le_u32 s5, 14
    s_cbranch_scc1 L_sp0
    v_mfma_f32_16x16x32_bf16 v[24:27], v[50:53], a[120:123], v[24:27]
    v_mfma_f32_16x16x32_bf16 v[28:31], v[48:51], a[120:123], v[28:31]
    s_cmp_le_u32 s5, 15
    s_cbranch_scc1 L_sp0
    v_mfma_f32_16x16x32_bf16 v[24:27], v[50:53], a[124:127], v[24:27]
    v_mfma_f32_16x16x32_bf16 v[28:31], v[48:51], a[124:127], v[28:31]
L_sp0:
    s_mov_b32 s5, 0
    s_cmp_le_u32 s6, 0
    s_cbranch_scc1 L_sp1
    v_mfma_f32_16x16x32_bf16 v[32:35], v[50:53], v[128:131], v[32:35]
    v_mfma_f32_16x16x32_bf16 v[36:39], v[48:51], v[128:131], v[36:39]
    s_cmp_le_u32 s6, 1
    s_cbranch_scc1 L_sp1
    v_mfma_f32_16x16x32_bf16 v[32:35], v[50:53], v[132:135], v[32:35]
    v_mfma_f32_16x16x32_bf16 v[36:39], v[48:51], v[132:135], v[36:39]
    s_cmp_le_u32 s6, 2
    s_cbranch_scc1 L_sp1
    v_mfma_f32_16x16x32_bf16 v[32:35], v[50:53], v[136:139], v[32:35]
    v_mfma_f32_16x16x32_bf16 v[36:39], v[48:51], v[136:139], v[36:39]
    s_cmp_le_u32 s6, 3
    s_cbranch_scc1 L_sp1
    v_mfma_f32_16x16x32_bf16 v[32:35], v[50:53], v[140:143], v[32:35]
    v_mfma_f32_16x16x32_bf16 v[36:39], v[48:51], v[140:143], v[36:39]
    s_cmp_le_u32 s6, 4
    s_cbranch_scc1 L_sp1
    v_mfma_f32_16x16x32_bf16 v[32:35], v[50:53], v[144:147], v[32:35]
    v_mfma_f32_16x16x32_bf16 v[36:39], v[48:51], v[144:147], v[36:39]
    s_cmp_le_u32 s6, 5
    s_cbranch_scc1 L_sp1
    v_mfma_f32_16x16x32_bf16 v[32:35], v[50:53], v[148:151], v[32:35]
    v_mfma_f32_16x16x32_bf16 v[36:39], v[48:51], v[148:151], v[36:39]
    s_cmp_le_u32 s6, 6
    s_cbranch_scc1 L_sp1
    v_mfma_f32_16x16x32_bf16 v[32:35], v[50:53], v[152:155], v[32:35]
    v_mfma_f32_16x16x32_bf16 v[36:39], v[48:51], v[152:155], v[36:39]
    s_cmp_le_u32 s6, 7
    s_cbranch_scc1 L_sp1
    v_mfma_f32_16x16x32_bf16 v[32:35], v[50:53], v[156:159], v[32:35]
    v_mfma_f32_16x16x32_bf16 v[36:39], v[48:51], v[156:159], v[36:39]
    s_cmp_le_u32 s6, 8
    s_cbranch_scc1 L_sp1
    v_mfma_f32_16x16x32_bf16 v[32:35], v[50:53], v[160:163], v[32:35]
    v_mfma_f32_16x16x32_bf16 v[36:39], v[48:51], v[160:163], v[36:39]
    s_cmp_le_u32 s6, 9
    s_cbranch_scc1 L_sp1
    v_mfma_f32_16x16x32_bf16 v[32:35], v[50:53], v[164:167], v[32:35]
    v_mfma_f32_16x16x32_bf16 v[36:39], v[48:51], v[164:167], v[36:39]
    s_cmp_le_u32 s6, 10
    s_cbranch_scc1 L_sp1
    v_mfma_f32_16x16x32_bf16 v[32:35], v[50:53], v[168:171], v[32:35]
    v_mfma_f32_16x16x32_bf16 v[36:39], v[48:51], v[168:171], v[36:39]
    s_cmp_le_u32 s6, 11
    s_cbranch_scc1 L_sp1
    v_mfma_f32_16x16x32_bf16 v[32:35], v[50:53], v[172:175], v[32:35]
    v_mfma_f32_16x16x32_bf16 v[36:39], v[48:51], v[172:175], v[36:39]
    s_cmp_le_u32 s6, 12
    s_cbranch_scc1 L_sp1
    v_mfma_f32_16x16x32_bf16 v[32:35], v[50:53], v[176:179], v[32:35]
    v_mfma_f32_16x16x32_bf16 v[36:39], v[48:51], v[176:179], v[36:39]
    s_cmp_le_u32 s6, 13
    s_cbranch_scc1 L_sp1
    v_mfma_f32_16x16x32_bf16 v[32:35], v[50:53], v[180:183], v[32:35]
    v_mfma_f32_16x16x32_bf16 v[36:39], v[48:51], v[180:183], v[36:39]
    s_cmp_le_u32 s6, 14
    s_cbranch_scc1 L_sp1
    v_mfma_f32_16x16x32_bf16 v[32:35], v[50:53], v[184:187], v[32:35]
    v_mfma_f32_16x16x32_bf16 v[36:39], v[48:51], v[184:187], v[36:39]
    s_cmp_le_u32 s6, 15
    s_cbranch_scc1 L_sp1
    v_mfma_f32_16x16x32_bf16 v[32:35], v[50:53], v[188:191], v[32:35]
    v_mfma_f32_16x16x32_bf16 v[36:39], v[48:51], v[188:191], v[36:39]
L_sp1:
    s_mov_b32 s6, 0
    s_setpc_b64 s[88:89]
L_done:
    s_cmp_lg_u32 s66, 0
    s_cbranch_scc1 L_meet
    s_waitcnt vmcnt(0)
    v_readfirstlane_b32 s82, v7
    s_nop 1
    v_mov_b32 v6, s82
    ds_write_b32 v5, v6 offset:128
    s_waitcnt lgkmcnt(0)
L_meet:
    s_barrier
    ds_read_b32 v7, v5 offset:128
    s_waitcnt lgkmcnt(0)
    v_readfirstlane_b32 s82, v7
    s_nop 0
    s_and_b32 s84, s82, 31
    s_cmp_lg_u32 s84, 15
    s_cbranch_scc1 L_fin
    s_lshr_b32 s82, s82, 8
    s_cmp_lg_u32 s76, 16
    s_cselect_b32 s84, 1, 0
    s_or_b32 s82, s82, s84
    s_cmp_eq_u32 s82, 0
    s_cbranch_scc1 L_fin
    s_mov_b32 s78, 1
    s_mov_b32 s83, 1
    s_mov_b32 s77, 0
L_cold:
    s_waitcnt vmcnt(0) lgkmcnt(0)
    s_barrier
    s_lshr_b32 s16, s77, 2
    s_lshl_b32 s17, s65, 2
    s_add_u32 s16, s16, s17
    s_lshl_b32 s18, s16, 4
    s_lshl_b32 s17, s66, 2
    s_add_u32 s18, s18, s17
    s_lshl_b32 s18, s18, 13
    s_add_u32 s18, s18, 0x2000000
    s_and_b32 s19, s77, 3
    s_mul_i32 s80, s66, 401408
    s_lshl_b32 s17, s19, 8
    s_add_u32 s80, s80, s17
    s_lshl_b32 s93, s16, 7
    s_add_u32 s93, s93, 0x4000000
    s_cmp_eq_u32 s19, 3
    s_cselect_b32 s17, 3, 7
    v_lshrrev_b32 v100, 8, v1
    v_bfe_u32 v101, v1, 5, 3
    v_mul_u32_u24 v102, 896, v100
    v_and_b32 v103, 16, v1
    v_add_u32 v102, v102, v103
    v_add_u32 v103, 0, v100
    v_xor_b32 v103, v103, v101
    v_and_b32 v103, s17, v103
    v_lshl_add_u32 v103, v103, 5, v102
    v_add_u32 v96, 0, v103
    v_add_u32 v103, 4, v100
    v_xor_b32 v103, v103, v101
    v_and_b32 v103, s17, v103
    v_lshl_add_u32 v103, v103, 5, v102
    v_add_u32 v97, 2560, v103
    v_add_u32 v103, 0, v100
    v_xor_b32 v103, v103, v101
    v_and_b32 v103, s17, v103
    v_lshl_add_u32 v103, v103, 5, v102
    v_add_u32 v98, 5120, v103
    v_add_u32 v103, 4, v100
    v_xor_b32 v103, v103, v101
    v_and_b32 v103, s17, v103
    v_lshl_add_u32 v103, v103, 5, v102
    v_add_u32 v99, 7680, v103
    buffer_load_dwordx4 v[192:195], v1, s[60:63], s18 offen offset:0 sc1
    buffer_load_dwordx4 v[196:199], v1, s[60:63], s18 offen offset:1024 sc1
    buffer_load_dwordx4 v[200:203], v1, s[60:63], s18 offen offset:2048 sc1
    buffer_load_dwordx4 v[204:207], v1, s[60:63], s18 offen offset:3072 sc1
    s_add_u32 s18, s18, 4096
    buffer_load_dwordx4 v[208:211], v1, s[60:63], s18 offen offset:0 sc1
    buffer_load_dwordx4 v[212:215], v1, s[60:63], s18 offen offset:1024 sc1
    buffer_load_dwordx4 v[216:219], v1, s[60:63], s18 offen offset:2048 sc1
    buffer_load_dwordx4 v[220:223], v1, s[60:63], s18 offen offset:3072 sc1
    s_add_u32 s18, s18, 4096
    buffer_load_dwordx4 v[224:227], v1, s[60:63], s18 offen offset:0 sc1
    buffer_load_dwordx4 v[228:231], v1, s[60:63], s18 offen offset:1024 sc1
    buffer_load_dwordx4 v[232:235], v1, s[60:63], s18 offen offset:2048 sc1
    buffer_load_dwordx4 v[236:239], v1, s[60:63], s18 offen offset:3072 sc1
    s_add_u32 s18, s18, 4096
    buffer_load_dwordx4 v[240:243], v1, s[60:63], s18 offen offset:0 sc1
    buffer_load_dwordx4 v[244:247], v1, s[60:63], s18 offen offset:1024 sc1
    buffer_load_dwordx4 v[248:251], v1, s[60:63], s18 offen offset:2048 sc1
    buffer_load_dwordx4 v[252:255], v1, s[60:63], s18 offen offset:3072 sc1
    s_add_u32 s18, s18, 4096
    buffer_load_dwordx4 a[128:131], v1, s[60:63], s18 offen offset:0 sc1
    buffer_load_dwordx4 a[132:135], v1, s[60:63], s18 offen offset:1024 sc1
    buffer_load_dwordx4 a[136:139], v1, s[60:63], s18 offen offset:2048 sc1
    buffer_load_dwordx4 a[140:143], v1, s[60:63], s18 offen offset:3072 sc1
    s_add_u32 s18, s18, 4096
    buffer_load_dwordx4 a[144:147], v1, s[60:63], s18 offen offset:0 sc1
    buffer_load_dwordx4 a[148:151], v1, s[60:63], s18 offen offset:1024 sc1
    buffer_load_dwordx4 a[152:155], v1, s[60:63], s18 offen offset:2048 sc1
    buffer_load_dwordx4 a[156:159], v1, s[60:63], s18 offen offset:3072 sc1
    s_add_u32 s18, s18, 4096
    buffer_load_dwordx4 a[160:163], v1, s[60:63], s18 offen offset:0 sc1
    buffer_load_dwordx4 a[164:167], v1, s[60:63], s18 offen offset:1024 sc1
    buffer_load_dwordx4 a[168:171], v1, s[60:63], s18 offen offset:2048 sc1
    buffer_load_dwordx4 a[172:175], v1, s[60:63], s18 offen offset:3072 sc1
    s_add_u32 s18, s18, 4096
    buffer_load_dwordx4 a[176:179], v1, s[60:63], s18 offen offset:0 sc1
    buffer_load_dwordx4 a[180:183], v1, s[60:63], s18 offen offset:1024 sc1
    buffer_load_dwordx4 a[184:187], v1, s[60:63], s18 offen offset:2048 sc1
    buffer_load_dwordx4 a[188:191], v1, s[60:63], s18 offen offset:3072 sc1
    s_add_u32 s18, s18, 4096
    s_waitcnt vmcnt(0)
    s_add_u32 m0, s67, 131072
    s_nop 0
    buffer_load_dwordx4 v96, s[56:59], s80 offen offset:0 lds
    buffer_load_dwordx4 v97, s[56:59], s80 offen offset:1024 lds
    buffer_load_dwordx4 v98, s[56:59], s80 offen offset:2048 lds
    buffer_load_dwordx4 v99, s[56:59], s80 offen offset:3072 lds
    s_add_u32 s80, s80, 14336
    s_add_u32 m0, s67, 147456
    s_nop 0
    buffer_load_dwordx4 v96, s[56:59], s80 offen offset:0 lds
    buffer_load_dwordx4 v97, s[56:59], s80 offen offset:1024 lds
    buffer_load_dwordx4 v98, s[56:59], s80 offen offset:2048 lds
    buffer_load_dwordx4 v99, s[56:59], s80 offen offset:3072 lds
    s_add_u32 s80, s80, 14336
    s_add_u32 m0, s67, 32768
    s_nop 0
    buffer_load_dwordx4 v96, s[56:59], s80 offen offset:0 lds
    buffer_load_dwordx4 v97, s[56:59], s80 offen offset:1024 lds
    buffer_load_dwordx4 v98, s[56:59], s80 offen offset:2048 lds
    buffer_load_dwordx4 v99, s[56:59], s80 offen offset:3072 lds
    s_add_u32 s80, s80, 14336
    s_add_u32 m0, s67, 98304
    s_nop 0
    buffer_load_dwordx4 v96, s[56:59], s80 offen offset:0 lds
    buffer_load_dwordx4 v97, s[56:59], s80 offen offset:1024 lds
    buffer_load_dwordx4 v98, s[56:59], s80 offen offset:2048 lds
    buffer_load_dwordx4 v99, s[56:59], s80 offen offset:3072 lds
    s_add_u32 s80, s80, 14336
    s_add_u32 m0, s67, 49152
    s_nop 0
    buffer_load_dwordx4 v96, s[56:59], s80 offen offset:0 lds
    buffer_load_dwordx4 v97, s[56:59], s80 offen offset:1024 lds
    buffer_load_dwordx4 v98, s[56:59], s80 offen offset:2048 lds
    buffer_load_dwordx4 v99, s[56:59], s80 offen offset:3072 lds
    s_add_u32 s80, s80, 14336
    s_add_u32 m0, s67, 114688
    s_nop 0
    buffer_load_dwordx4 v96, s[56:59], s80 offen offset:0 lds
    buffer_load_dwordx4 v97, s[56:59], s80 offen offset:1024 lds
    buffer_load_dwordx4 v98, s[56:59], s80 offen offset:2048 lds
    buffer_load_dwordx4 v99, s[56:59], s80 offen offset:3072 lds
    s_add_u32 s80, s80, 14336
    s_add_u32 m0, s67, 0
    s_nop 0
    buffer_load_dwordx4 v96, s[56:59], s80 offen offset:0 lds
    buffer_load_dwordx4 v97, s[56:59], s80 offen offset:1024 lds
    buffer_load_dwordx4 v98, s[56:59], s80 offen offset:2048 lds
    buffer_load_dwordx4 v99, s[56:59], s80 offen offset:3072 lds
    s_add_u32 s80, s80, 14336
    s_add_u32 m0, s67, 65536
    s_nop 0
    buffer_load_dwordx4 v96, s[56:59], s80 offen offset:0 lds
    buffer_load_dwordx4 v97, s[56:59], s80 offen offset:1024 lds
    buffer_load_dwordx4 v98, s[56:59], s80 offen offset:2048 lds
    buffer_load_dwordx4 v99, s[56:59], s80 offen offset:3072 lds
    s_add_u32 s80, s80, 14336
    s_add_u32 m0, s67, 16384
    s_nop 0
    buffer_load_dwordx4 v96, s[56:59], s80 offen offset:0 lds
    buffer_load_dwordx4 v97, s[56:59], s80 offen offset:1024 lds
    buffer_load_dwordx4 v98, s[56:59], s80 offen offset:2048 lds
    buffer_load_dwordx4 v99, s[56:59], s80 offen offset:3072 lds
    s_add_u32 s80, s80, 14336
    s_add_u32 m0, s67, 81920
    s_nop 0
    buffer_load_dwordx4 v96, s[56:59], s80 offen offset:0 lds
    buffer_load_dwordx4 v97, s[56:59], s80 offen offset:1024 lds
    buffer_load_dwordx4 v98, s[56:59], s80 offen offset:2048 lds
    buffer_load_dwordx4 v99, s[56:59], s80 offen offset:3072 lds
    s_add_u32 s80, s80, 14336
    s_waitcnt vmcnt(0) lgkmcnt(0)
    s_barrier
    s_branch L_roles
L_fin:
L_end:
    s_endpgm
L_code_end:
L_rare_1:
    s_mov_b32 s72, 1
    s_branch L_rp_1
L_rare_2:
    s_mov_b32 s72, 2
    s_branch L_rp_0
L_rare_3:
    s_mov_b32 s72, 3
    s_branch L_rp_1
L_rare_4:
    s_mov_b32 s72, 4
    s_branch L_rp_0
L_rare_9:
    s_mov_b32 s72, 9
    s_branch L_rp_1
L_rare_10:
    s_mov_b32 s72, 10
    s_branch L_rp_0
L_rare_11:
    s_mov_b32 s72, 11
    s_branch L_rp_1
L_rare_12:
    s_mov_b32 s72, 12
    s_branch L_rp_0
L_rare_13:
    s_mov_b32 s72, 13
    s_branch L_rp_1
L_rare_14:
    s_mov_b32 s72, 14
    s_branch L_rp_0
L_rare_15:
    s_mov_b32 s72, 15
    s_branch L_rp_1
L_rp_0:
    s_nop 15
    v_log_f32 v60, v56
    v_max3_f32 v63, v16, v17, v18
    v_max3_f32 v63, v63, v19, v24
    v_max3_f32 v63, v63, v25, v26
    v_max3_f32 v60, v60, v63, v27
    v_mov_b32 v63, v60
    s_nop 1
    v_permlane32_swap_b32 v60, v63
    v_max_f32 v60, v60, v63
    v_mov_b32 v63, v60
    s_nop 1
    v_permlane16_swap_b32 v60, v63
    v_max_f32 v60, v60, v63
    v_max_f32 v60, 0, v60
    v_exp_f32 v62, -v60
    v_sub_f32 v16, v16, v60
    v_sub_f32 v17, v17, v60
    v_sub_f32 v18, v18, v60
    v_sub_f32 v19, v19, v60
    v_sub_f32 v24, v24, v60
    v_sub_f32 v25, v25, v60
    v_sub_f32 v26, v26, v60
    v_sub_f32 v27, v27, v60
    v_sub_f32 v32, v32, v60
    v_sub_f32 v33, v33, v60
    v_sub_f32 v34, v34, v60
    v_sub_f32 v35, v35, v60
    v_sub_f32 v40, v40, v60
    v_sub_f32 v41, v41, v60
    v_sub_f32 v42, v42, v60
    v_sub_f32 v43, v43, v60
    v_sub_f32 v48, v48, v60
    v_sub_f32 v49, v49, v60
    v_sub_f32 v50, v50, v60
    v_sub_f32 v51, v51, v60
    v_mul_f32 v56, v56, v62
    v_accvgpr_read_b32 v64, a0
    v_accvgpr_read_b32 v65, a1
    v_accvgpr_read_b32 v66, a2
    v_accvgpr_read_b32 v67, a3
    v_mul_f32 v64, v64, v62
    v_mul_f32 v65, v65, v62
    v_mul_f32 v66, v66, v62
    v_mul_f32 v67, v67, v62
    v_accvgpr_write_b32 a0, v64
    v_accvgpr_write_b32 a1, v65
    v_accvgpr_write_b32 a2, v66
    v_accvgpr_write_b32 a3, v67
    v_accvgpr_read_b32 v64, a8
    v_accvgpr_read_b32 v65, a9
    v_accvgpr_read_b32 v66, a10
    v_accvgpr_read_b32 v67, a11
    v_mul_f32 v64, v64, v62
    v_mul_f32 v65, v65, v62
    v_mul_f32 v66, v66, v62
    v_mul_f32 v67, v67, v62
    v_accvgpr_write_b32 a8, v64
    v_accvgpr_write_b32 a9, v65
    v_accvgpr_write_b32 a10, v66
    v_accvgpr_write_b32 a11, v67
    v_accvgpr_read_b32 v64, a16
    v_accvgpr_read_b32 v65, a17
    v_accvgpr_read_b32 v66, a18
    v_accvgpr_read_b32 v67, a19
    v_mul_f32 v64, v64, v62
    v_mul_f32 v65, v65, v62
    v_mul_f32 v66, v66, v62
    v_mul_f32 v67, v67, v62
    v_accvgpr_write_b32 a16, v64
    v_accvgpr_write_b32 a17, v65
    v_accvgpr_write_b32 a18, v66
    v_accvgpr_write_b32 a19, v67
    v_accvgpr_read_b32 v64, a24
    v_accvgpr_read_b32 v65, a25
    v_accvgpr_read_b32 v66, a26
    v_accvgpr_read_b32 v67, a27
    v_mul_f32 v64, v64, v62
    v_mul_f32 v65, v65, v62
    v_mul_f32 v66, v66, v62
    v_mul_f32 v67, v67, v62
    v_accvgpr_write_b32 a24, v64
    v_accvgpr_write_b32 a25, v65
    v_accvgpr_write_b32 a26, v66
    v_accvgpr_write_b32 a27, v67
    v_accvgpr_read_b32 v64, a32
    v_accvgpr_read_b32 v65, a33
    v_accvgpr_read_b32 v66, a34
    v_accvgpr_read_b32 v67, a35
    v_mul_f32 v64, v64, v62
    v_mul_f32 v65, v65, v62
    v_mul_f32 v66, v66, v62
    v_mul_f32 v67, v67, v62
    v_accvgpr_write_b32 a32, v64
    v_accvgpr_write_b32 a33, v65
    v_accvgpr_write_b32 a34, v66
    v_accvgpr_write_b32 a35, v67
    v_accvgpr_read_b32 v64, a40
    v_accvgpr_read_b32 v65, a41
    v_accvgpr_read_b32 v66, a42
    v_accvgpr_read_b32 v67, a43
    v_mul_f32 v64, v64, v62
    v_mul_f32 v65, v65, v62
    v_mul_f32 v66, v66, v62
    v_mul_f32 v67, v67, v62
    v_accvgpr_write_b32 a40, v64
    v_accvgpr_write_b32 a41, v65
    v_accvgpr_write_b32 a42, v66
    v_accvgpr_write_b32 a43, v67
    v_accvgpr_read_b32 v64, a48
    v_accvgpr_read_b32 v65, a49
    v_accvgpr_read_b32 v66, a50
    v_accvgpr_read_b32 v67, a51
    v_mul_f32 v64, v64, v62
    v_mul_f32 v65, v65, v62
    v_mul_f32 v66, v66, v62
    v_mul_f32 v67, v67, v62
    v_accvgpr_write_b32 a48, v64
    v_accvgpr_write_b32 a49, v65
    v_accvgpr_write_b32 a50, v66
    v_accvgpr_write_b32 a51, v67
    v_accvgpr_read_b32 v64, a56
    v_accvgpr_read_b32 v65, a57
    v_accvgpr_read_b32 v66, a58
    v_accvgpr_read_b32 v67, a59
    v_mul_f32 v64, v64, v62
    v_mul_f32 v65, v65, v62
    v_mul_f32 v66, v66, v62
    v_mul_f32 v67, v67, v62
    v_accvgpr_write_b32 a56, v64
    v_accvgpr_write_b32 a57, v65
    v_accvgpr_write_b32 a58, v66
    v_accvgpr_write_b32 a59, v67
    v_accvgpr_read_b32 v64, a64
    v_accvgpr_read_b32 v65, a65
    v_accvgpr_read_b32 v66, a66
    v_accvgpr_read_b32 v67, a67
    v_mul_f32 v64, v64, v62
    v_mul_f32 v65, v65, v62
    v_mul_f32 v66, v66, v62
    v_mul_f32 v67, v67, v62
    v_accvgpr_write_b32 a64, v64
    v_accvgpr_write_b32 a65, v65
    v_accvgpr_write_b32 a66, v66
    v_accvgpr_write_b32 a67, v67
    v_accvgpr_read_b32 v64, a72
    v_accvgpr_read_b32 v65, a73
    v_accvgpr_read_b32 v66, a74
    v_accvgpr_read_b32 v67, a75
    v_mul_f32 v64, v64, v62
    v_mul_f32 v65, v65, v62
    v_mul_f32 v66, v66, v62
    v_mul_f32 v67, v67, v62
    v_accvgpr_write_b32 a72, v64
    v_accvgpr_write_b32 a73, v65
    v_accvgpr_write_b32 a74, v66
    v_accvgpr_write_b32 a75, v67
    v_accvgpr_read_b32 v64, a80
    v_accvgpr_read_b32 v65, a81
    v_accvgpr_read_b32 v66, a82
    v_accvgpr_read_b32 v67, a83
    v_mul_f32 v64, v64, v62
    v_mul_f32 v65, v65, v62
    v_mul_f32 v66, v66, v62
    v_mul_f32 v67, v67, v62
    v_accvgpr_write_b32 a80, v64
    v_accvgpr_write_b32 a81, v65
    v_accvgpr_write_b32 a82, v66
    v_accvgpr_write_b32 a83, v67
    v_accvgpr_read_b32 v64, a88
    v_accvgpr_read_b32 v65, a89
    v_accvgpr_read_b32 v66, a90
    v_accvgpr_read_b32 v67, a91
    v_mul_f32 v64, v64, v62
    v_mul_f32 v65, v65, v62
    v_mul_f32 v66, v66, v62
    v_mul_f32 v67, v67, v62
    v_accvgpr_write_b32 a88, v64
    v_accvgpr_write_b32 a89, v65
    v_accvgpr_write_b32 a90, v66
    v_accvgpr_write_b32 a91, v67
    v_accvgpr_read_b32 v64, a96
    v_accvgpr_read_b32 v65, a97
    v_accvgpr_read_b32 v66, a98
    v_accvgpr_read_b32 v67, a99
    v_mul_f32 v64, v64, v62
    v_mul_f32 v65, v65, v62
    v_mul_f32 v66, v66, v62
    v_mul_f32 v67, v67, v62
    v_accvgpr_write_b32 a96, v64
    v_accvgpr_write_b32 a97, v65
    v_accvgpr_write_b32 a98, v66
    v_accvgpr_write_b32 a99, v67
    v_accvgpr_read_b32 v64, a104
    v_accvgpr_read_b32 v65, a105
    v_accvgpr_read_b32 v66, a106
    v_accvgpr_read_b32 v67, a107
    v_mul_f32 v64, v64, v62
    v_mul_f32 v65, v65, v62
    v_mul_f32 v66, v66, v62
    v_mul_f32 v67, v67, v62
    v_accvgpr_write_b32 a104, v64
    v_accvgpr_write_b32 a105, v65
    v_accvgpr_write_b32 a106, v66
    v_accvgpr_write_b32 a107, v67
    v_accvgpr_read_b32 v64, a112
    v_accvgpr_read_b32 v65, a113
    v_accvgpr_read_b32 v66, a114
    v_accvgpr_read_b32 v67, a115
    v_mul_f32 v64, v64, v62
    v_mul_f32 v65, v65, v62
    v_mul_f32 v66, v66, v62
    v_mul_f32 v67, v67, v62
    v_accvgpr_write_b32 a112, v64
    v_accvgpr_write_b32 a113, v65
    v_accvgpr_write_b32 a114, v66
    v_accvgpr_write_b32 a115, v67
    v_accvgpr_read_b32 v64, a120
    v_accvgpr_read_b32 v65, a121
    v_accvgpr_read_b32 v66, a122
    v_accvgpr_read_b32 v67, a123
    v_mul_f32 v64, v64, v62
    v_mul_f32 v65, v65, v62
    v_mul_f32 v66, v66, v62
    v_mul_f32 v67, v67, v62
    v_accvgpr_write_b32 a120, v64
    v_accvgpr_write_b32 a121, v65
    v_accvgpr_write_b32 a122, v66
    v_accvgpr_write_b32 a123, v67
    v_exp_f32 v64, v16
    v_exp_f32 v65, v17
    v_exp_f32 v66, v18
    v_exp_f32 v67, v19
    v_exp_f32 v68, v24
    v_exp_f32 v69, v25
    v_exp_f32 v70, v26
    v_exp_f32 v71, v27
    v_add_f32 v58, v56, v64
    v_add_f32 v58, v58, v65
    v_add_f32 v58, v58, v66
    v_add_f32 v58, v58, v67
    v_add_f32 v58, v58, v68
    v_add_f32 v58, v58, v69
    v_add_f32 v58, v58, v70
    v_add_f32 v58, v58, v71
    v_cvt_pk_bf16_f32 v80, v64, v65
    v_cvt_pk_bf16_f32 v81, v66, v67
    v_cvt_pk_bf16_f32 v82, v68, v69
    v_cvt_pk_bf16_f32 v83, v70, v71
    v_log_f32 v61, v57
    v_max3_f32 v63, v20, v21, v22
    v_max3_f32 v63, v63, v23, v28
    v_max3_f32 v63, v63, v29, v30
    v_max3_f32 v61, v61, v63, v31
    v_mov_b32 v63, v61
    s_nop 1
    v_permlane32_swap_b32 v61, v63
    v_max_f32 v61, v61, v63
    v_mov_b32 v63, v61
    s_nop 1
    v_permlane16_swap_b32 v61, v63
    v_max_f32 v61, v61, v63
    v_max_f32 v61, 0, v61
    v_exp_f32 v62, -v61
    v_sub_f32 v20, v20, v61
    v_sub_f32 v21, v21, v61
    v_sub_f32 v22, v22, v61
    v_sub_f32 v23, v23, v61
    v_sub_f32 v28, v28, v61
    v_sub_f32 v29, v29, v61
    v_sub_f32 v30, v30, v61
    v_sub_f32 v31, v31, v61
    v_sub_f32 v36, v36, v61
    v_sub_f32 v37, v37, v61
    v_sub_f32 v38, v38, v61
    v_sub_f32 v39, v39, v61
    v_sub_f32 v44, v44, v61
    v_sub_f32 v45, v45, v61
    v_sub_f32 v46, v46, v61
    v_sub_f32 v47, v47, v61
    v_sub_f32 v52, v52, v61
    v_sub_f32 v53, v53, v61
    v_sub_f32 v54, v54, v61
    v_sub_f32 v55, v55, v61
    v_mul_f32 v57, v57, v62
    v_accvgpr_read_b32 v64, a4
    v_accvgpr_read_b32 v65, a5
    v_accvgpr_read_b32 v66, a6
    v_accvgpr_read_b32 v67, a7
    v_mul_f32 v64, v64, v62
    v_mul_f32 v65, v65, v62
    v_mul_f32 v66, v66, v62
    v_mul_f32 v67, v67, v62
    v_accvgpr_write_b32 a4, v64
    v_accvgpr_write_b32 a5, v65
    v_accvgpr_write_b32 a6, v66
    v_accvgpr_write_b32 a7, v67
    v_accvgpr_read_b32 v64, a12
    v_accvgpr_read_b32 v65, a13
    v_accvgpr_read_b32 v66, a14
    v_accvgpr_read_b32 v67, a15
    v_mul_f32 v64, v64, v62
    v_mul_f32 v65, v65, v62
    v_mul_f32 v66, v66, v62
    v_mul_f32 v67, v67, v62
    v_accvgpr_write_b32 a12, v64
    v_accvgpr_write_b32 a13, v65
    v_accvgpr_write_b32 a14, v66
    v_accvgpr_write_b32 a15, v67
    v_accvgpr_read_b32 v64, a20
    v_accvgpr_read_b32 v65, a21
    v_accvgpr_read_b32 v66, a22
    v_accvgpr_read_b32 v67, a23
    v_mul_f32 v64, v64, v62
    v_mul_f32 v65, v65, v62
    v_mul_f32 v66, v66, v62
    v_mul_f32 v67, v67, v62
    v_accvgpr_write_b32 a20, v64
    v_accvgpr_write_b32 a21, v65
    v_accvgpr_write_b32 a22, v66
    v_accvgpr_write_b32 a23, v67
    v_accvgpr_read_b32 v64, a28
    v_accvgpr_read_b32 v65, a29
    v_accvgpr_read_b32 v66, a30
    v_accvgpr_read_b32 v67, a31
    v_mul_f32 v64, v64, v62
    v_mul_f32 v65, v65, v62
    v_mul_f32 v66, v66, v62
    v_mul_f32 v67, v67, v62
    v_accvgpr_write_b32 a28, v64
    v_accvgpr_write_b32 a29, v65
    v_accvgpr_write_b32 a30, v66
    v_accvgpr_write_b32 a31, v67
    v_accvgpr_read_b32 v64, a36
    v_accvgpr_read_b32 v65, a37
    v_accvgpr_read_b32 v66, a38
    v_accvgpr_read_b32 v67, a39
    v_mul_f32 v64, v64, v62
    v_mul_f32 v65, v65, v62
    v_mul_f32 v66, v66, v62
    v_mul_f32 v67, v67, v62
    v_accvgpr_write_b32 a36, v64
    v_accvgpr_write_b32 a37, v65
    v_accvgpr_write_b32 a38, v66
    v_accvgpr_write_b32 a39, v67
    v_accvgpr_read_b32 v64, a44
    v_accvgpr_read_b32 v65, a45
    v_accvgpr_read_b32 v66, a46
    v_accvgpr_read_b32 v67, a47
    v_mul_f32 v64, v64, v62
    v_mul_f32 v65, v65, v62
    v_mul_f32 v66, v66, v62
    v_mul_f32 v67, v67, v62
    v_accvgpr_write_b32 a44, v64
    v_accvgpr_write_b32 a45, v65
    v_accvgpr_write_b32 a46, v66
    v_accvgpr_write_b32 a47, v67
    v_accvgpr_read_b32 v64, a52
    v_accvgpr_read_b32 v65, a53
    v_accvgpr_read_b32 v66, a54
    v_accvgpr_read_b32 v67, a55
    v_mul_f32 v64, v64, v62
    v_mul_f32 v65, v65, v62
    v_mul_f32 v66, v66, v62
    v_mul_f32 v67, v67, v62
    v_accvgpr_write_b32 a52, v64
    v_accvgpr_write_b32 a53, v65
    v_accvgpr_write_b32 a54, v66
    v_accvgpr_write_b32 a55, v67
    v_accvgpr_read_b32 v64, a60
    v_accvgpr_read_b32 v65, a61
    v_accvgpr_read_b32 v66, a62
    v_accvgpr_read_b32 v67, a63
    v_mul_f32 v64, v64, v62
    v_mul_f32 v65, v65, v62
    v_mul_f32 v66, v66, v62
    v_mul_f32 v67, v67, v62
    v_accvgpr_write_b32 a60, v64
    v_accvgpr_write_b32 a61, v65
    v_accvgpr_write_b32 a62, v66
    v_accvgpr_write_b32 a63, v67
    v_accvgpr_read_b32 v64, a68
    v_accvgpr_read_b32 v65, a69
    v_accvgpr_read_b32 v66, a70
    v_accvgpr_read_b32 v67, a71
    v_mul_f32 v64, v64, v62
    v_mul_f32 v65, v65, v62
    v_mul_f32 v66, v66, v62
    v_mul_f32 v67, v67, v62
    v_accvgpr_write_b32 a68, v64
    v_accvgpr_write_b32 a69, v65
    v_accvgpr_write_b32 a70, v66
    v_accvgpr_write_b32 a71, v67
    v_accvgpr_read_b32 v64, a76
    v_accvgpr_read_b32 v65, a77
    v_accvgpr_read_b32 v66, a78
    v_accvgpr_read_b32 v67, a79
    v_mul_f32 v64, v64, v62
    v_mul_f32 v65, v65, v62
    v_mul_f32 v66, v66, v62
    v_mul_f32 v67, v67, v62
    v_accvgpr_write_b32 a76, v64
    v_accvgpr_write_b32 a77, v65
    v_accvgpr_write_b32 a78, v66
    v_accvgpr_write_b32 a79, v67
    v_accvgpr_read_b32 v64, a84
    v_accvgpr_read_b32 v65, a85
    v_accvgpr_read_b32 v66, a86
    v_accvgpr_read_b32 v67, a87
    v_mul_f32 v64, v64, v62
    v_mul_f32 v65, v65, v62
    v_mul_f32 v66, v66, v62
    v_mul_f32 v67, v67, v62
    v_accvgpr_write_b32 a84, v64
    v_accvgpr_write_b32 a85, v65
    v_accvgpr_write_b32 a86, v66
    v_accvgpr_write_b32 a87, v67
    v_accvgpr_read_b32 v64, a92
    v_accvgpr_read_b32 v65, a93
    v_accvgpr_read_b32 v66, a94
    v_accvgpr_read_b32 v67, a95
    v_mul_f32 v64, v64, v62
    v_mul_f32 v65, v65, v62
    v_mul_f32 v66, v66, v62
    v_mul_f32 v67, v67, v62
    v_accvgpr_write_b32 a92, v64
    v_accvgpr_write_b32 a93, v65
    v_accvgpr_write_b32 a94, v66
    v_accvgpr_write_b32 a95, v67
    v_accvgpr_read_b32 v64, a100
    v_accvgpr_read_b32 v65, a101
    v_accvgpr_read_b32 v66, a102
    v_accvgpr_read_b32 v67, a103
    v_mul_f32 v64, v64, v62
    v_mul_f32 v65, v65, v62
    v_mul_f32 v66, v66, v62
    v_mul_f32 v67, v67, v62
    v_accvgpr_write_b32 a100, v64
    v_accvgpr_write_b32 a101, v65
    v_accvgpr_write_b32 a102, v66
    v_accvgpr_write_b32 a103, v67
    v_accvgpr_read_b32 v64, a108
    v_accvgpr_read_b32 v65, a109
    v_accvgpr_read_b32 v66, a110
    v_accvgpr_read_b32 v67, a111
    v_mul_f32 v64, v64, v62
    v_mul_f32 v65, v65, v62
    v_mul_f32 v66, v66, v62
    v_mul_f32 v67, v67, v62
    v_accvgpr_write_b32 a108, v64
    v_accvgpr_write_b32 a109, v65
    v_accvgpr_write_b32 a110, v66
    v_accvgpr_write_b32 a111, v67
    v_accvgpr_read_b32 v64, a116
    v_accvgpr_read_b32 v65, a117
    v_accvgpr_read_b32 v66, a118
    v_accvgpr_read_b32 v67, a119
    v_mul_f32 v64, v64, v62
    v_mul_f32 v65, v65, v62
    v_mul_f32 v66, v66, v62
    v_mul_f32 v67, v67, v62
    v_accvgpr_write_b32 a116, v64
    v_accvgpr_write_b32 a117, v65
    v_accvgpr_write_b32 a118, v66
    v_accvgpr_write_b32 a119, v67
    v_accvgpr_read_b32 v64, a124
    v_accvgpr_read_b32 v65, a125
    v_accvgpr_read_b32 v66, a126
    v_accvgpr_read_b32 v67, a127
    v_mul_f32 v64, v64, v62
    v_mul_f32 v65, v65, v62
    v_mul_f32 v66, v66, v62
    v_mul_f32 v67, v67, v62
    v_accvgpr_write_b32 a124, v64
    v_accvgpr_write_b32 a125, v65
    v_accvgpr_write_b32 a126, v66
    v_accvgpr_write_b32 a127, v67
    v_exp_f32 v64, v20
    v_exp_f32 v65, v21
    v_exp_f32 v66, v22
    v_exp_f32 v67, v23
    v_exp_f32 v68, v28
    v_exp_f32 v69, v29
    v_exp_f32 v70, v30
    v_exp_f32 v71, v31
    v_add_f32 v59, v57, v64
    v_add_f32 v59, v59, v65
    v_add_f32 v59, v59, v66
    v_add_f32 v59, v59, v67
    v_add_f32 v59, v59, v68
    v_add_f32 v59, v59, v69
    v_add_f32 v59, v59, v70
    v_add_f32 v59, v59, v71
    v_cvt_pk_bf16_f32 v84, v64, v65
    v_cvt_pk_bf16_f32 v85, v66, v67
    v_cvt_pk_bf16_f32 v86, v68, v69
    v_cvt_pk_bf16_f32 v87, v70, v71
    s_nop 3
    s_cmp_eq_u32 s72, 2
    s_cbranch_scc1 L_back_2
    s_cmp_eq_u32 s72, 4
    s_cbranch_scc1 L_back_4
    s_cmp_eq_u32 s72, 10
    s_cbranch_scc1 L_back_10
    s_cmp_eq_u32 s72, 12
    s_cbranch_scc1 L_back_12
    s_branch L_back_14
L_rp_1:
    s_nop 15
    v_log_f32 v60, v58
    v_max3_f32 v63, v32, v33, v34
    v_max3_f32 v63, v63, v35, v40
    v_max3_f32 v63, v63, v41, v42
    v_max3_f32 v60, v60, v63, v43
    v_mov_b32 v63, v60
    s_nop 1
    v_permlane32_swap_b32 v60, v63
    v_max_f32 v60, v60, v63
    v_mov_b32 v63, v60
    s_nop 1
    v_permlane16_swap_b32 v60, v63
    v_max_f32 v60, v60, v63
    v_max_f32 v60, 0, v60
    v_exp_f32 v62, -v60
    v_sub_f32 v32, v32, v60
    v_sub_f32 v33, v33, v60
    v_sub_f32 v34, v34, v60
    v_sub_f32 v35, v35, v60
    v_sub_f32 v40, v40, v60
    v_sub_f32 v41, v41, v60
    v_sub_f32 v42, v42, v60
    v_sub_f32 v43, v43, v60
    v_sub_f32 v16, v16, v60
    v_sub_f32 v17, v17, v60
    v_sub_f32 v18, v18, v60
    v_sub_f32 v19, v19, v60
    v_sub_f32 v24, v24, v60
    v_sub_f32 v25, v25, v60
    v_sub_f32 v26, v26, v60
    v_sub_f32 v27, v27, v60
    v_sub_f32 v48, v48, v60
    v_sub_f32 v49, v49, v60
    v_sub_f32 v50, v50, v60
    v_sub_f32 v51, v51, v60
    v_mul_f32 v58, v58, v62
    v_accvgpr_read_b32 v64, a0
    v_accvgpr_read_b32 v65, a1
    v_accvgpr_read_b32 v66, a2
    v_accvgpr_read_b32 v67, a3
    v_mul_f32 v64, v64, v62
    v_mul_f32 v65, v65, v62
    v_mul_f32 v66, v66, v62
    v_mul_f32 v67, v67, v62
    v_accvgpr_write_b32 a0, v64
    v_accvgpr_write_b32 a1, v65
    v_accvgpr_write_b32 a2, v66
    v_accvgpr_write_b32 a3, v67
    v_accvgpr_read_b32 v64, a8
    v_accvgpr_read_b32 v65, a9
    v_accvgpr_read_b32 v66, a10
    v_accvgpr_read_b32 v67, a11
    v_mul_f32 v64, v64, v62
    v_mul_f32 v65, v65, v62
    v_mul_f32 v66, v66, v62
    v_mul_f32 v67, v67, v62
    v_accvgpr_write_b32 a8, v64
    v_accvgpr_write_b32 a9, v65
    v_accvgpr_write_b32 a10, v66
    v_accvgpr_write_b32 a11, v67
    v_accvgpr_read_b32 v64, a16
    v_accvgpr_read_b32 v65, a17
    v_accvgpr_read_b32 v66, a18
    v_accvgpr_read_b32 v67, a19
    v_mul_f32 v64, v64, v62
    v_mul_f32 v65, v65, v62
    v_mul_f32 v66, v66, v62
    v_mul_f32 v67, v67, v62
    v_accvgpr_write_b32 a16, v64
    v_accvgpr_write_b32 a17, v65
    v_accvgpr_write_b32 a18, v66
    v_accvgpr_write_b32 a19, v67
    v_accvgpr_read_b32 v64, a24
    v_accvgpr_read_b32 v65, a25
    v_accvgpr_read_b32 v66, a26
    v_accvgpr_read_b32 v67, a27
    v_mul_f32 v64, v64, v62
    v_mul_f32 v65, v65, v62
    v_mul_f32 v66, v66, v62
    v_mul_f32 v67, v67, v62
    v_accvgpr_write_b32 a24, v64
    v_accvgpr_write_b32 a25, v65
    v_accvgpr_write_b32 a26, v66
    v_accvgpr_write_b32 a27, v67
    v_accvgpr_read_b32 v64, a32
    v_accvgpr_read_b32 v65, a33
    v_accvgpr_read_b32 v66, a34
    v_accvgpr_read_b32 v67, a35
    v_mul_f32 v64, v64, v62
    v_mul_f32 v65, v65, v62
    v_mul_f32 v66, v66, v62
    v_mul_f32 v67, v67, v62
    v_accvgpr_write_b32 a32, v64
    v_accvgpr_write_b32 a33, v65
    v_accvgpr_write_b32 a34, v66
    v_accvgpr_write_b32 a35, v67
    v_accvgpr_read_b32 v64, a40
    v_accvgpr_read_b32 v65, a41
    v_accvgpr_read_b32 v66, a42
    v_accvgpr_read_b32 v67, a43
    v_mul_f32 v64, v64, v62
    v_mul_f32 v65, v65, v62
    v_mul_f32 v66, v66, v62
    v_mul_f32 v67, v67, v62
    v_accvgpr_write_b32 a40, v64
    v_accvgpr_write_b32 a41, v65
    v_accvgpr_write_b32 a42, v66
    v_accvgpr_write_b32 a43, v67
    v_accvgpr_read_b32 v64, a48
    v_accvgpr_read_b32 v65, a49
    v_accvgpr_read_b32 v66, a50
    v_accvgpr_read_b32 v67, a51
    v_mul_f32 v64, v64, v62
    v_mul_f32 v65, v65, v62
    v_mul_f32 v66, v66, v62
    v_mul_f32 v67, v67, v62
    v_accvgpr_write_b32 a48, v64
    v_accvgpr_write_b32 a49, v65
    v_accvgpr_write_b32 a50, v66
    v_accvgpr_write_b32 a51, v67
    v_accvgpr_read_b32 v64, a56
    v_accvgpr_read_b32 v65, a57
    v_accvgpr_read_b32 v66, a58
    v_accvgpr_read_b32 v67, a59
    v_mul_f32 v64, v64, v62
    v_mul_f32 v65, v65, v62
    v_mul_f32 v66, v66, v62
    v_mul_f32 v67, v67, v62
    v_accvgpr_write_b32 a56, v64
    v_accvgpr_write_b32 a57, v65
    v_accvgpr_write_b32 a58, v66
    v_accvgpr_write_b32 a59, v67
    v_accvgpr_read_b32 v64, a64
    v_accvgpr_read_b32 v65, a65
    v_accvgpr_read_b32 v66, a66
    v_accvgpr_read_b32 v67, a67
    v_mul_f32 v64, v64, v62
    v_mul_f32 v65, v65, v62
    v_mul_f32 v66, v66, v62
    v_mul_f32 v67, v67, v62
    v_accvgpr_write_b32 a64, v64
    v_accvgpr_write_b32 a65, v65
    v_accvgpr_write_b32 a66, v66
    v_accvgpr_write_b32 a67, v67
    v_accvgpr_read_b32 v64, a72
    v_accvgpr_read_b32 v65, a73
    v_accvgpr_read_b32 v66, a74
    v_accvgpr_read_b32 v67, a75
    v_mul_f32 v64, v64, v62
    v_mul_f32 v65, v65, v62
    v_mul_f32 v66, v66, v62
    v_mul_f32 v67, v67, v62
    v_accvgpr_write_b32 a72, v64
    v_accvgpr_write_b32 a73, v65
    v_accvgpr_write_b32 a74, v66
    v_accvgpr_write_b32 a75, v67
    v_accvgpr_read_b32 v64, a80
    v_accvgpr_read_b32 v65, a81
    v_accvgpr_read_b32 v66, a82
    v_accvgpr_read_b32 v67, a83
    v_mul_f32 v64, v64, v62
    v_mul_f32 v65, v65, v62
    v_mul_f32 v66, v66, v62
    v_mul_f32 v67, v67, v62
    v_accvgpr_write_b32 a80, v64
    v_accvgpr_write_b32 a81, v65
    v_accvgpr_write_b32 a82, v66
    v_accvgpr_write_b32 a83, v67
    v_accvgpr_read_b32 v64, a88
    v_accvgpr_read_b32 v65, a89
    v_accvgpr_read_b32 v66, a90
    v_accvgpr_read_b32 v67, a91
    v_mul_f32 v64, v64, v62
    v_mul_f32 v65, v65, v62
    v_mul_f32 v66, v66, v62
    v_mul_f32 v67, v67, v62
    v_accvgpr_write_b32 a88, v64
    v_accvgpr_write_b32 a89, v65
    v_accvgpr_write_b32 a90, v66
    v_accvgpr_write_b32 a91, v67
    v_accvgpr_read_b32 v64, a96
    v_accvgpr_read_b32 v65, a97
    v_accvgpr_read_b32 v66, a98
    v_accvgpr_read_b32 v67, a99
    v_mul_f32 v64, v64, v62
    v_mul_f32 v65, v65, v62
    v_mul_f32 v66, v66, v62
    v_mul_f32 v67, v67, v62
    v_accvgpr_write_b32 a96, v64
    v_accvgpr_write_b32 a97, v65
    v_accvgpr_write_b32 a98, v66
    v_accvgpr_write_b32 a99, v67
    v_accvgpr_read_b32 v64, a104
    v_accvgpr_read_b32 v65, a105
    v_accvgpr_read_b32 v66, a106
    v_accvgpr_read_b32 v67, a107
    v_mul_f32 v64, v64, v62
    v_mul_f32 v65, v65, v62
    v_mul_f32 v66, v66, v62
    v_mul_f32 v67, v67, v62
    v_accvgpr_write_b32 a104, v64
    v_accvgpr_write_b32 a105, v65
    v_accvgpr_write_b32 a106, v66
    v_accvgpr_write_b32 a107, v67
    v_accvgpr_read_b32 v64, a112
    v_accvgpr_read_b32 v65, a113
    v_accvgpr_read_b32 v66, a114
    v_accvgpr_read_b32 v67, a115
    v_mul_f32 v64, v64, v62
    v_mul_f32 v65, v65, v62
    v_mul_f32 v66, v66, v62
    v_mul_f32 v67, v67, v62
    v_accvgpr_write_b32 a112, v64
    v_accvgpr_write_b32 a113, v65
    v_accvgpr_write_b32 a114, v66
    v_accvgpr_write_b32 a115, v67
    v_accvgpr_read_b32 v64, a120
    v_accvgpr_read_b32 v65, a121
    v_accvgpr_read_b32 v66, a122
    v_accvgpr_read_b32 v67, a123
    v_mul_f32 v64, v64, v62
    v_mul_f32 v65, v65, v62
    v_mul_f32 v66, v66, v62
    v_mul_f32 v67, v67, v62
    v_accvgpr_write_b32 a120, v64
    v_accvgpr_write_b32 a121, v65
    v_accvgpr_write_b32 a122, v66
    v_accvgpr_write_b32 a123, v67
    v_exp_f32 v64, v32
    v_exp_f32 v65, v33
    v_exp_f32 v66, v34
    v_exp_f32 v67, v35
    v_exp_f32 v68, v40
    v_exp_f32 v69, v41
    v_exp_f32 v70, v42
    v_exp_f32 v71, v43
    v_add_f32 v56, v58, v64
    v_add_f32 v56, v56, v65
    v_add_f32 v56, v56, v66
    v_add_f32 v56, v56, v67
    v_add_f32 v56, v56, v68
    v_add_f32 v56, v56, v69
    v_add_f32 v56, v56, v70
    v_add_f32 v56, v56, v71
    v_cvt_pk_bf16_f32 v88, v64, v65
    v_cvt_pk_bf16_f32 v89, v66, v67
    v_cvt_pk_bf16_f32 v90, v68, v69
    v_cvt_pk_bf16_f32 v91, v70, v71
    v_log_f32 v61, v59
    v_max3_f32 v63, v36, v37, v38
    v_max3_f32 v63, v63, v39, v44
    v_max3_f32 v63, v63, v45, v46
    v_max3_f32 v61, v61, v63, v47
    v_mov_b32 v63, v61
    s_nop 1
    v_permlane32_swap_b32 v61, v63
    v_max_f32 v61, v61, v63
    v_mov_b32 v63, v61
    s_nop 1
    v_permlane16_swap_b32 v61, v63
    v_max_f32 v61, v61, v63
    v_max_f32 v61, 0, v61
    v_exp_f32 v62, -v61
    v_sub_f32 v36, v36, v61
    v_sub_f32 v37, v37, v61
    v_sub_f32 v38, v38, v61
    v_sub_f32 v39, v39, v61
    v_sub_f32 v44, v44, v61
    v_sub_f32 v45, v45, v61
    v_sub_f32 v46, v46, v61
    v_sub_f32 v47, v47, v61
    v_sub_f32 v20, v20, v61
    v_sub_f32 v21, v21, v61
    v_sub_f32 v22, v22, v61
    v_sub_f32 v23, v23, v61
    v_sub_f32 v28, v28, v61
    v_sub_f32 v29, v29, v61
    v_sub_f32 v30, v30, v61
    v_sub_f32 v31, v31, v61
    v_sub_f32 v52, v52, v61
    v_sub_f32 v53, v53, v61
    v_sub_f32 v54, v54, v61
    v_sub_f32 v55, v55, v61
    v_mul_f32 v59, v59, v62
    v_accvgpr_read_b32 v64, a4
    v_accvgpr_read_b32 v65, a5
    v_accvgpr_read_b32 v66, a6
    v_accvgpr_read_b32 v67, a7
    v_mul_f32 v64, v64, v62
    v_mul_f32 v65, v65, v62
    v_mul_f32 v66, v66, v62
    v_mul_f32 v67, v67, v62
    v_accvgpr_write_b32 a4, v64
    v_accvgpr_write_b32 a5, v65
    v_accvgpr_write_b32 a6, v66
    v_accvgpr_write_b32 a7, v67
    v_accvgpr_read_b32 v64, a12
    v_accvgpr_read_b32 v65, a13
    v_accvgpr_read_b32 v66, a14
    v_accvgpr_read_b32 v67, a15
    v_mul_f32 v64, v64, v62
    v_mul_f32 v65, v65, v62
    v_mul_f32 v66, v66, v62
    v_mul_f32 v67, v67, v62
    v_accvgpr_write_b32 a12, v64
    v_accvgpr_write_b32 a13, v65
    v_accvgpr_write_b32 a14, v66
    v_accvgpr_write_b32 a15, v67
    v_accvgpr_read_b32 v64, a20
    v_accvgpr_read_b32 v65, a21
    v_accvgpr_read_b32 v66, a22
    v_accvgpr_read_b32 v67, a23
    v_mul_f32 v64, v64, v62
    v_mul_f32 v65, v65, v62
    v_mul_f32 v66, v66, v62
    v_mul_f32 v67, v67, v62
    v_accvgpr_write_b32 a20, v64
    v_accvgpr_write_b32 a21, v65
    v_accvgpr_write_b32 a22, v66
    v_accvgpr_write_b32 a23, v67
    v_accvgpr_read_b32 v64, a28
    v_accvgpr_read_b32 v65, a29
    v_accvgpr_read_b32 v66, a30
    v_accvgpr_read_b32 v67, a31
    v_mul_f32 v64, v64, v62
    v_mul_f32 v65, v65, v62
    v_mul_f32 v66, v66, v62
    v_mul_f32 v67, v67, v62
    v_accvgpr_write_b32 a28, v64
    v_accvgpr_write_b32 a29, v65
    v_accvgpr_write_b32 a30, v66
    v_accvgpr_write_b32 a31, v67
    v_accvgpr_read_b32 v64, a36
    v_accvgpr_read_b32 v65, a37
    v_accvgpr_read_b32 v66, a38
    v_accvgpr_read_b32 v67, a39
    v_mul_f32 v64, v64, v62
    v_mul_f32 v65, v65, v62
    v_mul_f32 v66, v66, v62
    v_mul_f32 v67, v67, v62
    v_accvgpr_write_b32 a36, v64
    v_accvgpr_write_b32 a37, v65
    v_accvgpr_write_b32 a38, v66
    v_accvgpr_write_b32 a39, v67
    v_accvgpr_read_b32 v64, a44
    v_accvgpr_read_b32 v65, a45
    v_accvgpr_read_b32 v66, a46
    v_accvgpr_read_b32 v67, a47
    v_mul_f32 v64, v64, v62
    v_mul_f32 v65, v65, v62
    v_mul_f32 v66, v66, v62
    v_mul_f32 v67, v67, v62
    v_accvgpr_write_b32 a44, v64
    v_accvgpr_write_b32 a45, v65
    v_accvgpr_write_b32 a46, v66
    v_accvgpr_write_b32 a47, v67
    v_accvgpr_read_b32 v64, a52
    v_accvgpr_read_b32 v65, a53
    v_accvgpr_read_b32 v66, a54
    v_accvgpr_read_b32 v67, a55
    v_mul_f32 v64, v64, v62
    v_mul_f32 v65, v65, v62
    v_mul_f32 v66, v66, v62
    v_mul_f32 v67, v67, v62
    v_accvgpr_write_b32 a52, v64
    v_accvgpr_write_b32 a53, v65
    v_accvgpr_write_b32 a54, v66
    v_accvgpr_write_b32 a55, v67
    v_accvgpr_read_b32 v64, a60
    v_accvgpr_read_b32 v65, a61
    v_accvgpr_read_b32 v66, a62
    v_accvgpr_read_b32 v67, a63
    v_mul_f32 v64, v64, v62
    v_mul_f32 v65, v65, v62
    v_mul_f32 v66, v66, v62
    v_mul_f32 v67, v67, v62
    v_accvgpr_write_b32 a60, v64
    v_accvgpr_write_b32 a61, v65
    v_accvgpr_write_b32 a62, v66
    v_accvgpr_write_b32 a63, v67
    v_accvgpr_read_b32 v64, a68
    v_accvgpr_read_b32 v65, a69
    v_accvgpr_read_b32 v66, a70
    v_accvgpr_read_b32 v67, a71
    v_mul_f32 v64, v64, v62
    v_mul_f32 v65, v65, v62
    v_mul_f32 v66, v66, v62
    v_mul_f32 v67, v67, v62
    v_accvgpr_write_b32 a68, v64
    v_accvgpr_write_b32 a69, v65
    v_accvgpr_write_b32 a70, v66
    v_accvgpr_write_b32 a71, v67
    v_accvgpr_read_b32 v64, a76
    v_accvgpr_read_b32 v65, a77
    v_accvgpr_read_b32 v66, a78
    v_accvgpr_read_b32 v67, a79
    v_mul_f32 v64, v64, v62
    v_mul_f32 v65, v65, v62
    v_mul_f32 v66, v66, v62
    v_mul_f32 v67, v67, v62
    v_accvgpr_write_b32 a76, v64
    v_accvgpr_write_b32 a77, v65
    v_accvgpr_write_b32 a78, v66
    v_accvgpr_write_b32 a79, v67
    v_accvgpr_read_b32 v64, a84
    v_accvgpr_read_b32 v65, a85
    v_accvgpr_read_b32 v66, a86
    v_accvgpr_read_b32 v67, a87
    v_mul_f32 v64, v64, v62
    v_mul_f32 v65, v65, v62
    v_mul_f32 v66, v66, v62
    v_mul_f32 v67, v67, v62
    v_accvgpr_write_b32 a84, v64
    v_accvgpr_write_b32 a85, v65
    v_accvgpr_write_b32 a86, v66
    v_accvgpr_write_b32 a87, v67
    v_accvgpr_read_b32 v64, a92
    v_accvgpr_read_b32 v65, a93
    v_accvgpr_read_b32 v66, a94
    v_accvgpr_read_b32 v67, a95
    v_mul_f32 v64, v64, v62
    v_mul_f32 v65, v65, v62
    v_mul_f32 v66, v66, v62
    v_mul_f32 v67, v67, v62
    v_accvgpr_write_b32 a92, v64
    v_accvgpr_write_b32 a93, v65
    v_accvgpr_write_b32 a94, v66
    v_accvgpr_write_b32 a95, v67
    v_accvgpr_read_b32 v64, a100
    v_accvgpr_read_b32 v65, a101
    v_accvgpr_read_b32 v66, a102
    v_accvgpr_read_b32 v67, a103
    v_mul_f32 v64, v64, v62
    v_mul_f32 v65, v65, v62
    v_mul_f32 v66, v66, v62
    v_mul_f32 v67, v67, v62
    v_accvgpr_write_b32 a100, v64
    v_accvgpr_write_b32 a101, v65
    v_accvgpr_write_b32 a102, v66
    v_accvgpr_write_b32 a103, v67
    v_accvgpr_read_b32 v64, a108
    v_accvgpr_read_b32 v65, a109
    v_accvgpr_read_b32 v66, a110
    v_accvgpr_read_b32 v67, a111
    v_mul_f32 v64, v64, v62
    v_mul_f32 v65, v65, v62
    v_mul_f32 v66, v66, v62
    v_mul_f32 v67, v67, v62
    v_accvgpr_write_b32 a108, v64
    v_accvgpr_write_b32 a109, v65
    v_accvgpr_write_b32 a110, v66
    v_accvgpr_write_b32 a111, v67
    v_accvgpr_read_b32 v64, a116
    v_accvgpr_read_b32 v65, a117
    v_accvgpr_read_b32 v66, a118
    v_accvgpr_read_b32 v67, a119
    v_mul_f32 v64, v64, v62
    v_mul_f32 v65, v65, v62
    v_mul_f32 v66, v66, v62
    v_mul_f32 v67, v67, v62
    v_accvgpr_write_b32 a116, v64
    v_accvgpr_write_b32 a117, v65
    v_accvgpr_write_b32 a118, v66
    v_accvgpr_write_b32 a119, v67
    v_accvgpr_read_b32 v64, a124
    v_accvgpr_read_b32 v65, a125
    v_accvgpr_read_b32 v66, a126
    v_accvgpr_read_b32 v67, a127
    v_mul_f32 v64, v64, v62
    v_mul_f32 v65, v65, v62
    v_mul_f32 v66, v66, v62
    v_mul_f32 v67, v67, v62
    v_accvgpr_write_b32 a124, v64
    v_accvgpr_write_b32 a125, v65
    v_accvgpr_write_b32 a126, v66
    v_accvgpr_write_b32 a127, v67
    v_exp_f32 v64, v36
    v_exp_f32 v65, v37
    v_exp_f32 v66, v38
    v_exp_f32 v67, v39
    v_exp_f32 v68, v44
    v_exp_f32 v69, v45
    v_exp_f32 v70, v46
    v_exp_f32 v71, v47
    v_add_f32 v57, v59, v64
    v_add_f32 v57, v57, v65
    v_add_f32 v57, v57, v66
    v_add_f32 v57, v57, v67
    v_add_f32 v57, v57, v68
    v_add_f32 v57, v57, v69
    v_add_f32 v57, v57, v70
    v_add_f32 v57, v57, v71
    v_cvt_pk_bf16_f32 v92, v64, v65
    v_cvt_pk_bf16_f32 v93, v66, v67
    v_cvt_pk_bf16_f32 v94, v68, v69
    v_cvt_pk_bf16_f32 v95, v70, v71
    s_nop 3
    s_cmp_eq_u32 s72, 1
    s_cbranch_scc1 L_back_1
    s_cmp_eq_u32 s72, 3
    s_cbranch_scc1 L_back_3
    s_cmp_eq_u32 s72, 9
    s_cbranch_scc1 L_back_9
    s_cmp_eq_u32 s72, 11
    s_cbranch_scc1 L_back_11
    s_cmp_eq_u32 s72, 13
    s_cbranch_scc1 L_back_13
    s_branch L_back_15
.section .rodata,"a"
.p2align 6
.amdhsa_kernel recurrent_scan__mha_block_cached__glu_gated_swiglu__prompt_kernel
  .amdhsa_next_free_vgpr 512
  .amdhsa_next_free_sgpr 102
  .amdhsa_accum_offset 256
  .amdhsa_group_segment_fixed_size 0
  .amdhsa_kernarg_size 96
  .amdhsa_user_sgpr_count 2
  .amdhsa_user_sgpr_kernarg_segment_ptr 1
  .amdhsa_system_sgpr_workgroup_id_x 1
.end_amdhsa_kernel
```
